```python
import torch

def _softmax(x, axis=-1):
    return torch.softmax(x, dim=axis)
def _gelu(x):
    return torch.nn.functional.gelu(x, approximate="tanh")
def _silu(x):
    return torch.nn.functional.silu(x)
def _sigmoid(x):
    return torch.sigmoid(x)
def _layernorm(x, axis=-1, eps=1e-5):
    m = x.mean(dim=axis, keepdim=True)
    v = x.var(dim=axis, keepdim=True, unbiased=False)
    return (x - m) / torch.sqrt(v + eps)
def _scatter_add(tgt, idx, src, axis=0):
    return tgt.clone().index_add_(axis, idx, src)
def _segment_sum(src, seg, n):
    out = torch.zeros((n,) + src.shape[1:], dtype=src.dtype)
    return out.index_add_(0, seg, src)
def _pad(x, pw):
    flat = tuple(v for pair in reversed(pw) for v in pair)
    return torch.nn.functional.pad(x, flat)

kernel_name = 'gated_mix__softmax_full_mha__compressed_kv_cla__prompt'

def setup_inputs():

    _w = (lambda a: (lambda t: t.to(torch.bfloat16) if t.is_floating_point() else t)(torch.as_tensor(a)))
    def _A_setup():
        B, S, D = 1, 2048, 512
        return {
            "x": _w((lambda *s: torch.randn(*s, dtype=torch.bfloat16) * 0.05)(B, S, D)),
            "wqkv": _w((lambda *s: torch.randn(*s, dtype=torch.bfloat16) * 1.6)(D, 3 * D)),
            "wo": _w((lambda *s: torch.randn(*s, dtype=torch.bfloat16) * 0.05)(D, D)),
        }
    _A_in = _A_setup()

    def _B_setup():
        B, H, Sq, Sk, D, M = 1, 32, 2048, 2048, 128, 512
        Dc = 4 * D
        return {
            "x": _w((lambda *s: torch.randn(*s, dtype=torch.bfloat16) * 0.05)(B, Sq, M)),
            "c_kv": _w((lambda *s: torch.randn(*s, dtype=torch.bfloat16) * 1.6)(B, Sk, Dc)),
            "w_q": _w((lambda *s: torch.randn(*s, dtype=torch.bfloat16) * 6.4)(M, H, D) * (M ** -0.5)),
            "w_uk": _w((lambda *s: torch.randn(*s, dtype=torch.bfloat16) * 6.4)(Dc, H, D) * (Dc ** -0.5)),
            "w_uv": _w((lambda *s: torch.randn(*s, dtype=torch.bfloat16) * 1.6)(Dc, H, D) * (Dc ** -0.5)),
            "w_o": _w((lambda *s: torch.randn(*s, dtype=torch.bfloat16) * 1.6)(H, D, M) * ((H * D) ** -0.5)),
        }
    _B_in = _B_setup()

    return {
        "A_x": _A_in["x"],
        "A_wqkv": _A_in["wqkv"],
        "A_wo": _A_in["wo"],
        "B_x": _B_in["x"],
        "B_c_kv": _B_in["c_kv"],
        "B_w_q": _B_in["w_q"],
        "B_w_uk": _B_in["w_uk"],
        "B_w_uv": _B_in["w_uv"],
        "B_w_o": _B_in["w_o"],
        "gate_w": _w((lambda *s: torch.randn(*s, dtype=torch.bfloat16) * 0.05)(512) * 16.0),
    }

def reference(A_x, A_wqkv, A_wo, B_x, B_c_kv, B_w_q, B_w_uk, B_w_uv, B_w_o, gate_w):
    def _A_ref(x, wqkv, wo):
        B, S, D = x.shape
        H = 32; Dh = D // H
        qkv = (lambda x, *d: x.permute(*d))((x @ wqkv).reshape(B, S, 3, H, Dh), 2, 0, 3, 1, 4)
        q, k, v = qkv[0], qkv[1], qkv[2]
        scale = Dh ** -0.5
        scores = torch.einsum("bhqd,bhkd->bhqk", q, k) * scale
        p = _softmax(scores, axis=-1)
        o = torch.einsum("bhqk,bhkd->bhqd", p, v)
        return (lambda x, *d: x.permute(*d))(o, 0, 2, 1, 3).reshape(B, S, D) @ wo

    def _B_ref(x, c_kv, w_q, w_uk, w_uv, w_o):
        B, Sq, M = x.shape[0], x.shape[1], x.shape[2]
        Sk = c_kv.shape[1]
        H, D = w_q.shape[1], w_q.shape[2]
        q = torch.einsum("bqm,mhd->bhqd", x, w_q)
        k = torch.einsum("bkc,chd->bhkd", c_kv, w_uk)
        v = torch.einsum("bkc,chd->bhkd", c_kv, w_uv)
        scores = torch.einsum("bhqd,bhkd->bhqk", q, k) * (D ** -0.5)
        off = Sk - Sq
        qi = torch.arange(Sq)[:, None]
        kj = torch.arange(Sk)[None, :]
        cmask = kj <= (qi + off)
        scores = torch.where(cmask[None, None], scores, -1e9)
        p = _softmax(scores, axis=-1)
        ctx = torch.einsum("bhqk,bhkd->bhqd", p, v)
        return torch.einsum("bhqd,hdm->bqm", ctx, w_o)

    x = A_x
    g = _sigmoid((x * gate_w).sum(-1, keepdims=True))
    a = _A_ref(x, A_wqkv, A_wo)
    b = _B_ref(x, B_c_kv, B_w_q, B_w_uk, B_w_uv, B_w_o)
    return g * a + (1 - g) * b
```

```asm
; @launch grid=(256,1,1) block=(256,1,1) lds=163840
.amdgcn_target "amdgcn-amd-amdhsa--gfx950"
.text
.globl gated_mix__softmax_full_mha__compressed_kv_cla__prompt_kernel
.p2align 8
.type gated_mix__softmax_full_mha__compressed_kv_cla__prompt_kernel,@function
gated_mix__softmax_full_mha__compressed_kv_cla__prompt_kernel:
    s_cmp_ge_u32 s2, 256
    s_cbranch_scc1 L_end
    s_load_dwordx2 s[4:5], s[0:1], 32
    s_load_dwordx2 s[12:13], s[0:1], 48
    s_load_dwordx2 s[8:9], s[0:1], 0
    s_load_dwordx2 s[16:17], s[0:1], 56
    s_load_dwordx2 s[20:21], s[0:1], 40
    s_load_dwordx2 s[24:25], s[0:1], 8
    s_load_dwordx2 s[28:29], s[0:1], 64
    s_load_dwordx2 s[32:33], s[0:1], 16
    s_load_dwordx2 s[36:37], s[0:1], 72
    s_load_dwordx2 s[40:41], s[0:1], 80
    s_load_dwordx2 s[44:45], s[0:1], 88
    s_load_dwordx2 s[48:49], s[0:1], 96
    v_lshrrev_b32 v1, 6, v0
    v_and_b32 v0, 63, v0
    v_readfirstlane_b32 s54, v1
    s_getpc_b64 s[90:91]
L_pc:
    s_lshr_b32 s67, s2, 3
    s_lshl_b32 s67, s67, 2
    s_add_u32 s67, s67, s54
    s_lshl_b32 s67, s67, 10
    v_and_b32 v126, 7, v0
    v_lshl_add_u32 v126, v126, 7, s67
    v_min_u32 v126, L_codeend-L_pc-4, v126
    global_load_dword v125, v126, s[90:91]
    s_mov_b32 s6, 0x200000
    s_mov_b32 s7, 0x20000
    s_mov_b32 s14, 0x400000
    s_mov_b32 s15, 0x20000
    s_and_b32 s67, s2, 7
    s_lshl_b32 s67, s67, 2
    s_bfe_u32 s68, s2, 0x20003
    s_xor_b32 s68, s68, 0
    s_add_u32 s52, s67, s68
    s_lshr_b32 s53, s2, 5
    s_lshl_b32 s61, s54, 12
    s_mul_i32 s62, s54, 24576
    s_add_u32 s62, s62, 65536
    s_lshl_b32 s67, s53, 18
    s_lshl_b32 s68, s54, 16
    s_add_u32 s63, s67, s68
    s_lshl_b32 s67, s52, 8
    s_lshl_b32 s68, s54, 18
    s_add_u32 s64, s67, s68
    v_lshrrev_b32 v28, 3, v0
    v_and_b32 v29, 7, v0
    v_lshlrev_b32 v30, 13, v28
    v_lshrrev_b32 v31, 1, v29
    v_bfe_u32 v32, v0, 4, 1
    v_xor_b32 v31, v31, v32
    v_and_b32 v32, 1, v0
    v_lshlrev_b32 v32, 4, v32
    v_add_u32 v33, v30, v32
    v_lshl_add_u32 v12, v31, 5, v33
    v_xor_b32 v13, 64, v12
    v_lshl_add_u32 v2, v29, 4, v30
    v_xor_b32 v3, 16, v2
    v_xor_b32 v4, 32, v2
    v_xor_b32 v5, 48, v2
    v_xor_b32 v6, 64, v2
    v_xor_b32 v7, 80, v2
    v_xor_b32 v8, 96, v2
    v_xor_b32 v9, 112, v2
    s_waitcnt lgkmcnt(0)
    s_mov_b32 s0, 0
    s_add_u32 s67, s0, 0
    s_and_b32 s67, s67, 3
    s_mul_i32 s67, s67, 1048576
    s_add_u32 s75, s67, s64
    s_add_u32 s67, s0, 1
    s_and_b32 s67, s67, 3
    s_mul_i32 s67, s67, 1048576
    s_add_u32 s98, s67, s64
    s_add_u32 s67, s0, 0
    s_and_b32 s67, s67, 3
    s_mul_i32 s67, s67, 256
    s_add_u32 s79, s67, s63
    s_add_u32 s67, s0, 1
    s_and_b32 s67, s67, 3
    s_mul_i32 s67, s67, 256
    s_add_u32 s92, s67, s63
    s_lshl_b32 s90, s2, 2
    s_add_u32 s90, s90, s54
    s_lshl_b32 s90, s90, 11
    v_lshrrev_b32 v124, 4, v0
    v_min_u32 v124, 1, v124
    v_lshlrev_b32 v124, 30, v124
    v_lshl_or_b32 v124, v0, 7, v124
    buffer_load_dword v125, v124, s[4:7], s90 offen offset:0
    s_add_u32 m0, s61, 0
    s_add_u32 s71, s75, 0
    buffer_load_dwordx4 v12, s[12:15], s71 offen lds
    s_add_u32 m0, s61, 1024
    s_add_u32 s71, s75, 65536
    buffer_load_dwordx4 v13, s[12:15], s71 offen lds
    s_add_u32 m0, s61, 2048
    s_add_u32 s71, s75, 131072
    buffer_load_dwordx4 v12, s[12:15], s71 offen lds
    s_add_u32 m0, s61, 3072
    s_add_u32 s71, s75, 196608
    buffer_load_dwordx4 v13, s[12:15], s71 offen lds
    s_add_u32 m0, s62, 0
    s_add_u32 s72, s79, 0
    buffer_load_dwordx4 v2, s[4:7], s72 offen offset:0 lds
    buffer_load_dwordx4 v3, s[4:7], s72 offen offset:1024 lds
    buffer_load_dwordx4 v4, s[4:7], s72 offen offset:2048 lds
    buffer_load_dwordx4 v5, s[4:7], s72 offen offset:3072 lds
    s_add_u32 m0, s62, 4096
    s_add_u32 s72, s79, 4096
    buffer_load_dwordx4 v6, s[4:7], s72 offen offset:0 lds
    buffer_load_dwordx4 v7, s[4:7], s72 offen offset:1024 lds
    buffer_load_dwordx4 v8, s[4:7], s72 offen offset:2048 lds
    buffer_load_dwordx4 v9, s[4:7], s72 offen offset:3072 lds
    s_add_u32 m0, s62, 8192
    s_add_u32 s72, s79, 128
    buffer_load_dwordx4 v2, s[4:7], s72 offen offset:0 lds
    buffer_load_dwordx4 v3, s[4:7], s72 offen offset:1024 lds
    buffer_load_dwordx4 v4, s[4:7], s72 offen offset:2048 lds
    buffer_load_dwordx4 v5, s[4:7], s72 offen offset:3072 lds
    s_add_u32 m0, s62, 12288
    s_add_u32 s72, s79, 4224
    buffer_load_dwordx4 v6, s[4:7], s72 offen offset:0 lds
    buffer_load_dwordx4 v7, s[4:7], s72 offen offset:1024 lds
    buffer_load_dwordx4 v8, s[4:7], s72 offen offset:2048 lds
    buffer_load_dwordx4 v9, s[4:7], s72 offen offset:3072 lds
    s_add_u32 m0, s61, 16384
    s_add_u32 s71, s75, 128
    buffer_load_dwordx4 v12, s[12:15], s71 offen lds
    s_add_u32 m0, s61, 17408
    s_add_u32 s71, s75, 65664
    buffer_load_dwordx4 v13, s[12:15], s71 offen lds
    s_add_u32 m0, s61, 18432
    s_add_u32 s71, s75, 131200
    buffer_load_dwordx4 v12, s[12:15], s71 offen lds
    s_add_u32 m0, s61, 19456
    s_add_u32 s71, s75, 196736
    buffer_load_dwordx4 v13, s[12:15], s71 offen lds
    s_lshr_b32 s90, s2, 3
    s_lshl_b32 s90, s90, 2
    s_add_u32 s90, s90, s54
    s_lshl_b32 s90, s90, 15
    s_lshr_b32 s91, s52, 2
    s_lshl_b32 s91, s91, 10
    s_add_u32 s90, s90, s91
    v_lshrrev_b32 v124, 5, v0
    v_min_u32 v124, 1, v124
    v_lshlrev_b32 v124, 30, v124
    v_lshl_or_b32 v124, v0, 10, v124
    v_and_b32 v126, 7, v0
    v_mul_u32_u24 v126, 896, v126
    v_sub_u32 v124, v124, v126
    buffer_load_dword v125, v124, s[12:15], s90 offen offset:0
    s_add_u32 s67, s0, 2
    s_and_b32 s67, s67, 3
    s_mul_i32 s67, s67, 1048576
    s_add_u32 s99, s67, s64
    s_add_u32 s67, s0, 3
    s_and_b32 s67, s67, 3
    s_mul_i32 s67, s67, 1048576
    s_add_u32 s3, s67, s64
    s_add_u32 s67, s0, 2
    s_and_b32 s67, s67, 3
    s_mul_i32 s67, s67, 256
    s_add_u32 s93, s67, s63
    s_add_u32 s67, s0, 3
    s_and_b32 s67, s67, 3
    s_mul_i32 s67, s67, 256
    s_add_u32 s94, s67, s63
    s_mov_b32 s10, 0x200000
    s_mov_b32 s11, 0x20000
    s_mov_b32 s18, 0x400000
    s_mov_b32 s19, 0x20000
    s_mov_b32 s22, 0x400000
    s_mov_b32 s23, 0x20000
    s_mov_b32 s26, 0x180000
    s_mov_b32 s27, 0x20000
    s_mov_b32 s30, 0x400000
    s_mov_b32 s31, 0x20000
    s_mov_b32 s34, 0x80000
    s_mov_b32 s35, 0x20000
    s_mov_b32 s38, 0x400
    s_mov_b32 s39, 0x20000
    s_mov_b32 s42, 0x200000
    s_mov_b32 s43, 0x20000
    s_mov_b32 s46, 0x100
    s_mov_b32 s47, 0x20000
    s_mov_b32 s50, 0x6000000
    s_mov_b32 s51, 0x20000
    s_and_b32 s55, s54, 1
    s_lshr_b32 s56, s54, 1
    s_mov_b32 s57, s53
    s_sub_u32 s58, 15, s53
    s_cmp_eq_u32 s56, 0
    s_cselect_b32 s67, s57, s58
    s_lshl_b32 s67, s67, 2
    s_add_u32 s59, s67, s55
    s_add_u32 s67, s67, 3
    s_sub_u32 s60, s67, s55
    s_lshl_b32 s67, s52, 5
    s_mul_i32 s68, s54, 98304
    s_add_u32 s65, s67, s68
    s_lshl_b32 s67, s52, 19
    s_lshl_b32 s68, s53, 16
    s_add_u32 s66, s67, s68
    s_lshl_b32 s68, s54, 14
    s_add_u32 s66, s66, s68
    s_mov_b32 s73, 0x3e0293ee
    s_mov_b32 s74, 0x3eb8aa3b
    v_lshlrev_b32 v1, 4, v0
    v_mul_u32_u24 v33, 3072, v28
    v_add_u32 v33, v33, v32
    v_min_u32 v34, 2, v31
    v_lshl_add_u32 v14, v34, 10, v33
    v_xor_b32 v34, 2, v31
    v_min_u32 v34, 2, v34
    v_lshl_add_u32 v15, v34, 10, v33
    v_lshrrev_b32 v30, 4, v0
    v_xor_b32 v31, v30, v29
    v_lshlrev_b32 v31, 4, v31
    v_lshl_add_u32 v31, v29, 10, v31
    v_bfe_u32 v32, v0, 3, 1
    v_lshl_add_u32 v31, v32, 7, v31
    v_add_u32 v10, s62, v31
    v_xor_b32 v11, 64, v10
    v_bfe_u32 v31, v0, 2, 2
    v_lshl_add_u32 v32, v30, 3, v31
    v_lshlrev_b32 v32, 7, v32
    v_and_b32 v33, 3, v0
    v_lshl_add_u32 v32, v33, 3, v32
    v_lshrrev_b32 v31, 1, v31
    v_and_b32 v33, 1, v30
    v_lshl_or_b32 v31, v33, 1, v31
    v_lshl_add_u32 v16, v31, 5, v32
    v_xor_b32 v17, 32, v16
    v_xor_b32 v18, 64, v16
    v_xor_b32 v19, 0x60, v16
    s_waitcnt vmcnt(13)
    ds_read_b128 a[0:3], v10 offset:0
    ds_read_b128 a[4:7], v10 offset:256
    ds_read_b128 a[8:11], v10 offset:512
    ds_read_b128 a[12:15], v10 offset:768
    ds_read_b128 a[16:19], v11 offset:0
    ds_read_b128 a[20:23], v11 offset:256
    ds_read_b128 a[24:27], v11 offset:512
    ds_read_b128 a[28:31], v11 offset:768
    s_waitcnt vmcnt(5)
    ds_read_b128 a[32:35], v10 offset:8192
    ds_read_b128 a[36:39], v10 offset:8448
    ds_read_b128 a[40:43], v10 offset:8704
    ds_read_b128 a[44:47], v10 offset:8960
    ds_read_b128 a[48:51], v11 offset:8192
    ds_read_b128 a[52:55], v11 offset:8448
    ds_read_b128 a[56:59], v11 offset:8704
    ds_read_b128 a[60:63], v11 offset:8960
    s_barrier
    ds_read_b64_tr_b16 v[64:65], v16 offset:0
    ds_read_b64_tr_b16 v[66:67], v16 offset:512
    ds_read_b64_tr_b16 v[68:69], v16 offset:4096
    ds_read_b64_tr_b16 v[70:71], v16 offset:4608
    ds_read_b64_tr_b16 v[72:73], v16 offset:8192
    ds_read_b64_tr_b16 v[74:75], v16 offset:8704
    ds_read_b64_tr_b16 v[76:77], v16 offset:12288
    ds_read_b64_tr_b16 v[78:79], v16 offset:12800
    s_waitcnt lgkmcnt(8)
    s_waitcnt lgkmcnt(0)
    v_mfma_f32_16x16x32_bf16 v[128:131], v[64:67], a[0:3], 0
    ds_read_b64_tr_b16 v[80:81], v17 offset:0
    s_add_u32 m0, s61, 32768
    v_mfma_f32_16x16x32_bf16 v[128:131], v[68:71], a[16:19], v[128:131]
    ds_read_b64_tr_b16 v[82:83], v17 offset:512
    s_add_u32 s71, s98, 0
    v_mfma_f32_16x16x32_bf16 v[128:131], v[72:75], a[32:35], v[128:131]
    buffer_load_dwordx4 v12, s[12:15], s71 offen lds
    v_mfma_f32_16x16x32_bf16 v[128:131], v[76:79], a[48:51], v[128:131]
    ds_read_b64_tr_b16 v[84:85], v17 offset:4096
    s_add_u32 m0, s61, 33792
    v_mfma_f32_16x16x32_bf16 v[132:135], v[64:67], a[4:7], 0
    ds_read_b64_tr_b16 v[86:87], v17 offset:4608
    s_add_u32 s71, s98, 65536
    v_mfma_f32_16x16x32_bf16 v[132:135], v[68:71], a[20:23], v[132:135]
    buffer_load_dwordx4 v13, s[12:15], s71 offen lds
    v_mfma_f32_16x16x32_bf16 v[132:135], v[72:75], a[36:39], v[132:135]
    ds_read_b64_tr_b16 v[88:89], v17 offset:8192
    s_add_u32 m0, s61, 34816
    v_mfma_f32_16x16x32_bf16 v[132:135], v[76:79], a[52:55], v[132:135]
    ds_read_b64_tr_b16 v[90:91], v17 offset:8704
    s_add_u32 s71, s98, 131072
    v_mfma_f32_16x16x32_bf16 v[136:139], v[64:67], a[8:11], 0
    buffer_load_dwordx4 v12, s[12:15], s71 offen lds
    v_mfma_f32_16x16x32_bf16 v[136:139], v[68:71], a[24:27], v[136:139]
    ds_read_b64_tr_b16 v[92:93], v17 offset:12288
    s_add_u32 m0, s61, 35840
    v_mfma_f32_16x16x32_bf16 v[136:139], v[72:75], a[40:43], v[136:139]
    ds_read_b64_tr_b16 v[94:95], v17 offset:12800
    s_add_u32 s71, s98, 196608
    v_mfma_f32_16x16x32_bf16 v[136:139], v[76:79], a[56:59], v[136:139]
    buffer_load_dwordx4 v13, s[12:15], s71 offen lds
    v_mfma_f32_16x16x32_bf16 v[140:143], v[64:67], a[12:15], 0
    s_or_b32 s91, s2, s54
    s_cselect_b32 s91, 0x40000000, 0
    v_min_u32 v62, 1, v0
    v_mfma_f32_16x16x32_bf16 v[140:143], v[68:71], a[28:31], v[140:143]
    v_lshlrev_b32 v62, 30, v62
    v_or_b32 v62, s91, v62
    v_mfma_f32_16x16x32_bf16 v[140:143], v[72:75], a[44:47], v[140:143]
    s_mov_b32 s91, 61669376
    s_add_u32 m0, s62, 16384
    v_mfma_f32_16x16x32_bf16 v[140:143], v[76:79], a[60:63], v[140:143]
    buffer_load_dword v63, v62, s[48:51], s91 offen sc1
    s_waitcnt lgkmcnt(0)
    v_mfma_f32_16x16x32_bf16 v[144:147], v[80:83], a[0:3], 0
    ds_read_b64_tr_b16 v[64:65], v18 offset:0
    s_add_u32 s72, s92, 0
    v_mfma_f32_16x16x32_bf16 v[144:147], v[84:87], a[16:19], v[144:147]
    ds_read_b64_tr_b16 v[66:67], v18 offset:512
    v_mfma_f32_16x16x32_bf16 v[144:147], v[88:91], a[32:35], v[144:147]
    buffer_load_dwordx4 v2, s[4:7], s72 offen offset:0 lds
    v_mfma_f32_16x16x32_bf16 v[144:147], v[92:95], a[48:51], v[144:147]
    ds_read_b64_tr_b16 v[68:69], v18 offset:4096
    v_mfma_f32_16x16x32_bf16 v[148:151], v[80:83], a[4:7], 0
    ds_read_b64_tr_b16 v[70:71], v18 offset:4608
    v_mfma_f32_16x16x32_bf16 v[148:151], v[84:87], a[20:23], v[148:151]
    buffer_load_dwordx4 v3, s[4:7], s72 offen offset:1024 lds
    v_mfma_f32_16x16x32_bf16 v[148:151], v[88:91], a[36:39], v[148:151]
    ds_read_b64_tr_b16 v[72:73], v18 offset:8192
    v_mfma_f32_16x16x32_bf16 v[148:151], v[92:95], a[52:55], v[148:151]
    ds_read_b64_tr_b16 v[74:75], v18 offset:8704
    v_mfma_f32_16x16x32_bf16 v[152:155], v[80:83], a[8:11], 0
    buffer_load_dwordx4 v4, s[4:7], s72 offen offset:2048 lds
    v_mfma_f32_16x16x32_bf16 v[152:155], v[84:87], a[24:27], v[152:155]
    ds_read_b64_tr_b16 v[76:77], v18 offset:12288
    v_mfma_f32_16x16x32_bf16 v[152:155], v[88:91], a[40:43], v[152:155]
    ds_read_b64_tr_b16 v[78:79], v18 offset:12800
    v_mfma_f32_16x16x32_bf16 v[152:155], v[92:95], a[56:59], v[152:155]
    buffer_load_dwordx4 v5, s[4:7], s72 offen offset:3072 lds
    v_mfma_f32_16x16x32_bf16 v[156:159], v[80:83], a[12:15], 0
    s_add_u32 m0, s62, 20480
    s_add_u32 s72, s92, 4096
    v_mfma_f32_16x16x32_bf16 v[156:159], v[84:87], a[28:31], v[156:159]
    v_mfma_f32_16x16x32_bf16 v[156:159], v[88:91], a[44:47], v[156:159]
    buffer_load_dwordx4 v6, s[4:7], s72 offen offset:0 lds
    v_mfma_f32_16x16x32_bf16 v[156:159], v[92:95], a[60:63], v[156:159]
    s_waitcnt lgkmcnt(0)
    v_mfma_f32_16x16x32_bf16 v[160:163], v[64:67], a[0:3], 0
    ds_read_b64_tr_b16 v[80:81], v19 offset:0
    v_mfma_f32_16x16x32_bf16 v[160:163], v[68:71], a[16:19], v[160:163]
    buffer_load_dwordx4 v7, s[4:7], s72 offen offset:1024 lds
    v_mfma_f32_16x16x32_bf16 v[160:163], v[72:75], a[32:35], v[160:163]
    ds_read_b64_tr_b16 v[82:83], v19 offset:512
    v_mfma_f32_16x16x32_bf16 v[160:163], v[76:79], a[48:51], v[160:163]
    ds_read_b64_tr_b16 v[84:85], v19 offset:4096
    v_mfma_f32_16x16x32_bf16 v[164:167], v[64:67], a[4:7], 0
    buffer_load_dwordx4 v8, s[4:7], s72 offen offset:2048 lds
    v_mfma_f32_16x16x32_bf16 v[164:167], v[68:71], a[20:23], v[164:167]
    ds_read_b64_tr_b16 v[86:87], v19 offset:4608
    v_mfma_f32_16x16x32_bf16 v[164:167], v[72:75], a[36:39], v[164:167]
    ds_read_b64_tr_b16 v[88:89], v19 offset:8192
    v_mfma_f32_16x16x32_bf16 v[164:167], v[76:79], a[52:55], v[164:167]
    buffer_load_dwordx4 v9, s[4:7], s72 offen offset:3072 lds
    v_mfma_f32_16x16x32_bf16 v[168:171], v[64:67], a[8:11], 0
    ds_read_b64_tr_b16 v[90:91], v19 offset:8704
    s_add_u32 m0, s62, 0
    v_mfma_f32_16x16x32_bf16 v[168:171], v[68:71], a[24:27], v[168:171]
    ds_read_b64_tr_b16 v[92:93], v19 offset:12288
    s_add_u32 s72, s92, 128
    v_mfma_f32_16x16x32_bf16 v[168:171], v[72:75], a[40:43], v[168:171]
    buffer_load_dwordx4 v2, s[4:7], s72 offen offset:0 lds
    v_mfma_f32_16x16x32_bf16 v[168:171], v[76:79], a[56:59], v[168:171]
    ds_read_b64_tr_b16 v[94:95], v19 offset:12800
    v_mfma_f32_16x16x32_bf16 v[172:175], v[64:67], a[12:15], 0
    v_mfma_f32_16x16x32_bf16 v[172:175], v[68:71], a[28:31], v[172:175]
    buffer_load_dwordx4 v3, s[4:7], s72 offen offset:1024 lds
    v_mfma_f32_16x16x32_bf16 v[172:175], v[72:75], a[44:47], v[172:175]
    v_mfma_f32_16x16x32_bf16 v[172:175], v[76:79], a[60:63], v[172:175]
    s_waitcnt lgkmcnt(0)
    s_waitcnt vmcnt(16)
    s_barrier
    v_mfma_f32_16x16x32_bf16 v[176:179], v[80:83], a[0:3], 0
    buffer_load_dwordx4 v4, s[4:7], s72 offen offset:2048 lds
    v_mfma_f32_16x16x32_bf16 v[176:179], v[84:87], a[16:19], v[176:179]
    ds_read_b64_tr_b16 v[64:65], v16 offset:16384
    v_mfma_f32_16x16x32_bf16 v[176:179], v[88:91], a[32:35], v[176:179]
    ds_read_b64_tr_b16 v[66:67], v16 offset:16896
    v_mfma_f32_16x16x32_bf16 v[176:179], v[92:95], a[48:51], v[176:179]
    buffer_load_dwordx4 v5, s[4:7], s72 offen offset:3072 lds
    v_mfma_f32_16x16x32_bf16 v[180:183], v[80:83], a[4:7], 0
    ds_read_b64_tr_b16 v[68:69], v16 offset:20480
    s_add_u32 m0, s62, 4096
    v_mfma_f32_16x16x32_bf16 v[180:183], v[84:87], a[20:23], v[180:183]
    ds_read_b64_tr_b16 v[70:71], v16 offset:20992
    s_add_u32 s72, s92, 4224
    v_mfma_f32_16x16x32_bf16 v[180:183], v[88:91], a[36:39], v[180:183]
    buffer_load_dwordx4 v6, s[4:7], s72 offen offset:0 lds
    v_mfma_f32_16x16x32_bf16 v[180:183], v[92:95], a[52:55], v[180:183]
    ds_read_b64_tr_b16 v[72:73], v16 offset:24576
    v_mfma_f32_16x16x32_bf16 v[184:187], v[80:83], a[8:11], 0
    ds_read_b64_tr_b16 v[74:75], v16 offset:25088
    v_mfma_f32_16x16x32_bf16 v[184:187], v[84:87], a[24:27], v[184:187]
    buffer_load_dwordx4 v7, s[4:7], s72 offen offset:1024 lds
    v_mfma_f32_16x16x32_bf16 v[184:187], v[88:91], a[40:43], v[184:187]
    ds_read_b64_tr_b16 v[76:77], v16 offset:28672
    v_mfma_f32_16x16x32_bf16 v[184:187], v[92:95], a[56:59], v[184:187]
    ds_read_b64_tr_b16 v[78:79], v16 offset:29184
    v_mfma_f32_16x16x32_bf16 v[188:191], v[80:83], a[12:15], 0
    buffer_load_dwordx4 v8, s[4:7], s72 offen offset:2048 lds
    v_mfma_f32_16x16x32_bf16 v[188:191], v[84:87], a[28:31], v[188:191]
    v_mfma_f32_16x16x32_bf16 v[188:191], v[88:91], a[44:47], v[188:191]
    v_mfma_f32_16x16x32_bf16 v[188:191], v[92:95], a[60:63], v[188:191]
    buffer_load_dwordx4 v9, s[4:7], s72 offen offset:3072 lds
    s_waitcnt lgkmcnt(0)
    v_mfma_f32_16x16x32_bf16 v[192:195], v[64:67], a[0:3], 0
    ds_read_b64_tr_b16 v[80:81], v17 offset:16384
    s_add_u32 m0, s61, 49152
    v_mfma_f32_16x16x32_bf16 v[192:195], v[68:71], a[16:19], v[192:195]
    ds_read_b64_tr_b16 v[82:83], v17 offset:16896
    s_add_u32 s71, s98, 128
    v_mfma_f32_16x16x32_bf16 v[192:195], v[72:75], a[32:35], v[192:195]
    buffer_load_dwordx4 v12, s[12:15], s71 offen lds
    v_mfma_f32_16x16x32_bf16 v[192:195], v[76:79], a[48:51], v[192:195]
    ds_read_b64_tr_b16 v[84:85], v17 offset:20480
    s_add_u32 m0, s61, 50176
    v_mfma_f32_16x16x32_bf16 v[196:199], v[64:67], a[4:7], 0
    ds_read_b64_tr_b16 v[86:87], v17 offset:20992
    s_add_u32 s71, s98, 65664
    v_mfma_f32_16x16x32_bf16 v[196:199], v[68:71], a[20:23], v[196:199]
    buffer_load_dwordx4 v13, s[12:15], s71 offen lds
    v_mfma_f32_16x16x32_bf16 v[196:199], v[72:75], a[36:39], v[196:199]
    ds_read_b64_tr_b16 v[88:89], v17 offset:24576
    s_add_u32 m0, s61, 51200
    v_mfma_f32_16x16x32_bf16 v[196:199], v[76:79], a[52:55], v[196:199]
    ds_read_b64_tr_b16 v[90:91], v17 offset:25088
    s_add_u32 s71, s98, 131200
    v_mfma_f32_16x16x32_bf16 v[200:203], v[64:67], a[8:11], 0
    buffer_load_dwordx4 v12, s[12:15], s71 offen lds
    v_mfma_f32_16x16x32_bf16 v[200:203], v[68:71], a[24:27], v[200:203]
    ds_read_b64_tr_b16 v[92:93], v17 offset:28672
    s_add_u32 m0, s61, 52224
    v_mfma_f32_16x16x32_bf16 v[200:203], v[72:75], a[40:43], v[200:203]
    ds_read_b64_tr_b16 v[94:95], v17 offset:29184
    s_add_u32 s71, s98, 196736
    v_mfma_f32_16x16x32_bf16 v[200:203], v[76:79], a[56:59], v[200:203]
    buffer_load_dwordx4 v13, s[12:15], s71 offen lds
    v_mfma_f32_16x16x32_bf16 v[204:207], v[64:67], a[12:15], 0
    s_add_u32 m0, s61, 0
    s_add_u32 s71, s99, 0
    v_mfma_f32_16x16x32_bf16 v[204:207], v[68:71], a[28:31], v[204:207]
    v_mfma_f32_16x16x32_bf16 v[204:207], v[72:75], a[44:47], v[204:207]
    buffer_load_dwordx4 v12, s[12:15], s71 offen lds
    v_mfma_f32_16x16x32_bf16 v[204:207], v[76:79], a[60:63], v[204:207]
    s_add_u32 m0, s61, 1024
    s_add_u32 s71, s99, 65536
    s_waitcnt lgkmcnt(0)
    v_mfma_f32_16x16x32_bf16 v[208:211], v[80:83], a[0:3], 0
    ds_read_b64_tr_b16 v[64:65], v18 offset:16384
    v_mfma_f32_16x16x32_bf16 v[208:211], v[84:87], a[16:19], v[208:211]
    buffer_load_dwordx4 v13, s[12:15], s71 offen lds
    v_mfma_f32_16x16x32_bf16 v[208:211], v[88:91], a[32:35], v[208:211]
    ds_read_b64_tr_b16 v[66:67], v18 offset:16896
    s_add_u32 m0, s61, 2048
    v_mfma_f32_16x16x32_bf16 v[208:211], v[92:95], a[48:51], v[208:211]
    ds_read_b64_tr_b16 v[68:69], v18 offset:20480
    s_add_u32 s71, s99, 131072
    v_mfma_f32_16x16x32_bf16 v[212:215], v[80:83], a[4:7], 0
    buffer_load_dwordx4 v12, s[12:15], s71 offen lds
    v_mfma_f32_16x16x32_bf16 v[212:215], v[84:87], a[20:23], v[212:215]
    ds_read_b64_tr_b16 v[70:71], v18 offset:20992
    s_add_u32 m0, s61, 3072
    v_mfma_f32_16x16x32_bf16 v[212:215], v[88:91], a[36:39], v[212:215]
    ds_read_b64_tr_b16 v[72:73], v18 offset:24576
    s_add_u32 s71, s99, 196608
    v_mfma_f32_16x16x32_bf16 v[212:215], v[92:95], a[52:55], v[212:215]
    buffer_load_dwordx4 v13, s[12:15], s71 offen lds
    v_mfma_f32_16x16x32_bf16 v[216:219], v[80:83], a[8:11], 0
    ds_read_b64_tr_b16 v[74:75], v18 offset:25088
    s_add_u32 m0, s62, 8192
    v_mfma_f32_16x16x32_bf16 v[216:219], v[84:87], a[24:27], v[216:219]
    ds_read_b64_tr_b16 v[76:77], v18 offset:28672
    s_add_u32 s72, s93, 0
    v_mfma_f32_16x16x32_bf16 v[216:219], v[88:91], a[40:43], v[216:219]
    buffer_load_dwordx4 v2, s[4:7], s72 offen offset:0 lds
    v_mfma_f32_16x16x32_bf16 v[216:219], v[92:95], a[56:59], v[216:219]
    ds_read_b64_tr_b16 v[78:79], v18 offset:29184
    v_mfma_f32_16x16x32_bf16 v[220:223], v[80:83], a[12:15], 0
    v_mfma_f32_16x16x32_bf16 v[220:223], v[84:87], a[28:31], v[220:223]
    buffer_load_dwordx4 v3, s[4:7], s72 offen offset:1024 lds
    v_mfma_f32_16x16x32_bf16 v[220:223], v[88:91], a[44:47], v[220:223]
    v_mfma_f32_16x16x32_bf16 v[220:223], v[92:95], a[60:63], v[220:223]
    s_waitcnt lgkmcnt(0)
    v_mfma_f32_16x16x32_bf16 v[224:227], v[64:67], a[0:3], 0
    buffer_load_dwordx4 v4, s[4:7], s72 offen offset:2048 lds
    v_mfma_f32_16x16x32_bf16 v[224:227], v[68:71], a[16:19], v[224:227]
    ds_read_b64_tr_b16 v[80:81], v19 offset:16384
    v_mfma_f32_16x16x32_bf16 v[224:227], v[72:75], a[32:35], v[224:227]
    ds_read_b64_tr_b16 v[82:83], v19 offset:16896
    v_mfma_f32_16x16x32_bf16 v[224:227], v[76:79], a[48:51], v[224:227]
    buffer_load_dwordx4 v5, s[4:7], s72 offen offset:3072 lds
    v_mfma_f32_16x16x32_bf16 v[228:231], v[64:67], a[4:7], 0
    ds_read_b64_tr_b16 v[84:85], v19 offset:20480
    s_waitcnt vmcnt(20)
    v_mfma_f32_16x16x32_bf16 v[228:231], v[68:71], a[20:23], v[228:231]
    ds_read_b64_tr_b16 v[86:87], v19 offset:20992
    ds_read_b128 a[64:67], v10 offset:16384
    v_mfma_f32_16x16x32_bf16 v[228:231], v[72:75], a[36:39], v[228:231]
    ds_read_b64_tr_b16 v[88:89], v19 offset:24576
    ds_read_b128 a[68:71], v10 offset:16640
    v_mfma_f32_16x16x32_bf16 v[228:231], v[76:79], a[52:55], v[228:231]
    ds_read_b64_tr_b16 v[90:91], v19 offset:25088
    ds_read_b128 a[72:75], v10 offset:16896
    v_mfma_f32_16x16x32_bf16 v[232:235], v[64:67], a[8:11], 0
    ds_read_b64_tr_b16 v[92:93], v19 offset:28672
    ds_read_b128 a[76:79], v10 offset:17152
    v_mfma_f32_16x16x32_bf16 v[232:235], v[68:71], a[24:27], v[232:235]
    ds_read_b64_tr_b16 v[94:95], v19 offset:29184
    ds_read_b128 a[80:83], v11 offset:16384
    v_mfma_f32_16x16x32_bf16 v[232:235], v[72:75], a[40:43], v[232:235]
    ds_read_b128 a[84:87], v11 offset:16640
    v_mfma_f32_16x16x32_bf16 v[232:235], v[76:79], a[56:59], v[232:235]
    ds_read_b128 a[88:91], v11 offset:16896
    v_mfma_f32_16x16x32_bf16 v[236:239], v[64:67], a[12:15], 0
    ds_read_b128 a[92:95], v11 offset:17152
    s_waitcnt vmcnt(12)
    v_mfma_f32_16x16x32_bf16 v[236:239], v[68:71], a[28:31], v[236:239]
    ds_read_b128 a[96:99], v10 offset:0
    v_mfma_f32_16x16x32_bf16 v[236:239], v[72:75], a[44:47], v[236:239]
    ds_read_b128 a[100:103], v10 offset:256
    v_mfma_f32_16x16x32_bf16 v[236:239], v[76:79], a[60:63], v[236:239]
    ds_read_b128 a[104:107], v10 offset:512
    s_waitcnt lgkmcnt(7)
    s_barrier
    v_mfma_f32_16x16x32_bf16 v[240:243], v[80:83], a[0:3], 0
    ds_read_b64_tr_b16 v[64:65], v16 offset:32768
    ds_read_b128 a[108:111], v10 offset:768
    v_mfma_f32_16x16x32_bf16 v[240:243], v[84:87], a[16:19], v[240:243]
    ds_read_b64_tr_b16 v[66:67], v16 offset:33280
    ds_read_b128 a[112:115], v11 offset:0
    v_mfma_f32_16x16x32_bf16 v[240:243], v[88:91], a[32:35], v[240:243]
    ds_read_b64_tr_b16 v[68:69], v16 offset:36864
    ds_read_b128 a[116:119], v11 offset:256
    v_mfma_f32_16x16x32_bf16 v[240:243], v[92:95], a[48:51], v[240:243]
    ds_read_b64_tr_b16 v[70:71], v16 offset:37376
    ds_read_b128 a[120:123], v11 offset:512
    v_mfma_f32_16x16x32_bf16 v[244:247], v[80:83], a[4:7], 0
    ds_read_b64_tr_b16 v[72:73], v16 offset:40960
    ds_read_b128 a[124:127], v11 offset:768
    v_mfma_f32_16x16x32_bf16 v[244:247], v[84:87], a[20:23], v[244:247]
    ds_read_b64_tr_b16 v[74:75], v16 offset:41472
    s_add_u32 m0, s61, 16384
    v_mfma_f32_16x16x32_bf16 v[244:247], v[88:91], a[36:39], v[244:247]
    ds_read_b64_tr_b16 v[76:77], v16 offset:45056
    s_add_u32 s71, s99, 128
    v_mfma_f32_16x16x32_bf16 v[244:247], v[92:95], a[52:55], v[244:247]
    buffer_load_dwordx4 v12, s[12:15], s71 offen lds
    v_mfma_f32_16x16x32_bf16 v[248:251], v[80:83], a[8:11], 0
    ds_read_b64_tr_b16 v[78:79], v16 offset:45568
    s_add_u32 m0, s61, 17408
    v_mfma_f32_16x16x32_bf16 v[248:251], v[84:87], a[24:27], v[248:251]
    s_add_u32 s71, s99, 65664
    v_mfma_f32_16x16x32_bf16 v[248:251], v[88:91], a[40:43], v[248:251]
    buffer_load_dwordx4 v13, s[12:15], s71 offen lds
    v_mfma_f32_16x16x32_bf16 v[248:251], v[92:95], a[56:59], v[248:251]
    s_add_u32 m0, s61, 18432
    s_add_u32 s71, s99, 131200
    v_mfma_f32_16x16x32_bf16 v[252:255], v[80:83], a[12:15], 0
    v_mfma_f32_16x16x32_bf16 v[252:255], v[84:87], a[28:31], v[252:255]
    buffer_load_dwordx4 v12, s[12:15], s71 offen lds
    v_mfma_f32_16x16x32_bf16 v[252:255], v[88:91], a[44:47], v[252:255]
    s_add_u32 m0, s61, 19456
    s_add_u32 s71, s99, 196736
    v_mfma_f32_16x16x32_bf16 v[252:255], v[92:95], a[60:63], v[252:255]
    s_waitcnt lgkmcnt(0)
    v_mfma_f32_16x16x32_bf16 v[128:131], v[64:67], a[64:67], v[128:131]
    buffer_load_dwordx4 v13, s[12:15], s71 offen lds
    v_mfma_f32_16x16x32_bf16 v[128:131], v[68:71], a[80:83], v[128:131]
    ds_read_b64_tr_b16 v[80:81], v17 offset:32768
    v_add_u32 v63, 1, v63
    v_mfma_f32_16x16x32_bf16 v[128:131], v[72:75], a[96:99], v[128:131]
    ds_read_b64_tr_b16 v[82:83], v17 offset:33280
    v_or_b32 v63, 0x80000000, v63
    v_mfma_f32_16x16x32_bf16 v[128:131], v[76:79], a[112:115], v[128:131]
    buffer_store_dword v63, v62, s[44:47], 0 offen sc1
    v_mfma_f32_16x16x32_bf16 v[132:135], v[64:67], a[68:71], v[132:135]
    ds_read_b64_tr_b16 v[84:85], v17 offset:36864
    s_cmp_lt_u32 s52, 16
    s_cselect_b32 s96, s57, s58
    v_mfma_f32_16x16x32_bf16 v[132:135], v[68:71], a[84:87], v[132:135]
    ds_read_b64_tr_b16 v[86:87], v17 offset:37376
    s_lshl_b32 s96, s96, 7
    v_mfma_f32_16x16x32_bf16 v[132:135], v[72:75], a[100:103], v[132:135]
    ds_read_b64_tr_b16 v[88:89], v17 offset:40960
    s_and_b32 s97, s52, 15
    v_mfma_f32_16x16x32_bf16 v[132:135], v[76:79], a[116:119], v[132:135]
    ds_read_b64_tr_b16 v[90:91], v17 offset:41472
    s_lshl_b32 s97, s97, 3
    v_mfma_f32_16x16x32_bf16 v[136:139], v[64:67], a[72:75], v[136:139]
    ds_read_b64_tr_b16 v[92:93], v17 offset:45056
    s_add_u32 s96, s96, s97
    v_mfma_f32_16x16x32_bf16 v[136:139], v[68:71], a[88:91], v[136:139]
    ds_read_b64_tr_b16 v[94:95], v17 offset:45568
    s_lshl_b32 s97, s54, 1
    v_mfma_f32_16x16x32_bf16 v[136:139], v[72:75], a[104:107], v[136:139]
    s_add_u32 s95, s96, s97
    s_lshl_b32 s97, s95, 10
    v_mfma_f32_16x16x32_bf16 v[136:139], v[76:79], a[120:123], v[136:139]
    buffer_load_dwordx4 v[96:99], v1, s[36:39], 0 offen
    v_mfma_f32_16x16x32_bf16 v[140:143], v[64:67], a[76:79], v[140:143]
    s_add_u32 m0, s62, 12288
    s_add_u32 s72, s93, 4096
    v_mfma_f32_16x16x32_bf16 v[140:143], v[68:71], a[92:95], v[140:143]
    v_mfma_f32_16x16x32_bf16 v[140:143], v[72:75], a[108:111], v[140:143]
    buffer_load_dwordx4 v[100:103], v1, s[8:11], s97 offen
    v_mfma_f32_16x16x32_bf16 v[140:143], v[76:79], a[124:127], v[140:143]
    s_waitcnt lgkmcnt(0)
    v_mfma_f32_16x16x32_bf16 v[144:147], v[80:83], a[64:67], v[144:147]
    ds_read_b64_tr_b16 v[64:65], v18 offset:32768
    v_mfma_f32_16x16x32_bf16 v[144:147], v[84:87], a[80:83], v[144:147]
    buffer_load_dwordx4 v[104:107], v1, s[8:11], s97 offen offset:1024
    v_mfma_f32_16x16x32_bf16 v[144:147], v[88:91], a[96:99], v[144:147]
    ds_read_b64_tr_b16 v[66:67], v18 offset:33280
    v_mfma_f32_16x16x32_bf16 v[144:147], v[92:95], a[112:115], v[144:147]
    ds_read_b64_tr_b16 v[68:69], v18 offset:36864
    v_mfma_f32_16x16x32_bf16 v[148:151], v[80:83], a[68:71], v[148:151]
    buffer_load_dwordx4 v6, s[4:7], s72 offen offset:0 lds
    v_mfma_f32_16x16x32_bf16 v[148:151], v[84:87], a[84:87], v[148:151]
    ds_read_b64_tr_b16 v[70:71], v18 offset:37376
    v_mfma_f32_16x16x32_bf16 v[148:151], v[88:91], a[100:103], v[148:151]
    ds_read_b64_tr_b16 v[72:73], v18 offset:40960
    v_mfma_f32_16x16x32_bf16 v[148:151], v[92:95], a[116:119], v[148:151]
    buffer_load_dwordx4 v7, s[4:7], s72 offen offset:1024 lds
    v_mfma_f32_16x16x32_bf16 v[152:155], v[80:83], a[72:75], v[152:155]
    ds_read_b64_tr_b16 v[74:75], v18 offset:41472
    v_mfma_f32_16x16x32_bf16 v[152:155], v[84:87], a[88:91], v[152:155]
    ds_read_b64_tr_b16 v[76:77], v18 offset:45056
    v_mfma_f32_16x16x32_bf16 v[152:155], v[88:91], a[104:107], v[152:155]
    buffer_load_dwordx4 v8, s[4:7], s72 offen offset:2048 lds
    v_mfma_f32_16x16x32_bf16 v[152:155], v[92:95], a[120:123], v[152:155]
    ds_read_b64_tr_b16 v[78:79], v18 offset:45568
    v_mfma_f32_16x16x32_bf16 v[156:159], v[80:83], a[76:79], v[156:159]
    v_mfma_f32_16x16x32_bf16 v[156:159], v[84:87], a[92:95], v[156:159]
    buffer_load_dwordx4 v9, s[4:7], s72 offen offset:3072 lds
    v_mfma_f32_16x16x32_bf16 v[156:159], v[88:91], a[108:111], v[156:159]
    s_add_u32 m0, s62, 16384
    s_add_u32 s72, s93, 128
    v_mfma_f32_16x16x32_bf16 v[156:159], v[92:95], a[124:127], v[156:159]
    s_waitcnt lgkmcnt(0)
    v_mfma_f32_16x16x32_bf16 v[160:163], v[64:67], a[64:67], v[160:163]
    buffer_load_dwordx4 v2, s[4:7], s72 offen offset:0 lds
    v_mfma_f32_16x16x32_bf16 v[160:163], v[68:71], a[80:83], v[160:163]
    ds_read_b64_tr_b16 v[80:81], v19 offset:32768
    v_mfma_f32_16x16x32_bf16 v[160:163], v[72:75], a[96:99], v[160:163]
    ds_read_b64_tr_b16 v[82:83], v19 offset:33280
    v_mfma_f32_16x16x32_bf16 v[160:163], v[76:79], a[112:115], v[160:163]
    buffer_load_dwordx4 v3, s[4:7], s72 offen offset:1024 lds
    v_mfma_f32_16x16x32_bf16 v[164:167], v[64:67], a[68:71], v[164:167]
    ds_read_b64_tr_b16 v[84:85], v19 offset:36864
    v_mfma_f32_16x16x32_bf16 v[164:167], v[68:71], a[84:87], v[164:167]
    ds_read_b64_tr_b16 v[86:87], v19 offset:37376
    v_mfma_f32_16x16x32_bf16 v[164:167], v[72:75], a[100:103], v[164:167]
    buffer_load_dwordx4 v4, s[4:7], s72 offen offset:2048 lds
    v_mfma_f32_16x16x32_bf16 v[164:167], v[76:79], a[116:119], v[164:167]
    ds_read_b64_tr_b16 v[88:89], v19 offset:40960
    v_mfma_f32_16x16x32_bf16 v[168:171], v[64:67], a[72:75], v[168:171]
    ds_read_b64_tr_b16 v[90:91], v19 offset:41472
    v_mfma_f32_16x16x32_bf16 v[168:171], v[68:71], a[88:91], v[168:171]
    buffer_load_dwordx4 v5, s[4:7], s72 offen offset:3072 lds
    v_mfma_f32_16x16x32_bf16 v[168:171], v[72:75], a[104:107], v[168:171]
    ds_read_b64_tr_b16 v[92:93], v19 offset:45056
    s_add_u32 m0, s62, 20480
    v_mfma_f32_16x16x32_bf16 v[168:171], v[76:79], a[120:123], v[168:171]
    ds_read_b64_tr_b16 v[94:95], v19 offset:45568
    s_add_u32 s72, s93, 4224
    v_mfma_f32_16x16x32_bf16 v[172:175], v[64:67], a[76:79], v[172:175]
    buffer_load_dwordx4 v6, s[4:7], s72 offen offset:0 lds
    v_mfma_f32_16x16x32_bf16 v[172:175], v[68:71], a[92:95], v[172:175]
    v_mfma_f32_16x16x32_bf16 v[172:175], v[72:75], a[108:111], v[172:175]
    v_mfma_f32_16x16x32_bf16 v[172:175], v[76:79], a[124:127], v[172:175]
    buffer_load_dwordx4 v7, s[4:7], s72 offen offset:1024 lds
    s_waitcnt lgkmcnt(0)
    s_waitcnt vmcnt(26)
    s_barrier
    v_mfma_f32_16x16x32_bf16 v[176:179], v[80:83], a[64:67], v[176:179]
    ds_read_b64_tr_b16 v[64:65], v16 offset:49152
    v_mfma_f32_16x16x32_bf16 v[176:179], v[84:87], a[80:83], v[176:179]
    ds_read_b64_tr_b16 v[66:67], v16 offset:49664
    v_mfma_f32_16x16x32_bf16 v[176:179], v[88:91], a[96:99], v[176:179]
    buffer_load_dwordx4 v8, s[4:7], s72 offen offset:2048 lds
    v_mfma_f32_16x16x32_bf16 v[176:179], v[92:95], a[112:115], v[176:179]
    ds_read_b64_tr_b16 v[68:69], v16 offset:53248
    v_mfma_f32_16x16x32_bf16 v[180:183], v[80:83], a[68:71], v[180:183]
    ds_read_b64_tr_b16 v[70:71], v16 offset:53760
    v_mfma_f32_16x16x32_bf16 v[180:183], v[84:87], a[84:87], v[180:183]
    buffer_load_dwordx4 v9, s[4:7], s72 offen offset:3072 lds
    v_mfma_f32_16x16x32_bf16 v[180:183], v[88:91], a[100:103], v[180:183]
    ds_read_b64_tr_b16 v[72:73], v16 offset:57344
    s_add_u32 m0, s61, 32768
    v_mfma_f32_16x16x32_bf16 v[180:183], v[92:95], a[116:119], v[180:183]
    ds_read_b64_tr_b16 v[74:75], v16 offset:57856
    s_add_u32 s71, s3, 0
    v_mfma_f32_16x16x32_bf16 v[184:187], v[80:83], a[72:75], v[184:187]
    buffer_load_dwordx4 v12, s[12:15], s71 offen lds
    v_mfma_f32_16x16x32_bf16 v[184:187], v[84:87], a[88:91], v[184:187]
    ds_read_b64_tr_b16 v[76:77], v16 offset:61440
    s_add_u32 m0, s61, 33792
    v_mfma_f32_16x16x32_bf16 v[184:187], v[88:91], a[104:107], v[184:187]
    ds_read_b64_tr_b16 v[78:79], v16 offset:61952
    s_add_u32 s71, s3, 65536
    v_mfma_f32_16x16x32_bf16 v[184:187], v[92:95], a[120:123], v[184:187]
    buffer_load_dwordx4 v13, s[12:15], s71 offen lds
    v_mfma_f32_16x16x32_bf16 v[188:191], v[80:83], a[76:79], v[188:191]
    s_add_u32 m0, s61, 34816
    s_add_u32 s71, s3, 131072
    v_mfma_f32_16x16x32_bf16 v[188:191], v[84:87], a[92:95], v[188:191]
    v_mfma_f32_16x16x32_bf16 v[188:191], v[88:91], a[108:111], v[188:191]
    buffer_load_dwordx4 v12, s[12:15], s71 offen lds
    v_mfma_f32_16x16x32_bf16 v[188:191], v[92:95], a[124:127], v[188:191]
    s_add_u32 m0, s61, 35840
    s_add_u32 s71, s3, 196608
    s_waitcnt lgkmcnt(0)
    v_mfma_f32_16x16x32_bf16 v[192:195], v[64:67], a[64:67], v[192:195]
    ds_read_b64_tr_b16 v[80:81], v17 offset:49152
    s_lshl_b32 s90, s2, 2
    v_mfma_f32_16x16x32_bf16 v[192:195], v[68:71], a[80:83], v[192:195]
    buffer_load_dwordx4 v13, s[12:15], s71 offen lds
    v_mfma_f32_16x16x32_bf16 v[192:195], v[72:75], a[96:99], v[192:195]
    ds_read_b64_tr_b16 v[82:83], v17 offset:49664
    s_add_u32 s90, s90, s54
    v_mfma_f32_16x16x32_bf16 v[192:195], v[76:79], a[112:115], v[192:195]
    ds_read_b64_tr_b16 v[84:85], v17 offset:53248
    s_lshl_b32 s90, s90, 11
    v_mfma_f32_16x16x32_bf16 v[196:199], v[64:67], a[68:71], v[196:199]
    ds_read_b64_tr_b16 v[86:87], v17 offset:53760
    v_lshrrev_b32 v124, 4, v0
    v_mfma_f32_16x16x32_bf16 v[196:199], v[68:71], a[84:87], v[196:199]
    ds_read_b64_tr_b16 v[88:89], v17 offset:57344
    v_min_u32 v124, 1, v124
    v_mfma_f32_16x16x32_bf16 v[196:199], v[72:75], a[100:103], v[196:199]
    ds_read_b64_tr_b16 v[90:91], v17 offset:57856
    v_lshlrev_b32 v124, 30, v124
    v_mfma_f32_16x16x32_bf16 v[196:199], v[76:79], a[116:119], v[196:199]
    ds_read_b64_tr_b16 v[92:93], v17 offset:61440
    v_lshl_or_b32 v124, v0, 7, v124
    v_mfma_f32_16x16x32_bf16 v[200:203], v[64:67], a[72:75], v[200:203]
    buffer_load_dword v125, v124, s[8:11], s90 offen offset:0
    v_mfma_f32_16x16x32_bf16 v[200:203], v[68:71], a[88:91], v[200:203]
    ds_read_b64_tr_b16 v[94:95], v17 offset:61952
    s_add_u32 m0, s62, 0
    v_mfma_f32_16x16x32_bf16 v[200:203], v[72:75], a[104:107], v[200:203]
    s_add_u32 s72, s94, 0
    v_mfma_f32_16x16x32_bf16 v[200:203], v[76:79], a[120:123], v[200:203]
    buffer_load_dwordx4 v2, s[4:7], s72 offen offset:0 lds
    v_mfma_f32_16x16x32_bf16 v[204:207], v[64:67], a[76:79], v[204:207]
    v_mfma_f32_16x16x32_bf16 v[204:207], v[68:71], a[92:95], v[204:207]
    v_mfma_f32_16x16x32_bf16 v[204:207], v[72:75], a[108:111], v[204:207]
    buffer_load_dwordx4 v3, s[4:7], s72 offen offset:1024 lds
    v_mfma_f32_16x16x32_bf16 v[204:207], v[76:79], a[124:127], v[204:207]
    s_waitcnt lgkmcnt(0)
    v_mfma_f32_16x16x32_bf16 v[208:211], v[80:83], a[64:67], v[208:211]
    ds_read_b64_tr_b16 v[64:65], v18 offset:49152
    v_mfma_f32_16x16x32_bf16 v[208:211], v[84:87], a[80:83], v[208:211]
    buffer_load_dwordx4 v4, s[4:7], s72 offen offset:2048 lds
    v_mfma_f32_16x16x32_bf16 v[208:211], v[88:91], a[96:99], v[208:211]
    ds_read_b64_tr_b16 v[66:67], v18 offset:49664
    v_mfma_f32_16x16x32_bf16 v[208:211], v[92:95], a[112:115], v[208:211]
    ds_read_b64_tr_b16 v[68:69], v18 offset:53248
    v_mfma_f32_16x16x32_bf16 v[212:215], v[80:83], a[68:71], v[212:215]
    buffer_load_dwordx4 v5, s[4:7], s72 offen offset:3072 lds
    v_mfma_f32_16x16x32_bf16 v[212:215], v[84:87], a[84:87], v[212:215]
    ds_read_b64_tr_b16 v[70:71], v18 offset:53760
    s_waitcnt vmcnt(17)
    v_mfma_f32_16x16x32_bf16 v[212:215], v[88:91], a[100:103], v[212:215]
    ds_read_b64_tr_b16 v[72:73], v18 offset:57344
    ds_read_b128 a[128:131], v10 offset:8192
    v_mfma_f32_16x16x32_bf16 v[212:215], v[92:95], a[116:119], v[212:215]
    ds_read_b64_tr_b16 v[74:75], v18 offset:57856
    ds_read_b128 a[132:135], v10 offset:8448
    v_mfma_f32_16x16x32_bf16 v[216:219], v[80:83], a[72:75], v[216:219]
    ds_read_b64_tr_b16 v[76:77], v18 offset:61440
    ds_read_b128 a[136:139], v10 offset:8704
    v_mfma_f32_16x16x32_bf16 v[216:219], v[84:87], a[88:91], v[216:219]
    ds_read_b64_tr_b16 v[78:79], v18 offset:61952
    ds_read_b128 a[140:143], v10 offset:8960
    v_mfma_f32_16x16x32_bf16 v[216:219], v[88:91], a[104:107], v[216:219]
    ds_read_b128 a[144:147], v11 offset:8192
    v_mfma_f32_16x16x32_bf16 v[216:219], v[92:95], a[120:123], v[216:219]
    ds_read_b128 a[148:151], v11 offset:8448
    v_mfma_f32_16x16x32_bf16 v[220:223], v[80:83], a[76:79], v[220:223]
    ds_read_b128 a[152:155], v11 offset:8704
    v_mfma_f32_16x16x32_bf16 v[220:223], v[84:87], a[92:95], v[220:223]
    ds_read_b128 a[156:159], v11 offset:8960
    v_mfma_f32_16x16x32_bf16 v[220:223], v[88:91], a[108:111], v[220:223]
    v_mfma_f32_16x16x32_bf16 v[220:223], v[92:95], a[124:127], v[220:223]
    s_waitcnt lgkmcnt(5)
    v_mfma_f32_16x16x32_bf16 v[224:227], v[64:67], a[64:67], v[224:227]
    ds_read_b64_tr_b16 v[80:81], v19 offset:49152
    s_waitcnt vmcnt(9)
    v_mfma_f32_16x16x32_bf16 v[224:227], v[68:71], a[80:83], v[224:227]
    ds_read_b64_tr_b16 v[82:83], v19 offset:49664
    ds_read_b128 a[160:163], v10 offset:16384
    v_mfma_f32_16x16x32_bf16 v[224:227], v[72:75], a[96:99], v[224:227]
    ds_read_b64_tr_b16 v[84:85], v19 offset:53248
    ds_read_b128 a[164:167], v10 offset:16640
    v_mfma_f32_16x16x32_bf16 v[224:227], v[76:79], a[112:115], v[224:227]
    ds_read_b64_tr_b16 v[86:87], v19 offset:53760
    ds_read_b128 a[168:171], v10 offset:16896
    v_mfma_f32_16x16x32_bf16 v[228:231], v[64:67], a[68:71], v[228:231]
    ds_read_b64_tr_b16 v[88:89], v19 offset:57344
    ds_read_b128 a[172:175], v10 offset:17152
    v_mfma_f32_16x16x32_bf16 v[228:231], v[68:71], a[84:87], v[228:231]
    ds_read_b64_tr_b16 v[90:91], v19 offset:57856
    ds_read_b128 a[176:179], v11 offset:16384
    v_mfma_f32_16x16x32_bf16 v[228:231], v[72:75], a[100:103], v[228:231]
    ds_read_b64_tr_b16 v[92:93], v19 offset:61440
    ds_read_b128 a[180:183], v11 offset:16640
    v_mfma_f32_16x16x32_bf16 v[228:231], v[76:79], a[116:119], v[228:231]
    ds_read_b64_tr_b16 v[94:95], v19 offset:61952
    ds_read_b128 a[184:187], v11 offset:16896
    v_mfma_f32_16x16x32_bf16 v[232:235], v[64:67], a[72:75], v[232:235]
    ds_read_b128 a[188:191], v11 offset:17152
    s_add_u32 m0, s62, 4096
    v_mfma_f32_16x16x32_bf16 v[232:235], v[68:71], a[88:91], v[232:235]
    s_add_u32 s72, s94, 4096
    v_mfma_f32_16x16x32_bf16 v[232:235], v[72:75], a[104:107], v[232:235]
    buffer_load_dwordx4 v6, s[4:7], s72 offen offset:0 lds
    v_mfma_f32_16x16x32_bf16 v[232:235], v[76:79], a[120:123], v[232:235]
    v_mfma_f32_16x16x32_bf16 v[236:239], v[64:67], a[76:79], v[236:239]
    v_mfma_f32_16x16x32_bf16 v[236:239], v[68:71], a[92:95], v[236:239]
    buffer_load_dwordx4 v7, s[4:7], s72 offen offset:1024 lds
    v_mfma_f32_16x16x32_bf16 v[236:239], v[72:75], a[108:111], v[236:239]
    v_mfma_f32_16x16x32_bf16 v[236:239], v[76:79], a[124:127], v[236:239]
    s_waitcnt lgkmcnt(2)
    s_barrier
    v_mfma_f32_16x16x32_bf16 v[240:243], v[80:83], a[64:67], v[240:243]
    buffer_load_dwordx4 v8, s[4:7], s72 offen offset:2048 lds
    v_mfma_f32_16x16x32_bf16 v[240:243], v[84:87], a[80:83], v[240:243]
    ds_read_b64_tr_b16 v[64:65], v16 offset:0
    v_mfma_f32_16x16x32_bf16 v[240:243], v[88:91], a[96:99], v[240:243]
    ds_read_b64_tr_b16 v[66:67], v16 offset:512
    v_mfma_f32_16x16x32_bf16 v[240:243], v[92:95], a[112:115], v[240:243]
    buffer_load_dwordx4 v9, s[4:7], s72 offen offset:3072 lds
    v_mfma_f32_16x16x32_bf16 v[244:247], v[80:83], a[68:71], v[244:247]
    ds_read_b64_tr_b16 v[68:69], v16 offset:4096
    s_add_u32 m0, s61, 49152
    v_mfma_f32_16x16x32_bf16 v[244:247], v[84:87], a[84:87], v[244:247]
    ds_read_b64_tr_b16 v[70:71], v16 offset:4608
    s_add_u32 s71, s3, 128
    v_mfma_f32_16x16x32_bf16 v[244:247], v[88:91], a[100:103], v[244:247]
    buffer_load_dwordx4 v12, s[12:15], s71 offen lds
    v_mfma_f32_16x16x32_bf16 v[244:247], v[92:95], a[116:119], v[244:247]
    ds_read_b64_tr_b16 v[72:73], v16 offset:8192
    s_add_u32 m0, s61, 50176
    v_mfma_f32_16x16x32_bf16 v[248:251], v[80:83], a[72:75], v[248:251]
    ds_read_b64_tr_b16 v[74:75], v16 offset:8704
    s_add_u32 s71, s3, 65664
    v_mfma_f32_16x16x32_bf16 v[248:251], v[84:87], a[88:91], v[248:251]
    buffer_load_dwordx4 v13, s[12:15], s71 offen lds
    v_mfma_f32_16x16x32_bf16 v[248:251], v[88:91], a[104:107], v[248:251]
    ds_read_b64_tr_b16 v[76:77], v16 offset:12288
    s_add_u32 m0, s61, 51200
    v_mfma_f32_16x16x32_bf16 v[248:251], v[92:95], a[120:123], v[248:251]
    ds_read_b64_tr_b16 v[78:79], v16 offset:12800
    s_add_u32 s71, s3, 131200
    v_mfma_f32_16x16x32_bf16 v[252:255], v[80:83], a[76:79], v[252:255]
    buffer_load_dwordx4 v12, s[12:15], s71 offen lds
    v_mfma_f32_16x16x32_bf16 v[252:255], v[84:87], a[92:95], v[252:255]
    s_add_u32 m0, s61, 52224
    s_add_u32 s71, s3, 196736
    v_mfma_f32_16x16x32_bf16 v[252:255], v[88:91], a[108:111], v[252:255]
    v_mfma_f32_16x16x32_bf16 v[252:255], v[92:95], a[124:127], v[252:255]
    buffer_load_dwordx4 v13, s[12:15], s71 offen lds
    s_waitcnt lgkmcnt(0)
    v_mfma_f32_16x16x32_bf16 v[128:131], v[64:67], a[128:131], v[128:131]
    ds_read_b64_tr_b16 v[80:81], v17 offset:0
    s_lshr_b32 s90, s2, 3
    v_mfma_f32_16x16x32_bf16 v[128:131], v[68:71], a[144:147], v[128:131]
    ds_read_b64_tr_b16 v[82:83], v17 offset:512
    s_lshl_b32 s90, s90, 2
    v_mfma_f32_16x16x32_bf16 v[128:131], v[72:75], a[160:163], v[128:131]
    ds_read_b64_tr_b16 v[84:85], v17 offset:4096
    s_add_u32 s90, s90, s54
    v_mfma_f32_16x16x32_bf16 v[128:131], v[76:79], a[176:179], v[128:131]
    ds_read_b64_tr_b16 v[86:87], v17 offset:4608
    s_lshl_b32 s90, s90, 15
    v_mfma_f32_16x16x32_bf16 v[132:135], v[64:67], a[132:135], v[132:135]
    ds_read_b64_tr_b16 v[88:89], v17 offset:8192
    s_lshr_b32 s91, s52, 2
    v_mfma_f32_16x16x32_bf16 v[132:135], v[68:71], a[148:151], v[132:135]
    ds_read_b64_tr_b16 v[90:91], v17 offset:8704
    s_lshl_b32 s91, s91, 10
    v_mfma_f32_16x16x32_bf16 v[132:135], v[72:75], a[164:167], v[132:135]
    ds_read_b64_tr_b16 v[92:93], v17 offset:12288
    s_add_u32 s90, s90, s91
    v_mfma_f32_16x16x32_bf16 v[132:135], v[76:79], a[180:183], v[132:135]
    ds_read_b64_tr_b16 v[94:95], v17 offset:12800
    v_lshrrev_b32 v124, 5, v0
    v_mfma_f32_16x16x32_bf16 v[136:139], v[64:67], a[136:139], v[136:139]
    v_min_u32 v124, 1, v124
    v_lshlrev_b32 v124, 30, v124
    v_mfma_f32_16x16x32_bf16 v[136:139], v[68:71], a[152:155], v[136:139]
    v_lshl_or_b32 v124, v0, 10, v124
    v_and_b32 v126, 7, v0
    v_mfma_f32_16x16x32_bf16 v[136:139], v[72:75], a[168:171], v[136:139]
    v_mul_u32_u24 v126, 896, v126
    v_sub_u32 v124, v124, v126
    v_mfma_f32_16x16x32_bf16 v[136:139], v[76:79], a[184:187], v[136:139]
    buffer_load_dword v125, v124, s[16:19], s90 offen offset:0
    v_mfma_f32_16x16x32_bf16 v[140:143], v[64:67], a[140:143], v[140:143]
    s_add_u32 m0, s62, 8192
    s_add_u32 s72, s94, 128
    v_mfma_f32_16x16x32_bf16 v[140:143], v[68:71], a[156:159], v[140:143]
    v_mfma_f32_16x16x32_bf16 v[140:143], v[72:75], a[172:175], v[140:143]
    v_mfma_f32_16x16x32_bf16 v[140:143], v[76:79], a[188:191], v[140:143]
    buffer_load_dwordx4 v2, s[4:7], s72 offen offset:0 lds
    s_waitcnt lgkmcnt(0)
    v_mfma_f32_16x16x32_bf16 v[144:147], v[80:83], a[128:131], v[144:147]
    ds_read_b64_tr_b16 v[64:65], v18 offset:0
    v_mfma_f32_16x16x32_bf16 v[144:147], v[84:87], a[144:147], v[144:147]
    ds_read_b64_tr_b16 v[66:67], v18 offset:512
    v_mfma_f32_16x16x32_bf16 v[144:147], v[88:91], a[160:163], v[144:147]
    ds_read_b64_tr_b16 v[68:69], v18 offset:4096
    v_mfma_f32_16x16x32_bf16 v[144:147], v[92:95], a[176:179], v[144:147]
    buffer_load_dwordx4 v3, s[4:7], s72 offen offset:1024 lds
    v_mfma_f32_16x16x32_bf16 v[148:151], v[80:83], a[132:135], v[148:151]
    ds_read_b64_tr_b16 v[70:71], v18 offset:4608
    v_mfma_f32_16x16x32_bf16 v[148:151], v[84:87], a[148:151], v[148:151]
    ds_read_b64_tr_b16 v[72:73], v18 offset:8192
    v_mfma_f32_16x16x32_bf16 v[148:151], v[88:91], a[164:167], v[148:151]
    ds_read_b64_tr_b16 v[74:75], v18 offset:8704
    v_mfma_f32_16x16x32_bf16 v[148:151], v[92:95], a[180:183], v[148:151]
    buffer_load_dwordx4 v4, s[4:7], s72 offen offset:2048 lds
    v_mfma_f32_16x16x32_bf16 v[152:155], v[80:83], a[136:139], v[152:155]
    ds_read_b64_tr_b16 v[76:77], v18 offset:12288
    v_mfma_f32_16x16x32_bf16 v[152:155], v[84:87], a[152:155], v[152:155]
    ds_read_b64_tr_b16 v[78:79], v18 offset:12800
    v_mfma_f32_16x16x32_bf16 v[152:155], v[88:91], a[168:171], v[152:155]
    v_mfma_f32_16x16x32_bf16 v[152:155], v[92:95], a[184:187], v[152:155]
    buffer_load_dwordx4 v5, s[4:7], s72 offen offset:3072 lds
    v_mfma_f32_16x16x32_bf16 v[156:159], v[80:83], a[140:143], v[156:159]
    s_add_u32 m0, s62, 12288
    s_add_u32 s72, s94, 4224
    v_mfma_f32_16x16x32_bf16 v[156:159], v[84:87], a[156:159], v[156:159]
    v_mfma_f32_16x16x32_bf16 v[156:159], v[88:91], a[172:175], v[156:159]
    v_mfma_f32_16x16x32_bf16 v[156:159], v[92:95], a[188:191], v[156:159]
    buffer_load_dwordx4 v6, s[4:7], s72 offen offset:0 lds
    s_waitcnt lgkmcnt(0)
    v_mfma_f32_16x16x32_bf16 v[160:163], v[64:67], a[128:131], v[160:163]
    ds_read_b64_tr_b16 v[80:81], v19 offset:0
    v_dot2_f32_bf16 v116, v100, v96, 0
    v_mfma_f32_16x16x32_bf16 v[160:163], v[68:71], a[144:147], v[160:163]
    ds_read_b64_tr_b16 v[82:83], v19 offset:512
    s_nop 0
    v_mfma_f32_16x16x32_bf16 v[160:163], v[72:75], a[160:163], v[160:163]
    ds_read_b64_tr_b16 v[84:85], v19 offset:4096
    v_dot2_f32_bf16 v117, v104, v96, 0
    v_mfma_f32_16x16x32_bf16 v[160:163], v[76:79], a[176:179], v[160:163]
    buffer_load_dwordx4 v7, s[4:7], s72 offen offset:1024 lds
    v_mfma_f32_16x16x32_bf16 v[164:167], v[64:67], a[132:135], v[164:167]
    ds_read_b64_tr_b16 v[86:87], v19 offset:4608
    s_nop 0
    v_mfma_f32_16x16x32_bf16 v[164:167], v[68:71], a[148:151], v[164:167]
    ds_read_b64_tr_b16 v[88:89], v19 offset:8192
    v_dot2_f32_bf16 v116, v101, v97, v116
    v_mfma_f32_16x16x32_bf16 v[164:167], v[72:75], a[164:167], v[164:167]
    ds_read_b64_tr_b16 v[90:91], v19 offset:8704
    s_nop 0
    v_mfma_f32_16x16x32_bf16 v[164:167], v[76:79], a[180:183], v[164:167]
    buffer_load_dwordx4 v8, s[4:7], s72 offen offset:2048 lds
    v_mfma_f32_16x16x32_bf16 v[168:171], v[64:67], a[136:139], v[168:171]
    ds_read_b64_tr_b16 v[92:93], v19 offset:12288
    v_dot2_f32_bf16 v117, v105, v97, v117
    v_mfma_f32_16x16x32_bf16 v[168:171], v[68:71], a[152:155], v[168:171]
    ds_read_b64_tr_b16 v[94:95], v19 offset:12800
    s_nop 0
    v_mfma_f32_16x16x32_bf16 v[168:171], v[72:75], a[168:171], v[168:171]
    v_dot2_f32_bf16 v116, v102, v98, v116
    s_nop 0
    v_mfma_f32_16x16x32_bf16 v[168:171], v[76:79], a[184:187], v[168:171]
    buffer_load_dwordx4 v9, s[4:7], s72 offen offset:3072 lds
    v_mfma_f32_16x16x32_bf16 v[172:175], v[64:67], a[140:143], v[172:175]
    v_dot2_f32_bf16 v117, v106, v98, v117
    s_nop 0
    v_mfma_f32_16x16x32_bf16 v[172:175], v[68:71], a[156:159], v[172:175]
    v_dot2_f32_bf16 v116, v103, v99, v116
    s_nop 0
    v_mfma_f32_16x16x32_bf16 v[172:175], v[72:75], a[172:175], v[172:175]
    v_dot2_f32_bf16 v117, v107, v99, v117
    s_nop 0
    v_mfma_f32_16x16x32_bf16 v[172:175], v[76:79], a[188:191], v[172:175]
    s_nop 1
    s_nop 0
    s_waitcnt lgkmcnt(0)
    s_barrier
    v_mfma_f32_16x16x32_bf16 v[176:179], v[80:83], a[128:131], v[176:179]
    ds_read_b64_tr_b16 v[64:65], v16 offset:16384
    s_add_u32 m0, s61, 0
    v_mfma_f32_16x16x32_bf16 v[176:179], v[84:87], a[144:147], v[176:179]
    ds_read_b64_tr_b16 v[66:67], v16 offset:16896
    s_add_u32 s71, s75, 0
    v_mfma_f32_16x16x32_bf16 v[176:179], v[88:91], a[160:163], v[176:179]
    buffer_load_dwordx4 v12, s[16:19], s71 offen lds
    v_mfma_f32_16x16x32_bf16 v[176:179], v[92:95], a[176:179], v[176:179]
    ds_read_b64_tr_b16 v[68:69], v16 offset:20480
    s_add_u32 m0, s61, 1024
    v_mfma_f32_16x16x32_bf16 v[180:183], v[80:83], a[132:135], v[180:183]
    ds_read_b64_tr_b16 v[70:71], v16 offset:20992
    s_add_u32 s71, s75, 65536
    v_mfma_f32_16x16x32_bf16 v[180:183], v[84:87], a[148:151], v[180:183]
    ds_read_b64_tr_b16 v[72:73], v16 offset:24576
    v_add_f32_dpp v116, v116, v116 quad_perm:[1,0,3,2] row_mask:0xf bank_mask:0xf
    v_mfma_f32_16x16x32_bf16 v[180:183], v[88:91], a[164:167], v[180:183]
    buffer_load_dwordx4 v13, s[16:19], s71 offen lds
    v_mfma_f32_16x16x32_bf16 v[180:183], v[92:95], a[180:183], v[180:183]
    ds_read_b64_tr_b16 v[74:75], v16 offset:25088
    s_add_u32 m0, s61, 2048
    v_mfma_f32_16x16x32_bf16 v[184:187], v[80:83], a[136:139], v[184:187]
    ds_read_b64_tr_b16 v[76:77], v16 offset:28672
    s_add_u32 s71, s75, 131072
    v_mfma_f32_16x16x32_bf16 v[184:187], v[84:87], a[152:155], v[184:187]
    ds_read_b64_tr_b16 v[78:79], v16 offset:29184
    v_add_f32_dpp v117, v117, v117 quad_perm:[1,0,3,2] row_mask:0xf bank_mask:0xf
    v_mfma_f32_16x16x32_bf16 v[184:187], v[88:91], a[168:171], v[184:187]
    buffer_load_dwordx4 v12, s[16:19], s71 offen lds
    v_mfma_f32_16x16x32_bf16 v[184:187], v[92:95], a[184:187], v[184:187]
    s_add_u32 m0, s61, 3072
    s_add_u32 s71, s75, 196608
    v_mfma_f32_16x16x32_bf16 v[188:191], v[80:83], a[140:143], v[188:191]
    s_nop 0
    v_add_f32_dpp v116, v116, v116 quad_perm:[2,3,0,1] row_mask:0xf bank_mask:0xf
    v_mfma_f32_16x16x32_bf16 v[188:191], v[84:87], a[156:159], v[188:191]
    v_add_f32_dpp v117, v117, v117 quad_perm:[2,3,0,1] row_mask:0xf bank_mask:0xf
    s_nop 0
    v_mfma_f32_16x16x32_bf16 v[188:191], v[88:91], a[172:175], v[188:191]
    buffer_load_dwordx4 v13, s[16:19], s71 offen lds
    v_mfma_f32_16x16x32_bf16 v[188:191], v[92:95], a[188:191], v[188:191]
    v_add_f32_dpp v116, v116, v116 row_half_mirror row_mask:0xf bank_mask:0xf
    v_add_f32_dpp v117, v117, v117 row_half_mirror row_mask:0xf bank_mask:0xf
    s_waitcnt lgkmcnt(0)
    v_mfma_f32_16x16x32_bf16 v[192:195], v[64:67], a[128:131], v[192:195]
    ds_read_b64_tr_b16 v[80:81], v17 offset:16384
    s_nop 0
    v_mfma_f32_16x16x32_bf16 v[192:195], v[68:71], a[144:147], v[192:195]
    ds_read_b64_tr_b16 v[82:83], v17 offset:16896
    v_add_f32_dpp v116, v116, v116 row_mirror row_mask:0xf bank_mask:0xf
    v_mfma_f32_16x16x32_bf16 v[192:195], v[72:75], a[160:163], v[192:195]
    ds_read_b64_tr_b16 v[84:85], v17 offset:20480
    v_add_f32_dpp v117, v117, v117 row_mirror row_mask:0xf bank_mask:0xf
    v_mfma_f32_16x16x32_bf16 v[192:195], v[76:79], a[176:179], v[192:195]
    ds_read_b64_tr_b16 v[86:87], v17 offset:20992
    v_mov_b32 v118, v116
    v_mfma_f32_16x16x32_bf16 v[196:199], v[64:67], a[132:135], v[196:199]
    ds_read_b64_tr_b16 v[88:89], v17 offset:24576
    v_mov_b32 v119, v117
    v_mfma_f32_16x16x32_bf16 v[196:199], v[68:71], a[148:151], v[196:199]
    ds_read_b64_tr_b16 v[90:91], v17 offset:25088
    s_nop 0
    v_mfma_f32_16x16x32_bf16 v[196:199], v[72:75], a[164:167], v[196:199]
    ds_read_b64_tr_b16 v[92:93], v17 offset:28672
    v_permlane16_swap_b32 v116, v118
    v_mfma_f32_16x16x32_bf16 v[196:199], v[76:79], a[180:183], v[196:199]
    ds_read_b64_tr_b16 v[94:95], v17 offset:29184
    v_permlane16_swap_b32 v117, v119
    v_mfma_f32_16x16x32_bf16 v[200:203], v[64:67], a[136:139], v[200:203]
    s_nop 0
    v_add_f32 v116, v116, v118
    v_mfma_f32_16x16x32_bf16 v[200:203], v[68:71], a[152:155], v[200:203]
    v_add_f32 v117, v117, v119
    v_mov_b32 v118, v116
    v_mfma_f32_16x16x32_bf16 v[200:203], v[72:75], a[168:171], v[200:203]
    v_mov_b32 v119, v117
    s_nop 0
    v_mfma_f32_16x16x32_bf16 v[200:203], v[76:79], a[184:187], v[200:203]
    v_permlane32_swap_b32 v116, v118
    v_permlane32_swap_b32 v117, v119
    v_mfma_f32_16x16x32_bf16 v[204:207], v[64:67], a[140:143], v[204:207]
    s_nop 0
    v_add_f32 v116, v116, v118
    v_mfma_f32_16x16x32_bf16 v[204:207], v[68:71], a[156:159], v[204:207]
    v_add_f32 v117, v117, v119
    v_cvt_pk_bf16_f32 v116, v116, v117
    v_mfma_f32_16x16x32_bf16 v[204:207], v[72:75], a[172:175], v[204:207]
    v_and_b32 v117, 0xffff0000, v116
    v_lshlrev_b32 v116, 16, v116
    v_mfma_f32_16x16x32_bf16 v[204:207], v[76:79], a[188:191], v[204:207]
    v_mul_f32 v116, 0xbfb8aa3b, v116
    v_mul_f32 v117, 0xbfb8aa3b, v117
    s_waitcnt lgkmcnt(0)
    v_mfma_f32_16x16x32_bf16 v[208:211], v[80:83], a[128:131], v[208:211]
    ds_read_b64_tr_b16 v[64:65], v18 offset:16384
    s_lshr_b32 s1, s2, 3
    v_mfma_f32_16x16x32_bf16 v[208:211], v[84:87], a[144:147], v[208:211]
    ds_read_b64_tr_b16 v[66:67], v18 offset:16896
    s_lshl_b32 s1, s1, 2
    v_mfma_f32_16x16x32_bf16 v[208:211], v[88:91], a[160:163], v[208:211]
    ds_read_b64_tr_b16 v[68:69], v18 offset:20480
    s_add_u32 s1, s1, s54
    v_mfma_f32_16x16x32_bf16 v[208:211], v[92:95], a[176:179], v[208:211]
    ds_read_b64_tr_b16 v[70:71], v18 offset:20992
    s_lshl_b32 s1, s1, 14
    v_mfma_f32_16x16x32_bf16 v[212:215], v[80:83], a[132:135], v[212:215]
    ds_read_b64_tr_b16 v[72:73], v18 offset:24576
    v_lshrrev_b32 v127, 4, v0
    v_mfma_f32_16x16x32_bf16 v[212:215], v[84:87], a[148:151], v[212:215]
    ds_read_b64_tr_b16 v[74:75], v18 offset:25088
    v_min_u32 v127, 1, v127
    v_mfma_f32_16x16x32_bf16 v[212:215], v[88:91], a[164:167], v[212:215]
    ds_read_b64_tr_b16 v[76:77], v18 offset:28672
    v_lshlrev_b32 v127, 30, v127
    v_mfma_f32_16x16x32_bf16 v[212:215], v[92:95], a[180:183], v[212:215]
    ds_read_b64_tr_b16 v[78:79], v18 offset:29184
    v_lshl_or_b32 v127, v0, 10, v127
    v_mfma_f32_16x16x32_bf16 v[216:219], v[80:83], a[136:139], v[216:219]
    buffer_load_dword v125, v127, s[8:11], s1 offen offset:0
    v_mfma_f32_16x16x32_bf16 v[216:219], v[84:87], a[152:155], v[216:219]
    s_waitcnt vmcnt(18)
    v_exp_f32 v116, v116
    v_mfma_f32_16x16x32_bf16 v[216:219], v[88:91], a[168:171], v[216:219]
    ds_read_b128 a[192:195], v10 offset:0
    v_exp_f32 v117, v117
    v_mfma_f32_16x16x32_bf16 v[216:219], v[92:95], a[184:187], v[216:219]
    ds_read_b128 a[196:199], v10 offset:256
    s_nop 0
    v_mfma_f32_16x16x32_bf16 v[220:223], v[80:83], a[140:143], v[220:223]
    ds_read_b128 a[200:203], v10 offset:512
    v_add_f32 v116, 1.0, v116
    v_mfma_f32_16x16x32_bf16 v[220:223], v[84:87], a[156:159], v[220:223]
    ds_read_b128 a[204:207], v10 offset:768
    v_add_f32 v117, 1.0, v117
    v_mfma_f32_16x16x32_bf16 v[220:223], v[88:91], a[172:175], v[220:223]
    ds_read_b128 a[208:211], v11 offset:0
    v_rcp_f32 v116, v116
    v_mfma_f32_16x16x32_bf16 v[220:223], v[92:95], a[188:191], v[220:223]
    ds_read_b128 a[212:215], v11 offset:256
    v_rcp_f32 v117, v117
    s_waitcnt lgkmcnt(6)
    v_mfma_f32_16x16x32_bf16 v[224:227], v[64:67], a[128:131], v[224:227]
    ds_read_b64_tr_b16 v[80:81], v19 offset:16384
    ds_read_b128 a[216:219], v11 offset:512
    v_mfma_f32_16x16x32_bf16 v[224:227], v[68:71], a[144:147], v[224:227]
    ds_read_b64_tr_b16 v[82:83], v19 offset:16896
    ds_read_b128 a[220:223], v11 offset:768
    v_mfma_f32_16x16x32_bf16 v[224:227], v[72:75], a[160:163], v[224:227]
    ds_read_b64_tr_b16 v[84:85], v19 offset:20480
    s_waitcnt vmcnt(5)
    v_mfma_f32_16x16x32_bf16 v[224:227], v[76:79], a[176:179], v[224:227]
    ds_read_b64_tr_b16 v[86:87], v19 offset:20992
    ds_read_b128 a[224:227], v10 offset:8192
    v_mfma_f32_16x16x32_bf16 v[228:231], v[64:67], a[132:135], v[228:231]
    ds_read_b64_tr_b16 v[88:89], v19 offset:24576
    ds_read_b128 a[228:231], v10 offset:8448
    v_mfma_f32_16x16x32_bf16 v[228:231], v[68:71], a[148:151], v[228:231]
    ds_read_b64_tr_b16 v[90:91], v19 offset:25088
    ds_read_b128 a[232:235], v10 offset:8704
    v_mfma_f32_16x16x32_bf16 v[228:231], v[72:75], a[164:167], v[228:231]
    ds_read_b64_tr_b16 v[92:93], v19 offset:28672
    ds_read_b128 a[236:239], v10 offset:8960
    v_mfma_f32_16x16x32_bf16 v[228:231], v[76:79], a[180:183], v[228:231]
    ds_read_b64_tr_b16 v[94:95], v19 offset:29184
    ds_read_b128 a[240:243], v11 offset:8192
    v_mfma_f32_16x16x32_bf16 v[232:235], v[64:67], a[136:139], v[232:235]
    ds_read_b128 a[244:247], v11 offset:8448
    s_nop 0
    v_mfma_f32_16x16x32_bf16 v[232:235], v[68:71], a[152:155], v[232:235]
    ds_read_b128 a[248:251], v11 offset:8704
    v_cvt_pk_bf16_f32 v116, v116, v117
    v_mfma_f32_16x16x32_bf16 v[232:235], v[72:75], a[168:171], v[232:235]
    ds_read_b128 a[252:255], v11 offset:8960
    v_and_b32 v117, 0xffff0000, v116
    v_mfma_f32_16x16x32_bf16 v[232:235], v[76:79], a[184:187], v[232:235]
    v_lshlrev_b32 v116, 16, v116
    v_mov_b32 v118, 0x40000000
    v_mfma_f32_16x16x32_bf16 v[236:239], v[64:67], a[140:143], v[236:239]
    v_cmp_eq_u32 vcc, 0, v0
    s_lshl_b32 s97, s95, 2
    v_mfma_f32_16x16x32_bf16 v[236:239], v[68:71], a[156:159], v[236:239]
    s_add_u32 s97, s97, 61603840
    v_cndmask_b32 v118, v118, v0, vcc
    v_mfma_f32_16x16x32_bf16 v[236:239], v[72:75], a[172:175], v[236:239]
    v_mfma_f32_16x16x32_bf16 v[236:239], v[76:79], a[188:191], v[236:239]
    s_waitcnt lgkmcnt(4)
    s_barrier
    v_mfma_f32_16x16x32_bf16 v[240:243], v[80:83], a[128:131], v[240:243]
    ds_read_b64_tr_b16 v[64:65], v16 offset:32768
    s_add_u32 m0, s61, 16384
    v_mfma_f32_16x16x32_bf16 v[240:243], v[84:87], a[144:147], v[240:243]
    ds_read_b64_tr_b16 v[66:67], v16 offset:33280
    s_add_u32 s71, s75, 128
    v_mfma_f32_16x16x32_bf16 v[240:243], v[88:91], a[160:163], v[240:243]
    buffer_load_dwordx4 v12, s[16:19], s71 offen lds
    v_mfma_f32_16x16x32_bf16 v[240:243], v[92:95], a[176:179], v[240:243]
    ds_read_b64_tr_b16 v[68:69], v16 offset:36864
    s_add_u32 m0, s61, 17408
    v_mfma_f32_16x16x32_bf16 v[244:247], v[80:83], a[132:135], v[244:247]
    ds_read_b64_tr_b16 v[70:71], v16 offset:37376
    s_add_u32 s71, s75, 65664
    v_mfma_f32_16x16x32_bf16 v[244:247], v[84:87], a[148:151], v[244:247]
    ds_read_b64_tr_b16 v[72:73], v16 offset:40960
    v_mfma_f32_16x16x32_bf16 v[244:247], v[88:91], a[164:167], v[244:247]
    buffer_load_dwordx4 v13, s[16:19], s71 offen lds
    v_mfma_f32_16x16x32_bf16 v[244:247], v[92:95], a[180:183], v[244:247]
    ds_read_b64_tr_b16 v[74:75], v16 offset:41472
    s_add_u32 m0, s61, 18432
    v_mfma_f32_16x16x32_bf16 v[248:251], v[80:83], a[136:139], v[248:251]
    ds_read_b64_tr_b16 v[76:77], v16 offset:45056
    s_add_u32 s71, s75, 131200
    v_mfma_f32_16x16x32_bf16 v[248:251], v[84:87], a[152:155], v[248:251]
    ds_read_b64_tr_b16 v[78:79], v16 offset:45568
    v_mfma_f32_16x16x32_bf16 v[248:251], v[88:91], a[168:171], v[248:251]
    buffer_load_dwordx4 v12, s[16:19], s71 offen lds
    v_mfma_f32_16x16x32_bf16 v[248:251], v[92:95], a[184:187], v[248:251]
    s_add_u32 m0, s61, 19456
    s_add_u32 s71, s75, 196736
    v_mfma_f32_16x16x32_bf16 v[252:255], v[80:83], a[140:143], v[252:255]
    v_mfma_f32_16x16x32_bf16 v[252:255], v[84:87], a[156:159], v[252:255]
    v_mfma_f32_16x16x32_bf16 v[252:255], v[88:91], a[172:175], v[252:255]
    buffer_load_dwordx4 v13, s[16:19], s71 offen lds
    v_mfma_f32_16x16x32_bf16 v[252:255], v[92:95], a[188:191], v[252:255]
    s_waitcnt lgkmcnt(0)
    v_mfma_f32_16x16x32_bf16 v[128:131], v[64:67], a[192:195], v[128:131]
    ds_read_b64_tr_b16 v[80:81], v17 offset:32768
    s_lshl_b32 s63, s59, 15
    v_mfma_f32_16x16x32_bf16 v[128:131], v[68:71], a[208:211], v[128:131]
    ds_read_b64_tr_b16 v[82:83], v17 offset:33280
    s_sub_u32 s72, s60, s59
    v_mfma_f32_16x16x32_bf16 v[128:131], v[72:75], a[224:227], v[128:131]
    buffer_store_dwordx2 v[116:117], v118, s[48:51], s97 offen sc1
    v_mfma_f32_16x16x32_bf16 v[128:131], v[76:79], a[240:243], v[128:131]
    ds_read_b64_tr_b16 v[84:85], v17 offset:36864
    s_sub_u32 s72, s72, 1
    v_mfma_f32_16x16x32_bf16 v[132:135], v[64:67], a[196:199], v[132:135]
    ds_read_b64_tr_b16 v[86:87], v17 offset:37376
    s_lshl_b32 s72, s72, 15
    v_mfma_f32_16x16x32_bf16 v[132:135], v[68:71], a[212:215], v[132:135]
    ds_read_b64_tr_b16 v[88:89], v17 offset:40960
    v_lshrrev_b32 v61, 5, v0
    v_mfma_f32_16x16x32_bf16 v[132:135], v[72:75], a[228:231], v[132:135]
    ds_read_b64_tr_b16 v[90:91], v17 offset:41472
    v_mul_lo_u32 v61, s72, v61
    v_mfma_f32_16x16x32_bf16 v[132:135], v[76:79], a[244:247], v[132:135]
    ds_read_b64_tr_b16 v[92:93], v17 offset:45056
    v_add_u32 v2, v2, v61
    v_mfma_f32_16x16x32_bf16 v[136:139], v[64:67], a[200:203], v[136:139]
    ds_read_b64_tr_b16 v[94:95], v17 offset:45568
    v_add_u32 v3, v3, v61
    v_mfma_f32_16x16x32_bf16 v[136:139], v[68:71], a[216:219], v[136:139]
    v_add_u32 v4, v4, v61
    v_add_u32 v5, v5, v61
    v_mfma_f32_16x16x32_bf16 v[136:139], v[72:75], a[232:235], v[136:139]
    v_add_u32 v6, v6, v61
    v_add_u32 v7, v7, v61
    v_mfma_f32_16x16x32_bf16 v[136:139], v[76:79], a[248:251], v[136:139]
    v_add_u32 v8, v8, v61
    v_add_u32 v9, v9, v61
    v_mfma_f32_16x16x32_bf16 v[140:143], v[64:67], a[204:207], v[140:143]
    s_add_u32 s72, s0, 0
    s_and_b32 s72, s72, 3
    v_mfma_f32_16x16x32_bf16 v[140:143], v[68:71], a[220:223], v[140:143]
    s_mul_i32 s72, s72, 256
    s_add_u32 s79, s72, s63
    v_mfma_f32_16x16x32_bf16 v[140:143], v[72:75], a[236:239], v[140:143]
    s_add_u32 s72, s0, 1
    s_and_b32 s72, s72, 3
    v_mfma_f32_16x16x32_bf16 v[140:143], v[76:79], a[252:255], v[140:143]
    s_mul_i32 s72, s72, 256
    s_add_u32 s92, s72, s63
    s_waitcnt lgkmcnt(0)
    v_mfma_f32_16x16x32_bf16 v[144:147], v[80:83], a[192:195], v[144:147]
    buffer_load_dword v125, v127, s[8:11], s1 offen offset:128
    v_mfma_f32_16x16x32_bf16 v[144:147], v[84:87], a[208:211], v[144:147]
    ds_read_b64_tr_b16 v[64:65], v18 offset:32768
    s_add_u32 s72, s0, 2
    v_mfma_f32_16x16x32_bf16 v[144:147], v[88:91], a[224:227], v[144:147]
    ds_read_b64_tr_b16 v[66:67], v18 offset:33280
    s_and_b32 s72, s72, 3
    v_mfma_f32_16x16x32_bf16 v[144:147], v[92:95], a[240:243], v[144:147]
    ds_read_b64_tr_b16 v[68:69], v18 offset:36864
    s_mul_i32 s72, s72, 256
    v_mfma_f32_16x16x32_bf16 v[148:151], v[80:83], a[196:199], v[148:151]
    ds_read_b64_tr_b16 v[70:71], v18 offset:37376
    s_add_u32 s93, s72, s63
    v_mfma_f32_16x16x32_bf16 v[148:151], v[84:87], a[212:215], v[148:151]
    ds_read_b64_tr_b16 v[72:73], v18 offset:40960
    s_add_u32 s72, s0, 3
    v_mfma_f32_16x16x32_bf16 v[148:151], v[88:91], a[228:231], v[148:151]
    ds_read_b64_tr_b16 v[74:75], v18 offset:41472
    s_and_b32 s72, s72, 3
    v_mfma_f32_16x16x32_bf16 v[148:151], v[92:95], a[244:247], v[148:151]
    ds_read_b64_tr_b16 v[76:77], v18 offset:45056
    s_mul_i32 s72, s72, 256
    v_mfma_f32_16x16x32_bf16 v[152:155], v[80:83], a[200:203], v[152:155]
    ds_read_b64_tr_b16 v[78:79], v18 offset:45568
    s_add_u32 s94, s72, s63
    v_mfma_f32_16x16x32_bf16 v[152:155], v[84:87], a[216:219], v[152:155]
    v_mfma_f32_16x16x32_bf16 v[152:155], v[88:91], a[232:235], v[152:155]
    v_mfma_f32_16x16x32_bf16 v[152:155], v[92:95], a[248:251], v[152:155]
    v_mfma_f32_16x16x32_bf16 v[156:159], v[80:83], a[204:207], v[156:159]
    v_mfma_f32_16x16x32_bf16 v[156:159], v[84:87], a[220:223], v[156:159]
    v_mfma_f32_16x16x32_bf16 v[156:159], v[88:91], a[236:239], v[156:159]
    v_mfma_f32_16x16x32_bf16 v[156:159], v[92:95], a[252:255], v[156:159]
    s_waitcnt lgkmcnt(0)
    v_mfma_f32_16x16x32_bf16 v[160:163], v[64:67], a[192:195], v[160:163]
    ds_read_b64_tr_b16 v[80:81], v19 offset:32768
    s_add_u32 m0, s62, 16384
    v_mfma_f32_16x16x32_bf16 v[160:163], v[68:71], a[208:211], v[160:163]
    ds_read_b64_tr_b16 v[82:83], v19 offset:33280
    s_add_u32 s72, s79, 0
    v_mfma_f32_16x16x32_bf16 v[160:163], v[72:75], a[224:227], v[160:163]
    buffer_load_dwordx4 v2, s[8:11], s72 offen offset:0 lds
    v_mfma_f32_16x16x32_bf16 v[160:163], v[76:79], a[240:243], v[160:163]
    ds_read_b64_tr_b16 v[84:85], v19 offset:36864
    v_mul_f32 v128, s73, v128
    v_mfma_f32_16x16x32_bf16 v[164:167], v[64:67], a[196:199], v[164:167]
    ds_read_b64_tr_b16 v[86:87], v19 offset:37376
    v_mul_f32 v129, s73, v129
    v_mfma_f32_16x16x32_bf16 v[164:167], v[68:71], a[212:215], v[164:167]
    ds_read_b64_tr_b16 v[88:89], v19 offset:40960
    v_mul_f32 v130, s73, v130
    v_mfma_f32_16x16x32_bf16 v[164:167], v[72:75], a[228:231], v[164:167]
    buffer_load_dwordx4 v3, s[8:11], s72 offen offset:1024 lds
    v_mfma_f32_16x16x32_bf16 v[164:167], v[76:79], a[244:247], v[164:167]
    ds_read_b64_tr_b16 v[90:91], v19 offset:41472
    v_mul_f32 v131, s73, v131
    v_mfma_f32_16x16x32_bf16 v[168:171], v[64:67], a[200:203], v[168:171]
    ds_read_b64_tr_b16 v[92:93], v19 offset:45056
    v_mul_f32 v144, s73, v144
    v_mfma_f32_16x16x32_bf16 v[168:171], v[68:71], a[216:219], v[168:171]
    ds_read_b64_tr_b16 v[94:95], v19 offset:45568
    v_mul_f32 v145, s73, v145
    v_mfma_f32_16x16x32_bf16 v[168:171], v[72:75], a[232:235], v[168:171]
    buffer_load_dwordx4 v4, s[8:11], s72 offen offset:2048 lds
    v_mfma_f32_16x16x32_bf16 v[168:171], v[76:79], a[248:251], v[168:171]
    v_mul_f32 v146, s73, v146
    v_mul_f32 v147, s73, v147
    v_mfma_f32_16x16x32_bf16 v[172:175], v[64:67], a[204:207], v[172:175]
    v_cvt_pk_bf16_f32 v28, v128, v129
    v_cvt_pk_bf16_f32 v29, v130, v131
    v_mfma_f32_16x16x32_bf16 v[172:175], v[68:71], a[220:223], v[172:175]
    v_cvt_pk_bf16_f32 v30, v144, v145
    v_cvt_pk_bf16_f32 v31, v146, v147
    v_mfma_f32_16x16x32_bf16 v[172:175], v[72:75], a[236:239], v[172:175]
    buffer_load_dwordx4 v5, s[8:11], s72 offen offset:3072 lds
    v_mfma_f32_16x16x32_bf16 v[172:175], v[76:79], a[252:255], v[172:175]
    s_add_u32 m0, s62, 20480
    s_add_u32 s72, s79, 4096
    s_waitcnt lgkmcnt(0)
    s_barrier
    v_mfma_f32_16x16x32_bf16 v[176:179], v[80:83], a[192:195], v[176:179]
    ds_read_b64_tr_b16 v[64:65], v16 offset:49152
    v_mul_f32 v132, s73, v132
    v_mfma_f32_16x16x32_bf16 v[176:179], v[84:87], a[208:211], v[176:179]
    ds_read_b64_tr_b16 v[66:67], v16 offset:49664
    v_mul_f32 v133, s73, v133
    v_mfma_f32_16x16x32_bf16 v[176:179], v[88:91], a[224:227], v[176:179]
    buffer_load_dwordx4 v6, s[8:11], s72 offen offset:0 lds
    v_mfma_f32_16x16x32_bf16 v[176:179], v[92:95], a[240:243], v[176:179]
    ds_read_b64_tr_b16 v[68:69], v16 offset:53248
    v_mul_f32 v134, s73, v134
    v_mfma_f32_16x16x32_bf16 v[180:183], v[80:83], a[196:199], v[180:183]
    ds_read_b64_tr_b16 v[70:71], v16 offset:53760
    v_mul_f32 v135, s73, v135
    v_mfma_f32_16x16x32_bf16 v[180:183], v[84:87], a[212:215], v[180:183]
    ds_read_b64_tr_b16 v[72:73], v16 offset:57344
    v_mul_f32 v148, s73, v148
    v_mfma_f32_16x16x32_bf16 v[180:183], v[88:91], a[228:231], v[180:183]
    buffer_load_dwordx4 v7, s[8:11], s72 offen offset:1024 lds
    v_mfma_f32_16x16x32_bf16 v[180:183], v[92:95], a[244:247], v[180:183]
    ds_read_b64_tr_b16 v[74:75], v16 offset:57856
    v_mul_f32 v149, s73, v149
    v_mfma_f32_16x16x32_bf16 v[184:187], v[80:83], a[200:203], v[184:187]
    ds_read_b64_tr_b16 v[76:77], v16 offset:61440
    v_mul_f32 v150, s73, v150
    v_mfma_f32_16x16x32_bf16 v[184:187], v[84:87], a[216:219], v[184:187]
    ds_read_b64_tr_b16 v[78:79], v16 offset:61952
    v_mul_f32 v151, s73, v151
    v_mfma_f32_16x16x32_bf16 v[184:187], v[88:91], a[232:235], v[184:187]
    buffer_load_dwordx4 v8, s[8:11], s72 offen offset:2048 lds
    v_mfma_f32_16x16x32_bf16 v[184:187], v[92:95], a[248:251], v[184:187]
    v_cvt_pk_bf16_f32 v32, v132, v133
    v_cvt_pk_bf16_f32 v33, v134, v135
    v_mfma_f32_16x16x32_bf16 v[188:191], v[80:83], a[204:207], v[188:191]
    v_cvt_pk_bf16_f32 v34, v148, v149
    v_cvt_pk_bf16_f32 v35, v150, v151
    v_mfma_f32_16x16x32_bf16 v[188:191], v[84:87], a[220:223], v[188:191]
    v_mul_f32 v136, s73, v136
    v_mul_f32 v137, s73, v137
    v_mfma_f32_16x16x32_bf16 v[188:191], v[88:91], a[236:239], v[188:191]
    buffer_load_dwordx4 v9, s[8:11], s72 offen offset:3072 lds
    v_mfma_f32_16x16x32_bf16 v[188:191], v[92:95], a[252:255], v[188:191]
    s_add_u32 m0, s61, 32768
    s_add_u32 s71, s98, 0
    s_waitcnt lgkmcnt(0)
    v_mfma_f32_16x16x32_bf16 v[192:195], v[64:67], a[192:195], v[192:195]
    ds_read_b64_tr_b16 v[80:81], v17 offset:49152
    v_mul_f32 v138, s73, v138
    v_mfma_f32_16x16x32_bf16 v[192:195], v[68:71], a[208:211], v[192:195]
    ds_read_b64_tr_b16 v[82:83], v17 offset:49664
    v_mul_f32 v139, s73, v139
    v_mfma_f32_16x16x32_bf16 v[192:195], v[72:75], a[224:227], v[192:195]
    buffer_load_dwordx4 v12, s[16:19], s71 offen lds
    v_mfma_f32_16x16x32_bf16 v[192:195], v[76:79], a[240:243], v[192:195]
    ds_read_b64_tr_b16 v[84:85], v17 offset:53248
    s_add_u32 m0, s61, 33792
    v_mfma_f32_16x16x32_bf16 v[196:199], v[64:67], a[196:199], v[196:199]
    ds_read_b64_tr_b16 v[86:87], v17 offset:53760
    s_add_u32 s71, s98, 65536
    v_mfma_f32_16x16x32_bf16 v[196:199], v[68:71], a[212:215], v[196:199]
    ds_read_b64_tr_b16 v[88:89], v17 offset:57344
    v_mul_f32 v152, s73, v152
    v_mfma_f32_16x16x32_bf16 v[196:199], v[72:75], a[228:231], v[196:199]
    buffer_load_dwordx4 v13, s[16:19], s71 offen lds
    v_mfma_f32_16x16x32_bf16 v[196:199], v[76:79], a[244:247], v[196:199]
    ds_read_b64_tr_b16 v[90:91], v17 offset:57856
    s_add_u32 m0, s61, 34816
    v_mfma_f32_16x16x32_bf16 v[200:203], v[64:67], a[200:203], v[200:203]
    ds_read_b64_tr_b16 v[92:93], v17 offset:61440
    s_add_u32 s71, s98, 131072
    v_mfma_f32_16x16x32_bf16 v[200:203], v[68:71], a[216:219], v[200:203]
    ds_read_b64_tr_b16 v[94:95], v17 offset:61952
    v_mul_f32 v153, s73, v153
    v_mfma_f32_16x16x32_bf16 v[200:203], v[72:75], a[232:235], v[200:203]
    buffer_load_dwordx4 v12, s[16:19], s71 offen lds
    v_mfma_f32_16x16x32_bf16 v[200:203], v[76:79], a[248:251], v[200:203]
    s_add_u32 m0, s61, 35840
    s_add_u32 s71, s98, 196608
    v_mfma_f32_16x16x32_bf16 v[204:207], v[64:67], a[204:207], v[204:207]
    v_mul_f32 v154, s73, v154
    v_mul_f32 v155, s73, v155
    v_mfma_f32_16x16x32_bf16 v[204:207], v[68:71], a[220:223], v[204:207]
    v_cvt_pk_bf16_f32 v36, v136, v137
    v_cvt_pk_bf16_f32 v37, v138, v139
    v_mfma_f32_16x16x32_bf16 v[204:207], v[72:75], a[236:239], v[204:207]
    buffer_load_dwordx4 v13, s[16:19], s71 offen lds
    v_mfma_f32_16x16x32_bf16 v[204:207], v[76:79], a[252:255], v[204:207]
    v_cvt_pk_bf16_f32 v38, v152, v153
    v_cvt_pk_bf16_f32 v39, v154, v155
    s_waitcnt lgkmcnt(0)
    v_mfma_f32_16x16x32_bf16 v[208:211], v[80:83], a[192:195], v[208:211]
    ds_read_b64_tr_b16 v[64:65], v18 offset:49152
    v_mul_f32 v140, s73, v140
    v_mfma_f32_16x16x32_bf16 v[208:211], v[84:87], a[208:211], v[208:211]
    ds_read_b64_tr_b16 v[66:67], v18 offset:49664
    v_mul_f32 v141, s73, v141
    v_mfma_f32_16x16x32_bf16 v[208:211], v[88:91], a[224:227], v[208:211]
    buffer_load_dword v125, v127, s[8:11], s1 offen offset:256
    v_mfma_f32_16x16x32_bf16 v[208:211], v[92:95], a[240:243], v[208:211]
    ds_read_b64_tr_b16 v[68:69], v18 offset:53248
    v_mul_f32 v142, s73, v142
    v_mfma_f32_16x16x32_bf16 v[212:215], v[80:83], a[196:199], v[212:215]
    ds_read_b64_tr_b16 v[70:71], v18 offset:53760
    v_mul_f32 v143, s73, v143
    v_mfma_f32_16x16x32_bf16 v[212:215], v[84:87], a[212:215], v[212:215]
    ds_read_b64_tr_b16 v[72:73], v18 offset:57344
    v_mul_f32 v156, s73, v156
    v_mfma_f32_16x16x32_bf16 v[212:215], v[88:91], a[228:231], v[212:215]
    ds_read_b64_tr_b16 v[74:75], v18 offset:57856
    v_mul_f32 v157, s73, v157
    v_mfma_f32_16x16x32_bf16 v[212:215], v[92:95], a[244:247], v[212:215]
    ds_read_b64_tr_b16 v[76:77], v18 offset:61440
    v_mul_f32 v158, s73, v158
    v_mfma_f32_16x16x32_bf16 v[216:219], v[80:83], a[200:203], v[216:219]
    ds_read_b64_tr_b16 v[78:79], v18 offset:61952
    v_mul_f32 v159, s73, v159
    v_mfma_f32_16x16x32_bf16 v[216:219], v[84:87], a[216:219], v[216:219]
    v_cvt_pk_bf16_f32 v40, v140, v141
    v_cvt_pk_bf16_f32 v41, v142, v143
    v_mfma_f32_16x16x32_bf16 v[216:219], v[88:91], a[232:235], v[216:219]
    v_cvt_pk_bf16_f32 v42, v156, v157
    v_cvt_pk_bf16_f32 v43, v158, v159
    v_mfma_f32_16x16x32_bf16 v[216:219], v[92:95], a[248:251], v[216:219]
    v_mul_f32 v160, s73, v160
    v_mul_f32 v161, s73, v161
    v_mfma_f32_16x16x32_bf16 v[220:223], v[80:83], a[204:207], v[220:223]
    v_mul_f32 v162, s73, v162
    v_mul_f32 v163, s73, v163
    v_mfma_f32_16x16x32_bf16 v[220:223], v[84:87], a[220:223], v[220:223]
    v_mul_f32 v176, s73, v176
    v_mul_f32 v177, s73, v177
    v_mfma_f32_16x16x32_bf16 v[220:223], v[88:91], a[236:239], v[220:223]
    v_mul_f32 v178, s73, v178
    v_mul_f32 v179, s73, v179
    v_mfma_f32_16x16x32_bf16 v[220:223], v[92:95], a[252:255], v[220:223]
    v_cvt_pk_bf16_f32 v44, v160, v161
    v_cvt_pk_bf16_f32 v45, v162, v163
    s_waitcnt lgkmcnt(0)
    v_mfma_f32_16x16x32_bf16 v[224:227], v[64:67], a[192:195], v[224:227]
    ds_read_b64_tr_b16 v[80:81], v19 offset:49152
    v_cvt_pk_bf16_f32 v46, v176, v177
    v_mfma_f32_16x16x32_bf16 v[224:227], v[68:71], a[208:211], v[224:227]
    ds_read_b64_tr_b16 v[82:83], v19 offset:49664
    v_cvt_pk_bf16_f32 v47, v178, v179
    v_mfma_f32_16x16x32_bf16 v[224:227], v[72:75], a[224:227], v[224:227]
    ds_read_b64_tr_b16 v[84:85], v19 offset:53248
    v_mul_f32 v164, s73, v164
    v_mfma_f32_16x16x32_bf16 v[224:227], v[76:79], a[240:243], v[224:227]
    ds_read_b64_tr_b16 v[86:87], v19 offset:53760
    v_mul_f32 v165, s73, v165
    v_mfma_f32_16x16x32_bf16 v[228:231], v[64:67], a[196:199], v[228:231]
    ds_read_b64_tr_b16 v[88:89], v19 offset:57344
    v_mul_f32 v166, s73, v166
    v_mfma_f32_16x16x32_bf16 v[228:231], v[68:71], a[212:215], v[228:231]
    ds_read_b64_tr_b16 v[90:91], v19 offset:57856
    v_mul_f32 v167, s73, v167
    v_mfma_f32_16x16x32_bf16 v[228:231], v[72:75], a[228:231], v[228:231]
    ds_read_b64_tr_b16 v[92:93], v19 offset:61440
    v_mul_f32 v180, s73, v180
    v_mfma_f32_16x16x32_bf16 v[228:231], v[76:79], a[244:247], v[228:231]
    ds_read_b64_tr_b16 v[94:95], v19 offset:61952
    v_mul_f32 v181, s73, v181
    v_mfma_f32_16x16x32_bf16 v[232:235], v[64:67], a[200:203], v[232:235]
    v_mul_f32 v182, s73, v182
    v_mul_f32 v183, s73, v183
    v_mfma_f32_16x16x32_bf16 v[232:235], v[68:71], a[216:219], v[232:235]
    v_cvt_pk_bf16_f32 v48, v164, v165
    v_cvt_pk_bf16_f32 v49, v166, v167
    v_mfma_f32_16x16x32_bf16 v[232:235], v[72:75], a[232:235], v[232:235]
    v_cvt_pk_bf16_f32 v50, v180, v181
    v_cvt_pk_bf16_f32 v51, v182, v183
    v_mfma_f32_16x16x32_bf16 v[232:235], v[76:79], a[248:251], v[232:235]
    v_mul_f32 v168, s73, v168
    v_mul_f32 v169, s73, v169
    v_mfma_f32_16x16x32_bf16 v[236:239], v[64:67], a[204:207], v[236:239]
    v_mul_f32 v170, s73, v170
    v_mul_f32 v171, s73, v171
    v_mfma_f32_16x16x32_bf16 v[236:239], v[68:71], a[220:223], v[236:239]
    v_mul_f32 v184, s73, v184
    v_mul_f32 v185, s73, v185
    v_mfma_f32_16x16x32_bf16 v[236:239], v[72:75], a[236:239], v[236:239]
    v_mul_f32 v186, s73, v186
    v_mul_f32 v187, s73, v187
    v_mfma_f32_16x16x32_bf16 v[236:239], v[76:79], a[252:255], v[236:239]
    v_cvt_pk_bf16_f32 v52, v168, v169
    v_cvt_pk_bf16_f32 v53, v170, v171
    s_waitcnt lgkmcnt(0)
    s_waitcnt vmcnt(20)
    s_barrier
    v_mfma_f32_16x16x32_bf16 v[240:243], v[80:83], a[192:195], v[240:243]
    ds_read_b64_tr_b16 v[64:65], v16 offset:0
    s_add_u32 m0, s61, 49152
    v_mfma_f32_16x16x32_bf16 v[240:243], v[84:87], a[208:211], v[240:243]
    ds_read_b64_tr_b16 v[66:67], v16 offset:512
    s_add_u32 s71, s98, 128
    v_mfma_f32_16x16x32_bf16 v[240:243], v[88:91], a[224:227], v[240:243]
    buffer_load_dwordx4 v12, s[16:19], s71 offen lds
    v_mfma_f32_16x16x32_bf16 v[240:243], v[92:95], a[240:243], v[240:243]
    ds_read_b64_tr_b16 v[68:69], v16 offset:4096
    s_add_u32 m0, s61, 50176
    v_mfma_f32_16x16x32_bf16 v[244:247], v[80:83], a[196:199], v[244:247]
    ds_read_b64_tr_b16 v[70:71], v16 offset:4608
    s_add_u32 s71, s98, 65664
    v_mfma_f32_16x16x32_bf16 v[244:247], v[84:87], a[212:215], v[244:247]
    ds_read_b64_tr_b16 v[72:73], v16 offset:8192
    s_lshr_b32 s90, s2, 3
    v_mfma_f32_16x16x32_bf16 v[244:247], v[88:91], a[228:231], v[244:247]
    buffer_load_dwordx4 v13, s[16:19], s71 offen lds
    v_mfma_f32_16x16x32_bf16 v[244:247], v[92:95], a[244:247], v[244:247]
    ds_read_b64_tr_b16 v[74:75], v16 offset:8704
    s_add_u32 m0, s61, 51200
    v_mfma_f32_16x16x32_bf16 v[248:251], v[80:83], a[200:203], v[248:251]
    ds_read_b64_tr_b16 v[76:77], v16 offset:12288
    s_add_u32 s71, s98, 131200
    v_mfma_f32_16x16x32_bf16 v[248:251], v[84:87], a[216:219], v[248:251]
    ds_read_b64_tr_b16 v[78:79], v16 offset:12800
    s_lshl_b32 s90, s90, 2
    v_mfma_f32_16x16x32_bf16 v[248:251], v[88:91], a[232:235], v[248:251]
    buffer_load_dwordx4 v12, s[16:19], s71 offen lds
    v_mfma_f32_16x16x32_bf16 v[248:251], v[92:95], a[248:251], v[248:251]
    s_add_u32 m0, s61, 52224
    s_add_u32 s71, s98, 196736
    v_mfma_f32_16x16x32_bf16 v[252:255], v[80:83], a[204:207], v[252:255]
    s_add_u32 s90, s90, s54
    s_lshl_b32 s90, s90, 15
    v_mfma_f32_16x16x32_bf16 v[252:255], v[84:87], a[220:223], v[252:255]
    s_lshr_b32 s91, s52, 2
    s_lshl_b32 s91, s91, 10
    v_mfma_f32_16x16x32_bf16 v[252:255], v[88:91], a[236:239], v[252:255]
    buffer_load_dwordx4 v13, s[16:19], s71 offen lds
    v_mfma_f32_16x16x32_bf16 v[252:255], v[92:95], a[252:255], v[252:255]
    s_add_u32 s90, s90, s91
    v_lshrrev_b32 v124, 5, v0
    s_waitcnt lgkmcnt(0)
    v_mfma_f32_16x16x32_bf16 v[128:131], a[0:3], v[64:67], 0
    ds_read_b64_tr_b16 v[80:81], v17 offset:0
    v_min_u32 v124, 1, v124
    v_mfma_f32_16x16x32_bf16 v[128:131], a[16:19], v[68:71], v[128:131]
    ds_read_b64_tr_b16 v[82:83], v17 offset:512
    v_lshlrev_b32 v124, 30, v124
    v_mfma_f32_16x16x32_bf16 v[128:131], a[32:35], v[72:75], v[128:131]
    ds_read_b64_tr_b16 v[84:85], v17 offset:4096
    v_lshl_or_b32 v124, v0, 10, v124
    v_mfma_f32_16x16x32_bf16 v[128:131], a[48:51], v[76:79], v[128:131]
    ds_read_b64_tr_b16 v[86:87], v17 offset:4608
    v_and_b32 v126, 7, v0
    v_mfma_f32_16x16x32_bf16 v[132:135], a[4:7], v[64:67], 0
    ds_read_b64_tr_b16 v[88:89], v17 offset:8192
    v_mul_u32_u24 v126, 896, v126
    v_mfma_f32_16x16x32_bf16 v[132:135], a[20:23], v[68:71], v[132:135]
    ds_read_b64_tr_b16 v[90:91], v17 offset:8704
    v_sub_u32 v124, v124, v126
    v_mfma_f32_16x16x32_bf16 v[132:135], a[36:39], v[72:75], v[132:135]
    buffer_load_dword v125, v124, s[20:23], s90 offen offset:0
    v_mfma_f32_16x16x32_bf16 v[132:135], a[52:55], v[76:79], v[132:135]
    ds_read_b64_tr_b16 v[92:93], v17 offset:12288
    s_add_u32 m0, s62, 0
    v_mfma_f32_16x16x32_bf16 v[136:139], a[8:11], v[64:67], 0
    ds_read_b64_tr_b16 v[94:95], v17 offset:12800
    s_add_u32 s72, s79, 128
    v_mfma_f32_16x16x32_bf16 v[136:139], a[24:27], v[68:71], v[136:139]
    v_cvt_pk_bf16_f32 v54, v184, v185
    v_cvt_pk_bf16_f32 v55, v186, v187
    v_mfma_f32_16x16x32_bf16 v[136:139], a[40:43], v[72:75], v[136:139]
    buffer_load_dwordx4 v2, s[8:11], s72 offen offset:0 lds
    v_mfma_f32_16x16x32_bf16 v[136:139], a[56:59], v[76:79], v[136:139]
    v_mul_f32 v172, s73, v172
    v_mul_f32 v173, s73, v173
    v_mfma_f32_16x16x32_bf16 v[140:143], a[12:15], v[64:67], 0
    v_mul_f32 v174, s73, v174
    v_mul_f32 v175, s73, v175
    v_mfma_f32_16x16x32_bf16 v[140:143], a[28:31], v[68:71], v[140:143]
    v_mul_f32 v188, s73, v188
    v_mul_f32 v189, s73, v189
    v_mfma_f32_16x16x32_bf16 v[140:143], a[44:47], v[72:75], v[140:143]
    buffer_load_dwordx4 v3, s[8:11], s72 offen offset:1024 lds
    v_mfma_f32_16x16x32_bf16 v[140:143], a[60:63], v[76:79], v[140:143]
    v_mul_f32 v190, s73, v190
    v_mul_f32 v191, s73, v191
    s_waitcnt lgkmcnt(0)
    v_mfma_f32_16x16x32_bf16 v[144:147], a[0:3], v[80:83], 0
    ds_read_b64_tr_b16 v[64:65], v18 offset:0
    v_cvt_pk_bf16_f32 v56, v172, v173
    v_mfma_f32_16x16x32_bf16 v[144:147], a[16:19], v[84:87], v[144:147]
    ds_read_b64_tr_b16 v[66:67], v18 offset:512
    v_cvt_pk_bf16_f32 v57, v174, v175
    v_mfma_f32_16x16x32_bf16 v[144:147], a[32:35], v[88:91], v[144:147]
    buffer_load_dwordx4 v4, s[8:11], s72 offen offset:2048 lds
    v_mfma_f32_16x16x32_bf16 v[144:147], a[48:51], v[92:95], v[144:147]
    ds_read_b64_tr_b16 v[68:69], v18 offset:4096
    v_cvt_pk_bf16_f32 v58, v188, v189
    v_mfma_f32_16x16x32_bf16 v[148:151], a[4:7], v[80:83], 0
    ds_read_b64_tr_b16 v[70:71], v18 offset:4608
    v_cvt_pk_bf16_f32 v59, v190, v191
    v_mfma_f32_16x16x32_bf16 v[148:151], a[20:23], v[84:87], v[148:151]
    ds_read_b64_tr_b16 v[72:73], v18 offset:8192
    v_mul_f32 v192, s73, v192
    v_mfma_f32_16x16x32_bf16 v[148:151], a[36:39], v[88:91], v[148:151]
    buffer_load_dwordx4 v5, s[8:11], s72 offen offset:3072 lds
    v_mfma_f32_16x16x32_bf16 v[148:151], a[52:55], v[92:95], v[148:151]
    ds_read_b64_tr_b16 v[74:75], v18 offset:8704
    s_add_u32 m0, s62, 4096
    v_mfma_f32_16x16x32_bf16 v[152:155], a[8:11], v[80:83], 0
    ds_read_b64_tr_b16 v[76:77], v18 offset:12288
    s_add_u32 s72, s79, 4224
    v_mfma_f32_16x16x32_bf16 v[152:155], a[24:27], v[84:87], v[152:155]
    ds_read_b64_tr_b16 v[78:79], v18 offset:12800
    v_mul_f32 v193, s73, v193
    v_mfma_f32_16x16x32_bf16 v[152:155], a[40:43], v[88:91], v[152:155]
    buffer_load_dwordx4 v6, s[8:11], s72 offen offset:0 lds
    v_mfma_f32_16x16x32_bf16 v[152:155], a[56:59], v[92:95], v[152:155]
    v_mul_f32 v194, s73, v194
    v_mul_f32 v195, s73, v195
    v_mfma_f32_16x16x32_bf16 v[156:159], a[12:15], v[80:83], 0
    v_mul_f32 v208, s73, v208
    v_mul_f32 v209, s73, v209
    v_mfma_f32_16x16x32_bf16 v[156:159], a[28:31], v[84:87], v[156:159]
    v_mul_f32 v210, s73, v210
    v_mul_f32 v211, s73, v211
    v_mfma_f32_16x16x32_bf16 v[156:159], a[44:47], v[88:91], v[156:159]
    buffer_load_dwordx4 v7, s[8:11], s72 offen offset:1024 lds
    v_mfma_f32_16x16x32_bf16 v[156:159], a[60:63], v[92:95], v[156:159]
    v_cvt_pk_bf16_f32 v96, v192, v193
    v_cvt_pk_bf16_f32 v97, v194, v195
    s_waitcnt lgkmcnt(0)
    v_mfma_f32_16x16x32_bf16 v[160:163], a[0:3], v[64:67], 0
    ds_read_b64_tr_b16 v[80:81], v19 offset:0
    v_cvt_pk_bf16_f32 v98, v208, v209
    v_mfma_f32_16x16x32_bf16 v[160:163], a[16:19], v[68:71], v[160:163]
    ds_read_b64_tr_b16 v[82:83], v19 offset:512
    v_cvt_pk_bf16_f32 v99, v210, v211
    v_mfma_f32_16x16x32_bf16 v[160:163], a[32:35], v[72:75], v[160:163]
    buffer_load_dwordx4 v8, s[8:11], s72 offen offset:2048 lds
    v_mfma_f32_16x16x32_bf16 v[160:163], a[48:51], v[76:79], v[160:163]
    ds_read_b64_tr_b16 v[84:85], v19 offset:4096
    v_mul_f32 v196, s73, v196
    v_mfma_f32_16x16x32_bf16 v[164:167], a[4:7], v[64:67], 0
    ds_read_b64_tr_b16 v[86:87], v19 offset:4608
    v_mul_f32 v197, s73, v197
    v_mfma_f32_16x16x32_bf16 v[164:167], a[20:23], v[68:71], v[164:167]
    ds_read_b64_tr_b16 v[88:89], v19 offset:8192
    v_mul_f32 v198, s73, v198
    v_mfma_f32_16x16x32_bf16 v[164:167], a[36:39], v[72:75], v[164:167]
    buffer_load_dwordx4 v9, s[8:11], s72 offen offset:3072 lds
    v_mfma_f32_16x16x32_bf16 v[164:167], a[52:55], v[76:79], v[164:167]
    ds_read_b64_tr_b16 v[90:91], v19 offset:8704
    v_mul_f32 v199, s73, v199
    v_mfma_f32_16x16x32_bf16 v[168:171], a[8:11], v[64:67], 0
    ds_read_b64_tr_b16 v[92:93], v19 offset:12288
    v_mul_f32 v212, s73, v212
    v_mfma_f32_16x16x32_bf16 v[168:171], a[24:27], v[68:71], v[168:171]
    ds_read_b64_tr_b16 v[94:95], v19 offset:12800
    v_mul_f32 v213, s73, v213
    v_mfma_f32_16x16x32_bf16 v[168:171], a[40:43], v[72:75], v[168:171]
    v_mul_f32 v214, s73, v214
    v_mul_f32 v215, s73, v215
    v_mfma_f32_16x16x32_bf16 v[168:171], a[56:59], v[76:79], v[168:171]
    v_cvt_pk_bf16_f32 v100, v196, v197
    v_cvt_pk_bf16_f32 v101, v198, v199
    v_mfma_f32_16x16x32_bf16 v[172:175], a[12:15], v[64:67], 0
    v_cvt_pk_bf16_f32 v102, v212, v213
    v_cvt_pk_bf16_f32 v103, v214, v215
    v_mfma_f32_16x16x32_bf16 v[172:175], a[28:31], v[68:71], v[172:175]
    v_mul_f32 v200, s73, v200
    v_mul_f32 v201, s73, v201
    v_mfma_f32_16x16x32_bf16 v[172:175], a[44:47], v[72:75], v[172:175]
    v_mul_f32 v202, s73, v202
    v_mul_f32 v203, s73, v203
    v_mfma_f32_16x16x32_bf16 v[172:175], a[60:63], v[76:79], v[172:175]
    v_mul_f32 v216, s73, v216
    v_mul_f32 v217, s73, v217
    s_waitcnt lgkmcnt(0)
    s_waitcnt vmcnt(28)
    s_barrier
    v_mfma_f32_16x16x32_bf16 v[176:179], a[0:3], v[80:83], 0
    ds_read_b64_tr_b16 v[64:65], v16 offset:16384
    s_add_u32 m0, s61, 0
    v_mfma_f32_16x16x32_bf16 v[176:179], a[16:19], v[84:87], v[176:179]
    ds_read_b64_tr_b16 v[66:67], v16 offset:16896
    s_add_u32 s71, s99, 0
    v_mfma_f32_16x16x32_bf16 v[176:179], a[32:35], v[88:91], v[176:179]
    buffer_load_dwordx4 v12, s[16:19], s71 offen lds
    v_mfma_f32_16x16x32_bf16 v[176:179], a[48:51], v[92:95], v[176:179]
    ds_read_b64_tr_b16 v[68:69], v16 offset:20480
    s_add_u32 m0, s61, 1024
    v_mfma_f32_16x16x32_bf16 v[180:183], a[4:7], v[80:83], 0
    ds_read_b64_tr_b16 v[70:71], v16 offset:20992
    s_add_u32 s71, s99, 65536
    v_mfma_f32_16x16x32_bf16 v[180:183], a[20:23], v[84:87], v[180:183]
    ds_read_b64_tr_b16 v[72:73], v16 offset:24576
    v_mul_f32 v218, s73, v218
    v_mfma_f32_16x16x32_bf16 v[180:183], a[36:39], v[88:91], v[180:183]
    buffer_load_dwordx4 v13, s[16:19], s71 offen lds
    v_mfma_f32_16x16x32_bf16 v[180:183], a[52:55], v[92:95], v[180:183]
    ds_read_b64_tr_b16 v[74:75], v16 offset:25088
    s_add_u32 m0, s61, 2048
    v_mfma_f32_16x16x32_bf16 v[184:187], a[8:11], v[80:83], 0
    ds_read_b64_tr_b16 v[76:77], v16 offset:28672
    s_add_u32 s71, s99, 131072
    v_mfma_f32_16x16x32_bf16 v[184:187], a[24:27], v[84:87], v[184:187]
    ds_read_b64_tr_b16 v[78:79], v16 offset:29184
    v_mul_f32 v219, s73, v219
    v_mfma_f32_16x16x32_bf16 v[184:187], a[40:43], v[88:91], v[184:187]
    buffer_load_dwordx4 v12, s[16:19], s71 offen lds
    v_mfma_f32_16x16x32_bf16 v[184:187], a[56:59], v[92:95], v[184:187]
    s_add_u32 m0, s61, 3072
    s_add_u32 s71, s99, 196608
    v_mfma_f32_16x16x32_bf16 v[188:191], a[12:15], v[80:83], 0
    v_cvt_pk_bf16_f32 v104, v200, v201
    v_cvt_pk_bf16_f32 v105, v202, v203
    v_mfma_f32_16x16x32_bf16 v[188:191], a[28:31], v[84:87], v[188:191]
    v_cvt_pk_bf16_f32 v106, v216, v217
    v_cvt_pk_bf16_f32 v107, v218, v219
    v_mfma_f32_16x16x32_bf16 v[188:191], a[44:47], v[88:91], v[188:191]
    buffer_load_dwordx4 v13, s[16:19], s71 offen lds
    v_mfma_f32_16x16x32_bf16 v[188:191], a[60:63], v[92:95], v[188:191]
    v_mul_f32 v204, s73, v204
    v_mul_f32 v205, s73, v205
    v_mul_f32 v206, s73, v206
    v_mul_f32 v207, s73, v207
    v_mul_f32 v220, s73, v220
    v_mul_f32 v221, s73, v221
    v_mul_f32 v222, s73, v222
    v_mul_f32 v223, s73, v223
    v_cvt_pk_bf16_f32 v108, v204, v205
    v_cvt_pk_bf16_f32 v109, v206, v207
    v_cvt_pk_bf16_f32 v110, v220, v221
    v_cvt_pk_bf16_f32 v111, v222, v223
    s_waitcnt lgkmcnt(0)
    v_mfma_f32_16x16x32_bf16 v[192:195], a[0:3], v[64:67], 0
    ds_read_b64_tr_b16 v[80:81], v17 offset:16384
    s_add_u32 s69, s66, 0
    v_mfma_f32_16x16x32_bf16 v[192:195], a[16:19], v[68:71], v[192:195]
    ds_read_b64_tr_b16 v[82:83], v17 offset:16896
    v_mul_f32 v224, s73, v224
    v_mfma_f32_16x16x32_bf16 v[192:195], a[32:35], v[72:75], v[192:195]
    buffer_store_dwordx4 v[28:31], v1, s[48:51], s69 offen offset:0 sc1
    v_mfma_f32_16x16x32_bf16 v[192:195], a[48:51], v[76:79], v[192:195]
    ds_read_b64_tr_b16 v[84:85], v17 offset:20480
    v_mul_f32 v225, s73, v225
    v_mfma_f32_16x16x32_bf16 v[196:199], a[4:7], v[64:67], 0
    ds_read_b64_tr_b16 v[86:87], v17 offset:20992
    v_mul_f32 v226, s73, v226
    v_mfma_f32_16x16x32_bf16 v[196:199], a[20:23], v[68:71], v[196:199]
    ds_read_b64_tr_b16 v[88:89], v17 offset:24576
    v_mul_f32 v227, s73, v227
    v_mfma_f32_16x16x32_bf16 v[196:199], a[36:39], v[72:75], v[196:199]
    ds_read_b64_tr_b16 v[90:91], v17 offset:25088
    v_mul_f32 v240, s73, v240
    v_mfma_f32_16x16x32_bf16 v[196:199], a[52:55], v[76:79], v[196:199]
    ds_read_b64_tr_b16 v[92:93], v17 offset:28672
    v_mul_f32 v241, s73, v241
    v_mfma_f32_16x16x32_bf16 v[200:203], a[8:11], v[64:67], 0
    ds_read_b64_tr_b16 v[94:95], v17 offset:29184
    v_mul_f32 v242, s73, v242
    v_mfma_f32_16x16x32_bf16 v[200:203], a[24:27], v[68:71], v[200:203]
    v_mul_f32 v243, s73, v243
    v_cvt_pk_bf16_f32 v112, v224, v225
    v_mfma_f32_16x16x32_bf16 v[200:203], a[40:43], v[72:75], v[200:203]
    v_cvt_pk_bf16_f32 v113, v226, v227
    v_cvt_pk_bf16_f32 v114, v240, v241
    v_mfma_f32_16x16x32_bf16 v[200:203], a[56:59], v[76:79], v[200:203]
    v_cvt_pk_bf16_f32 v115, v242, v243
    v_mul_f32 v228, s73, v228
    v_mfma_f32_16x16x32_bf16 v[204:207], a[12:15], v[64:67], 0
    v_mul_f32 v229, s73, v229
    v_mul_f32 v230, s73, v230
    v_mfma_f32_16x16x32_bf16 v[204:207], a[28:31], v[68:71], v[204:207]
    v_mul_f32 v231, s73, v231
    v_mul_f32 v244, s73, v244
    v_mfma_f32_16x16x32_bf16 v[204:207], a[44:47], v[72:75], v[204:207]
    v_mul_f32 v245, s73, v245
    v_mul_f32 v246, s73, v246
    v_mfma_f32_16x16x32_bf16 v[204:207], a[60:63], v[76:79], v[204:207]
    v_mul_f32 v247, s73, v247
    v_cvt_pk_bf16_f32 v116, v228, v229
    s_waitcnt lgkmcnt(0)
    v_mfma_f32_16x16x32_bf16 v[208:211], a[0:3], v[80:83], 0
    buffer_load_dword v125, v127, s[8:11], s1 offen offset:384
    v_mfma_f32_16x16x32_bf16 v[208:211], a[16:19], v[84:87], v[208:211]
    ds_read_b64_tr_b16 v[64:65], v18 offset:16384
    s_add_u32 s69, s66, 4096
    v_mfma_f32_16x16x32_bf16 v[208:211], a[32:35], v[88:91], v[208:211]
    ds_read_b64_tr_b16 v[66:67], v18 offset:16896
    v_cvt_pk_bf16_f32 v117, v230, v231
    v_mfma_f32_16x16x32_bf16 v[208:211], a[48:51], v[92:95], v[208:211]
    ds_read_b64_tr_b16 v[68:69], v18 offset:20480
    v_cvt_pk_bf16_f32 v118, v244, v245
    v_mfma_f32_16x16x32_bf16 v[212:215], a[4:7], v[80:83], 0
    buffer_store_dwordx4 v[32:35], v1, s[48:51], s69 offen offset:0 sc1
    v_mfma_f32_16x16x32_bf16 v[212:215], a[20:23], v[84:87], v[212:215]
    ds_read_b64_tr_b16 v[70:71], v18 offset:20992
    v_cvt_pk_bf16_f32 v119, v246, v247
    v_mfma_f32_16x16x32_bf16 v[212:215], a[36:39], v[88:91], v[212:215]
    ds_read_b64_tr_b16 v[72:73], v18 offset:24576
    v_mul_f32 v232, s73, v232
    v_mfma_f32_16x16x32_bf16 v[212:215], a[52:55], v[92:95], v[212:215]
    ds_read_b64_tr_b16 v[74:75], v18 offset:25088
    v_mul_f32 v233, s73, v233
    v_mfma_f32_16x16x32_bf16 v[216:219], a[8:11], v[80:83], 0
    ds_read_b64_tr_b16 v[76:77], v18 offset:28672
    v_mul_f32 v234, s73, v234
    v_mfma_f32_16x16x32_bf16 v[216:219], a[24:27], v[84:87], v[216:219]
    ds_read_b64_tr_b16 v[78:79], v18 offset:29184
    v_mul_f32 v235, s73, v235
    v_mfma_f32_16x16x32_bf16 v[216:219], a[40:43], v[88:91], v[216:219]
    v_mul_f32 v248, s73, v248
    v_mul_f32 v249, s73, v249
    v_mfma_f32_16x16x32_bf16 v[216:219], a[56:59], v[92:95], v[216:219]
    v_mul_f32 v250, s73, v250
    v_mul_f32 v251, s73, v251
    v_mfma_f32_16x16x32_bf16 v[220:223], a[12:15], v[80:83], 0
    v_cvt_pk_bf16_f32 v120, v232, v233
    v_cvt_pk_bf16_f32 v121, v234, v235
    v_mfma_f32_16x16x32_bf16 v[220:223], a[28:31], v[84:87], v[220:223]
    v_cvt_pk_bf16_f32 v122, v248, v249
    v_cvt_pk_bf16_f32 v123, v250, v251
    v_mfma_f32_16x16x32_bf16 v[220:223], a[44:47], v[88:91], v[220:223]
    v_mul_f32 v236, s73, v236
    v_mul_f32 v237, s73, v237
    v_mfma_f32_16x16x32_bf16 v[220:223], a[60:63], v[92:95], v[220:223]
    v_mul_f32 v238, s73, v238
    v_mul_f32 v239, s73, v239
    v_mul_f32 v252, s73, v252
    v_mul_f32 v253, s73, v253
    v_mul_f32 v254, s73, v254
    v_mul_f32 v255, s73, v255
    v_cvt_pk_bf16_f32 v20, v236, v237
    v_cvt_pk_bf16_f32 v21, v238, v239
    v_cvt_pk_bf16_f32 v22, v252, v253
    v_cvt_pk_bf16_f32 v23, v254, v255
    s_waitcnt lgkmcnt(0)
    v_mfma_f32_16x16x32_bf16 v[224:227], a[0:3], v[64:67], 0
    ds_read_b64_tr_b16 v[80:81], v19 offset:16384
    s_add_u32 s69, s66, 8192
    v_mfma_f32_16x16x32_bf16 v[224:227], a[16:19], v[68:71], v[224:227]
    buffer_store_dwordx4 v[36:39], v1, s[48:51], s69 offen offset:0 sc1
    v_mfma_f32_16x16x32_bf16 v[224:227], a[32:35], v[72:75], v[224:227]
    ds_read_b64_tr_b16 v[82:83], v19 offset:16896
    v_mfma_f32_16x16x32_bf16 v[224:227], a[48:51], v[76:79], v[224:227]
    ds_read_b64_tr_b16 v[84:85], v19 offset:20480
    v_mfma_f32_16x16x32_bf16 v[228:231], a[4:7], v[64:67], 0
    ds_read_b64_tr_b16 v[86:87], v19 offset:20992
    v_mfma_f32_16x16x32_bf16 v[228:231], a[20:23], v[68:71], v[228:231]
    ds_read_b64_tr_b16 v[88:89], v19 offset:24576
    v_mfma_f32_16x16x32_bf16 v[228:231], a[36:39], v[72:75], v[228:231]
    ds_read_b64_tr_b16 v[90:91], v19 offset:25088
    v_mfma_f32_16x16x32_bf16 v[228:231], a[52:55], v[76:79], v[228:231]
    ds_read_b64_tr_b16 v[92:93], v19 offset:28672
    v_mfma_f32_16x16x32_bf16 v[232:235], a[8:11], v[64:67], 0
    ds_read_b64_tr_b16 v[94:95], v19 offset:29184
    v_mfma_f32_16x16x32_bf16 v[232:235], a[24:27], v[68:71], v[232:235]
    v_mfma_f32_16x16x32_bf16 v[232:235], a[40:43], v[72:75], v[232:235]
    v_mfma_f32_16x16x32_bf16 v[232:235], a[56:59], v[76:79], v[232:235]
    v_mfma_f32_16x16x32_bf16 v[236:239], a[12:15], v[64:67], 0
    v_mfma_f32_16x16x32_bf16 v[236:239], a[28:31], v[68:71], v[236:239]
    v_mfma_f32_16x16x32_bf16 v[236:239], a[44:47], v[72:75], v[236:239]
    v_mfma_f32_16x16x32_bf16 v[236:239], a[60:63], v[76:79], v[236:239]
    s_waitcnt lgkmcnt(0)
    s_waitcnt vmcnt(22)
    s_barrier
    v_mfma_f32_16x16x32_bf16 v[240:243], a[0:3], v[80:83], 0
    ds_read_b64_tr_b16 v[64:65], v16 offset:32768
    s_add_u32 m0, s61, 16384
    v_mfma_f32_16x16x32_bf16 v[240:243], a[16:19], v[84:87], v[240:243]
    ds_read_b64_tr_b16 v[66:67], v16 offset:33280
    s_add_u32 s71, s99, 128
    v_mfma_f32_16x16x32_bf16 v[240:243], a[32:35], v[88:91], v[240:243]
    buffer_load_dwordx4 v12, s[16:19], s71 offen lds
    v_mfma_f32_16x16x32_bf16 v[240:243], a[48:51], v[92:95], v[240:243]
    ds_read_b64_tr_b16 v[68:69], v16 offset:36864
    s_add_u32 m0, s61, 17408
    v_mfma_f32_16x16x32_bf16 v[244:247], a[4:7], v[80:83], 0
    ds_read_b64_tr_b16 v[70:71], v16 offset:37376
    s_add_u32 s71, s99, 65664
    v_mfma_f32_16x16x32_bf16 v[244:247], a[20:23], v[84:87], v[244:247]
    ds_read_b64_tr_b16 v[72:73], v16 offset:40960
    v_mfma_f32_16x16x32_bf16 v[244:247], a[36:39], v[88:91], v[244:247]
    buffer_load_dwordx4 v13, s[16:19], s71 offen lds
    v_mfma_f32_16x16x32_bf16 v[244:247], a[52:55], v[92:95], v[244:247]
    ds_read_b64_tr_b16 v[74:75], v16 offset:41472
    s_add_u32 m0, s61, 18432
    v_mfma_f32_16x16x32_bf16 v[248:251], a[8:11], v[80:83], 0
    ds_read_b64_tr_b16 v[76:77], v16 offset:45056
    s_add_u32 s71, s99, 131200
    v_mfma_f32_16x16x32_bf16 v[248:251], a[24:27], v[84:87], v[248:251]
    ds_read_b64_tr_b16 v[78:79], v16 offset:45568
    v_mfma_f32_16x16x32_bf16 v[248:251], a[40:43], v[88:91], v[248:251]
    buffer_load_dwordx4 v12, s[16:19], s71 offen lds
    v_mfma_f32_16x16x32_bf16 v[248:251], a[56:59], v[92:95], v[248:251]
    s_add_u32 m0, s61, 19456
    s_add_u32 s71, s99, 196736
    v_mfma_f32_16x16x32_bf16 v[252:255], a[12:15], v[80:83], 0
    v_mfma_f32_16x16x32_bf16 v[252:255], a[28:31], v[84:87], v[252:255]
    v_mfma_f32_16x16x32_bf16 v[252:255], a[44:47], v[88:91], v[252:255]
    buffer_load_dwordx4 v13, s[16:19], s71 offen lds
    v_mfma_f32_16x16x32_bf16 v[252:255], a[60:63], v[92:95], v[252:255]
    s_waitcnt lgkmcnt(0)
    v_mfma_f32_16x16x32_bf16 v[128:131], a[64:67], v[64:67], v[128:131]
    ds_read_b64_tr_b16 v[80:81], v17 offset:32768
    s_add_u32 s69, s66, 12288
    v_mfma_f32_16x16x32_bf16 v[128:131], a[80:83], v[68:71], v[128:131]
    ds_read_b64_tr_b16 v[82:83], v17 offset:33280
    s_add_u32 m0, s62, 8192
    v_mfma_f32_16x16x32_bf16 v[128:131], a[96:99], v[72:75], v[128:131]
    buffer_store_dwordx4 v[40:43], v1, s[48:51], s69 offen offset:0 sc1
    v_mfma_f32_16x16x32_bf16 v[128:131], a[112:115], v[76:79], v[128:131]
    ds_read_b64_tr_b16 v[84:85], v17 offset:36864
    s_add_u32 s72, s92, 0
    v_mfma_f32_16x16x32_bf16 v[132:135], a[68:71], v[64:67], v[132:135]
    ds_read_b64_tr_b16 v[86:87], v17 offset:37376
    v_mfma_f32_16x16x32_bf16 v[132:135], a[84:87], v[68:71], v[132:135]
    ds_read_b64_tr_b16 v[88:89], v17 offset:40960
    v_mfma_f32_16x16x32_bf16 v[132:135], a[100:103], v[72:75], v[132:135]
    buffer_load_dwordx4 v2, s[8:11], s72 offen offset:0 lds
    v_mfma_f32_16x16x32_bf16 v[132:135], a[116:119], v[76:79], v[132:135]
    ds_read_b64_tr_b16 v[90:91], v17 offset:41472
    v_mfma_f32_16x16x32_bf16 v[136:139], a[72:75], v[64:67], v[136:139]
    ds_read_b64_tr_b16 v[92:93], v17 offset:45056
    v_mfma_f32_16x16x32_bf16 v[136:139], a[88:91], v[68:71], v[136:139]
    ds_read_b64_tr_b16 v[94:95], v17 offset:45568
    v_mfma_f32_16x16x32_bf16 v[136:139], a[104:107], v[72:75], v[136:139]
    buffer_load_dwordx4 v3, s[8:11], s72 offen offset:1024 lds
    v_mfma_f32_16x16x32_bf16 v[136:139], a[120:123], v[76:79], v[136:139]
    v_mfma_f32_16x16x32_bf16 v[140:143], a[76:79], v[64:67], v[140:143]
    v_mfma_f32_16x16x32_bf16 v[140:143], a[92:95], v[68:71], v[140:143]
    v_mfma_f32_16x16x32_bf16 v[140:143], a[108:111], v[72:75], v[140:143]
    buffer_load_dwordx4 v4, s[8:11], s72 offen offset:2048 lds
    v_mfma_f32_16x16x32_bf16 v[140:143], a[124:127], v[76:79], v[140:143]
    s_waitcnt lgkmcnt(0)
    v_mfma_f32_16x16x32_bf16 v[144:147], a[64:67], v[80:83], v[144:147]
    ds_read_b64_tr_b16 v[64:65], v18 offset:32768
    s_add_u32 s69, s66, 0
    v_mfma_f32_16x16x32_bf16 v[144:147], a[80:83], v[84:87], v[144:147]
    ds_read_b64_tr_b16 v[66:67], v18 offset:33280
    v_mfma_f32_16x16x32_bf16 v[144:147], a[96:99], v[88:91], v[144:147]
    buffer_store_dwordx4 v[44:47], v1, s[48:51], s69 offen offset:1024 sc1
    v_mfma_f32_16x16x32_bf16 v[144:147], a[112:115], v[92:95], v[144:147]
    ds_read_b64_tr_b16 v[68:69], v18 offset:36864
    v_mfma_f32_16x16x32_bf16 v[148:151], a[68:71], v[80:83], v[148:151]
    ds_read_b64_tr_b16 v[70:71], v18 offset:37376
    v_mfma_f32_16x16x32_bf16 v[148:151], a[84:87], v[84:87], v[148:151]
    ds_read_b64_tr_b16 v[72:73], v18 offset:40960
    v_mfma_f32_16x16x32_bf16 v[148:151], a[100:103], v[88:91], v[148:151]
    buffer_load_dwordx4 v5, s[8:11], s72 offen offset:3072 lds
    v_mfma_f32_16x16x32_bf16 v[148:151], a[116:119], v[92:95], v[148:151]
    ds_read_b64_tr_b16 v[74:75], v18 offset:41472
    s_add_u32 m0, s62, 12288
    v_mfma_f32_16x16x32_bf16 v[152:155], a[72:75], v[80:83], v[152:155]
    ds_read_b64_tr_b16 v[76:77], v18 offset:45056
    s_add_u32 s72, s92, 4096
    v_mfma_f32_16x16x32_bf16 v[152:155], a[88:91], v[84:87], v[152:155]
    ds_read_b64_tr_b16 v[78:79], v18 offset:45568
    v_mfma_f32_16x16x32_bf16 v[152:155], a[104:107], v[88:91], v[152:155]
    buffer_load_dwordx4 v6, s[8:11], s72 offen offset:0 lds
    v_mfma_f32_16x16x32_bf16 v[152:155], a[120:123], v[92:95], v[152:155]
    v_mfma_f32_16x16x32_bf16 v[156:159], a[76:79], v[80:83], v[156:159]
    v_mfma_f32_16x16x32_bf16 v[156:159], a[92:95], v[84:87], v[156:159]
    v_mfma_f32_16x16x32_bf16 v[156:159], a[108:111], v[88:91], v[156:159]
    buffer_load_dwordx4 v7, s[8:11], s72 offen offset:1024 lds
    v_mfma_f32_16x16x32_bf16 v[156:159], a[124:127], v[92:95], v[156:159]
    s_waitcnt lgkmcnt(0)
    v_mfma_f32_16x16x32_bf16 v[160:163], a[64:67], v[64:67], v[160:163]
    ds_read_b64_tr_b16 v[80:81], v19 offset:32768
    v_mfma_f32_16x16x32_bf16 v[160:163], a[80:83], v[68:71], v[160:163]
    ds_read_b64_tr_b16 v[82:83], v19 offset:33280
    v_mfma_f32_16x16x32_bf16 v[160:163], a[96:99], v[72:75], v[160:163]
    buffer_load_dwordx4 v8, s[8:11], s72 offen offset:2048 lds
    v_mfma_f32_16x16x32_bf16 v[160:163], a[112:115], v[76:79], v[160:163]
    ds_read_b64_tr_b16 v[84:85], v19 offset:36864
    v_mfma_f32_16x16x32_bf16 v[164:167], a[68:71], v[64:67], v[164:167]
    ds_read_b64_tr_b16 v[86:87], v19 offset:37376
    v_mfma_f32_16x16x32_bf16 v[164:167], a[84:87], v[68:71], v[164:167]
    ds_read_b64_tr_b16 v[88:89], v19 offset:40960
    v_mfma_f32_16x16x32_bf16 v[164:167], a[100:103], v[72:75], v[164:167]
    buffer_load_dwordx4 v9, s[8:11], s72 offen offset:3072 lds
    v_mfma_f32_16x16x32_bf16 v[164:167], a[116:119], v[76:79], v[164:167]
    ds_read_b64_tr_b16 v[90:91], v19 offset:41472
    v_mfma_f32_16x16x32_bf16 v[168:171], a[72:75], v[64:67], v[168:171]
    ds_read_b64_tr_b16 v[92:93], v19 offset:45056
    v_mfma_f32_16x16x32_bf16 v[168:171], a[88:91], v[68:71], v[168:171]
    ds_read_b64_tr_b16 v[94:95], v19 offset:45568
    v_mfma_f32_16x16x32_bf16 v[168:171], a[104:107], v[72:75], v[168:171]
    v_mfma_f32_16x16x32_bf16 v[168:171], a[120:123], v[76:79], v[168:171]
    v_mfma_f32_16x16x32_bf16 v[172:175], a[76:79], v[64:67], v[172:175]
    v_mfma_f32_16x16x32_bf16 v[172:175], a[92:95], v[68:71], v[172:175]
    v_mfma_f32_16x16x32_bf16 v[172:175], a[108:111], v[72:75], v[172:175]
    v_mfma_f32_16x16x32_bf16 v[172:175], a[124:127], v[76:79], v[172:175]
    s_waitcnt lgkmcnt(0)
    s_waitcnt vmcnt(31)
    s_barrier
    v_mfma_f32_16x16x32_bf16 v[176:179], a[64:67], v[80:83], v[176:179]
    ds_read_b64_tr_b16 v[64:65], v16 offset:49152
    s_add_u32 m0, s61, 32768
    v_mfma_f32_16x16x32_bf16 v[176:179], a[80:83], v[84:87], v[176:179]
    ds_read_b64_tr_b16 v[66:67], v16 offset:49664
    s_add_u32 s71, s3, 0
    v_mfma_f32_16x16x32_bf16 v[176:179], a[96:99], v[88:91], v[176:179]
    buffer_load_dwordx4 v12, s[16:19], s71 offen lds
    v_mfma_f32_16x16x32_bf16 v[176:179], a[112:115], v[92:95], v[176:179]
    ds_read_b64_tr_b16 v[68:69], v16 offset:53248
    s_add_u32 m0, s61, 33792
    v_mfma_f32_16x16x32_bf16 v[180:183], a[68:71], v[80:83], v[180:183]
    ds_read_b64_tr_b16 v[70:71], v16 offset:53760
    s_add_u32 s71, s3, 65536
    v_mfma_f32_16x16x32_bf16 v[180:183], a[84:87], v[84:87], v[180:183]
    ds_read_b64_tr_b16 v[72:73], v16 offset:57344
    s_add_u32 s69, s66, 4096
    v_mfma_f32_16x16x32_bf16 v[180:183], a[100:103], v[88:91], v[180:183]
    buffer_load_dwordx4 v13, s[16:19], s71 offen lds
    v_mfma_f32_16x16x32_bf16 v[180:183], a[116:119], v[92:95], v[180:183]
    ds_read_b64_tr_b16 v[74:75], v16 offset:57856
    s_add_u32 m0, s61, 34816
    v_mfma_f32_16x16x32_bf16 v[184:187], a[72:75], v[80:83], v[184:187]
    ds_read_b64_tr_b16 v[76:77], v16 offset:61440
    s_add_u32 s71, s3, 131072
    v_mfma_f32_16x16x32_bf16 v[184:187], a[88:91], v[84:87], v[184:187]
    ds_read_b64_tr_b16 v[78:79], v16 offset:61952
    v_mfma_f32_16x16x32_bf16 v[184:187], a[104:107], v[88:91], v[184:187]
    buffer_load_dwordx4 v12, s[16:19], s71 offen lds
    v_mfma_f32_16x16x32_bf16 v[184:187], a[120:123], v[92:95], v[184:187]
    s_add_u32 m0, s61, 35840
    s_add_u32 s71, s3, 196608
    v_mfma_f32_16x16x32_bf16 v[188:191], a[76:79], v[80:83], v[188:191]
    v_mfma_f32_16x16x32_bf16 v[188:191], a[92:95], v[84:87], v[188:191]
    v_mfma_f32_16x16x32_bf16 v[188:191], a[108:111], v[88:91], v[188:191]
    buffer_load_dwordx4 v13, s[16:19], s71 offen lds
    v_mfma_f32_16x16x32_bf16 v[188:191], a[124:127], v[92:95], v[188:191]
    s_waitcnt lgkmcnt(0)
    v_mfma_f32_16x16x32_bf16 v[192:195], a[64:67], v[64:67], v[192:195]
    ds_read_b64_tr_b16 v[80:81], v17 offset:49152
    v_mfma_f32_16x16x32_bf16 v[192:195], a[80:83], v[68:71], v[192:195]
    ds_read_b64_tr_b16 v[82:83], v17 offset:49664
    ds_read_b128 a[0:3], v10 offset:16384
    v_mfma_f32_16x16x32_bf16 v[192:195], a[96:99], v[72:75], v[192:195]
    buffer_store_dwordx4 v[48:51], v1, s[48:51], s69 offen offset:1024 sc1
    v_mfma_f32_16x16x32_bf16 v[192:195], a[112:115], v[76:79], v[192:195]
    ds_read_b64_tr_b16 v[84:85], v17 offset:53248
    ds_read_b128 a[4:7], v10 offset:16640
    v_mfma_f32_16x16x32_bf16 v[196:199], a[68:71], v[64:67], v[196:199]
    ds_read_b64_tr_b16 v[86:87], v17 offset:53760
    ds_read_b128 a[8:11], v10 offset:16896
    v_mfma_f32_16x16x32_bf16 v[196:199], a[84:87], v[68:71], v[196:199]
    ds_read_b64_tr_b16 v[88:89], v17 offset:57344
    ds_read_b128 a[12:15], v10 offset:17152
    v_mfma_f32_16x16x32_bf16 v[196:199], a[100:103], v[72:75], v[196:199]
    ds_read_b64_tr_b16 v[90:91], v17 offset:57856
    ds_read_b128 a[16:19], v11 offset:16384
    v_mfma_f32_16x16x32_bf16 v[196:199], a[116:119], v[76:79], v[196:199]
    ds_read_b64_tr_b16 v[92:93], v17 offset:61440
    ds_read_b128 a[20:23], v11 offset:16640
    v_mfma_f32_16x16x32_bf16 v[200:203], a[72:75], v[64:67], v[200:203]
    ds_read_b64_tr_b16 v[94:95], v17 offset:61952
    ds_read_b128 a[24:27], v11 offset:16896
    v_mfma_f32_16x16x32_bf16 v[200:203], a[88:91], v[68:71], v[200:203]
    ds_read_b128 a[28:31], v11 offset:17152
    s_add_u32 s69, s66, 8192
    v_mfma_f32_16x16x32_bf16 v[200:203], a[104:107], v[72:75], v[200:203]
    buffer_store_dwordx4 v[52:55], v1, s[48:51], s69 offen offset:1024 sc1
    v_mfma_f32_16x16x32_bf16 v[200:203], a[120:123], v[76:79], v[200:203]
    v_mfma_f32_16x16x32_bf16 v[204:207], a[76:79], v[64:67], v[204:207]
    v_mfma_f32_16x16x32_bf16 v[204:207], a[92:95], v[68:71], v[204:207]
    v_mfma_f32_16x16x32_bf16 v[204:207], a[108:111], v[72:75], v[204:207]
    v_mfma_f32_16x16x32_bf16 v[204:207], a[124:127], v[76:79], v[204:207]
    s_waitcnt lgkmcnt(2)
    v_mfma_f32_16x16x32_bf16 v[208:211], a[64:67], v[80:83], v[208:211]
    buffer_load_dword v125, v127, s[8:11], s1 offen offset:512
    v_mfma_f32_16x16x32_bf16 v[208:211], a[80:83], v[84:87], v[208:211]
    ds_read_b64_tr_b16 v[64:65], v18 offset:49152
    v_mfma_f32_16x16x32_bf16 v[208:211], a[96:99], v[88:91], v[208:211]
    ds_read_b64_tr_b16 v[66:67], v18 offset:49664
    v_mfma_f32_16x16x32_bf16 v[208:211], a[112:115], v[92:95], v[208:211]
    ds_read_b64_tr_b16 v[68:69], v18 offset:53248
    v_mfma_f32_16x16x32_bf16 v[212:215], a[68:71], v[80:83], v[212:215]
    ds_read_b64_tr_b16 v[70:71], v18 offset:53760
    v_mfma_f32_16x16x32_bf16 v[212:215], a[84:87], v[84:87], v[212:215]
    ds_read_b64_tr_b16 v[72:73], v18 offset:57344
    v_mfma_f32_16x16x32_bf16 v[212:215], a[100:103], v[88:91], v[212:215]
    ds_read_b64_tr_b16 v[74:75], v18 offset:57856
    v_mfma_f32_16x16x32_bf16 v[212:215], a[116:119], v[92:95], v[212:215]
    ds_read_b64_tr_b16 v[76:77], v18 offset:61440
    v_mfma_f32_16x16x32_bf16 v[216:219], a[72:75], v[80:83], v[216:219]
    ds_read_b64_tr_b16 v[78:79], v18 offset:61952
    v_mfma_f32_16x16x32_bf16 v[216:219], a[88:91], v[84:87], v[216:219]
    v_mfma_f32_16x16x32_bf16 v[216:219], a[104:107], v[88:91], v[216:219]
    v_mfma_f32_16x16x32_bf16 v[216:219], a[120:123], v[92:95], v[216:219]
    v_mfma_f32_16x16x32_bf16 v[220:223], a[76:79], v[80:83], v[220:223]
    v_mfma_f32_16x16x32_bf16 v[220:223], a[92:95], v[84:87], v[220:223]
    v_mfma_f32_16x16x32_bf16 v[220:223], a[108:111], v[88:91], v[220:223]
    v_mfma_f32_16x16x32_bf16 v[220:223], a[124:127], v[92:95], v[220:223]
    s_waitcnt lgkmcnt(0)
    v_mfma_f32_16x16x32_bf16 v[224:227], a[64:67], v[64:67], v[224:227]
    ds_read_b64_tr_b16 v[80:81], v19 offset:49152
    s_add_u32 s69, s66, 12288
    v_mfma_f32_16x16x32_bf16 v[224:227], a[80:83], v[68:71], v[224:227]
    buffer_store_dwordx4 v[56:59], v1, s[48:51], s69 offen offset:1024 sc1
    v_mfma_f32_16x16x32_bf16 v[224:227], a[96:99], v[72:75], v[224:227]
    ds_read_b64_tr_b16 v[82:83], v19 offset:49664
    v_mfma_f32_16x16x32_bf16 v[224:227], a[112:115], v[76:79], v[224:227]
    ds_read_b64_tr_b16 v[84:85], v19 offset:53248
    v_mfma_f32_16x16x32_bf16 v[228:231], a[68:71], v[64:67], v[228:231]
    ds_read_b64_tr_b16 v[86:87], v19 offset:53760
    v_mfma_f32_16x16x32_bf16 v[228:231], a[84:87], v[68:71], v[228:231]
    ds_read_b64_tr_b16 v[88:89], v19 offset:57344
    v_mfma_f32_16x16x32_bf16 v[228:231], a[100:103], v[72:75], v[228:231]
    ds_read_b64_tr_b16 v[90:91], v19 offset:57856
    v_mfma_f32_16x16x32_bf16 v[228:231], a[116:119], v[76:79], v[228:231]
    ds_read_b64_tr_b16 v[92:93], v19 offset:61440
    v_mfma_f32_16x16x32_bf16 v[232:235], a[72:75], v[64:67], v[232:235]
    ds_read_b64_tr_b16 v[94:95], v19 offset:61952
    v_mfma_f32_16x16x32_bf16 v[232:235], a[88:91], v[68:71], v[232:235]
    v_mfma_f32_16x16x32_bf16 v[232:235], a[104:107], v[72:75], v[232:235]
    v_mfma_f32_16x16x32_bf16 v[232:235], a[120:123], v[76:79], v[232:235]
    v_mfma_f32_16x16x32_bf16 v[236:239], a[76:79], v[64:67], v[236:239]
    v_mfma_f32_16x16x32_bf16 v[236:239], a[92:95], v[68:71], v[236:239]
    v_mfma_f32_16x16x32_bf16 v[236:239], a[108:111], v[72:75], v[236:239]
    v_mfma_f32_16x16x32_bf16 v[236:239], a[124:127], v[76:79], v[236:239]
    s_waitcnt lgkmcnt(0)
    s_waitcnt vmcnt(26)
    s_barrier
    v_mfma_f32_16x16x32_bf16 v[240:243], a[64:67], v[80:83], v[240:243]
    ds_read_b64_tr_b16 v[64:65], v16 offset:0
    s_add_u32 m0, s61, 49152
    v_mfma_f32_16x16x32_bf16 v[240:243], a[80:83], v[84:87], v[240:243]
    ds_read_b64_tr_b16 v[66:67], v16 offset:512
    s_add_u32 s71, s3, 128
    v_mfma_f32_16x16x32_bf16 v[240:243], a[96:99], v[88:91], v[240:243]
    buffer_load_dwordx4 v12, s[16:19], s71 offen lds
    v_mfma_f32_16x16x32_bf16 v[240:243], a[112:115], v[92:95], v[240:243]
    ds_read_b64_tr_b16 v[68:69], v16 offset:4096
    s_add_u32 m0, s61, 50176
    v_mfma_f32_16x16x32_bf16 v[244:247], a[68:71], v[80:83], v[244:247]
    ds_read_b64_tr_b16 v[70:71], v16 offset:4608
    s_add_u32 s71, s3, 65664
    v_mfma_f32_16x16x32_bf16 v[244:247], a[84:87], v[84:87], v[244:247]
    ds_read_b64_tr_b16 v[72:73], v16 offset:8192
    s_add_u32 s69, s66, 0
    v_mfma_f32_16x16x32_bf16 v[244:247], a[100:103], v[88:91], v[244:247]
    buffer_load_dwordx4 v13, s[16:19], s71 offen lds
    v_mfma_f32_16x16x32_bf16 v[244:247], a[116:119], v[92:95], v[244:247]
    ds_read_b64_tr_b16 v[74:75], v16 offset:8704
    s_add_u32 m0, s61, 51200
    v_mfma_f32_16x16x32_bf16 v[248:251], a[72:75], v[80:83], v[248:251]
    ds_read_b64_tr_b16 v[76:77], v16 offset:12288
    s_add_u32 s71, s3, 131200
    v_mfma_f32_16x16x32_bf16 v[248:251], a[88:91], v[84:87], v[248:251]
    ds_read_b64_tr_b16 v[78:79], v16 offset:12800
    v_mfma_f32_16x16x32_bf16 v[248:251], a[104:107], v[88:91], v[248:251]
    buffer_load_dwordx4 v12, s[16:19], s71 offen lds
    v_mfma_f32_16x16x32_bf16 v[248:251], a[120:123], v[92:95], v[248:251]
    s_add_u32 m0, s61, 52224
    s_add_u32 s71, s3, 196736
    v_mfma_f32_16x16x32_bf16 v[252:255], a[76:79], v[80:83], v[252:255]
    v_mfma_f32_16x16x32_bf16 v[252:255], a[92:95], v[84:87], v[252:255]
    v_mfma_f32_16x16x32_bf16 v[252:255], a[108:111], v[88:91], v[252:255]
    buffer_load_dwordx4 v13, s[16:19], s71 offen lds
    v_mfma_f32_16x16x32_bf16 v[252:255], a[124:127], v[92:95], v[252:255]
    s_waitcnt lgkmcnt(0)
    v_mfma_f32_16x16x32_bf16 v[128:131], a[128:131], v[64:67], v[128:131]
    ds_read_b64_tr_b16 v[80:81], v17 offset:0
    v_mfma_f32_16x16x32_bf16 v[128:131], a[144:147], v[68:71], v[128:131]
    ds_read_b64_tr_b16 v[82:83], v17 offset:512
    ds_read_b128 a[32:35], v10 offset:0
    v_mfma_f32_16x16x32_bf16 v[128:131], a[160:163], v[72:75], v[128:131]
    buffer_store_dwordx4 v[96:99], v1, s[48:51], s69 offen offset:2048 sc1
    v_mfma_f32_16x16x32_bf16 v[128:131], a[176:179], v[76:79], v[128:131]
    ds_read_b64_tr_b16 v[84:85], v17 offset:4096
    ds_read_b128 a[36:39], v10 offset:256
    v_mfma_f32_16x16x32_bf16 v[132:135], a[132:135], v[64:67], v[132:135]
    ds_read_b64_tr_b16 v[86:87], v17 offset:4608
    ds_read_b128 a[40:43], v10 offset:512
    v_mfma_f32_16x16x32_bf16 v[132:135], a[148:151], v[68:71], v[132:135]
    ds_read_b64_tr_b16 v[88:89], v17 offset:8192
    ds_read_b128 a[44:47], v10 offset:768
    v_mfma_f32_16x16x32_bf16 v[132:135], a[164:167], v[72:75], v[132:135]
    ds_read_b64_tr_b16 v[90:91], v17 offset:8704
    ds_read_b128 a[48:51], v11 offset:0
    v_mfma_f32_16x16x32_bf16 v[132:135], a[180:183], v[76:79], v[132:135]
    ds_read_b64_tr_b16 v[92:93], v17 offset:12288
    ds_read_b128 a[52:55], v11 offset:256
    v_mfma_f32_16x16x32_bf16 v[136:139], a[136:139], v[64:67], v[136:139]
    ds_read_b64_tr_b16 v[94:95], v17 offset:12800
    ds_read_b128 a[56:59], v11 offset:512
    v_mfma_f32_16x16x32_bf16 v[136:139], a[152:155], v[68:71], v[136:139]
    ds_read_b128 a[60:63], v11 offset:768
    s_add_u32 m0, s62, 16384
    v_mfma_f32_16x16x32_bf16 v[136:139], a[168:171], v[72:75], v[136:139]
    s_add_u32 s72, s92, 128
    v_mfma_f32_16x16x32_bf16 v[136:139], a[184:187], v[76:79], v[136:139]
    buffer_load_dwordx4 v2, s[8:11], s72 offen offset:0 lds
    v_mfma_f32_16x16x32_bf16 v[140:143], a[140:143], v[64:67], v[140:143]
    v_mfma_f32_16x16x32_bf16 v[140:143], a[156:159], v[68:71], v[140:143]
    v_mfma_f32_16x16x32_bf16 v[140:143], a[172:175], v[72:75], v[140:143]
    v_mfma_f32_16x16x32_bf16 v[140:143], a[188:191], v[76:79], v[140:143]
    buffer_load_dwordx4 v3, s[8:11], s72 offen offset:1024 lds
    s_waitcnt lgkmcnt(2)
    v_mfma_f32_16x16x32_bf16 v[144:147], a[128:131], v[80:83], v[144:147]
    ds_read_b64_tr_b16 v[64:65], v18 offset:0
    s_add_u32 s69, s66, 4096
    v_mfma_f32_16x16x32_bf16 v[144:147], a[144:147], v[84:87], v[144:147]
    ds_read_b64_tr_b16 v[66:67], v18 offset:512
    v_mfma_f32_16x16x32_bf16 v[144:147], a[160:163], v[88:91], v[144:147]
    ds_read_b64_tr_b16 v[68:69], v18 offset:4096
    v_mfma_f32_16x16x32_bf16 v[144:147], a[176:179], v[92:95], v[144:147]
    buffer_store_dwordx4 v[100:103], v1, s[48:51], s69 offen offset:2048 sc1
    v_mfma_f32_16x16x32_bf16 v[148:151], a[132:135], v[80:83], v[148:151]
    ds_read_b64_tr_b16 v[70:71], v18 offset:4608
    v_mfma_f32_16x16x32_bf16 v[148:151], a[148:151], v[84:87], v[148:151]
    ds_read_b64_tr_b16 v[72:73], v18 offset:8192
    v_mfma_f32_16x16x32_bf16 v[148:151], a[164:167], v[88:91], v[148:151]
    ds_read_b64_tr_b16 v[74:75], v18 offset:8704
    v_mfma_f32_16x16x32_bf16 v[148:151], a[180:183], v[92:95], v[148:151]
    buffer_load_dwordx4 v4, s[8:11], s72 offen offset:2048 lds
    v_mfma_f32_16x16x32_bf16 v[152:155], a[136:139], v[80:83], v[152:155]
    ds_read_b64_tr_b16 v[76:77], v18 offset:12288
    v_mfma_f32_16x16x32_bf16 v[152:155], a[152:155], v[84:87], v[152:155]
    ds_read_b64_tr_b16 v[78:79], v18 offset:12800
    v_mfma_f32_16x16x32_bf16 v[152:155], a[168:171], v[88:91], v[152:155]
    v_mfma_f32_16x16x32_bf16 v[152:155], a[184:187], v[92:95], v[152:155]
    buffer_load_dwordx4 v5, s[8:11], s72 offen offset:3072 lds
    v_mfma_f32_16x16x32_bf16 v[156:159], a[140:143], v[80:83], v[156:159]
    s_add_u32 m0, s62, 20480
    s_add_u32 s72, s92, 4224
    v_mfma_f32_16x16x32_bf16 v[156:159], a[156:159], v[84:87], v[156:159]
    v_mfma_f32_16x16x32_bf16 v[156:159], a[172:175], v[88:91], v[156:159]
    v_mfma_f32_16x16x32_bf16 v[156:159], a[188:191], v[92:95], v[156:159]
    buffer_load_dwordx4 v6, s[8:11], s72 offen offset:0 lds
    s_waitcnt lgkmcnt(0)
    v_mfma_f32_16x16x32_bf16 v[160:163], a[128:131], v[64:67], v[160:163]
    ds_read_b64_tr_b16 v[80:81], v19 offset:0
    s_add_u32 s69, s66, 8192
    v_mfma_f32_16x16x32_bf16 v[160:163], a[144:147], v[68:71], v[160:163]
    ds_read_b64_tr_b16 v[82:83], v19 offset:512
    v_mfma_f32_16x16x32_bf16 v[160:163], a[160:163], v[72:75], v[160:163]
    ds_read_b64_tr_b16 v[84:85], v19 offset:4096
    v_mfma_f32_16x16x32_bf16 v[160:163], a[176:179], v[76:79], v[160:163]
    buffer_store_dwordx4 v[104:107], v1, s[48:51], s69 offen offset:2048 sc1
    v_mfma_f32_16x16x32_bf16 v[164:167], a[132:135], v[64:67], v[164:167]
    ds_read_b64_tr_b16 v[86:87], v19 offset:4608
    v_mfma_f32_16x16x32_bf16 v[164:167], a[148:151], v[68:71], v[164:167]
    ds_read_b64_tr_b16 v[88:89], v19 offset:8192
    v_mfma_f32_16x16x32_bf16 v[164:167], a[164:167], v[72:75], v[164:167]
    ds_read_b64_tr_b16 v[90:91], v19 offset:8704
    v_mfma_f32_16x16x32_bf16 v[164:167], a[180:183], v[76:79], v[164:167]
    buffer_load_dwordx4 v7, s[8:11], s72 offen offset:1024 lds
    v_mfma_f32_16x16x32_bf16 v[168:171], a[136:139], v[64:67], v[168:171]
    ds_read_b64_tr_b16 v[92:93], v19 offset:12288
    v_mfma_f32_16x16x32_bf16 v[168:171], a[152:155], v[68:71], v[168:171]
    ds_read_b64_tr_b16 v[94:95], v19 offset:12800
    v_mfma_f32_16x16x32_bf16 v[168:171], a[168:171], v[72:75], v[168:171]
    v_mfma_f32_16x16x32_bf16 v[168:171], a[184:187], v[76:79], v[168:171]
    buffer_load_dwordx4 v8, s[8:11], s72 offen offset:2048 lds
    v_mfma_f32_16x16x32_bf16 v[172:175], a[140:143], v[64:67], v[172:175]
    v_mfma_f32_16x16x32_bf16 v[172:175], a[156:159], v[68:71], v[172:175]
    v_mfma_f32_16x16x32_bf16 v[172:175], a[172:175], v[72:75], v[172:175]
    v_mfma_f32_16x16x32_bf16 v[172:175], a[188:191], v[76:79], v[172:175]
    buffer_load_dwordx4 v9, s[8:11], s72 offen offset:3072 lds
    s_waitcnt lgkmcnt(0)
    s_waitcnt vmcnt(33)
    s_barrier
    v_mfma_f32_16x16x32_bf16 v[176:179], a[128:131], v[80:83], v[176:179]
    ds_read_b64_tr_b16 v[64:65], v16 offset:16384
    s_add_u32 m0, s61, 0
    v_mfma_f32_16x16x32_bf16 v[176:179], a[144:147], v[84:87], v[176:179]
    ds_read_b64_tr_b16 v[66:67], v16 offset:16896
    s_add_u32 s71, s75, 0
    v_mfma_f32_16x16x32_bf16 v[176:179], a[160:163], v[88:91], v[176:179]
    ds_read_b64_tr_b16 v[68:69], v16 offset:20480
    v_mfma_f32_16x16x32_bf16 v[176:179], a[176:179], v[92:95], v[176:179]
    buffer_load_dwordx4 v12, s[20:23], s71 offen lds
    v_mfma_f32_16x16x32_bf16 v[180:183], a[132:135], v[80:83], v[180:183]
    ds_read_b64_tr_b16 v[70:71], v16 offset:20992
    s_add_u32 m0, s61, 1024
    v_mfma_f32_16x16x32_bf16 v[180:183], a[148:151], v[84:87], v[180:183]
    ds_read_b64_tr_b16 v[72:73], v16 offset:24576
    s_add_u32 s71, s75, 65536
    v_mfma_f32_16x16x32_bf16 v[180:183], a[164:167], v[88:91], v[180:183]
    ds_read_b64_tr_b16 v[74:75], v16 offset:25088
    v_mfma_f32_16x16x32_bf16 v[180:183], a[180:183], v[92:95], v[180:183]
    buffer_load_dwordx4 v13, s[20:23], s71 offen lds
    v_mfma_f32_16x16x32_bf16 v[184:187], a[136:139], v[80:83], v[184:187]
    ds_read_b64_tr_b16 v[76:77], v16 offset:28672
    s_add_u32 m0, s61, 2048
    v_mfma_f32_16x16x32_bf16 v[184:187], a[152:155], v[84:87], v[184:187]
    ds_read_b64_tr_b16 v[78:79], v16 offset:29184
    s_add_u32 s71, s75, 131072
    v_mfma_f32_16x16x32_bf16 v[184:187], a[168:171], v[88:91], v[184:187]
    v_mfma_f32_16x16x32_bf16 v[184:187], a[184:187], v[92:95], v[184:187]
    buffer_load_dwordx4 v12, s[20:23], s71 offen lds
    v_mfma_f32_16x16x32_bf16 v[188:191], a[140:143], v[80:83], v[188:191]
    s_add_u32 m0, s61, 3072
    s_add_u32 s71, s75, 196608
    v_mfma_f32_16x16x32_bf16 v[188:191], a[156:159], v[84:87], v[188:191]
    v_mfma_f32_16x16x32_bf16 v[188:191], a[172:175], v[88:91], v[188:191]
    v_mfma_f32_16x16x32_bf16 v[188:191], a[188:191], v[92:95], v[188:191]
    buffer_load_dwordx4 v13, s[20:23], s71 offen lds
    s_waitcnt lgkmcnt(0)
    v_mfma_f32_16x16x32_bf16 v[192:195], a[128:131], v[64:67], v[192:195]
    ds_read_b64_tr_b16 v[80:81], v17 offset:16384
    s_add_u32 s69, s66, 12288
    v_mfma_f32_16x16x32_bf16 v[192:195], a[144:147], v[68:71], v[192:195]
    ds_read_b64_tr_b16 v[82:83], v17 offset:16896
    v_mfma_f32_16x16x32_bf16 v[192:195], a[160:163], v[72:75], v[192:195]
    ds_read_b64_tr_b16 v[84:85], v17 offset:20480
    v_mfma_f32_16x16x32_bf16 v[192:195], a[176:179], v[76:79], v[192:195]
    buffer_store_dwordx4 v[108:111], v1, s[48:51], s69 offen offset:2048 sc1
    v_mfma_f32_16x16x32_bf16 v[196:199], a[132:135], v[64:67], v[196:199]
    ds_read_b64_tr_b16 v[86:87], v17 offset:20992
    v_mfma_f32_16x16x32_bf16 v[196:199], a[148:151], v[68:71], v[196:199]
    ds_read_b64_tr_b16 v[88:89], v17 offset:24576
    v_mfma_f32_16x16x32_bf16 v[196:199], a[164:167], v[72:75], v[196:199]
    ds_read_b64_tr_b16 v[90:91], v17 offset:25088
    v_mfma_f32_16x16x32_bf16 v[196:199], a[180:183], v[76:79], v[196:199]
    ds_read_b64_tr_b16 v[92:93], v17 offset:28672
    v_mfma_f32_16x16x32_bf16 v[200:203], a[136:139], v[64:67], v[200:203]
    ds_read_b64_tr_b16 v[94:95], v17 offset:29184
    v_mfma_f32_16x16x32_bf16 v[200:203], a[152:155], v[68:71], v[200:203]
    v_mfma_f32_16x16x32_bf16 v[200:203], a[168:171], v[72:75], v[200:203]
    v_mfma_f32_16x16x32_bf16 v[200:203], a[184:187], v[76:79], v[200:203]
    v_mfma_f32_16x16x32_bf16 v[204:207], a[140:143], v[64:67], v[204:207]
    v_mfma_f32_16x16x32_bf16 v[204:207], a[156:159], v[68:71], v[204:207]
    v_mfma_f32_16x16x32_bf16 v[204:207], a[172:175], v[72:75], v[204:207]
    v_mfma_f32_16x16x32_bf16 v[204:207], a[188:191], v[76:79], v[204:207]
    s_waitcnt lgkmcnt(0)
    v_mfma_f32_16x16x32_bf16 v[208:211], a[128:131], v[80:83], v[208:211]
    buffer_load_dword v125, v127, s[8:11], s1 offen offset:640
    v_mfma_f32_16x16x32_bf16 v[208:211], a[144:147], v[84:87], v[208:211]
    ds_read_b64_tr_b16 v[64:65], v18 offset:16384
    s_add_u32 s69, s66, 0
    v_mfma_f32_16x16x32_bf16 v[208:211], a[160:163], v[88:91], v[208:211]
    ds_read_b64_tr_b16 v[66:67], v18 offset:16896
    v_mfma_f32_16x16x32_bf16 v[208:211], a[176:179], v[92:95], v[208:211]
    ds_read_b64_tr_b16 v[68:69], v18 offset:20480
    v_mfma_f32_16x16x32_bf16 v[212:215], a[132:135], v[80:83], v[212:215]
    buffer_store_dwordx4 v[112:115], v1, s[48:51], s69 offen offset:3072 sc1
    v_mfma_f32_16x16x32_bf16 v[212:215], a[148:151], v[84:87], v[212:215]
    ds_read_b64_tr_b16 v[70:71], v18 offset:20992
    v_mfma_f32_16x16x32_bf16 v[212:215], a[164:167], v[88:91], v[212:215]
    ds_read_b64_tr_b16 v[72:73], v18 offset:24576
    v_mfma_f32_16x16x32_bf16 v[212:215], a[180:183], v[92:95], v[212:215]
    ds_read_b64_tr_b16 v[74:75], v18 offset:25088
    v_mfma_f32_16x16x32_bf16 v[216:219], a[136:139], v[80:83], v[216:219]
    ds_read_b64_tr_b16 v[76:77], v18 offset:28672
    v_mfma_f32_16x16x32_bf16 v[216:219], a[152:155], v[84:87], v[216:219]
    ds_read_b64_tr_b16 v[78:79], v18 offset:29184
    v_mfma_f32_16x16x32_bf16 v[216:219], a[168:171], v[88:91], v[216:219]
    v_mfma_f32_16x16x32_bf16 v[216:219], a[184:187], v[92:95], v[216:219]
    v_mfma_f32_16x16x32_bf16 v[220:223], a[140:143], v[80:83], v[220:223]
    v_mfma_f32_16x16x32_bf16 v[220:223], a[156:159], v[84:87], v[220:223]
    v_mfma_f32_16x16x32_bf16 v[220:223], a[172:175], v[88:91], v[220:223]
    v_mfma_f32_16x16x32_bf16 v[220:223], a[188:191], v[92:95], v[220:223]
    s_waitcnt lgkmcnt(0)
    v_mfma_f32_16x16x32_bf16 v[224:227], a[128:131], v[64:67], v[224:227]
    ds_read_b64_tr_b16 v[80:81], v19 offset:16384
    s_waitcnt vmcnt(30)
    v_mfma_f32_16x16x32_bf16 v[224:227], a[144:147], v[68:71], v[224:227]
    ds_read_b64_tr_b16 v[82:83], v19 offset:16896
    ds_read_b128 a[64:67], v10 offset:8192
    v_mfma_f32_16x16x32_bf16 v[224:227], a[160:163], v[72:75], v[224:227]
    ds_read_b64_tr_b16 v[84:85], v19 offset:20480
    ds_read_b128 a[68:71], v10 offset:8448
    v_mfma_f32_16x16x32_bf16 v[224:227], a[176:179], v[76:79], v[224:227]
    ds_read_b64_tr_b16 v[86:87], v19 offset:20992
    ds_read_b128 a[72:75], v10 offset:8704
    v_mfma_f32_16x16x32_bf16 v[228:231], a[132:135], v[64:67], v[228:231]
    ds_read_b64_tr_b16 v[88:89], v19 offset:24576
    ds_read_b128 a[76:79], v10 offset:8960
    v_mfma_f32_16x16x32_bf16 v[228:231], a[148:151], v[68:71], v[228:231]
    ds_read_b64_tr_b16 v[90:91], v19 offset:25088
    ds_read_b128 a[80:83], v11 offset:8192
    v_mfma_f32_16x16x32_bf16 v[228:231], a[164:167], v[72:75], v[228:231]
    ds_read_b64_tr_b16 v[92:93], v19 offset:28672
    ds_read_b128 a[84:87], v11 offset:8448
    v_mfma_f32_16x16x32_bf16 v[228:231], a[180:183], v[76:79], v[228:231]
    ds_read_b64_tr_b16 v[94:95], v19 offset:29184
    ds_read_b128 a[88:91], v11 offset:8704
    v_mfma_f32_16x16x32_bf16 v[232:235], a[136:139], v[64:67], v[232:235]
    ds_read_b128 a[92:95], v11 offset:8960
    s_add_u32 m0, s62, 0
    v_mfma_f32_16x16x32_bf16 v[232:235], a[152:155], v[68:71], v[232:235]
    s_add_u32 s72, s93, 0
    v_mfma_f32_16x16x32_bf16 v[232:235], a[168:171], v[72:75], v[232:235]
    buffer_load_dwordx4 v2, s[8:11], s72 offen offset:0 lds
    v_mfma_f32_16x16x32_bf16 v[232:235], a[184:187], v[76:79], v[232:235]
    v_mfma_f32_16x16x32_bf16 v[236:239], a[140:143], v[64:67], v[236:239]
    v_mfma_f32_16x16x32_bf16 v[236:239], a[156:159], v[68:71], v[236:239]
    v_mfma_f32_16x16x32_bf16 v[236:239], a[172:175], v[72:75], v[236:239]
    buffer_load_dwordx4 v3, s[8:11], s72 offen offset:1024 lds
    v_mfma_f32_16x16x32_bf16 v[236:239], a[188:191], v[76:79], v[236:239]
    s_waitcnt lgkmcnt(2)
    s_waitcnt vmcnt(28)
    s_barrier
    v_mfma_f32_16x16x32_bf16 v[240:243], a[128:131], v[80:83], v[240:243]
    ds_read_b64_tr_b16 v[64:65], v16 offset:32768
    s_add_u32 s69, s66, 4096
    v_mfma_f32_16x16x32_bf16 v[240:243], a[144:147], v[84:87], v[240:243]
    ds_read_b64_tr_b16 v[66:67], v16 offset:33280
    v_mfma_f32_16x16x32_bf16 v[240:243], a[160:163], v[88:91], v[240:243]
    buffer_store_dwordx4 v[116:119], v1, s[48:51], s69 offen offset:3072 sc1
    v_mfma_f32_16x16x32_bf16 v[240:243], a[176:179], v[92:95], v[240:243]
    ds_read_b64_tr_b16 v[68:69], v16 offset:36864
    v_mfma_f32_16x16x32_bf16 v[244:247], a[132:135], v[80:83], v[244:247]
    ds_read_b64_tr_b16 v[70:71], v16 offset:37376
    v_mfma_f32_16x16x32_bf16 v[244:247], a[148:151], v[84:87], v[244:247]
    ds_read_b64_tr_b16 v[72:73], v16 offset:40960
    v_mfma_f32_16x16x32_bf16 v[244:247], a[164:167], v[88:91], v[244:247]
    buffer_load_dwordx4 v4, s[8:11], s72 offen offset:2048 lds
    v_mfma_f32_16x16x32_bf16 v[244:247], a[180:183], v[92:95], v[244:247]
    ds_read_b64_tr_b16 v[74:75], v16 offset:41472
    v_mfma_f32_16x16x32_bf16 v[248:251], a[136:139], v[80:83], v[248:251]
    ds_read_b64_tr_b16 v[76:77], v16 offset:45056
    v_mfma_f32_16x16x32_bf16 v[248:251], a[152:155], v[84:87], v[248:251]
    ds_read_b64_tr_b16 v[78:79], v16 offset:45568
    v_mfma_f32_16x16x32_bf16 v[248:251], a[168:171], v[88:91], v[248:251]
    buffer_load_dwordx4 v5, s[8:11], s72 offen offset:3072 lds
    v_mfma_f32_16x16x32_bf16 v[248:251], a[184:187], v[92:95], v[248:251]
    s_add_u32 m0, s61, 16384
    s_add_u32 s71, s75, 128
    v_mfma_f32_16x16x32_bf16 v[252:255], a[140:143], v[80:83], v[252:255]
    v_mfma_f32_16x16x32_bf16 v[252:255], a[156:159], v[84:87], v[252:255]
    v_mfma_f32_16x16x32_bf16 v[252:255], a[172:175], v[88:91], v[252:255]
    buffer_load_dwordx4 v12, s[20:23], s71 offen lds
    v_mfma_f32_16x16x32_bf16 v[252:255], a[188:191], v[92:95], v[252:255]
    s_add_u32 m0, s61, 17408
    s_add_u32 s71, s75, 65664
    s_waitcnt lgkmcnt(0)
    v_mfma_f32_16x16x32_bf16 v[128:131], a[192:195], v[64:67], v[128:131]
    ds_read_b64_tr_b16 v[80:81], v17 offset:32768
    s_add_u32 s69, s66, 8192
    v_mfma_f32_16x16x32_bf16 v[128:131], a[208:211], v[68:71], v[128:131]
    ds_read_b64_tr_b16 v[82:83], v17 offset:33280
    v_mfma_f32_16x16x32_bf16 v[128:131], a[224:227], v[72:75], v[128:131]
    buffer_load_dwordx4 v13, s[20:23], s71 offen lds
    v_mfma_f32_16x16x32_bf16 v[128:131], a[240:243], v[76:79], v[128:131]
    ds_read_b64_tr_b16 v[84:85], v17 offset:36864
    s_add_u32 m0, s61, 18432
    v_mfma_f32_16x16x32_bf16 v[132:135], a[196:199], v[64:67], v[132:135]
    ds_read_b64_tr_b16 v[86:87], v17 offset:37376
    s_add_u32 s71, s75, 131200
    v_mfma_f32_16x16x32_bf16 v[132:135], a[212:215], v[68:71], v[132:135]
    ds_read_b64_tr_b16 v[88:89], v17 offset:40960
    v_mfma_f32_16x16x32_bf16 v[132:135], a[228:231], v[72:75], v[132:135]
    buffer_load_dwordx4 v12, s[20:23], s71 offen lds
    v_mfma_f32_16x16x32_bf16 v[132:135], a[244:247], v[76:79], v[132:135]
    ds_read_b64_tr_b16 v[90:91], v17 offset:41472
    s_add_u32 m0, s61, 19456
    v_mfma_f32_16x16x32_bf16 v[136:139], a[200:203], v[64:67], v[136:139]
    ds_read_b64_tr_b16 v[92:93], v17 offset:45056
    s_add_u32 s71, s75, 196736
    v_mfma_f32_16x16x32_bf16 v[136:139], a[216:219], v[68:71], v[136:139]
    ds_read_b64_tr_b16 v[94:95], v17 offset:45568
    v_mfma_f32_16x16x32_bf16 v[136:139], a[232:235], v[72:75], v[136:139]
    buffer_load_dwordx4 v13, s[20:23], s71 offen lds
    v_mfma_f32_16x16x32_bf16 v[136:139], a[248:251], v[76:79], v[136:139]
    s_add_u32 m0, s62, 4096
    s_add_u32 s72, s93, 4096
    v_mfma_f32_16x16x32_bf16 v[140:143], a[204:207], v[64:67], v[140:143]
    v_mfma_f32_16x16x32_bf16 v[140:143], a[220:223], v[68:71], v[140:143]
    v_mfma_f32_16x16x32_bf16 v[140:143], a[236:239], v[72:75], v[140:143]
    buffer_store_dwordx4 v[120:123], v1, s[48:51], s69 offen offset:3072 sc1
    v_mfma_f32_16x16x32_bf16 v[140:143], a[252:255], v[76:79], v[140:143]
    s_waitcnt lgkmcnt(0)
    v_mfma_f32_16x16x32_bf16 v[144:147], a[192:195], v[80:83], v[144:147]
    ds_read_b64_tr_b16 v[64:65], v18 offset:32768
    v_cvt_pk_bf16_f32 v28, v128, v129
    v_mfma_f32_16x16x32_bf16 v[144:147], a[208:211], v[84:87], v[144:147]
    ds_read_b64_tr_b16 v[66:67], v18 offset:33280
    v_cvt_pk_bf16_f32 v29, v130, v131
    v_mfma_f32_16x16x32_bf16 v[144:147], a[224:227], v[88:91], v[144:147]
    buffer_load_dword v125, v127, s[8:11], s1 offen offset:768
    v_mfma_f32_16x16x32_bf16 v[144:147], a[240:243], v[92:95], v[144:147]
    ds_read_b64_tr_b16 v[68:69], v18 offset:36864
    v_cvt_pk_bf16_f32 v30, v132, v133
    v_mfma_f32_16x16x32_bf16 v[148:151], a[196:199], v[80:83], v[148:151]
    ds_read_b64_tr_b16 v[70:71], v18 offset:37376
    v_cvt_pk_bf16_f32 v31, v134, v135
    v_mfma_f32_16x16x32_bf16 v[148:151], a[212:215], v[84:87], v[148:151]
    ds_read_b64_tr_b16 v[72:73], v18 offset:40960
    v_cvt_pk_bf16_f32 v32, v136, v137
    v_mfma_f32_16x16x32_bf16 v[148:151], a[228:231], v[88:91], v[148:151]
    buffer_load_dwordx4 v6, s[8:11], s72 offen offset:0 lds
    v_mfma_f32_16x16x32_bf16 v[148:151], a[244:247], v[92:95], v[148:151]
    ds_read_b64_tr_b16 v[74:75], v18 offset:41472
    v_cvt_pk_bf16_f32 v33, v138, v139
    v_mfma_f32_16x16x32_bf16 v[152:155], a[200:203], v[80:83], v[152:155]
    ds_read_b64_tr_b16 v[76:77], v18 offset:45056
    v_cvt_pk_bf16_f32 v34, v140, v141
    v_mfma_f32_16x16x32_bf16 v[152:155], a[216:219], v[84:87], v[152:155]
    ds_read_b64_tr_b16 v[78:79], v18 offset:45568
    v_cvt_pk_bf16_f32 v35, v142, v143
    v_mfma_f32_16x16x32_bf16 v[152:155], a[232:235], v[88:91], v[152:155]
    buffer_load_dwordx4 v7, s[8:11], s72 offen offset:1024 lds
    v_mfma_f32_16x16x32_bf16 v[152:155], a[248:251], v[92:95], v[152:155]
    v_mfma_f32_16x16x32_bf16 v[156:159], a[204:207], v[80:83], v[156:159]
    v_mfma_f32_16x16x32_bf16 v[156:159], a[220:223], v[84:87], v[156:159]
    v_mfma_f32_16x16x32_bf16 v[156:159], a[236:239], v[88:91], v[156:159]
    buffer_load_dwordx4 v8, s[8:11], s72 offen offset:2048 lds
    v_mfma_f32_16x16x32_bf16 v[156:159], a[252:255], v[92:95], v[156:159]
    s_waitcnt lgkmcnt(0)
    v_mfma_f32_16x16x32_bf16 v[160:163], a[192:195], v[64:67], v[160:163]
    ds_read_b64_tr_b16 v[80:81], v19 offset:32768
    s_add_u32 s69, s66, 12288
    v_mfma_f32_16x16x32_bf16 v[160:163], a[208:211], v[68:71], v[160:163]
    ds_read_b64_tr_b16 v[82:83], v19 offset:33280
    v_cvt_pk_bf16_f32 v36, v144, v145
    v_mfma_f32_16x16x32_bf16 v[160:163], a[224:227], v[72:75], v[160:163]
    buffer_store_dwordx4 v[20:23], v1, s[48:51], s69 offen offset:3072 sc1
    v_mfma_f32_16x16x32_bf16 v[160:163], a[240:243], v[76:79], v[160:163]
    ds_read_b64_tr_b16 v[84:85], v19 offset:36864
    v_cvt_pk_bf16_f32 v37, v146, v147
    v_mfma_f32_16x16x32_bf16 v[164:167], a[196:199], v[64:67], v[164:167]
    ds_read_b64_tr_b16 v[86:87], v19 offset:37376
    v_cvt_pk_bf16_f32 v38, v148, v149
    v_mfma_f32_16x16x32_bf16 v[164:167], a[212:215], v[68:71], v[164:167]
    ds_read_b64_tr_b16 v[88:89], v19 offset:40960
    v_cvt_pk_bf16_f32 v39, v150, v151
    v_mfma_f32_16x16x32_bf16 v[164:167], a[228:231], v[72:75], v[164:167]
    buffer_load_dwordx4 v9, s[8:11], s72 offen offset:3072 lds
    v_mfma_f32_16x16x32_bf16 v[164:167], a[244:247], v[76:79], v[164:167]
    ds_read_b64_tr_b16 v[90:91], v19 offset:41472
    v_cvt_pk_bf16_f32 v40, v152, v153
    v_mfma_f32_16x16x32_bf16 v[168:171], a[200:203], v[64:67], v[168:171]
    ds_read_b64_tr_b16 v[92:93], v19 offset:45056
    v_cvt_pk_bf16_f32 v41, v154, v155
    v_mfma_f32_16x16x32_bf16 v[168:171], a[216:219], v[68:71], v[168:171]
    ds_read_b64_tr_b16 v[94:95], v19 offset:45568
    v_cvt_pk_bf16_f32 v42, v156, v157
    v_mfma_f32_16x16x32_bf16 v[168:171], a[232:235], v[72:75], v[168:171]
    v_cvt_pk_bf16_f32 v43, v158, v159
    v_mfma_f32_16x16x32_bf16 v[168:171], a[248:251], v[76:79], v[168:171]
    v_mfma_f32_16x16x32_bf16 v[172:175], a[204:207], v[64:67], v[172:175]
    v_mfma_f32_16x16x32_bf16 v[172:175], a[220:223], v[68:71], v[172:175]
    v_mfma_f32_16x16x32_bf16 v[172:175], a[236:239], v[72:75], v[172:175]
    v_mfma_f32_16x16x32_bf16 v[172:175], a[252:255], v[76:79], v[172:175]
    s_waitcnt lgkmcnt(0)
    s_waitcnt vmcnt(34)
    s_barrier
    v_mfma_f32_16x16x32_bf16 v[176:179], a[192:195], v[80:83], v[176:179]
    ds_read_b64_tr_b16 v[64:65], v16 offset:49152
    s_add_u32 m0, s61, 32768
    v_mfma_f32_16x16x32_bf16 v[176:179], a[208:211], v[84:87], v[176:179]
    ds_read_b64_tr_b16 v[66:67], v16 offset:49664
    s_add_u32 s71, s98, 0
    v_mfma_f32_16x16x32_bf16 v[176:179], a[224:227], v[88:91], v[176:179]
    buffer_load_dwordx4 v12, s[20:23], s71 offen lds
    v_mfma_f32_16x16x32_bf16 v[176:179], a[240:243], v[92:95], v[176:179]
    ds_read_b64_tr_b16 v[68:69], v16 offset:53248
    s_add_u32 m0, s61, 33792
    v_mfma_f32_16x16x32_bf16 v[180:183], a[196:199], v[80:83], v[180:183]
    ds_read_b64_tr_b16 v[70:71], v16 offset:53760
    s_add_u32 s71, s98, 65536
    v_mfma_f32_16x16x32_bf16 v[180:183], a[212:215], v[84:87], v[180:183]
    ds_read_b64_tr_b16 v[72:73], v16 offset:57344
    v_cvt_pk_bf16_f32 v44, v160, v161
    v_mfma_f32_16x16x32_bf16 v[180:183], a[228:231], v[88:91], v[180:183]
    buffer_load_dwordx4 v13, s[20:23], s71 offen lds
    v_mfma_f32_16x16x32_bf16 v[180:183], a[244:247], v[92:95], v[180:183]
    ds_read_b64_tr_b16 v[74:75], v16 offset:57856
    s_add_u32 m0, s61, 34816
    v_mfma_f32_16x16x32_bf16 v[184:187], a[200:203], v[80:83], v[184:187]
    ds_read_b64_tr_b16 v[76:77], v16 offset:61440
    s_add_u32 s71, s98, 131072
    v_mfma_f32_16x16x32_bf16 v[184:187], a[216:219], v[84:87], v[184:187]
    ds_read_b64_tr_b16 v[78:79], v16 offset:61952
    v_cvt_pk_bf16_f32 v45, v162, v163
    v_mfma_f32_16x16x32_bf16 v[184:187], a[232:235], v[88:91], v[184:187]
    buffer_load_dwordx4 v12, s[20:23], s71 offen lds
    v_mfma_f32_16x16x32_bf16 v[184:187], a[248:251], v[92:95], v[184:187]
    s_add_u32 m0, s61, 35840
    s_add_u32 s71, s98, 196608
    v_mfma_f32_16x16x32_bf16 v[188:191], a[204:207], v[80:83], v[188:191]
    v_cvt_pk_bf16_f32 v46, v164, v165
    v_cvt_pk_bf16_f32 v47, v166, v167
    v_mfma_f32_16x16x32_bf16 v[188:191], a[220:223], v[84:87], v[188:191]
    v_cvt_pk_bf16_f32 v48, v168, v169
    v_cvt_pk_bf16_f32 v49, v170, v171
    v_mfma_f32_16x16x32_bf16 v[188:191], a[236:239], v[88:91], v[188:191]
    buffer_load_dwordx4 v13, s[20:23], s71 offen lds
    v_mfma_f32_16x16x32_bf16 v[188:191], a[252:255], v[92:95], v[188:191]
    v_cvt_pk_bf16_f32 v50, v172, v173
    v_cvt_pk_bf16_f32 v51, v174, v175
    s_waitcnt lgkmcnt(0)
    v_mfma_f32_16x16x32_bf16 v[192:195], a[192:195], v[64:67], v[192:195]
    ds_read_b64_tr_b16 v[80:81], v17 offset:49152
    s_waitcnt vmcnt(27)
    v_mfma_f32_16x16x32_bf16 v[192:195], a[208:211], v[68:71], v[192:195]
    ds_read_b64_tr_b16 v[82:83], v17 offset:49664
    ds_read_b128 a[96:99], v10 offset:16384
    v_mfma_f32_16x16x32_bf16 v[192:195], a[224:227], v[72:75], v[192:195]
    ds_read_b64_tr_b16 v[84:85], v17 offset:53248
    ds_read_b128 a[100:103], v10 offset:16640
    v_mfma_f32_16x16x32_bf16 v[192:195], a[240:243], v[76:79], v[192:195]
    ds_read_b64_tr_b16 v[86:87], v17 offset:53760
    ds_read_b128 a[104:107], v10 offset:16896
    v_mfma_f32_16x16x32_bf16 v[196:199], a[196:199], v[64:67], v[196:199]
    ds_read_b64_tr_b16 v[88:89], v17 offset:57344
    ds_read_b128 a[108:111], v10 offset:17152
    v_mfma_f32_16x16x32_bf16 v[196:199], a[212:215], v[68:71], v[196:199]
    ds_read_b64_tr_b16 v[90:91], v17 offset:57856
    ds_read_b128 a[112:115], v11 offset:16384
    v_mfma_f32_16x16x32_bf16 v[196:199], a[228:231], v[72:75], v[196:199]
    ds_read_b64_tr_b16 v[92:93], v17 offset:61440
    ds_read_b128 a[116:119], v11 offset:16640
    v_mfma_f32_16x16x32_bf16 v[196:199], a[244:247], v[76:79], v[196:199]
    ds_read_b64_tr_b16 v[94:95], v17 offset:61952
    ds_read_b128 a[120:123], v11 offset:16896
    v_mfma_f32_16x16x32_bf16 v[200:203], a[200:203], v[64:67], v[200:203]
    ds_read_b128 a[124:127], v11 offset:17152
    s_add_u32 m0, s62, 8192
    v_mfma_f32_16x16x32_bf16 v[200:203], a[216:219], v[68:71], v[200:203]
    s_add_u32 s72, s93, 128
    v_cvt_pk_bf16_f32 v52, v176, v177
    v_mfma_f32_16x16x32_bf16 v[200:203], a[232:235], v[72:75], v[200:203]
    buffer_load_dwordx4 v2, s[8:11], s72 offen offset:0 lds
    v_mfma_f32_16x16x32_bf16 v[200:203], a[248:251], v[76:79], v[200:203]
    v_cvt_pk_bf16_f32 v53, v178, v179
    v_cvt_pk_bf16_f32 v54, v180, v181
    v_mfma_f32_16x16x32_bf16 v[204:207], a[204:207], v[64:67], v[204:207]
    v_cvt_pk_bf16_f32 v55, v182, v183
    v_cvt_pk_bf16_f32 v56, v184, v185
    v_mfma_f32_16x16x32_bf16 v[204:207], a[220:223], v[68:71], v[204:207]
    v_cvt_pk_bf16_f32 v57, v186, v187
    v_cvt_pk_bf16_f32 v58, v188, v189
    v_mfma_f32_16x16x32_bf16 v[204:207], a[236:239], v[72:75], v[204:207]
    buffer_load_dwordx4 v3, s[8:11], s72 offen offset:1024 lds
    v_mfma_f32_16x16x32_bf16 v[204:207], a[252:255], v[76:79], v[204:207]
    v_cvt_pk_bf16_f32 v59, v190, v191
    s_waitcnt lgkmcnt(2)
    v_mfma_f32_16x16x32_bf16 v[208:211], a[192:195], v[80:83], v[208:211]
    ds_read_b64_tr_b16 v[64:65], v18 offset:49152
    v_cvt_pk_bf16_f32 v96, v192, v193
    v_mfma_f32_16x16x32_bf16 v[208:211], a[208:211], v[84:87], v[208:211]
    ds_read_b64_tr_b16 v[66:67], v18 offset:49664
    v_cvt_pk_bf16_f32 v97, v194, v195
    v_mfma_f32_16x16x32_bf16 v[208:211], a[224:227], v[88:91], v[208:211]
    buffer_load_dwordx4 v4, s[8:11], s72 offen offset:2048 lds
    v_mfma_f32_16x16x32_bf16 v[208:211], a[240:243], v[92:95], v[208:211]
    ds_read_b64_tr_b16 v[68:69], v18 offset:53248
    v_cvt_pk_bf16_f32 v98, v196, v197
    v_mfma_f32_16x16x32_bf16 v[212:215], a[196:199], v[80:83], v[212:215]
    ds_read_b64_tr_b16 v[70:71], v18 offset:53760
    v_cvt_pk_bf16_f32 v99, v198, v199
    v_mfma_f32_16x16x32_bf16 v[212:215], a[212:215], v[84:87], v[212:215]
    ds_read_b64_tr_b16 v[72:73], v18 offset:57344
    v_cvt_pk_bf16_f32 v100, v200, v201
    v_mfma_f32_16x16x32_bf16 v[212:215], a[228:231], v[88:91], v[212:215]
    buffer_load_dwordx4 v5, s[8:11], s72 offen offset:3072 lds
    v_mfma_f32_16x16x32_bf16 v[212:215], a[244:247], v[92:95], v[212:215]
    ds_read_b64_tr_b16 v[74:75], v18 offset:57856
    s_add_u32 m0, s62, 12288
    v_mfma_f32_16x16x32_bf16 v[216:219], a[200:203], v[80:83], v[216:219]
    ds_read_b64_tr_b16 v[76:77], v18 offset:61440
    s_add_u32 s72, s93, 4224
    v_mfma_f32_16x16x32_bf16 v[216:219], a[216:219], v[84:87], v[216:219]
    ds_read_b64_tr_b16 v[78:79], v18 offset:61952
    v_cvt_pk_bf16_f32 v101, v202, v203
    v_mfma_f32_16x16x32_bf16 v[216:219], a[232:235], v[88:91], v[216:219]
    buffer_load_dwordx4 v6, s[8:11], s72 offen offset:0 lds
    v_mfma_f32_16x16x32_bf16 v[216:219], a[248:251], v[92:95], v[216:219]
    v_cvt_pk_bf16_f32 v102, v204, v205
    v_cvt_pk_bf16_f32 v103, v206, v207
    v_mfma_f32_16x16x32_bf16 v[220:223], a[204:207], v[80:83], v[220:223]
    v_mfma_f32_16x16x32_bf16 v[220:223], a[220:223], v[84:87], v[220:223]
    v_mfma_f32_16x16x32_bf16 v[220:223], a[236:239], v[88:91], v[220:223]
    buffer_load_dwordx4 v7, s[8:11], s72 offen offset:1024 lds
    v_mfma_f32_16x16x32_bf16 v[220:223], a[252:255], v[92:95], v[220:223]
    s_waitcnt lgkmcnt(0)
    v_mfma_f32_16x16x32_bf16 v[224:227], a[192:195], v[64:67], v[224:227]
    ds_read_b64_tr_b16 v[80:81], v19 offset:49152
    s_add_u32 s69, s66, 16777216
    v_mfma_f32_16x16x32_bf16 v[224:227], a[208:211], v[68:71], v[224:227]
    ds_read_b64_tr_b16 v[82:83], v19 offset:49664
    v_cvt_pk_bf16_f32 v104, v208, v209
    v_mfma_f32_16x16x32_bf16 v[224:227], a[224:227], v[72:75], v[224:227]
    buffer_store_dwordx4 v[28:31], v1, s[48:51], s69 offen offset:0 sc1
    v_mfma_f32_16x16x32_bf16 v[224:227], a[240:243], v[76:79], v[224:227]
    ds_read_b64_tr_b16 v[84:85], v19 offset:53248
    v_cvt_pk_bf16_f32 v105, v210, v211
    v_mfma_f32_16x16x32_bf16 v[228:231], a[196:199], v[64:67], v[228:231]
    ds_read_b64_tr_b16 v[86:87], v19 offset:53760
    v_cvt_pk_bf16_f32 v106, v212, v213
    v_mfma_f32_16x16x32_bf16 v[228:231], a[212:215], v[68:71], v[228:231]
    ds_read_b64_tr_b16 v[88:89], v19 offset:57344
    v_cvt_pk_bf16_f32 v107, v214, v215
    v_mfma_f32_16x16x32_bf16 v[228:231], a[228:231], v[72:75], v[228:231]
    buffer_load_dwordx4 v8, s[8:11], s72 offen offset:2048 lds
    v_mfma_f32_16x16x32_bf16 v[228:231], a[244:247], v[76:79], v[228:231]
    ds_read_b64_tr_b16 v[90:91], v19 offset:57856
    v_cvt_pk_bf16_f32 v108, v216, v217
    v_mfma_f32_16x16x32_bf16 v[232:235], a[200:203], v[64:67], v[232:235]
    ds_read_b64_tr_b16 v[92:93], v19 offset:61440
    v_cvt_pk_bf16_f32 v109, v218, v219
    v_mfma_f32_16x16x32_bf16 v[232:235], a[216:219], v[68:71], v[232:235]
    ds_read_b64_tr_b16 v[94:95], v19 offset:61952
    v_cvt_pk_bf16_f32 v110, v220, v221
    v_mfma_f32_16x16x32_bf16 v[232:235], a[232:235], v[72:75], v[232:235]
    buffer_load_dwordx4 v9, s[8:11], s72 offen offset:3072 lds
    v_mfma_f32_16x16x32_bf16 v[232:235], a[248:251], v[76:79], v[232:235]
    v_cvt_pk_bf16_f32 v111, v222, v223
    v_mfma_f32_16x16x32_bf16 v[236:239], a[204:207], v[64:67], v[236:239]
    v_mfma_f32_16x16x32_bf16 v[236:239], a[220:223], v[68:71], v[236:239]
    v_mfma_f32_16x16x32_bf16 v[236:239], a[236:239], v[72:75], v[236:239]
    v_mfma_f32_16x16x32_bf16 v[236:239], a[252:255], v[76:79], v[236:239]
    s_waitcnt lgkmcnt(0)
    s_waitcnt vmcnt(32)
    s_barrier
    v_mfma_f32_16x16x32_bf16 v[240:243], a[192:195], v[80:83], v[240:243]
    ds_read_b64_tr_b16 v[64:65], v16 offset:0
    s_add_u32 m0, s61, 49152
    v_mfma_f32_16x16x32_bf16 v[240:243], a[208:211], v[84:87], v[240:243]
    ds_read_b64_tr_b16 v[66:67], v16 offset:512
    s_add_u32 s71, s98, 128
    v_mfma_f32_16x16x32_bf16 v[240:243], a[224:227], v[88:91], v[240:243]
    buffer_load_dwordx4 v12, s[20:23], s71 offen lds
    v_mfma_f32_16x16x32_bf16 v[240:243], a[240:243], v[92:95], v[240:243]
    ds_read_b64_tr_b16 v[68:69], v16 offset:4096
    s_add_u32 m0, s61, 50176
    v_mfma_f32_16x16x32_bf16 v[244:247], a[196:199], v[80:83], v[244:247]
    ds_read_b64_tr_b16 v[70:71], v16 offset:4608
    s_add_u32 s71, s98, 65664
    v_mfma_f32_16x16x32_bf16 v[244:247], a[212:215], v[84:87], v[244:247]
    ds_read_b64_tr_b16 v[72:73], v16 offset:8192
    s_add_u32 s69, s66, 16785408
    v_mfma_f32_16x16x32_bf16 v[244:247], a[228:231], v[88:91], v[244:247]
    buffer_load_dwordx4 v13, s[20:23], s71 offen lds
    v_mfma_f32_16x16x32_bf16 v[244:247], a[244:247], v[92:95], v[244:247]
    ds_read_b64_tr_b16 v[74:75], v16 offset:8704
    s_add_u32 m0, s61, 51200
    v_mfma_f32_16x16x32_bf16 v[248:251], a[200:203], v[80:83], v[248:251]
    ds_read_b64_tr_b16 v[76:77], v16 offset:12288
    s_add_u32 s71, s98, 131200
    v_mfma_f32_16x16x32_bf16 v[248:251], a[216:219], v[84:87], v[248:251]
    ds_read_b64_tr_b16 v[78:79], v16 offset:12800
    v_cvt_pk_bf16_f32 v112, v224, v225
    v_mfma_f32_16x16x32_bf16 v[248:251], a[232:235], v[88:91], v[248:251]
    buffer_load_dwordx4 v12, s[20:23], s71 offen lds
    v_mfma_f32_16x16x32_bf16 v[248:251], a[248:251], v[92:95], v[248:251]
    s_add_u32 m0, s61, 52224
    s_add_u32 s71, s98, 196736
    v_mfma_f32_16x16x32_bf16 v[252:255], a[204:207], v[80:83], v[252:255]
    v_cvt_pk_bf16_f32 v113, v226, v227
    v_cvt_pk_bf16_f32 v114, v228, v229
    v_mfma_f32_16x16x32_bf16 v[252:255], a[220:223], v[84:87], v[252:255]
    v_cvt_pk_bf16_f32 v115, v230, v231
    v_cvt_pk_bf16_f32 v116, v232, v233
    v_mfma_f32_16x16x32_bf16 v[252:255], a[236:239], v[88:91], v[252:255]
    buffer_load_dwordx4 v13, s[20:23], s71 offen lds
    v_mfma_f32_16x16x32_bf16 v[252:255], a[252:255], v[92:95], v[252:255]
    v_cvt_pk_bf16_f32 v117, v234, v235
    v_cvt_pk_bf16_f32 v118, v236, v237
    s_waitcnt lgkmcnt(0)
    v_mfma_f32_16x16x32_bf16 v[128:131], v[64:67], a[0:3], 0
    ds_read_b64_tr_b16 v[80:81], v17 offset:0
    v_cvt_pk_bf16_f32 v119, v238, v239
    v_mfma_f32_16x16x32_bf16 v[128:131], v[68:71], a[16:19], v[128:131]
    ds_read_b64_tr_b16 v[82:83], v17 offset:512
    v_cvt_pk_bf16_f32 v120, v240, v241
    v_mfma_f32_16x16x32_bf16 v[128:131], v[72:75], a[32:35], v[128:131]
    buffer_store_dwordx4 v[32:35], v1, s[48:51], s69 offen offset:0 sc1
    v_mfma_f32_16x16x32_bf16 v[128:131], v[76:79], a[48:51], v[128:131]
    ds_read_b64_tr_b16 v[84:85], v17 offset:4096
    s_add_u32 s69, s66, 16777216
    v_mfma_f32_16x16x32_bf16 v[132:135], v[64:67], a[4:7], 0
    ds_read_b64_tr_b16 v[86:87], v17 offset:4608
    v_cvt_pk_bf16_f32 v121, v242, v243
    v_mfma_f32_16x16x32_bf16 v[132:135], v[68:71], a[20:23], v[132:135]
    ds_read_b64_tr_b16 v[88:89], v17 offset:8192
    v_cvt_pk_bf16_f32 v122, v244, v245
    v_mfma_f32_16x16x32_bf16 v[132:135], v[72:75], a[36:39], v[132:135]
    buffer_store_dwordx4 v[36:39], v1, s[48:51], s69 offen offset:1024 sc1
    v_mfma_f32_16x16x32_bf16 v[132:135], v[76:79], a[52:55], v[132:135]
    ds_read_b64_tr_b16 v[90:91], v17 offset:8704
    v_cvt_pk_bf16_f32 v123, v246, v247
    v_mfma_f32_16x16x32_bf16 v[136:139], v[64:67], a[8:11], 0
    ds_read_b64_tr_b16 v[92:93], v17 offset:12288
    v_cvt_pk_bf16_f32 v20, v248, v249
    v_mfma_f32_16x16x32_bf16 v[136:139], v[68:71], a[24:27], v[136:139]
    ds_read_b64_tr_b16 v[94:95], v17 offset:12800
    v_cvt_pk_bf16_f32 v21, v250, v251
    v_mfma_f32_16x16x32_bf16 v[136:139], v[72:75], a[40:43], v[136:139]
    v_cvt_pk_bf16_f32 v22, v252, v253
    v_cvt_pk_bf16_f32 v23, v254, v255
    v_mfma_f32_16x16x32_bf16 v[136:139], v[76:79], a[56:59], v[136:139]
    v_mfma_f32_16x16x32_bf16 v[140:143], v[64:67], a[12:15], 0
    v_mfma_f32_16x16x32_bf16 v[140:143], v[68:71], a[28:31], v[140:143]
    v_mfma_f32_16x16x32_bf16 v[140:143], v[72:75], a[44:47], v[140:143]
    v_mfma_f32_16x16x32_bf16 v[140:143], v[76:79], a[60:63], v[140:143]
    s_waitcnt lgkmcnt(0)
    v_mfma_f32_16x16x32_bf16 v[144:147], v[80:83], a[0:3], 0
    buffer_load_dword v125, v127, s[8:11], s1 offen offset:896
    v_mfma_f32_16x16x32_bf16 v[144:147], v[84:87], a[16:19], v[144:147]
    ds_read_b64_tr_b16 v[64:65], v18 offset:0
    v_mfma_f32_16x16x32_bf16 v[144:147], v[88:91], a[32:35], v[144:147]
    ds_read_b64_tr_b16 v[66:67], v18 offset:512
    v_mfma_f32_16x16x32_bf16 v[144:147], v[92:95], a[48:51], v[144:147]
    ds_read_b64_tr_b16 v[68:69], v18 offset:4096
    v_mfma_f32_16x16x32_bf16 v[148:151], v[80:83], a[4:7], 0
    ds_read_b64_tr_b16 v[70:71], v18 offset:4608
    v_mfma_f32_16x16x32_bf16 v[148:151], v[84:87], a[20:23], v[148:151]
    ds_read_b64_tr_b16 v[72:73], v18 offset:8192
    v_mfma_f32_16x16x32_bf16 v[148:151], v[88:91], a[36:39], v[148:151]
    ds_read_b64_tr_b16 v[74:75], v18 offset:8704
    v_mfma_f32_16x16x32_bf16 v[148:151], v[92:95], a[52:55], v[148:151]
    ds_read_b64_tr_b16 v[76:77], v18 offset:12288
    v_mfma_f32_16x16x32_bf16 v[152:155], v[80:83], a[8:11], 0
    ds_read_b64_tr_b16 v[78:79], v18 offset:12800
    v_mfma_f32_16x16x32_bf16 v[152:155], v[84:87], a[24:27], v[152:155]
    v_mfma_f32_16x16x32_bf16 v[152:155], v[88:91], a[40:43], v[152:155]
    v_mfma_f32_16x16x32_bf16 v[152:155], v[92:95], a[56:59], v[152:155]
    v_mfma_f32_16x16x32_bf16 v[156:159], v[80:83], a[12:15], 0
    v_mfma_f32_16x16x32_bf16 v[156:159], v[84:87], a[28:31], v[156:159]
    v_mfma_f32_16x16x32_bf16 v[156:159], v[88:91], a[44:47], v[156:159]
    v_mfma_f32_16x16x32_bf16 v[156:159], v[92:95], a[60:63], v[156:159]
    s_waitcnt lgkmcnt(0)
    v_mfma_f32_16x16x32_bf16 v[160:163], v[64:67], a[0:3], 0
    ds_read_b64_tr_b16 v[80:81], v19 offset:0
    s_add_u32 s69, s66, 16785408
    v_mfma_f32_16x16x32_bf16 v[160:163], v[68:71], a[16:19], v[160:163]
    buffer_store_dwordx4 v[40:43], v1, s[48:51], s69 offen offset:1024 sc1
    v_mfma_f32_16x16x32_bf16 v[160:163], v[72:75], a[32:35], v[160:163]
    ds_read_b64_tr_b16 v[82:83], v19 offset:512
    s_waitcnt vmcnt(21)
    v_mfma_f32_16x16x32_bf16 v[160:163], v[76:79], a[48:51], v[160:163]
    ds_read_b64_tr_b16 v[84:85], v19 offset:4096
    ds_read_b128 a[128:131], v10 offset:0
    v_mfma_f32_16x16x32_bf16 v[164:167], v[64:67], a[4:7], 0
    ds_read_b64_tr_b16 v[86:87], v19 offset:4608
    ds_read_b128 a[132:135], v10 offset:256
    v_mfma_f32_16x16x32_bf16 v[164:167], v[68:71], a[20:23], v[164:167]
    ds_read_b64_tr_b16 v[88:89], v19 offset:8192
    ds_read_b128 a[136:139], v10 offset:512
    v_mfma_f32_16x16x32_bf16 v[164:167], v[72:75], a[36:39], v[164:167]
    ds_read_b64_tr_b16 v[90:91], v19 offset:8704
    ds_read_b128 a[140:143], v10 offset:768
    v_mfma_f32_16x16x32_bf16 v[164:167], v[76:79], a[52:55], v[164:167]
    ds_read_b64_tr_b16 v[92:93], v19 offset:12288
    ds_read_b128 a[144:147], v11 offset:0
    v_mfma_f32_16x16x32_bf16 v[168:171], v[64:67], a[8:11], 0
    ds_read_b64_tr_b16 v[94:95], v19 offset:12800
    ds_read_b128 a[148:151], v11 offset:256
    v_mfma_f32_16x16x32_bf16 v[168:171], v[68:71], a[24:27], v[168:171]
    ds_read_b128 a[152:155], v11 offset:512
    v_mfma_f32_16x16x32_bf16 v[168:171], v[72:75], a[40:43], v[168:171]
    ds_read_b128 a[156:159], v11 offset:768
    s_add_u32 m0, s62, 16384
    v_mfma_f32_16x16x32_bf16 v[168:171], v[76:79], a[56:59], v[168:171]
    s_add_u32 s72, s94, 0
    v_mfma_f32_16x16x32_bf16 v[172:175], v[64:67], a[12:15], 0
    buffer_load_dwordx4 v2, s[8:11], s72 offen offset:0 lds
    v_mfma_f32_16x16x32_bf16 v[172:175], v[68:71], a[28:31], v[172:175]
    v_mfma_f32_16x16x32_bf16 v[172:175], v[72:75], a[44:47], v[172:175]
    v_mfma_f32_16x16x32_bf16 v[172:175], v[76:79], a[60:63], v[172:175]
    s_waitcnt lgkmcnt(3)
    s_barrier
    v_mfma_f32_16x16x32_bf16 v[176:179], v[80:83], a[0:3], 0
    buffer_load_dwordx4 v3, s[8:11], s72 offen offset:1024 lds
    v_mfma_f32_16x16x32_bf16 v[176:179], v[84:87], a[16:19], v[176:179]
    ds_read_b64_tr_b16 v[64:65], v16 offset:16384
    s_add_u32 s69, s66, 16777216
    v_mfma_f32_16x16x32_bf16 v[176:179], v[88:91], a[32:35], v[176:179]
    ds_read_b64_tr_b16 v[66:67], v16 offset:16896
    v_mfma_f32_16x16x32_bf16 v[176:179], v[92:95], a[48:51], v[176:179]
    ds_read_b64_tr_b16 v[68:69], v16 offset:20480
    v_mfma_f32_16x16x32_bf16 v[180:183], v[80:83], a[4:7], 0
    buffer_store_dwordx4 v[44:47], v1, s[48:51], s69 offen offset:2048 sc1
    v_mfma_f32_16x16x32_bf16 v[180:183], v[84:87], a[20:23], v[180:183]
    ds_read_b64_tr_b16 v[70:71], v16 offset:20992
    v_mfma_f32_16x16x32_bf16 v[180:183], v[88:91], a[36:39], v[180:183]
    ds_read_b64_tr_b16 v[72:73], v16 offset:24576
    v_mfma_f32_16x16x32_bf16 v[180:183], v[92:95], a[52:55], v[180:183]
    ds_read_b64_tr_b16 v[74:75], v16 offset:25088
    v_mfma_f32_16x16x32_bf16 v[184:187], v[80:83], a[8:11], 0
    buffer_load_dwordx4 v4, s[8:11], s72 offen offset:2048 lds
    v_mfma_f32_16x16x32_bf16 v[184:187], v[84:87], a[24:27], v[184:187]
    ds_read_b64_tr_b16 v[76:77], v16 offset:28672
    v_mfma_f32_16x16x32_bf16 v[184:187], v[88:91], a[40:43], v[184:187]
    ds_read_b64_tr_b16 v[78:79], v16 offset:29184
    v_mfma_f32_16x16x32_bf16 v[184:187], v[92:95], a[56:59], v[184:187]
    v_mfma_f32_16x16x32_bf16 v[188:191], v[80:83], a[12:15], 0
    buffer_load_dwordx4 v5, s[8:11], s72 offen offset:3072 lds
    v_mfma_f32_16x16x32_bf16 v[188:191], v[84:87], a[28:31], v[188:191]
    s_add_u32 m0, s61, 0
    s_add_u32 s71, s99, 0
    v_mfma_f32_16x16x32_bf16 v[188:191], v[88:91], a[44:47], v[188:191]
    v_mfma_f32_16x16x32_bf16 v[188:191], v[92:95], a[60:63], v[188:191]
    s_waitcnt lgkmcnt(0)
    v_mfma_f32_16x16x32_bf16 v[192:195], v[64:67], a[0:3], 0
    buffer_load_dwordx4 v12, s[20:23], s71 offen lds
    v_mfma_f32_16x16x32_bf16 v[192:195], v[68:71], a[16:19], v[192:195]
    ds_read_b64_tr_b16 v[80:81], v17 offset:16384
    s_add_u32 m0, s61, 1024
    v_mfma_f32_16x16x32_bf16 v[192:195], v[72:75], a[32:35], v[192:195]
    ds_read_b64_tr_b16 v[82:83], v17 offset:16896
    s_add_u32 s71, s99, 65536
    v_mfma_f32_16x16x32_bf16 v[192:195], v[76:79], a[48:51], v[192:195]
    ds_read_b64_tr_b16 v[84:85], v17 offset:20480
    s_and_b32 s90, s52, 3
    v_mfma_f32_16x16x32_bf16 v[196:199], v[64:67], a[4:7], 0
    buffer_load_dwordx4 v13, s[20:23], s71 offen lds
    v_mfma_f32_16x16x32_bf16 v[196:199], v[68:71], a[20:23], v[196:199]
    ds_read_b64_tr_b16 v[86:87], v17 offset:20992
    s_add_u32 m0, s61, 2048
    v_mfma_f32_16x16x32_bf16 v[196:199], v[72:75], a[36:39], v[196:199]
    ds_read_b64_tr_b16 v[88:89], v17 offset:24576
    s_add_u32 s71, s99, 131072
    v_mfma_f32_16x16x32_bf16 v[196:199], v[76:79], a[52:55], v[196:199]
    ds_read_b64_tr_b16 v[90:91], v17 offset:25088
    s_lshl_b32 s90, s90, 3
    v_mfma_f32_16x16x32_bf16 v[200:203], v[64:67], a[8:11], 0
    buffer_load_dwordx4 v12, s[20:23], s71 offen lds
    v_mfma_f32_16x16x32_bf16 v[200:203], v[68:71], a[24:27], v[200:203]
    ds_read_b64_tr_b16 v[92:93], v17 offset:28672
    s_add_u32 m0, s61, 3072
    v_mfma_f32_16x16x32_bf16 v[200:203], v[72:75], a[40:43], v[200:203]
    ds_read_b64_tr_b16 v[94:95], v17 offset:29184
    s_add_u32 s71, s99, 196608
    v_mfma_f32_16x16x32_bf16 v[200:203], v[76:79], a[56:59], v[200:203]
    s_add_u32 s90, s90, s53
    s_lshl_b32 s90, s90, 2
    v_mfma_f32_16x16x32_bf16 v[204:207], v[64:67], a[12:15], 0
    buffer_load_dwordx4 v13, s[20:23], s71 offen lds
    v_mfma_f32_16x16x32_bf16 v[204:207], v[68:71], a[28:31], v[204:207]
    s_add_u32 s90, s90, s54
    s_mul_i32 s90, s90, 12288
    v_mfma_f32_16x16x32_bf16 v[204:207], v[72:75], a[44:47], v[204:207]
    s_lshl_b32 s91, s52, 5
    s_add_u32 s90, s90, s91
    v_mfma_f32_16x16x32_bf16 v[204:207], v[76:79], a[60:63], v[204:207]
    v_lshrrev_b32 v124, 4, v0
    v_min_u32 v124, 1, v124
    s_waitcnt lgkmcnt(0)
    v_mfma_f32_16x16x32_bf16 v[208:211], v[80:83], a[0:3], 0
    ds_read_b64_tr_b16 v[64:65], v18 offset:16384
    v_lshlrev_b32 v124, 30, v124
    v_mfma_f32_16x16x32_bf16 v[208:211], v[84:87], a[16:19], v[208:211]
    ds_read_b64_tr_b16 v[66:67], v18 offset:16896
    v_lshl_or_b32 v124, v0, 10, v124
    v_mfma_f32_16x16x32_bf16 v[208:211], v[88:91], a[32:35], v[208:211]
    buffer_load_dword v125, v124, s[24:27], s90 offen offset:0
    v_mfma_f32_16x16x32_bf16 v[208:211], v[92:95], a[48:51], v[208:211]
    ds_read_b64_tr_b16 v[68:69], v18 offset:20480
    s_add_u32 s69, s66, 16785408
    v_mfma_f32_16x16x32_bf16 v[212:215], v[80:83], a[4:7], 0
    ds_read_b64_tr_b16 v[70:71], v18 offset:20992
    s_add_u32 m0, s62, 20480
    v_mfma_f32_16x16x32_bf16 v[212:215], v[84:87], a[20:23], v[212:215]
    ds_read_b64_tr_b16 v[72:73], v18 offset:24576
    s_add_u32 s72, s94, 4096
    v_mfma_f32_16x16x32_bf16 v[212:215], v[88:91], a[36:39], v[212:215]
    buffer_store_dwordx4 v[48:51], v1, s[48:51], s69 offen offset:2048 sc1
    v_mfma_f32_16x16x32_bf16 v[212:215], v[92:95], a[52:55], v[212:215]
    ds_read_b64_tr_b16 v[74:75], v18 offset:25088
    v_mfma_f32_16x16x32_bf16 v[216:219], v[80:83], a[8:11], 0
    ds_read_b64_tr_b16 v[76:77], v18 offset:28672
    v_mfma_f32_16x16x32_bf16 v[216:219], v[84:87], a[24:27], v[216:219]
    ds_read_b64_tr_b16 v[78:79], v18 offset:29184
    v_mfma_f32_16x16x32_bf16 v[216:219], v[88:91], a[40:43], v[216:219]
    buffer_load_dwordx4 v6, s[8:11], s72 offen offset:0 lds
    v_mfma_f32_16x16x32_bf16 v[216:219], v[92:95], a[56:59], v[216:219]
    v_mfma_f32_16x16x32_bf16 v[220:223], v[80:83], a[12:15], 0
    v_mfma_f32_16x16x32_bf16 v[220:223], v[84:87], a[28:31], v[220:223]
    v_mfma_f32_16x16x32_bf16 v[220:223], v[88:91], a[44:47], v[220:223]
    buffer_load_dwordx4 v7, s[8:11], s72 offen offset:1024 lds
    v_mfma_f32_16x16x32_bf16 v[220:223], v[92:95], a[60:63], v[220:223]
    s_waitcnt lgkmcnt(0)
    v_mfma_f32_16x16x32_bf16 v[224:227], v[64:67], a[0:3], 0
    ds_read_b64_tr_b16 v[80:81], v19 offset:16384
    s_add_u32 s69, s66, 16777216
    v_mfma_f32_16x16x32_bf16 v[224:227], v[68:71], a[16:19], v[224:227]
    ds_read_b64_tr_b16 v[82:83], v19 offset:16896
    v_mfma_f32_16x16x32_bf16 v[224:227], v[72:75], a[32:35], v[224:227]
    buffer_store_dwordx4 v[52:55], v1, s[48:51], s69 offen offset:3072 sc1
    v_mfma_f32_16x16x32_bf16 v[224:227], v[76:79], a[48:51], v[224:227]
    ds_read_b64_tr_b16 v[84:85], v19 offset:20480
    v_mfma_f32_16x16x32_bf16 v[228:231], v[64:67], a[4:7], 0
    ds_read_b64_tr_b16 v[86:87], v19 offset:20992
    v_mfma_f32_16x16x32_bf16 v[228:231], v[68:71], a[20:23], v[228:231]
    ds_read_b64_tr_b16 v[88:89], v19 offset:24576
    v_mfma_f32_16x16x32_bf16 v[228:231], v[72:75], a[36:39], v[228:231]
    buffer_load_dwordx4 v8, s[8:11], s72 offen offset:2048 lds
    v_mfma_f32_16x16x32_bf16 v[228:231], v[76:79], a[52:55], v[228:231]
    ds_read_b64_tr_b16 v[90:91], v19 offset:25088
    v_mfma_f32_16x16x32_bf16 v[232:235], v[64:67], a[8:11], 0
    ds_read_b64_tr_b16 v[92:93], v19 offset:28672
    v_mfma_f32_16x16x32_bf16 v[232:235], v[68:71], a[24:27], v[232:235]
    ds_read_b64_tr_b16 v[94:95], v19 offset:29184
    v_mfma_f32_16x16x32_bf16 v[232:235], v[72:75], a[40:43], v[232:235]
    buffer_load_dwordx4 v9, s[8:11], s72 offen offset:3072 lds
    v_mfma_f32_16x16x32_bf16 v[232:235], v[76:79], a[56:59], v[232:235]
    v_mfma_f32_16x16x32_bf16 v[236:239], v[64:67], a[12:15], 0
    v_mfma_f32_16x16x32_bf16 v[236:239], v[68:71], a[28:31], v[236:239]
    v_mfma_f32_16x16x32_bf16 v[236:239], v[72:75], a[44:47], v[236:239]
    v_mfma_f32_16x16x32_bf16 v[236:239], v[76:79], a[60:63], v[236:239]
    s_waitcnt lgkmcnt(0)
    s_waitcnt vmcnt(33)
    s_barrier
    v_mfma_f32_16x16x32_bf16 v[240:243], v[80:83], a[0:3], 0
    ds_read_b64_tr_b16 v[64:65], v16 offset:32768
    s_add_u32 m0, s61, 16384
    v_mfma_f32_16x16x32_bf16 v[240:243], v[84:87], a[16:19], v[240:243]
    ds_read_b64_tr_b16 v[66:67], v16 offset:33280
    s_add_u32 s71, s99, 128
    v_mfma_f32_16x16x32_bf16 v[240:243], v[88:91], a[32:35], v[240:243]
    buffer_load_dwordx4 v12, s[20:23], s71 offen lds
    v_mfma_f32_16x16x32_bf16 v[240:243], v[92:95], a[48:51], v[240:243]
    ds_read_b64_tr_b16 v[68:69], v16 offset:36864
    s_add_u32 m0, s61, 17408
    v_mfma_f32_16x16x32_bf16 v[244:247], v[80:83], a[4:7], 0
    ds_read_b64_tr_b16 v[70:71], v16 offset:37376
    s_add_u32 s71, s99, 65664
    v_mfma_f32_16x16x32_bf16 v[244:247], v[84:87], a[20:23], v[244:247]
    ds_read_b64_tr_b16 v[72:73], v16 offset:40960
    v_mfma_f32_16x16x32_bf16 v[244:247], v[88:91], a[36:39], v[244:247]
    buffer_load_dwordx4 v13, s[20:23], s71 offen lds
    v_mfma_f32_16x16x32_bf16 v[244:247], v[92:95], a[52:55], v[244:247]
    ds_read_b64_tr_b16 v[74:75], v16 offset:41472
    s_add_u32 m0, s61, 18432
    v_mfma_f32_16x16x32_bf16 v[248:251], v[80:83], a[8:11], 0
    ds_read_b64_tr_b16 v[76:77], v16 offset:45056
    s_add_u32 s71, s99, 131200
    v_mfma_f32_16x16x32_bf16 v[248:251], v[84:87], a[24:27], v[248:251]
    ds_read_b64_tr_b16 v[78:79], v16 offset:45568
    v_mfma_f32_16x16x32_bf16 v[248:251], v[88:91], a[40:43], v[248:251]
    buffer_load_dwordx4 v12, s[20:23], s71 offen lds
    v_mfma_f32_16x16x32_bf16 v[248:251], v[92:95], a[56:59], v[248:251]
    s_add_u32 m0, s61, 19456
    s_add_u32 s71, s99, 196736
    v_mfma_f32_16x16x32_bf16 v[252:255], v[80:83], a[12:15], 0
    v_mfma_f32_16x16x32_bf16 v[252:255], v[84:87], a[28:31], v[252:255]
    v_mfma_f32_16x16x32_bf16 v[252:255], v[88:91], a[44:47], v[252:255]
    buffer_load_dwordx4 v13, s[20:23], s71 offen lds
    v_mfma_f32_16x16x32_bf16 v[252:255], v[92:95], a[60:63], v[252:255]
    s_waitcnt lgkmcnt(0)
    v_mfma_f32_16x16x32_bf16 v[128:131], v[64:67], a[64:67], v[128:131]
    ds_read_b64_tr_b16 v[80:81], v17 offset:32768
    s_cmp_eq_u32 s54, 0
    s_cselect_b32 s91, 0, 0x40000000
    v_mfma_f32_16x16x32_bf16 v[128:131], v[68:71], a[80:83], v[128:131]
    ds_read_b64_tr_b16 v[82:83], v17 offset:33280
    v_lshrrev_b32 v62, 0, v0
    v_mfma_f32_16x16x32_bf16 v[128:131], v[72:75], a[96:99], v[128:131]
    ds_read_b64_tr_b16 v[84:85], v17 offset:36864
    v_min_u32 v62, 1, v62
    v_mfma_f32_16x16x32_bf16 v[128:131], v[76:79], a[112:115], v[128:131]
    ds_read_b64_tr_b16 v[86:87], v17 offset:37376
    v_lshlrev_b32 v62, 30, v62
    v_mfma_f32_16x16x32_bf16 v[132:135], v[64:67], a[68:71], v[132:135]
    ds_read_b64_tr_b16 v[88:89], v17 offset:40960
    v_lshl_or_b32 v62, v0, 2, v62
    v_mfma_f32_16x16x32_bf16 v[132:135], v[68:71], a[84:87], v[132:135]
    ds_read_b64_tr_b16 v[90:91], v17 offset:41472
    v_or_b32 v62, s91, v62
    v_mfma_f32_16x16x32_bf16 v[132:135], v[72:75], a[100:103], v[132:135]
    buffer_load_dword v63, v62, s[44:47], 0 offen sc1
    v_mfma_f32_16x16x32_bf16 v[132:135], v[76:79], a[116:119], v[132:135]
    ds_read_b64_tr_b16 v[92:93], v17 offset:45056
    s_add_u32 s69, s66, 16785408
    v_mfma_f32_16x16x32_bf16 v[136:139], v[64:67], a[72:75], v[136:139]
    ds_read_b64_tr_b16 v[94:95], v17 offset:45568
    s_waitcnt vmcnt(29)
    v_mfma_f32_16x16x32_bf16 v[136:139], v[68:71], a[88:91], v[136:139]
    ds_read_b128 a[160:163], v10 offset:8192
    v_mfma_f32_16x16x32_bf16 v[136:139], v[72:75], a[104:107], v[136:139]
    buffer_store_dwordx4 v[56:59], v1, s[48:51], s69 offen offset:3072 sc1
    v_mfma_f32_16x16x32_bf16 v[136:139], v[76:79], a[120:123], v[136:139]
    ds_read_b128 a[164:167], v10 offset:8448
    v_mfma_f32_16x16x32_bf16 v[140:143], v[64:67], a[76:79], v[140:143]
    ds_read_b128 a[168:171], v10 offset:8704
    v_mfma_f32_16x16x32_bf16 v[140:143], v[68:71], a[92:95], v[140:143]
    ds_read_b128 a[172:175], v10 offset:8960
    v_mfma_f32_16x16x32_bf16 v[140:143], v[72:75], a[108:111], v[140:143]
    ds_read_b128 a[176:179], v11 offset:8192
    v_mfma_f32_16x16x32_bf16 v[140:143], v[76:79], a[124:127], v[140:143]
    ds_read_b128 a[180:183], v11 offset:8448
    s_waitcnt lgkmcnt(6)
    v_mfma_f32_16x16x32_bf16 v[144:147], v[80:83], a[64:67], v[144:147]
    ds_read_b64_tr_b16 v[64:65], v18 offset:32768
    ds_read_b128 a[184:187], v11 offset:8704
    v_mfma_f32_16x16x32_bf16 v[144:147], v[84:87], a[80:83], v[144:147]
    ds_read_b64_tr_b16 v[66:67], v18 offset:33280
    ds_read_b128 a[188:191], v11 offset:8960
    v_mfma_f32_16x16x32_bf16 v[144:147], v[88:91], a[96:99], v[144:147]
    ds_read_b64_tr_b16 v[68:69], v18 offset:36864
    s_add_u32 s69, s66, 16781312
    v_mfma_f32_16x16x32_bf16 v[144:147], v[92:95], a[112:115], v[144:147]
    buffer_store_dwordx4 v[96:99], v1, s[48:51], s69 offen offset:0 sc1
    v_mfma_f32_16x16x32_bf16 v[148:151], v[80:83], a[68:71], v[148:151]
    ds_read_b64_tr_b16 v[70:71], v18 offset:37376
    s_add_u32 m0, s62, 0
    v_mfma_f32_16x16x32_bf16 v[148:151], v[84:87], a[84:87], v[148:151]
    ds_read_b64_tr_b16 v[72:73], v18 offset:40960
    s_add_u32 s72, s94, 128
    v_mfma_f32_16x16x32_bf16 v[148:151], v[88:91], a[100:103], v[148:151]
    ds_read_b64_tr_b16 v[74:75], v18 offset:41472
    v_mfma_f32_16x16x32_bf16 v[148:151], v[92:95], a[116:119], v[148:151]
    buffer_load_dwordx4 v2, s[8:11], s72 offen offset:0 lds
    v_mfma_f32_16x16x32_bf16 v[152:155], v[80:83], a[72:75], v[152:155]
    ds_read_b64_tr_b16 v[76:77], v18 offset:45056
    v_mfma_f32_16x16x32_bf16 v[152:155], v[84:87], a[88:91], v[152:155]
    ds_read_b64_tr_b16 v[78:79], v18 offset:45568
    v_mfma_f32_16x16x32_bf16 v[152:155], v[88:91], a[104:107], v[152:155]
    v_mfma_f32_16x16x32_bf16 v[152:155], v[92:95], a[120:123], v[152:155]
    buffer_load_dwordx4 v3, s[8:11], s72 offen offset:1024 lds
    v_mfma_f32_16x16x32_bf16 v[156:159], v[80:83], a[76:79], v[156:159]
    v_mfma_f32_16x16x32_bf16 v[156:159], v[84:87], a[92:95], v[156:159]
    v_mfma_f32_16x16x32_bf16 v[156:159], v[88:91], a[108:111], v[156:159]
    v_mfma_f32_16x16x32_bf16 v[156:159], v[92:95], a[124:127], v[156:159]
    buffer_load_dwordx4 v4, s[8:11], s72 offen offset:2048 lds
    s_waitcnt lgkmcnt(0)
    v_mfma_f32_16x16x32_bf16 v[160:163], v[64:67], a[64:67], v[160:163]
    ds_read_b64_tr_b16 v[80:81], v19 offset:32768
    v_mfma_f32_16x16x32_bf16 v[160:163], v[68:71], a[80:83], v[160:163]
    ds_read_b64_tr_b16 v[82:83], v19 offset:33280
    v_mfma_f32_16x16x32_bf16 v[160:163], v[72:75], a[96:99], v[160:163]
    ds_read_b64_tr_b16 v[84:85], v19 offset:36864
    v_mfma_f32_16x16x32_bf16 v[160:163], v[76:79], a[112:115], v[160:163]
    buffer_load_dwordx4 v5, s[8:11], s72 offen offset:3072 lds
    v_mfma_f32_16x16x32_bf16 v[164:167], v[64:67], a[68:71], v[164:167]
    ds_read_b64_tr_b16 v[86:87], v19 offset:37376
    s_add_u32 m0, s62, 4096
    v_mfma_f32_16x16x32_bf16 v[164:167], v[68:71], a[84:87], v[164:167]
    ds_read_b64_tr_b16 v[88:89], v19 offset:40960
    s_add_u32 s72, s94, 4224
    v_mfma_f32_16x16x32_bf16 v[164:167], v[72:75], a[100:103], v[164:167]
    ds_read_b64_tr_b16 v[90:91], v19 offset:41472
    v_mfma_f32_16x16x32_bf16 v[164:167], v[76:79], a[116:119], v[164:167]
    buffer_load_dwordx4 v6, s[8:11], s72 offen offset:0 lds
    v_mfma_f32_16x16x32_bf16 v[168:171], v[64:67], a[72:75], v[168:171]
    ds_read_b64_tr_b16 v[92:93], v19 offset:45056
    v_mfma_f32_16x16x32_bf16 v[168:171], v[68:71], a[88:91], v[168:171]
    ds_read_b64_tr_b16 v[94:95], v19 offset:45568
    v_mfma_f32_16x16x32_bf16 v[168:171], v[72:75], a[104:107], v[168:171]
    v_mfma_f32_16x16x32_bf16 v[168:171], v[76:79], a[120:123], v[168:171]
    buffer_load_dwordx4 v7, s[8:11], s72 offen offset:1024 lds
    v_mfma_f32_16x16x32_bf16 v[172:175], v[64:67], a[76:79], v[172:175]
    v_mfma_f32_16x16x32_bf16 v[172:175], v[68:71], a[92:95], v[172:175]
    v_mfma_f32_16x16x32_bf16 v[172:175], v[72:75], a[108:111], v[172:175]
    v_mfma_f32_16x16x32_bf16 v[172:175], v[76:79], a[124:127], v[172:175]
    buffer_load_dwordx4 v8, s[8:11], s72 offen offset:2048 lds
    s_waitcnt lgkmcnt(0)
    s_waitcnt vmcnt(34)
    s_barrier
    v_mfma_f32_16x16x32_bf16 v[176:179], v[80:83], a[64:67], v[176:179]
    ds_read_b64_tr_b16 v[64:65], v16 offset:49152
    s_add_u32 s69, s66, 16789504
    v_mfma_f32_16x16x32_bf16 v[176:179], v[84:87], a[80:83], v[176:179]
    ds_read_b64_tr_b16 v[66:67], v16 offset:49664
    v_mfma_f32_16x16x32_bf16 v[176:179], v[88:91], a[96:99], v[176:179]
    ds_read_b64_tr_b16 v[68:69], v16 offset:53248
    v_mfma_f32_16x16x32_bf16 v[176:179], v[92:95], a[112:115], v[176:179]
    buffer_store_dwordx4 v[100:103], v1, s[48:51], s69 offen offset:0 sc1
    v_mfma_f32_16x16x32_bf16 v[180:183], v[80:83], a[68:71], v[180:183]
    ds_read_b64_tr_b16 v[70:71], v16 offset:53760
    v_mfma_f32_16x16x32_bf16 v[180:183], v[84:87], a[84:87], v[180:183]
    ds_read_b64_tr_b16 v[72:73], v16 offset:57344
    v_mfma_f32_16x16x32_bf16 v[180:183], v[88:91], a[100:103], v[180:183]
    ds_read_b64_tr_b16 v[74:75], v16 offset:57856
    v_mfma_f32_16x16x32_bf16 v[180:183], v[92:95], a[116:119], v[180:183]
    buffer_load_dwordx4 v9, s[8:11], s72 offen offset:3072 lds
    v_mfma_f32_16x16x32_bf16 v[184:187], v[80:83], a[72:75], v[184:187]
    ds_read_b64_tr_b16 v[76:77], v16 offset:61440
    s_add_u32 m0, s61, 32768
    v_mfma_f32_16x16x32_bf16 v[184:187], v[84:87], a[88:91], v[184:187]
    ds_read_b64_tr_b16 v[78:79], v16 offset:61952
    s_add_u32 s71, s3, 0
    v_mfma_f32_16x16x32_bf16 v[184:187], v[88:91], a[104:107], v[184:187]
    v_mfma_f32_16x16x32_bf16 v[184:187], v[92:95], a[120:123], v[184:187]
    buffer_load_dwordx4 v12, s[20:23], s71 offen lds
    v_mfma_f32_16x16x32_bf16 v[188:191], v[80:83], a[76:79], v[188:191]
    s_add_u32 m0, s61, 33792
    s_add_u32 s71, s3, 65536
    v_mfma_f32_16x16x32_bf16 v[188:191], v[84:87], a[92:95], v[188:191]
    v_mfma_f32_16x16x32_bf16 v[188:191], v[88:91], a[108:111], v[188:191]
    v_mfma_f32_16x16x32_bf16 v[188:191], v[92:95], a[124:127], v[188:191]
    buffer_load_dwordx4 v13, s[20:23], s71 offen lds
    s_waitcnt lgkmcnt(0)
    v_mfma_f32_16x16x32_bf16 v[192:195], v[64:67], a[64:67], v[192:195]
    ds_read_b64_tr_b16 v[80:81], v17 offset:49152
    s_add_u32 m0, s61, 34816
    v_mfma_f32_16x16x32_bf16 v[192:195], v[68:71], a[80:83], v[192:195]
    ds_read_b64_tr_b16 v[82:83], v17 offset:49664
    s_add_u32 s71, s3, 131072
    v_mfma_f32_16x16x32_bf16 v[192:195], v[72:75], a[96:99], v[192:195]
    ds_read_b64_tr_b16 v[84:85], v17 offset:53248
    s_add_u32 s69, s66, 16781312
    v_mfma_f32_16x16x32_bf16 v[192:195], v[76:79], a[112:115], v[192:195]
    buffer_load_dwordx4 v12, s[20:23], s71 offen lds
    v_mfma_f32_16x16x32_bf16 v[196:199], v[64:67], a[68:71], v[196:199]
    ds_read_b64_tr_b16 v[86:87], v17 offset:53760
    s_add_u32 m0, s61, 35840
    v_mfma_f32_16x16x32_bf16 v[196:199], v[68:71], a[84:87], v[196:199]
    ds_read_b64_tr_b16 v[88:89], v17 offset:57344
    s_add_u32 s71, s3, 196608
    v_mfma_f32_16x16x32_bf16 v[196:199], v[72:75], a[100:103], v[196:199]
    ds_read_b64_tr_b16 v[90:91], v17 offset:57856
    v_mfma_f32_16x16x32_bf16 v[196:199], v[76:79], a[116:119], v[196:199]
    buffer_load_dwordx4 v13, s[20:23], s71 offen lds
    v_mfma_f32_16x16x32_bf16 v[200:203], v[64:67], a[72:75], v[200:203]
    ds_read_b64_tr_b16 v[92:93], v17 offset:61440
    v_mfma_f32_16x16x32_bf16 v[200:203], v[68:71], a[88:91], v[200:203]
    ds_read_b64_tr_b16 v[94:95], v17 offset:61952
    v_mfma_f32_16x16x32_bf16 v[200:203], v[72:75], a[104:107], v[200:203]
    v_mfma_f32_16x16x32_bf16 v[200:203], v[76:79], a[120:123], v[200:203]
    buffer_store_dwordx4 v[104:107], v1, s[48:51], s69 offen offset:1024 sc1
    v_mfma_f32_16x16x32_bf16 v[204:207], v[64:67], a[76:79], v[204:207]
    v_mfma_f32_16x16x32_bf16 v[204:207], v[68:71], a[92:95], v[204:207]
    v_mfma_f32_16x16x32_bf16 v[204:207], v[72:75], a[108:111], v[204:207]
    v_mfma_f32_16x16x32_bf16 v[204:207], v[76:79], a[124:127], v[204:207]
    s_waitcnt lgkmcnt(0)
    v_mfma_f32_16x16x32_bf16 v[208:211], v[80:83], a[64:67], v[208:211]
    ds_read_b64_tr_b16 v[64:65], v18 offset:49152
    v_mfma_f32_16x16x32_bf16 v[208:211], v[84:87], a[80:83], v[208:211]
    ds_read_b64_tr_b16 v[66:67], v18 offset:49664
    v_mfma_f32_16x16x32_bf16 v[208:211], v[88:91], a[96:99], v[208:211]
    ds_read_b64_tr_b16 v[68:69], v18 offset:53248
    v_mfma_f32_16x16x32_bf16 v[208:211], v[92:95], a[112:115], v[208:211]
    ds_read_b64_tr_b16 v[70:71], v18 offset:53760
    v_mfma_f32_16x16x32_bf16 v[212:215], v[80:83], a[68:71], v[212:215]
    ds_read_b64_tr_b16 v[72:73], v18 offset:57344
    v_mfma_f32_16x16x32_bf16 v[212:215], v[84:87], a[84:87], v[212:215]
    ds_read_b64_tr_b16 v[74:75], v18 offset:57856
    v_mfma_f32_16x16x32_bf16 v[212:215], v[88:91], a[100:103], v[212:215]
    ds_read_b64_tr_b16 v[76:77], v18 offset:61440
    v_mfma_f32_16x16x32_bf16 v[212:215], v[92:95], a[116:119], v[212:215]
    ds_read_b64_tr_b16 v[78:79], v18 offset:61952
    v_mfma_f32_16x16x32_bf16 v[216:219], v[80:83], a[72:75], v[216:219]
    v_mfma_f32_16x16x32_bf16 v[216:219], v[84:87], a[88:91], v[216:219]
    v_mfma_f32_16x16x32_bf16 v[216:219], v[88:91], a[104:107], v[216:219]
    v_mfma_f32_16x16x32_bf16 v[216:219], v[92:95], a[120:123], v[216:219]
    v_mfma_f32_16x16x32_bf16 v[220:223], v[80:83], a[76:79], v[220:223]
    v_mfma_f32_16x16x32_bf16 v[220:223], v[84:87], a[92:95], v[220:223]
    v_mfma_f32_16x16x32_bf16 v[220:223], v[88:91], a[108:111], v[220:223]
    v_mfma_f32_16x16x32_bf16 v[220:223], v[92:95], a[124:127], v[220:223]
    s_waitcnt lgkmcnt(0)
    v_mfma_f32_16x16x32_bf16 v[224:227], v[64:67], a[64:67], v[224:227]
    ds_read_b64_tr_b16 v[80:81], v19 offset:49152
    s_add_u32 s69, s66, 16789504
    v_mfma_f32_16x16x32_bf16 v[224:227], v[68:71], a[80:83], v[224:227]
    buffer_store_dwordx4 v[108:111], v1, s[48:51], s69 offen offset:1024 sc1
    v_mfma_f32_16x16x32_bf16 v[224:227], v[72:75], a[96:99], v[224:227]
    ds_read_b64_tr_b16 v[82:83], v19 offset:49664
    v_mfma_f32_16x16x32_bf16 v[224:227], v[76:79], a[112:115], v[224:227]
    ds_read_b64_tr_b16 v[84:85], v19 offset:53248
    v_mfma_f32_16x16x32_bf16 v[228:231], v[64:67], a[68:71], v[228:231]
    ds_read_b64_tr_b16 v[86:87], v19 offset:53760
    v_mfma_f32_16x16x32_bf16 v[228:231], v[68:71], a[84:87], v[228:231]
    ds_read_b64_tr_b16 v[88:89], v19 offset:57344
    v_mfma_f32_16x16x32_bf16 v[228:231], v[72:75], a[100:103], v[228:231]
    ds_read_b64_tr_b16 v[90:91], v19 offset:57856
    v_mfma_f32_16x16x32_bf16 v[228:231], v[76:79], a[116:119], v[228:231]
    ds_read_b64_tr_b16 v[92:93], v19 offset:61440
    v_mfma_f32_16x16x32_bf16 v[232:235], v[64:67], a[72:75], v[232:235]
    ds_read_b64_tr_b16 v[94:95], v19 offset:61952
    v_mfma_f32_16x16x32_bf16 v[232:235], v[68:71], a[88:91], v[232:235]
    v_mfma_f32_16x16x32_bf16 v[232:235], v[72:75], a[104:107], v[232:235]
    v_mfma_f32_16x16x32_bf16 v[232:235], v[76:79], a[120:123], v[232:235]
    v_mfma_f32_16x16x32_bf16 v[236:239], v[64:67], a[76:79], v[236:239]
    v_mfma_f32_16x16x32_bf16 v[236:239], v[68:71], a[92:95], v[236:239]
    v_mfma_f32_16x16x32_bf16 v[236:239], v[72:75], a[108:111], v[236:239]
    v_mfma_f32_16x16x32_bf16 v[236:239], v[76:79], a[124:127], v[236:239]
    s_waitcnt lgkmcnt(0)
    s_waitcnt vmcnt(29)
    s_barrier
    v_mfma_f32_16x16x32_bf16 v[240:243], v[80:83], a[64:67], v[240:243]
    ds_read_b64_tr_b16 v[64:65], v16 offset:0
    s_add_u32 m0, s61, 49152
    v_mfma_f32_16x16x32_bf16 v[240:243], v[84:87], a[80:83], v[240:243]
    ds_read_b64_tr_b16 v[66:67], v16 offset:512
    s_add_u32 s71, s3, 128
    v_mfma_f32_16x16x32_bf16 v[240:243], v[88:91], a[96:99], v[240:243]
    buffer_load_dwordx4 v12, s[20:23], s71 offen lds
    v_mfma_f32_16x16x32_bf16 v[240:243], v[92:95], a[112:115], v[240:243]
    ds_read_b64_tr_b16 v[68:69], v16 offset:4096
    s_add_u32 m0, s61, 50176
    v_mfma_f32_16x16x32_bf16 v[244:247], v[80:83], a[68:71], v[244:247]
    ds_read_b64_tr_b16 v[70:71], v16 offset:4608
    s_add_u32 s71, s3, 65664
    v_mfma_f32_16x16x32_bf16 v[244:247], v[84:87], a[84:87], v[244:247]
    ds_read_b64_tr_b16 v[72:73], v16 offset:8192
    s_add_u32 s69, s66, 16781312
    v_mfma_f32_16x16x32_bf16 v[244:247], v[88:91], a[100:103], v[244:247]
    buffer_load_dwordx4 v13, s[20:23], s71 offen lds
    v_mfma_f32_16x16x32_bf16 v[244:247], v[92:95], a[116:119], v[244:247]
    ds_read_b64_tr_b16 v[74:75], v16 offset:8704
    s_add_u32 m0, s61, 51200
    v_mfma_f32_16x16x32_bf16 v[248:251], v[80:83], a[72:75], v[248:251]
    ds_read_b64_tr_b16 v[76:77], v16 offset:12288
    s_add_u32 s71, s3, 131200
    v_mfma_f32_16x16x32_bf16 v[248:251], v[84:87], a[88:91], v[248:251]
    ds_read_b64_tr_b16 v[78:79], v16 offset:12800
    v_mfma_f32_16x16x32_bf16 v[248:251], v[88:91], a[104:107], v[248:251]
    buffer_load_dwordx4 v12, s[20:23], s71 offen lds
    v_mfma_f32_16x16x32_bf16 v[248:251], v[92:95], a[120:123], v[248:251]
    s_add_u32 m0, s61, 52224
    s_add_u32 s71, s3, 196736
    v_mfma_f32_16x16x32_bf16 v[252:255], v[80:83], a[76:79], v[252:255]
    v_mfma_f32_16x16x32_bf16 v[252:255], v[84:87], a[92:95], v[252:255]
    v_mfma_f32_16x16x32_bf16 v[252:255], v[88:91], a[108:111], v[252:255]
    buffer_load_dwordx4 v13, s[20:23], s71 offen lds
    v_mfma_f32_16x16x32_bf16 v[252:255], v[92:95], a[124:127], v[252:255]
    s_waitcnt lgkmcnt(0)
    v_mfma_f32_16x16x32_bf16 v[128:131], v[64:67], a[128:131], v[128:131]
    ds_read_b64_tr_b16 v[80:81], v17 offset:0
    s_waitcnt vmcnt(21)
    s_mov_b32 s78, 0x20000
L_tag:
    v_readfirstlane_b32 s12, v63
    s_cmp_lg_u32 s54, 0
    s_cbranch_scc1 L_tag_done
    s_cmp_lg_u32 s12, 0
    s_cbranch_scc1 L_tag_done
    s_sub_u32 s78, s78, 1
    s_cbranch_scc1 L_tag_done
    buffer_load_dword v63, v62, s[44:47], 0 offen sc1
    s_waitcnt vmcnt(0)
    s_branch L_tag
L_tag_done:
    v_mfma_f32_16x16x32_bf16 v[128:131], v[68:71], a[144:147], v[128:131]
    ds_read_b64_tr_b16 v[82:83], v17 offset:512
    v_mfma_f32_16x16x32_bf16 v[128:131], v[72:75], a[160:163], v[128:131]
    buffer_store_dwordx4 v[112:115], v1, s[48:51], s69 offen offset:2048 sc1
    v_mfma_f32_16x16x32_bf16 v[128:131], v[76:79], a[176:179], v[128:131]
    ds_read_b64_tr_b16 v[84:85], v17 offset:4096
    ds_read_b128 a[192:195], v10 offset:16384
    v_mfma_f32_16x16x32_bf16 v[132:135], v[64:67], a[132:135], v[132:135]
    ds_read_b64_tr_b16 v[86:87], v17 offset:4608
    ds_read_b128 a[196:199], v10 offset:16640
    v_mfma_f32_16x16x32_bf16 v[132:135], v[68:71], a[148:151], v[132:135]
    ds_read_b64_tr_b16 v[88:89], v17 offset:8192
    ds_read_b128 a[200:203], v10 offset:16896
    v_mfma_f32_16x16x32_bf16 v[132:135], v[72:75], a[164:167], v[132:135]
    ds_read_b64_tr_b16 v[90:91], v17 offset:8704
    ds_read_b128 a[204:207], v10 offset:17152
    v_mfma_f32_16x16x32_bf16 v[132:135], v[76:79], a[180:183], v[132:135]
    ds_read_b64_tr_b16 v[92:93], v17 offset:12288
    ds_read_b128 a[208:211], v11 offset:16384
    v_mfma_f32_16x16x32_bf16 v[136:139], v[64:67], a[136:139], v[136:139]
    ds_read_b64_tr_b16 v[94:95], v17 offset:12800
    ds_read_b128 a[212:215], v11 offset:16640
    v_mfma_f32_16x16x32_bf16 v[136:139], v[68:71], a[152:155], v[136:139]
    ds_read_b128 a[216:219], v11 offset:16896
    v_mfma_f32_16x16x32_bf16 v[136:139], v[72:75], a[168:171], v[136:139]
    ds_read_b128 a[220:223], v11 offset:17152
    v_mfma_f32_16x16x32_bf16 v[136:139], v[76:79], a[184:187], v[136:139]
    v_mfma_f32_16x16x32_bf16 v[140:143], v[64:67], a[140:143], v[140:143]
    v_mfma_f32_16x16x32_bf16 v[140:143], v[68:71], a[156:159], v[140:143]
    v_mfma_f32_16x16x32_bf16 v[140:143], v[72:75], a[172:175], v[140:143]
    v_mfma_f32_16x16x32_bf16 v[140:143], v[76:79], a[188:191], v[140:143]
    s_waitcnt lgkmcnt(3)
    v_mfma_f32_16x16x32_bf16 v[144:147], v[80:83], a[128:131], v[144:147]
    ds_read_b64_tr_b16 v[64:65], v18 offset:0
    s_add_u32 s69, s66, 16789504
    v_mfma_f32_16x16x32_bf16 v[144:147], v[84:87], a[144:147], v[144:147]
    buffer_store_dwordx4 v[116:119], v1, s[48:51], s69 offen offset:2048 sc1
    v_mfma_f32_16x16x32_bf16 v[144:147], v[88:91], a[160:163], v[144:147]
    ds_read_b64_tr_b16 v[66:67], v18 offset:512
    v_mfma_f32_16x16x32_bf16 v[144:147], v[92:95], a[176:179], v[144:147]
    ds_read_b64_tr_b16 v[68:69], v18 offset:4096
    v_mfma_f32_16x16x32_bf16 v[148:151], v[80:83], a[132:135], v[148:151]
    ds_read_b64_tr_b16 v[70:71], v18 offset:4608
    v_mfma_f32_16x16x32_bf16 v[148:151], v[84:87], a[148:151], v[148:151]
    ds_read_b64_tr_b16 v[72:73], v18 offset:8192
    v_mfma_f32_16x16x32_bf16 v[148:151], v[88:91], a[164:167], v[148:151]
    ds_read_b64_tr_b16 v[74:75], v18 offset:8704
    v_mfma_f32_16x16x32_bf16 v[148:151], v[92:95], a[180:183], v[148:151]
    ds_read_b64_tr_b16 v[76:77], v18 offset:12288
    v_mfma_f32_16x16x32_bf16 v[152:155], v[80:83], a[136:139], v[152:155]
    ds_read_b64_tr_b16 v[78:79], v18 offset:12800
    v_mfma_f32_16x16x32_bf16 v[152:155], v[84:87], a[152:155], v[152:155]
    v_mfma_f32_16x16x32_bf16 v[152:155], v[88:91], a[168:171], v[152:155]
    v_mfma_f32_16x16x32_bf16 v[152:155], v[92:95], a[184:187], v[152:155]
    v_mfma_f32_16x16x32_bf16 v[156:159], v[80:83], a[140:143], v[156:159]
    v_mfma_f32_16x16x32_bf16 v[156:159], v[84:87], a[156:159], v[156:159]
    v_mfma_f32_16x16x32_bf16 v[156:159], v[88:91], a[172:175], v[156:159]
    v_mfma_f32_16x16x32_bf16 v[156:159], v[92:95], a[188:191], v[156:159]
    s_waitcnt lgkmcnt(0)
    v_mfma_f32_16x16x32_bf16 v[160:163], v[64:67], a[128:131], v[160:163]
    ds_read_b64_tr_b16 v[80:81], v19 offset:0
    s_add_u32 s69, s66, 16781312
    v_mfma_f32_16x16x32_bf16 v[160:163], v[68:71], a[144:147], v[160:163]
    buffer_store_dwordx4 v[120:123], v1, s[48:51], s69 offen offset:3072 sc1
    v_mfma_f32_16x16x32_bf16 v[160:163], v[72:75], a[160:163], v[160:163]
    ds_read_b64_tr_b16 v[82:83], v19 offset:512
    v_mfma_f32_16x16x32_bf16 v[160:163], v[76:79], a[176:179], v[160:163]
    ds_read_b64_tr_b16 v[84:85], v19 offset:4096
    v_mfma_f32_16x16x32_bf16 v[164:167], v[64:67], a[132:135], v[164:167]
    ds_read_b64_tr_b16 v[86:87], v19 offset:4608
    v_mfma_f32_16x16x32_bf16 v[164:167], v[68:71], a[148:151], v[164:167]
    ds_read_b64_tr_b16 v[88:89], v19 offset:8192
    v_mfma_f32_16x16x32_bf16 v[164:167], v[72:75], a[164:167], v[164:167]
    ds_read_b64_tr_b16 v[90:91], v19 offset:8704
    v_mfma_f32_16x16x32_bf16 v[164:167], v[76:79], a[180:183], v[164:167]
    ds_read_b64_tr_b16 v[92:93], v19 offset:12288
    v_mfma_f32_16x16x32_bf16 v[168:171], v[64:67], a[136:139], v[168:171]
    ds_read_b64_tr_b16 v[94:95], v19 offset:12800
    v_mfma_f32_16x16x32_bf16 v[168:171], v[68:71], a[152:155], v[168:171]
    v_mfma_f32_16x16x32_bf16 v[168:171], v[72:75], a[168:171], v[168:171]
    v_mfma_f32_16x16x32_bf16 v[168:171], v[76:79], a[184:187], v[168:171]
    v_mfma_f32_16x16x32_bf16 v[172:175], v[64:67], a[140:143], v[172:175]
    v_mfma_f32_16x16x32_bf16 v[172:175], v[68:71], a[156:159], v[172:175]
    v_mfma_f32_16x16x32_bf16 v[172:175], v[72:75], a[172:175], v[172:175]
    v_mfma_f32_16x16x32_bf16 v[172:175], v[76:79], a[188:191], v[172:175]
    s_waitcnt lgkmcnt(0)
    s_barrier
    v_mfma_f32_16x16x32_bf16 v[176:179], v[80:83], a[128:131], v[176:179]
    ds_read_b64_tr_b16 v[64:65], v16 offset:16384
    s_add_u32 s71, s0, 0
    v_mfma_f32_16x16x32_bf16 v[176:179], v[84:87], a[144:147], v[176:179]
    ds_read_b64_tr_b16 v[66:67], v16 offset:16896
    s_and_b32 s71, s71, 3
    v_mfma_f32_16x16x32_bf16 v[176:179], v[88:91], a[160:163], v[176:179]
    ds_read_b64_tr_b16 v[68:69], v16 offset:20480
    s_mul_i32 s71, s71, 393216
    v_mfma_f32_16x16x32_bf16 v[176:179], v[92:95], a[176:179], v[176:179]
    ds_read_b64_tr_b16 v[70:71], v16 offset:20992
    s_add_u32 s75, s71, s65
    v_mfma_f32_16x16x32_bf16 v[180:183], v[80:83], a[132:135], v[180:183]
    ds_read_b64_tr_b16 v[72:73], v16 offset:24576
    s_add_u32 s71, s0, 1
    v_mfma_f32_16x16x32_bf16 v[180:183], v[84:87], a[148:151], v[180:183]
    ds_read_b64_tr_b16 v[74:75], v16 offset:25088
    s_and_b32 s71, s71, 3
    v_mfma_f32_16x16x32_bf16 v[180:183], v[88:91], a[164:167], v[180:183]
    ds_read_b64_tr_b16 v[76:77], v16 offset:28672
    s_mul_i32 s71, s71, 393216
    v_mfma_f32_16x16x32_bf16 v[180:183], v[92:95], a[180:183], v[180:183]
    ds_read_b64_tr_b16 v[78:79], v16 offset:29184
    s_add_u32 s98, s71, s65
    v_mfma_f32_16x16x32_bf16 v[184:187], v[80:83], a[136:139], v[184:187]
    s_add_u32 s71, s0, 2
    s_and_b32 s71, s71, 3
    v_mfma_f32_16x16x32_bf16 v[184:187], v[84:87], a[152:155], v[184:187]
    s_mul_i32 s71, s71, 393216
    s_add_u32 s99, s71, s65
    v_mfma_f32_16x16x32_bf16 v[184:187], v[88:91], a[168:171], v[184:187]
    s_add_u32 s71, s0, 3
    s_and_b32 s71, s71, 3
    v_mfma_f32_16x16x32_bf16 v[184:187], v[92:95], a[184:187], v[184:187]
    s_mul_i32 s71, s71, 393216
    s_add_u32 s3, s71, s65
    v_mfma_f32_16x16x32_bf16 v[188:191], v[80:83], a[140:143], v[188:191]
    s_add_u32 m0, s61, 0
    s_add_u32 s71, s75, 0
    v_mfma_f32_16x16x32_bf16 v[188:191], v[84:87], a[156:159], v[188:191]
    buffer_load_dwordx4 v14, s[24:27], s71 offen lds
    v_mfma_f32_16x16x32_bf16 v[188:191], v[88:91], a[172:175], v[188:191]
    s_add_u32 m0, s61, 1024
    s_add_u32 s71, s75, 24576
    v_mfma_f32_16x16x32_bf16 v[188:191], v[92:95], a[188:191], v[188:191]
    s_waitcnt lgkmcnt(0)
    v_mfma_f32_16x16x32_bf16 v[192:195], v[64:67], a[128:131], v[192:195]
    ds_read_b64_tr_b16 v[80:81], v17 offset:16384
    s_add_u32 s69, s66, 16789504
    v_mfma_f32_16x16x32_bf16 v[192:195], v[68:71], a[144:147], v[192:195]
    buffer_load_dwordx4 v15, s[24:27], s71 offen lds
    v_mfma_f32_16x16x32_bf16 v[192:195], v[72:75], a[160:163], v[192:195]
    ds_read_b64_tr_b16 v[82:83], v17 offset:16896
    s_add_u32 m0, s61, 2048
    v_mfma_f32_16x16x32_bf16 v[192:195], v[76:79], a[176:179], v[192:195]
    ds_read_b64_tr_b16 v[84:85], v17 offset:20480
    s_add_u32 s71, s75, 49152
    v_mfma_f32_16x16x32_bf16 v[196:199], v[64:67], a[132:135], v[196:199]
    ds_read_b64_tr_b16 v[86:87], v17 offset:20992
    s_waitcnt vmcnt(15)
    v_mfma_f32_16x16x32_bf16 v[196:199], v[68:71], a[148:151], v[196:199]
    buffer_load_dwordx4 v14, s[24:27], s71 offen lds
    v_mfma_f32_16x16x32_bf16 v[196:199], v[72:75], a[164:167], v[196:199]
    ds_read_b64_tr_b16 v[88:89], v17 offset:24576
    ds_read_b128 a[224:227], v10 offset:0
    v_mfma_f32_16x16x32_bf16 v[196:199], v[76:79], a[180:183], v[196:199]
    ds_read_b64_tr_b16 v[90:91], v17 offset:25088
    ds_read_b128 a[228:231], v10 offset:256
    v_mfma_f32_16x16x32_bf16 v[200:203], v[64:67], a[136:139], v[200:203]
    ds_read_b64_tr_b16 v[92:93], v17 offset:28672
    ds_read_b128 a[232:235], v10 offset:512
    v_mfma_f32_16x16x32_bf16 v[200:203], v[68:71], a[152:155], v[200:203]
    buffer_store_dwordx4 v[20:23], v1, s[48:51], s69 offen offset:3072 sc1
    v_mfma_f32_16x16x32_bf16 v[200:203], v[72:75], a[168:171], v[200:203]
    ds_read_b64_tr_b16 v[94:95], v17 offset:29184
    ds_read_b128 a[236:239], v10 offset:768
    v_mfma_f32_16x16x32_bf16 v[200:203], v[76:79], a[184:187], v[200:203]
    ds_read_b128 a[240:243], v11 offset:0
    s_add_u32 m0, s61, 3072
    v_mfma_f32_16x16x32_bf16 v[204:207], v[64:67], a[140:143], v[204:207]
    ds_read_b128 a[244:247], v11 offset:256
    s_add_u32 s71, s75, 73728
    v_mfma_f32_16x16x32_bf16 v[204:207], v[68:71], a[156:159], v[204:207]
    buffer_load_dwordx4 v15, s[24:27], s71 offen lds
    v_mfma_f32_16x16x32_bf16 v[204:207], v[72:75], a[172:175], v[204:207]
    ds_read_b128 a[248:251], v11 offset:512
    v_mfma_f32_16x16x32_bf16 v[204:207], v[76:79], a[188:191], v[204:207]
    ds_read_b128 a[252:255], v11 offset:768
    s_waitcnt lgkmcnt(5)
    v_mfma_f32_16x16x32_bf16 v[208:211], v[80:83], a[128:131], v[208:211]
    ds_read_b64_tr_b16 v[64:65], v18 offset:16384
    v_mfma_f32_16x16x32_bf16 v[208:211], v[84:87], a[144:147], v[208:211]
    ds_read_b64_tr_b16 v[66:67], v18 offset:16896
    v_mfma_f32_16x16x32_bf16 v[208:211], v[88:91], a[160:163], v[208:211]
    ds_read_b64_tr_b16 v[68:69], v18 offset:20480
    v_mfma_f32_16x16x32_bf16 v[208:211], v[92:95], a[176:179], v[208:211]
    ds_read_b64_tr_b16 v[70:71], v18 offset:20992
    v_mfma_f32_16x16x32_bf16 v[212:215], v[80:83], a[132:135], v[212:215]
    ds_read_b64_tr_b16 v[72:73], v18 offset:24576
    v_mfma_f32_16x16x32_bf16 v[212:215], v[84:87], a[148:151], v[212:215]
    ds_read_b64_tr_b16 v[74:75], v18 offset:25088
    v_mfma_f32_16x16x32_bf16 v[212:215], v[88:91], a[164:167], v[212:215]
    ds_read_b64_tr_b16 v[76:77], v18 offset:28672
    v_mfma_f32_16x16x32_bf16 v[212:215], v[92:95], a[180:183], v[212:215]
    ds_read_b64_tr_b16 v[78:79], v18 offset:29184
    v_mfma_f32_16x16x32_bf16 v[216:219], v[80:83], a[136:139], v[216:219]
    v_mfma_f32_16x16x32_bf16 v[216:219], v[84:87], a[152:155], v[216:219]
    v_mfma_f32_16x16x32_bf16 v[216:219], v[88:91], a[168:171], v[216:219]
    v_mfma_f32_16x16x32_bf16 v[216:219], v[92:95], a[184:187], v[216:219]
    v_mfma_f32_16x16x32_bf16 v[220:223], v[80:83], a[140:143], v[220:223]
    v_mfma_f32_16x16x32_bf16 v[220:223], v[84:87], a[156:159], v[220:223]
    v_mfma_f32_16x16x32_bf16 v[220:223], v[88:91], a[172:175], v[220:223]
    v_mfma_f32_16x16x32_bf16 v[220:223], v[92:95], a[188:191], v[220:223]
    s_waitcnt lgkmcnt(0)
    v_mfma_f32_16x16x32_bf16 v[224:227], v[64:67], a[128:131], v[224:227]
    ds_read_b64_tr_b16 v[80:81], v19 offset:16384
    v_mfma_f32_16x16x32_bf16 v[224:227], v[68:71], a[144:147], v[224:227]
    ds_read_b64_tr_b16 v[82:83], v19 offset:16896
    v_mfma_f32_16x16x32_bf16 v[224:227], v[72:75], a[160:163], v[224:227]
    ds_read_b64_tr_b16 v[84:85], v19 offset:20480
    v_mfma_f32_16x16x32_bf16 v[224:227], v[76:79], a[176:179], v[224:227]
    ds_read_b64_tr_b16 v[86:87], v19 offset:20992
    v_mfma_f32_16x16x32_bf16 v[228:231], v[64:67], a[132:135], v[228:231]
    ds_read_b64_tr_b16 v[88:89], v19 offset:24576
    v_mfma_f32_16x16x32_bf16 v[228:231], v[68:71], a[148:151], v[228:231]
    ds_read_b64_tr_b16 v[90:91], v19 offset:25088
    v_mfma_f32_16x16x32_bf16 v[228:231], v[72:75], a[164:167], v[228:231]
    ds_read_b64_tr_b16 v[92:93], v19 offset:28672
    v_mfma_f32_16x16x32_bf16 v[228:231], v[76:79], a[180:183], v[228:231]
    ds_read_b64_tr_b16 v[94:95], v19 offset:29184
    v_mfma_f32_16x16x32_bf16 v[232:235], v[64:67], a[136:139], v[232:235]
    v_mfma_f32_16x16x32_bf16 v[232:235], v[68:71], a[152:155], v[232:235]
    v_mfma_f32_16x16x32_bf16 v[232:235], v[72:75], a[168:171], v[232:235]
    v_mfma_f32_16x16x32_bf16 v[232:235], v[76:79], a[184:187], v[232:235]
    v_mfma_f32_16x16x32_bf16 v[236:239], v[64:67], a[140:143], v[236:239]
    v_mfma_f32_16x16x32_bf16 v[236:239], v[68:71], a[156:159], v[236:239]
    v_mfma_f32_16x16x32_bf16 v[236:239], v[72:75], a[172:175], v[236:239]
    v_mfma_f32_16x16x32_bf16 v[236:239], v[76:79], a[188:191], v[236:239]
    s_waitcnt lgkmcnt(0)
    s_waitcnt vmcnt(14)
    s_barrier
    v_mfma_f32_16x16x32_bf16 v[240:243], v[80:83], a[128:131], v[240:243]
    ds_read_b64_tr_b16 v[64:65], v16 offset:32768
    s_add_u32 m0, s61, 16384
    v_mfma_f32_16x16x32_bf16 v[240:243], v[84:87], a[144:147], v[240:243]
    ds_read_b64_tr_b16 v[66:67], v16 offset:33280
    s_add_u32 s71, s98, 0
    v_mfma_f32_16x16x32_bf16 v[240:243], v[88:91], a[160:163], v[240:243]
    buffer_load_dwordx4 v14, s[24:27], s71 offen lds
    v_mfma_f32_16x16x32_bf16 v[240:243], v[92:95], a[176:179], v[240:243]
    ds_read_b64_tr_b16 v[68:69], v16 offset:36864
    s_add_u32 m0, s61, 17408
    v_mfma_f32_16x16x32_bf16 v[244:247], v[80:83], a[132:135], v[244:247]
    ds_read_b64_tr_b16 v[70:71], v16 offset:37376
    s_add_u32 s71, s98, 24576
    v_mfma_f32_16x16x32_bf16 v[244:247], v[84:87], a[148:151], v[244:247]
    ds_read_b64_tr_b16 v[72:73], v16 offset:40960
    v_mfma_f32_16x16x32_bf16 v[244:247], v[88:91], a[164:167], v[244:247]
    buffer_load_dwordx4 v15, s[24:27], s71 offen lds
    v_mfma_f32_16x16x32_bf16 v[244:247], v[92:95], a[180:183], v[244:247]
    ds_read_b64_tr_b16 v[74:75], v16 offset:41472
    s_add_u32 m0, s61, 18432
    v_mfma_f32_16x16x32_bf16 v[248:251], v[80:83], a[136:139], v[248:251]
    ds_read_b64_tr_b16 v[76:77], v16 offset:45056
    s_add_u32 s71, s98, 49152
    v_mfma_f32_16x16x32_bf16 v[248:251], v[84:87], a[152:155], v[248:251]
    ds_read_b64_tr_b16 v[78:79], v16 offset:45568
    v_mfma_f32_16x16x32_bf16 v[248:251], v[88:91], a[168:171], v[248:251]
    buffer_load_dwordx4 v14, s[24:27], s71 offen lds
    v_mfma_f32_16x16x32_bf16 v[248:251], v[92:95], a[184:187], v[248:251]
    s_add_u32 m0, s61, 19456
    s_add_u32 s71, s98, 73728
    v_mfma_f32_16x16x32_bf16 v[252:255], v[80:83], a[140:143], v[252:255]
    v_mfma_f32_16x16x32_bf16 v[252:255], v[84:87], a[156:159], v[252:255]
    v_mfma_f32_16x16x32_bf16 v[252:255], v[88:91], a[172:175], v[252:255]
    buffer_load_dwordx4 v15, s[24:27], s71 offen lds
    v_mfma_f32_16x16x32_bf16 v[252:255], v[92:95], a[188:191], v[252:255]
    s_waitcnt lgkmcnt(0)
    v_mfma_f32_16x16x32_bf16 v[128:131], v[64:67], a[192:195], v[128:131]
    ds_read_b64_tr_b16 v[80:81], v17 offset:32768
    s_lshl_b32 s70, s54, 13
    v_mfma_f32_16x16x32_bf16 v[128:131], v[68:71], a[208:211], v[128:131]
    ds_read_b64_tr_b16 v[82:83], v17 offset:33280
    s_add_u32 s70, s70, 131072
    v_mfma_f32_16x16x32_bf16 v[128:131], v[72:75], a[224:227], v[128:131]
    ds_read_b64_tr_b16 v[84:85], v17 offset:36864
    v_add_u32 v61, s70, v1
    v_mfma_f32_16x16x32_bf16 v[128:131], v[76:79], a[240:243], v[128:131]
    ds_read_b64_tr_b16 v[86:87], v17 offset:37376
    v_mfma_f32_16x16x32_bf16 v[132:135], v[64:67], a[196:199], v[132:135]
    ds_read_b64_tr_b16 v[88:89], v17 offset:40960
    v_mfma_f32_16x16x32_bf16 v[132:135], v[68:71], a[212:215], v[132:135]
    ds_read_b64_tr_b16 v[90:91], v17 offset:41472
    v_mfma_f32_16x16x32_bf16 v[132:135], v[72:75], a[228:231], v[132:135]
    ds_read_b64_tr_b16 v[92:93], v17 offset:45056
    v_mfma_f32_16x16x32_bf16 v[132:135], v[76:79], a[244:247], v[132:135]
    ds_read_b64_tr_b16 v[94:95], v17 offset:45568
    v_mfma_f32_16x16x32_bf16 v[136:139], v[64:67], a[200:203], v[136:139]
    v_mfma_f32_16x16x32_bf16 v[136:139], v[68:71], a[216:219], v[136:139]
    v_mfma_f32_16x16x32_bf16 v[136:139], v[72:75], a[232:235], v[136:139]
    v_mfma_f32_16x16x32_bf16 v[136:139], v[76:79], a[248:251], v[136:139]
    v_mfma_f32_16x16x32_bf16 v[140:143], v[64:67], a[204:207], v[140:143]
    v_mfma_f32_16x16x32_bf16 v[140:143], v[68:71], a[220:223], v[140:143]
    v_mfma_f32_16x16x32_bf16 v[140:143], v[72:75], a[236:239], v[140:143]
    v_mfma_f32_16x16x32_bf16 v[140:143], v[76:79], a[252:255], v[140:143]
    s_waitcnt lgkmcnt(0)
    v_mfma_f32_16x16x32_bf16 v[144:147], v[80:83], a[192:195], v[144:147]
    ds_read_b64_tr_b16 v[64:65], v18 offset:32768
    v_mfma_f32_16x16x32_bf16 v[144:147], v[84:87], a[208:211], v[144:147]
    ds_read_b64_tr_b16 v[66:67], v18 offset:33280
    v_mfma_f32_16x16x32_bf16 v[144:147], v[88:91], a[224:227], v[144:147]
    ds_read_b64_tr_b16 v[68:69], v18 offset:36864
    v_mfma_f32_16x16x32_bf16 v[144:147], v[92:95], a[240:243], v[144:147]
    ds_read_b64_tr_b16 v[70:71], v18 offset:37376
    v_mfma_f32_16x16x32_bf16 v[148:151], v[80:83], a[196:199], v[148:151]
    ds_read_b64_tr_b16 v[72:73], v18 offset:40960
    v_mfma_f32_16x16x32_bf16 v[148:151], v[84:87], a[212:215], v[148:151]
    ds_read_b64_tr_b16 v[74:75], v18 offset:41472
    v_mfma_f32_16x16x32_bf16 v[148:151], v[88:91], a[228:231], v[148:151]
    ds_read_b64_tr_b16 v[76:77], v18 offset:45056
    v_mfma_f32_16x16x32_bf16 v[148:151], v[92:95], a[244:247], v[148:151]
    ds_read_b64_tr_b16 v[78:79], v18 offset:45568
    v_mfma_f32_16x16x32_bf16 v[152:155], v[80:83], a[200:203], v[152:155]
    v_mfma_f32_16x16x32_bf16 v[152:155], v[84:87], a[216:219], v[152:155]
    v_mfma_f32_16x16x32_bf16 v[152:155], v[88:91], a[232:235], v[152:155]
    v_mfma_f32_16x16x32_bf16 v[152:155], v[92:95], a[248:251], v[152:155]
    v_mfma_f32_16x16x32_bf16 v[156:159], v[80:83], a[204:207], v[156:159]
    v_mfma_f32_16x16x32_bf16 v[156:159], v[84:87], a[220:223], v[156:159]
    v_mfma_f32_16x16x32_bf16 v[156:159], v[88:91], a[236:239], v[156:159]
    v_mfma_f32_16x16x32_bf16 v[156:159], v[92:95], a[252:255], v[156:159]
    s_waitcnt lgkmcnt(0)
    v_mfma_f32_16x16x32_bf16 v[160:163], v[64:67], a[192:195], v[160:163]
    ds_read_b64_tr_b16 v[80:81], v19 offset:32768
    v_cvt_pk_bf16_f32 v28, v128, v129
    v_mfma_f32_16x16x32_bf16 v[160:163], v[68:71], a[208:211], v[160:163]
    ds_read_b64_tr_b16 v[82:83], v19 offset:33280
    v_cvt_pk_bf16_f32 v29, v130, v131
    v_mfma_f32_16x16x32_bf16 v[160:163], v[72:75], a[224:227], v[160:163]
    ds_read_b64_tr_b16 v[84:85], v19 offset:36864
    v_cvt_pk_bf16_f32 v30, v144, v145
    v_mfma_f32_16x16x32_bf16 v[160:163], v[76:79], a[240:243], v[160:163]
    ds_read_b64_tr_b16 v[86:87], v19 offset:37376
    v_cvt_pk_bf16_f32 v31, v146, v147
    v_mfma_f32_16x16x32_bf16 v[164:167], v[64:67], a[196:199], v[164:167]
    ds_read_b64_tr_b16 v[88:89], v19 offset:40960
    v_mfma_f32_16x16x32_bf16 v[164:167], v[68:71], a[212:215], v[164:167]
    ds_read_b64_tr_b16 v[90:91], v19 offset:41472
    v_mfma_f32_16x16x32_bf16 v[164:167], v[72:75], a[228:231], v[164:167]
    ds_read_b64_tr_b16 v[92:93], v19 offset:45056
    v_mfma_f32_16x16x32_bf16 v[164:167], v[76:79], a[244:247], v[164:167]
    ds_read_b64_tr_b16 v[94:95], v19 offset:45568
    v_mfma_f32_16x16x32_bf16 v[168:171], v[64:67], a[200:203], v[168:171]
    ds_write_b128 v61, v[28:31] offset:0
    v_mfma_f32_16x16x32_bf16 v[168:171], v[68:71], a[216:219], v[168:171]
    v_cvt_pk_bf16_f32 v32, v132, v133
    v_cvt_pk_bf16_f32 v33, v134, v135
    v_mfma_f32_16x16x32_bf16 v[168:171], v[72:75], a[232:235], v[168:171]
    v_cvt_pk_bf16_f32 v34, v148, v149
    v_cvt_pk_bf16_f32 v35, v150, v151
    v_mfma_f32_16x16x32_bf16 v[168:171], v[76:79], a[248:251], v[168:171]
    v_mfma_f32_16x16x32_bf16 v[172:175], v[64:67], a[204:207], v[172:175]
    ds_write_b128 v61, v[32:35] offset:2048
    v_mfma_f32_16x16x32_bf16 v[172:175], v[68:71], a[220:223], v[172:175]
    v_cvt_pk_bf16_f32 v36, v136, v137
    v_cvt_pk_bf16_f32 v37, v138, v139
    v_mfma_f32_16x16x32_bf16 v[172:175], v[72:75], a[236:239], v[172:175]
    v_cvt_pk_bf16_f32 v38, v152, v153
    v_cvt_pk_bf16_f32 v39, v154, v155
    v_mfma_f32_16x16x32_bf16 v[172:175], v[76:79], a[252:255], v[172:175]
    s_waitcnt lgkmcnt(2)
    s_waitcnt vmcnt(5)
    s_barrier
    v_mfma_f32_16x16x32_bf16 v[176:179], v[80:83], a[192:195], v[176:179]
    ds_read_b64_tr_b16 v[64:65], v16 offset:49152
    s_add_u32 m0, s61, 32768
    v_mfma_f32_16x16x32_bf16 v[176:179], v[84:87], a[208:211], v[176:179]
    ds_read_b64_tr_b16 v[66:67], v16 offset:49664
    s_add_u32 s71, s99, 0
    v_mfma_f32_16x16x32_bf16 v[176:179], v[88:91], a[224:227], v[176:179]
    buffer_load_dwordx4 v14, s[24:27], s71 offen lds
    v_mfma_f32_16x16x32_bf16 v[176:179], v[92:95], a[240:243], v[176:179]
    ds_read_b64_tr_b16 v[68:69], v16 offset:53248
    s_add_u32 m0, s61, 33792
    v_mfma_f32_16x16x32_bf16 v[180:183], v[80:83], a[196:199], v[180:183]
    ds_read_b64_tr_b16 v[70:71], v16 offset:53760
    s_add_u32 s71, s99, 24576
    v_mfma_f32_16x16x32_bf16 v[180:183], v[84:87], a[212:215], v[180:183]
    ds_read_b64_tr_b16 v[72:73], v16 offset:57344
    s_cmp_lg_u32 s54, 0
    s_cbranch_scc1 L_sig0
    s_lshl_b32 s67, s52, 7
    s_add_u32 s67, s67, 61669376
    s_lshl2_add_u32 s67, s53, s67
    v_min_u32 v62, 1, v0
    v_lshlrev_b32 v62, 30, v62
    v_mov_b32 v63, s12
    buffer_store_dword v63, v62, s[48:51], s67 offen sc1
L_sig0:
    v_mfma_f32_16x16x32_bf16 v[180:183], v[88:91], a[228:231], v[180:183]
    buffer_load_dwordx4 v15, s[24:27], s71 offen lds
    v_mfma_f32_16x16x32_bf16 v[180:183], v[92:95], a[244:247], v[180:183]
    ds_read_b64_tr_b16 v[74:75], v16 offset:57856
    s_add_u32 m0, s61, 34816
    v_mfma_f32_16x16x32_bf16 v[184:187], v[80:83], a[200:203], v[184:187]
    ds_read_b64_tr_b16 v[76:77], v16 offset:61440
    s_add_u32 s71, s99, 49152
    v_mfma_f32_16x16x32_bf16 v[184:187], v[84:87], a[216:219], v[184:187]
    ds_read_b64_tr_b16 v[78:79], v16 offset:61952
    v_mfma_f32_16x16x32_bf16 v[184:187], v[88:91], a[232:235], v[184:187]
    buffer_load_dwordx4 v14, s[24:27], s71 offen lds
    v_mfma_f32_16x16x32_bf16 v[184:187], v[92:95], a[248:251], v[184:187]
    ds_write_b128 v61, v[36:39] offset:4096
    v_mfma_f32_16x16x32_bf16 v[188:191], v[80:83], a[204:207], v[188:191]
    s_add_u32 m0, s61, 35840
    s_add_u32 s71, s99, 73728
    v_mfma_f32_16x16x32_bf16 v[188:191], v[84:87], a[220:223], v[188:191]
    v_cvt_pk_bf16_f32 v40, v140, v141
    v_cvt_pk_bf16_f32 v41, v142, v143
    v_mfma_f32_16x16x32_bf16 v[188:191], v[88:91], a[236:239], v[188:191]
    buffer_load_dwordx4 v15, s[24:27], s71 offen lds
    v_mfma_f32_16x16x32_bf16 v[188:191], v[92:95], a[252:255], v[188:191]
    v_cvt_pk_bf16_f32 v42, v156, v157
    v_cvt_pk_bf16_f32 v43, v158, v159
    s_waitcnt lgkmcnt(1)
    v_mfma_f32_16x16x32_bf16 v[192:195], v[64:67], a[192:195], v[192:195]
    ds_read_b64_tr_b16 v[80:81], v17 offset:49152
    s_lshl_b32 s96, s56, 13
    v_mfma_f32_16x16x32_bf16 v[192:195], v[68:71], a[208:211], v[192:195]
    ds_read_b64_tr_b16 v[82:83], v17 offset:49664
    s_add_u32 s96, s96, 65536
    v_mfma_f32_16x16x32_bf16 v[192:195], v[72:75], a[224:227], v[192:195]
    ds_read_b64_tr_b16 v[84:85], v17 offset:53248
    v_add_u32 v3, s96, v1
    v_mfma_f32_16x16x32_bf16 v[192:195], v[76:79], a[240:243], v[192:195]
    ds_read_b64_tr_b16 v[86:87], v17 offset:53760
    v_mov_b32 v2, v3
    v_mfma_f32_16x16x32_bf16 v[196:199], v[64:67], a[196:199], v[196:199]
    ds_read_b64_tr_b16 v[88:89], v17 offset:57344
    s_mov_b32 s62, 0
    v_mfma_f32_16x16x32_bf16 v[196:199], v[68:71], a[212:215], v[196:199]
    ds_read_b64_tr_b16 v[90:91], v17 offset:57856
    v_and_b32 v20, 15, v0
    v_mfma_f32_16x16x32_bf16 v[196:199], v[72:75], a[228:231], v[196:199]
    ds_read_b64_tr_b16 v[92:93], v17 offset:61440
    v_lshrrev_b32 v21, 4, v0
    v_mfma_f32_16x16x32_bf16 v[196:199], v[76:79], a[244:247], v[196:199]
    ds_read_b64_tr_b16 v[94:95], v17 offset:61952
    v_lshlrev_b32 v22, 2, v21
    v_mfma_f32_16x16x32_bf16 v[200:203], v[64:67], a[200:203], v[200:203]
    ds_write_b128 v61, v[40:43] offset:6144
    v_mfma_f32_16x16x32_bf16 v[200:203], v[68:71], a[216:219], v[200:203]
    v_cvt_pk_bf16_f32 v44, v160, v161
    v_cvt_pk_bf16_f32 v45, v162, v163
    v_mfma_f32_16x16x32_bf16 v[200:203], v[72:75], a[232:235], v[200:203]
    v_cvt_pk_bf16_f32 v46, v176, v177
    v_cvt_pk_bf16_f32 v47, v178, v179
    v_mfma_f32_16x16x32_bf16 v[200:203], v[76:79], a[248:251], v[200:203]
    v_sub_u32 v22, v20, v22
    v_and_b32 v23, 3, v0
    v_mfma_f32_16x16x32_bf16 v[204:207], v[64:67], a[204:207], v[204:207]
    ds_write_b128 v61, v[44:47] offset:1024
    v_mfma_f32_16x16x32_bf16 v[204:207], v[68:71], a[220:223], v[204:207]
    v_cvt_pk_bf16_f32 v48, v164, v165
    v_cvt_pk_bf16_f32 v49, v166, v167
    v_mfma_f32_16x16x32_bf16 v[204:207], v[72:75], a[236:239], v[204:207]
    v_cvt_pk_bf16_f32 v50, v180, v181
    v_cvt_pk_bf16_f32 v51, v182, v183
    v_mfma_f32_16x16x32_bf16 v[204:207], v[76:79], a[252:255], v[204:207]
    v_cmp_eq_u32 s[14:15], 0, v23
    v_mov_b32 v23, 0x3f803f80
    s_waitcnt lgkmcnt(2)
    v_mfma_f32_16x16x32_bf16 v[208:211], v[80:83], a[192:195], v[208:211]
    ds_read_b64_tr_b16 v[64:65], v18 offset:49152
    v_lshlrev_b32 v60, 4, v20
    v_mfma_f32_16x16x32_bf16 v[208:211], v[84:87], a[208:211], v[208:211]
    ds_read_b64_tr_b16 v[66:67], v18 offset:49664
    v_cndmask_b32 v4, 0, v23, s[14:15]
    v_mfma_f32_16x16x32_bf16 v[208:211], v[88:91], a[224:227], v[208:211]
    ds_read_b64_tr_b16 v[68:69], v18 offset:53248
    v_and_b32 v24, 1, v21
    v_mfma_f32_16x16x32_bf16 v[208:211], v[92:95], a[240:243], v[208:211]
    ds_read_b64_tr_b16 v[70:71], v18 offset:53760
    v_lshl_add_u32 v60, v24, 9, v60
    v_mfma_f32_16x16x32_bf16 v[212:215], v[80:83], a[196:199], v[212:215]
    ds_read_b64_tr_b16 v[72:73], v18 offset:57344
    v_lshrrev_b32 v24, 1, v21
    v_mfma_f32_16x16x32_bf16 v[212:215], v[84:87], a[212:215], v[212:215]
    ds_read_b64_tr_b16 v[74:75], v18 offset:57856
    v_lshl_add_u32 v60, v24, 10, v60
    v_mfma_f32_16x16x32_bf16 v[212:215], v[88:91], a[228:231], v[212:215]
    ds_read_b64_tr_b16 v[76:77], v18 offset:61440
    s_lshl_b32 s96, s56, 8
    v_mfma_f32_16x16x32_bf16 v[212:215], v[92:95], a[244:247], v[212:215]
    ds_read_b64_tr_b16 v[78:79], v18 offset:61952
    v_add_u32 v60, s96, v60
    v_mfma_f32_16x16x32_bf16 v[216:219], v[80:83], a[200:203], v[216:219]
    ds_write_b128 v61, v[48:51] offset:3072
    v_mfma_f32_16x16x32_bf16 v[216:219], v[84:87], a[216:219], v[216:219]
    v_cvt_pk_bf16_f32 v52, v168, v169
    v_cvt_pk_bf16_f32 v53, v170, v171
    v_mfma_f32_16x16x32_bf16 v[216:219], v[88:91], a[232:235], v[216:219]
    v_cvt_pk_bf16_f32 v54, v184, v185
    v_cvt_pk_bf16_f32 v55, v186, v187
    v_mfma_f32_16x16x32_bf16 v[216:219], v[92:95], a[248:251], v[216:219]
    s_mov_b32 s64, 0
    v_mov_b32 v5, v4
    v_mfma_f32_16x16x32_bf16 v[220:223], v[80:83], a[204:207], v[220:223]
    ds_write_b128 v61, v[52:55] offset:5120
    v_mfma_f32_16x16x32_bf16 v[220:223], v[84:87], a[220:223], v[220:223]
    v_cvt_pk_bf16_f32 v56, v172, v173
    v_cvt_pk_bf16_f32 v57, v174, v175
    v_mfma_f32_16x16x32_bf16 v[220:223], v[88:91], a[236:239], v[220:223]
    v_cvt_pk_bf16_f32 v58, v188, v189
    v_cvt_pk_bf16_f32 v59, v190, v191
    v_mfma_f32_16x16x32_bf16 v[220:223], v[92:95], a[252:255], v[220:223]
    v_mov_b32 v6, v4
    v_mov_b32 v7, v4
    s_waitcnt lgkmcnt(2)
    v_mfma_f32_16x16x32_bf16 v[224:227], v[64:67], a[192:195], v[224:227]
    ds_read_b64_tr_b16 v[80:81], v19 offset:49152
    s_sub_i32 s96, s55, s56
    v_mfma_f32_16x16x32_bf16 v[224:227], v[68:71], a[208:211], v[224:227]
    ds_read_b64_tr_b16 v[82:83], v19 offset:49664
    s_lshl_b32 s96, s96, 5
    v_mfma_f32_16x16x32_bf16 v[224:227], v[72:75], a[224:227], v[224:227]
    ds_read_b64_tr_b16 v[84:85], v19 offset:53248
    s_add_u32 s97, s55, s56
    v_mfma_f32_16x16x32_bf16 v[224:227], v[76:79], a[240:243], v[224:227]
    ds_read_b64_tr_b16 v[86:87], v19 offset:53760
    s_sub_i32 s97, 1, s97
    v_mfma_f32_16x16x32_bf16 v[228:231], v[64:67], a[196:199], v[228:231]
    ds_read_b64_tr_b16 v[88:89], v19 offset:57344
    s_lshl_b32 s97, s97, 5
    v_mfma_f32_16x16x32_bf16 v[228:231], v[68:71], a[212:215], v[228:231]
    ds_read_b64_tr_b16 v[90:91], v19 offset:57856
    v_add_u32 v24, s96, v22
    v_mfma_f32_16x16x32_bf16 v[228:231], v[72:75], a[228:231], v[228:231]
    ds_read_b64_tr_b16 v[92:93], v19 offset:61440
    v_add_u32 v25, s97, v22
    v_mfma_f32_16x16x32_bf16 v[228:231], v[76:79], a[244:247], v[228:231]
    ds_read_b64_tr_b16 v[94:95], v19 offset:61952
    s_lshl_b32 s96, s56, 4
    v_mfma_f32_16x16x32_bf16 v[232:235], v[64:67], a[200:203], v[232:235]
    ds_write_b128 v61, v[56:59] offset:7168
    v_mfma_f32_16x16x32_bf16 v[232:235], v[68:71], a[216:219], v[232:235]
    s_lshl_b32 s70, s54, 13
    s_add_u32 s70, s70, 98304
    v_mfma_f32_16x16x32_bf16 v[232:235], v[72:75], a[232:235], v[232:235]
    v_add_u32 v61, s70, v1
    v_cvt_pk_bf16_f32 v28, v192, v193
    v_mfma_f32_16x16x32_bf16 v[232:235], v[76:79], a[248:251], v[232:235]
    v_cvt_pk_bf16_f32 v29, v194, v195
    v_cvt_pk_bf16_f32 v30, v208, v209
    v_mfma_f32_16x16x32_bf16 v[236:239], v[64:67], a[204:207], v[236:239]
    v_cvt_pk_bf16_f32 v31, v210, v211
    s_sub_u32 s97, 16, s96
    v_mfma_f32_16x16x32_bf16 v[236:239], v[68:71], a[220:223], v[236:239]
    ds_write_b128 v61, v[28:31] offset:0
    v_mfma_f32_16x16x32_bf16 v[236:239], v[72:75], a[236:239], v[236:239]
    v_cvt_pk_bf16_f32 v32, v196, v197
    v_cvt_pk_bf16_f32 v33, v198, v199
    v_mfma_f32_16x16x32_bf16 v[236:239], v[76:79], a[252:255], v[236:239]
    v_cvt_pk_bf16_f32 v34, v212, v213
    v_cvt_pk_bf16_f32 v35, v214, v215
    s_waitcnt lgkmcnt(2)
    s_waitcnt vmcnt(8)
    s_barrier
    v_mfma_f32_16x16x32_bf16 v[240:243], v[80:83], a[192:195], v[240:243]
    ds_read_b64_tr_b16 v[64:65], v16 offset:0
    s_add_u32 m0, s61, 49152
    v_mfma_f32_16x16x32_bf16 v[240:243], v[84:87], a[208:211], v[240:243]
    ds_read_b64_tr_b16 v[66:67], v16 offset:512
    s_add_u32 s71, s3, 0
    v_mfma_f32_16x16x32_bf16 v[240:243], v[88:91], a[224:227], v[240:243]
    buffer_load_dwordx4 v14, s[24:27], s71 offen lds
    v_mfma_f32_16x16x32_bf16 v[240:243], v[92:95], a[240:243], v[240:243]
    ds_read_b64_tr_b16 v[68:69], v16 offset:4096
    s_add_u32 m0, s61, 50176
    v_mfma_f32_16x16x32_bf16 v[244:247], v[80:83], a[196:199], v[244:247]
    ds_read_b64_tr_b16 v[70:71], v16 offset:4608
    s_add_u32 s71, s3, 24576
    v_mfma_f32_16x16x32_bf16 v[244:247], v[84:87], a[212:215], v[244:247]
    ds_read_b64_tr_b16 v[72:73], v16 offset:8192
    v_add_u32 v27, s96, v24
    v_mfma_f32_16x16x32_bf16 v[244:247], v[88:91], a[228:231], v[244:247]
    buffer_load_dwordx4 v15, s[24:27], s71 offen lds
    v_mfma_f32_16x16x32_bf16 v[244:247], v[92:95], a[244:247], v[244:247]
    ds_read_b64_tr_b16 v[74:75], v16 offset:8704
    s_add_u32 m0, s61, 51200
    v_mfma_f32_16x16x32_bf16 v[248:251], v[80:83], a[200:203], v[248:251]
    ds_read_b64_tr_b16 v[76:77], v16 offset:12288
    s_add_u32 s71, s3, 49152
    v_mfma_f32_16x16x32_bf16 v[248:251], v[84:87], a[216:219], v[248:251]
    ds_read_b64_tr_b16 v[78:79], v16 offset:12800
    v_add_u32 v23, s96, v25
    v_mfma_f32_16x16x32_bf16 v[248:251], v[88:91], a[232:235], v[248:251]
    buffer_load_dwordx4 v14, s[24:27], s71 offen lds
    v_mfma_f32_16x16x32_bf16 v[248:251], v[92:95], a[248:251], v[248:251]
    ds_write_b128 v61, v[32:35] offset:2048
    v_mfma_f32_16x16x32_bf16 v[252:255], v[80:83], a[204:207], v[252:255]
    s_add_u32 m0, s61, 52224
    s_add_u32 s71, s3, 73728
    v_mfma_f32_16x16x32_bf16 v[252:255], v[84:87], a[220:223], v[252:255]
    v_cvt_pk_bf16_f32 v36, v200, v201
    v_cvt_pk_bf16_f32 v37, v202, v203
    v_mfma_f32_16x16x32_bf16 v[252:255], v[88:91], a[236:239], v[252:255]
    buffer_load_dwordx4 v15, s[24:27], s71 offen lds
    v_mfma_f32_16x16x32_bf16 v[252:255], v[92:95], a[252:255], v[252:255]
    v_cvt_pk_bf16_f32 v38, v216, v217
    v_cvt_pk_bf16_f32 v39, v218, v219
    s_waitcnt lgkmcnt(1)
    v_mfma_f32_16x16x32_bf16 v[128:131], v[64:67], a[0:3], 0
    ds_read_b64_tr_b16 v[80:81], v17 offset:0
    v_add_u32 v24, s97, v24
    v_mfma_f32_16x16x32_bf16 v[128:131], v[68:71], a[16:19], v[128:131]
    ds_read_b64_tr_b16 v[82:83], v17 offset:512
    v_add_u32 v25, s97, v25
    v_mfma_f32_16x16x32_bf16 v[128:131], v[72:75], a[32:35], v[128:131]
    ds_read_b64_tr_b16 v[84:85], v17 offset:4096
    v_mov_b32 v26, 0xff7fffff
    v_mfma_f32_16x16x32_bf16 v[128:131], v[76:79], a[48:51], v[128:131]
    ds_read_b64_tr_b16 v[86:87], v17 offset:4608
    v_cmp_gt_i32 s[14:15], 0, v24
    v_mfma_f32_16x16x32_bf16 v[132:135], v[64:67], a[4:7], 0
    ds_read_b64_tr_b16 v[88:89], v17 offset:8192
    v_cmp_gt_i32 s[100:101], 1, v24
    v_mfma_f32_16x16x32_bf16 v[132:135], v[68:71], a[20:23], v[132:135]
    ds_read_b64_tr_b16 v[90:91], v17 offset:8704
    v_cmp_gt_i32 s[96:97], 2, v24
    v_mfma_f32_16x16x32_bf16 v[132:135], v[72:75], a[36:39], v[132:135]
    ds_read_b64_tr_b16 v[92:93], v17 offset:12288
    v_cndmask_b32 v96, 0, v26, s[14:15]
    v_mfma_f32_16x16x32_bf16 v[132:135], v[76:79], a[52:55], v[132:135]
    ds_read_b64_tr_b16 v[94:95], v17 offset:12800
    v_cmp_gt_i32 s[14:15], 3, v24
    v_mfma_f32_16x16x32_bf16 v[136:139], v[64:67], a[8:11], 0
    ds_write_b128 v61, v[36:39] offset:4096
    v_mfma_f32_16x16x32_bf16 v[136:139], v[68:71], a[24:27], v[136:139]
    v_cvt_pk_bf16_f32 v40, v204, v205
    v_cvt_pk_bf16_f32 v41, v206, v207
    v_mfma_f32_16x16x32_bf16 v[136:139], v[72:75], a[40:43], v[136:139]
    v_cvt_pk_bf16_f32 v42, v220, v221
    v_cvt_pk_bf16_f32 v43, v222, v223
    v_mfma_f32_16x16x32_bf16 v[136:139], v[76:79], a[56:59], v[136:139]
    v_cndmask_b32 v97, 0, v26, s[100:101]
    v_cmp_gt_i32 s[100:101], 16, v24
    v_mfma_f32_16x16x32_bf16 v[140:143], v[64:67], a[12:15], 0
    ds_write_b128 v61, v[40:43] offset:6144
    v_mfma_f32_16x16x32_bf16 v[140:143], v[68:71], a[28:31], v[140:143]
    v_cvt_pk_bf16_f32 v44, v224, v225
    v_cvt_pk_bf16_f32 v45, v226, v227
    v_mfma_f32_16x16x32_bf16 v[140:143], v[72:75], a[44:47], v[140:143]
    v_cvt_pk_bf16_f32 v46, v240, v241
    v_cvt_pk_bf16_f32 v47, v242, v243
    v_mfma_f32_16x16x32_bf16 v[140:143], v[76:79], a[60:63], v[140:143]
    v_cndmask_b32 v98, 0, v26, s[96:97]
    v_cmp_gt_i32 s[96:97], 17, v24
    s_waitcnt lgkmcnt(2)
    v_mfma_f32_16x16x32_bf16 v[144:147], v[80:83], a[0:3], 0
    ds_read_b64_tr_b16 v[64:65], v18 offset:0
    v_cndmask_b32 v99, 0, v26, s[14:15]
    v_mfma_f32_16x16x32_bf16 v[144:147], v[84:87], a[16:19], v[144:147]
    ds_read_b64_tr_b16 v[66:67], v18 offset:512
    v_cmp_gt_i32 s[14:15], 18, v24
    v_mfma_f32_16x16x32_bf16 v[144:147], v[88:91], a[32:35], v[144:147]
    ds_read_b64_tr_b16 v[68:69], v18 offset:4096
    v_cndmask_b32 v100, 0, v26, s[100:101]
    v_mfma_f32_16x16x32_bf16 v[144:147], v[92:95], a[48:51], v[144:147]
    ds_read_b64_tr_b16 v[70:71], v18 offset:4608
    v_cmp_gt_i32 s[100:101], 19, v24
    v_mfma_f32_16x16x32_bf16 v[148:151], v[80:83], a[4:7], 0
    ds_read_b64_tr_b16 v[72:73], v18 offset:8192
    v_cndmask_b32 v101, 0, v26, s[96:97]
    v_mfma_f32_16x16x32_bf16 v[148:151], v[84:87], a[20:23], v[148:151]
    ds_read_b64_tr_b16 v[74:75], v18 offset:8704
    v_cmp_gt_i32 s[96:97], 0, v27
    v_mfma_f32_16x16x32_bf16 v[148:151], v[88:91], a[36:39], v[148:151]
    ds_read_b64_tr_b16 v[76:77], v18 offset:12288
    v_cndmask_b32 v102, 0, v26, s[14:15]
    v_mfma_f32_16x16x32_bf16 v[148:151], v[92:95], a[52:55], v[148:151]
    ds_read_b64_tr_b16 v[78:79], v18 offset:12800
    v_cmp_gt_i32 s[14:15], 1, v27
    v_mfma_f32_16x16x32_bf16 v[152:155], v[80:83], a[8:11], 0
    ds_write_b128 v61, v[44:47] offset:1024
    v_mfma_f32_16x16x32_bf16 v[152:155], v[84:87], a[24:27], v[152:155]
    v_cvt_pk_bf16_f32 v48, v228, v229
    v_cvt_pk_bf16_f32 v49, v230, v231
    v_mfma_f32_16x16x32_bf16 v[152:155], v[88:91], a[40:43], v[152:155]
    v_cvt_pk_bf16_f32 v50, v244, v245
    v_cvt_pk_bf16_f32 v51, v246, v247
    v_mfma_f32_16x16x32_bf16 v[152:155], v[92:95], a[56:59], v[152:155]
    v_cndmask_b32 v103, 0, v26, s[100:101]
    v_cmp_gt_i32 s[100:101], 2, v27
    v_mfma_f32_16x16x32_bf16 v[156:159], v[80:83], a[12:15], 0
    ds_write_b128 v61, v[48:51] offset:3072
    v_mfma_f32_16x16x32_bf16 v[156:159], v[84:87], a[28:31], v[156:159]
    v_cvt_pk_bf16_f32 v52, v232, v233
    v_cvt_pk_bf16_f32 v53, v234, v235
    v_mfma_f32_16x16x32_bf16 v[156:159], v[88:91], a[44:47], v[156:159]
    v_cvt_pk_bf16_f32 v54, v248, v249
    v_cvt_pk_bf16_f32 v55, v250, v251
    v_mfma_f32_16x16x32_bf16 v[156:159], v[92:95], a[60:63], v[156:159]
    v_cndmask_b32 v104, 0, v26, s[96:97]
    v_cmp_gt_i32 s[96:97], 3, v27
    s_waitcnt lgkmcnt(2)
    s_waitcnt vmcnt(8)
    s_barrier
    v_mfma_f32_16x16x32_bf16 v[160:163], a[0:3], v[64:67], 0
    ds_read_b64_tr_b16 v[80:81], v16 offset:16384
    s_lshl_b32 s13, s52, 7
    v_mfma_f32_16x16x32_bf16 v[160:163], a[16:19], v[68:71], v[160:163]
    ds_read_b64_tr_b16 v[82:83], v16 offset:16896
    s_add_u32 s13, s13, 61669376
    v_mfma_f32_16x16x32_bf16 v[160:163], a[32:35], v[72:75], v[160:163]
    ds_read_b64_tr_b16 v[84:85], v16 offset:20480
    s_cmp_eq_u32 s54, 0
    s_cselect_b32 s91, 0, 0x40000000
    v_mfma_f32_16x16x32_bf16 v[160:163], a[48:51], v[76:79], v[160:163]
    ds_read_b64_tr_b16 v[86:87], v16 offset:20992
    v_lshrrev_b32 v62, 3, v0
    v_mfma_f32_16x16x32_bf16 v[164:167], a[4:7], v[64:67], 0
    ds_read_b64_tr_b16 v[88:89], v16 offset:24576
    v_min_u32 v62, 1, v62
    v_mfma_f32_16x16x32_bf16 v[164:167], a[20:23], v[68:71], v[164:167]
    ds_read_b64_tr_b16 v[90:91], v16 offset:25088
    v_lshlrev_b32 v62, 30, v62
    v_mfma_f32_16x16x32_bf16 v[164:167], a[36:39], v[72:75], v[164:167]
    ds_read_b64_tr_b16 v[92:93], v16 offset:28672
    v_lshl_or_b32 v62, v0, 2, v62
    v_mfma_f32_16x16x32_bf16 v[164:167], a[52:55], v[76:79], v[164:167]
    ds_read_b64_tr_b16 v[94:95], v16 offset:29184
    v_or_b32 v62, s91, v62
    v_mfma_f32_16x16x32_bf16 v[168:171], a[8:11], v[64:67], 0
    buffer_load_dword v63, v62, s[48:51], s13 offen sc1
    v_mfma_f32_16x16x32_bf16 v[168:171], a[24:27], v[68:71], v[168:171]
    ds_write_b128 v61, v[52:55] offset:5120
    v_mfma_f32_16x16x32_bf16 v[168:171], a[40:43], v[72:75], v[168:171]
    v_cvt_pk_bf16_f32 v56, v236, v237
    v_cvt_pk_bf16_f32 v57, v238, v239
    v_mfma_f32_16x16x32_bf16 v[168:171], a[56:59], v[76:79], v[168:171]
    v_cvt_pk_bf16_f32 v58, v252, v253
    v_cvt_pk_bf16_f32 v59, v254, v255
    v_mfma_f32_16x16x32_bf16 v[172:175], a[12:15], v[64:67], 0
    v_cndmask_b32 v105, 0, v26, s[14:15]
    v_cmp_gt_i32 s[14:15], 16, v27
    v_mfma_f32_16x16x32_bf16 v[172:175], a[28:31], v[68:71], v[172:175]
    ds_write_b128 v61, v[56:59] offset:7168
    v_mfma_f32_16x16x32_bf16 v[172:175], a[44:47], v[72:75], v[172:175]
    v_cndmask_b32 v106, 0, v26, s[100:101]
    v_cmp_gt_i32 s[100:101], 17, v27
    v_mfma_f32_16x16x32_bf16 v[172:175], a[60:63], v[76:79], v[172:175]
    v_cndmask_b32 v107, 0, v26, s[96:97]
    v_cmp_gt_i32 s[96:97], 18, v27
    s_waitcnt lgkmcnt(2)
    v_mfma_f32_16x16x32_bf16 v[128:131], v[80:83], a[64:67], v[128:131]
    ds_read_b64_tr_b16 v[64:65], v17 offset:16384
    s_lshl_b32 s72, s55, 13
    v_mfma_f32_16x16x32_bf16 v[128:131], v[84:87], a[80:83], v[128:131]
    ds_read_b64_tr_b16 v[66:67], v17 offset:16896
    s_add_u32 s72, s72, 131072
    v_mfma_f32_16x16x32_bf16 v[128:131], v[88:91], a[96:99], v[128:131]
    ds_read_b64_tr_b16 v[68:69], v17 offset:20480
    v_add_u32 v11, s72, v1
    v_mfma_f32_16x16x32_bf16 v[128:131], v[92:95], a[112:115], v[128:131]
    ds_read_b64_tr_b16 v[70:71], v17 offset:20992
    s_lshl_b32 s72, s56, 11
    v_mfma_f32_16x16x32_bf16 v[132:135], v[80:83], a[68:71], v[132:135]
    ds_read_b64_tr_b16 v[72:73], v17 offset:24576
    v_add_u32 v11, s72, v11
    v_mfma_f32_16x16x32_bf16 v[132:135], v[84:87], a[84:87], v[132:135]
    ds_read_b64_tr_b16 v[74:75], v17 offset:25088
    v_xor_b32 v10, 0x800, v11
    v_mfma_f32_16x16x32_bf16 v[132:135], v[88:91], a[100:103], v[132:135]
    ds_read_b64_tr_b16 v[76:77], v17 offset:28672
    ds_read_b128 a[0:3], v10 offset:0
    v_mfma_f32_16x16x32_bf16 v[132:135], v[92:95], a[116:119], v[132:135]
    ds_read_b64_tr_b16 v[78:79], v17 offset:29184
    ds_read_b128 a[4:7], v10 offset:1024
    v_mfma_f32_16x16x32_bf16 v[136:139], v[80:83], a[72:75], v[136:139]
    ds_read_b128 a[8:11], v11 offset:0
    v_cndmask_b32 v108, 0, v26, s[14:15]
    v_mfma_f32_16x16x32_bf16 v[136:139], v[84:87], a[88:91], v[136:139]
    ds_read_b128 a[12:15], v11 offset:1024
    v_cmp_gt_i32 s[14:15], 19, v27
    v_mfma_f32_16x16x32_bf16 v[136:139], v[88:91], a[104:107], v[136:139]
    ds_read_b128 a[16:19], v10 offset:4096
    v_cndmask_b32 v109, 0, v26, s[100:101]
    v_mfma_f32_16x16x32_bf16 v[136:139], v[92:95], a[120:123], v[136:139]
    ds_read_b128 a[20:23], v10 offset:5120
    v_cmp_gt_i32 s[100:101], 0, v25
    v_mfma_f32_16x16x32_bf16 v[140:143], v[80:83], a[76:79], v[140:143]
    ds_read_b128 a[24:27], v11 offset:4096
    v_cndmask_b32 v110, 0, v26, s[96:97]
    v_mfma_f32_16x16x32_bf16 v[140:143], v[84:87], a[92:95], v[140:143]
    ds_read_b128 a[28:31], v11 offset:5120
    v_cmp_gt_i32 s[96:97], 1, v25
    v_mfma_f32_16x16x32_bf16 v[140:143], v[88:91], a[108:111], v[140:143]
    ds_read_b128 a[32:35], v10 offset:16384
    v_cndmask_b32 v111, 0, v26, s[14:15]
    v_mfma_f32_16x16x32_bf16 v[140:143], v[92:95], a[124:127], v[140:143]
    ds_read_b128 a[36:39], v10 offset:17408
    v_cmp_gt_i32 s[14:15], 2, v25
    s_waitcnt lgkmcnt(9)
    v_mfma_f32_16x16x32_bf16 v[144:147], v[64:67], a[64:67], v[144:147]
    ds_read_b64_tr_b16 v[80:81], v18 offset:16384
    ds_read_b128 a[40:43], v11 offset:16384
    v_mfma_f32_16x16x32_bf16 v[144:147], v[68:71], a[80:83], v[144:147]
    ds_read_b64_tr_b16 v[82:83], v18 offset:16896
    ds_read_b128 a[44:47], v11 offset:17408
    v_mfma_f32_16x16x32_bf16 v[144:147], v[72:75], a[96:99], v[144:147]
    ds_read_b64_tr_b16 v[84:85], v18 offset:20480
    ds_read_b128 a[48:51], v10 offset:20480
    v_mfma_f32_16x16x32_bf16 v[144:147], v[76:79], a[112:115], v[144:147]
    ds_read_b64_tr_b16 v[86:87], v18 offset:20992
    ds_read_b128 a[52:55], v10 offset:21504
    v_mfma_f32_16x16x32_bf16 v[148:151], v[64:67], a[68:71], v[148:151]
    ds_read_b64_tr_b16 v[88:89], v18 offset:24576
    ds_read_b128 a[56:59], v11 offset:20480
    v_mfma_f32_16x16x32_bf16 v[148:151], v[68:71], a[84:87], v[148:151]
    ds_read_b64_tr_b16 v[90:91], v18 offset:25088
    ds_read_b128 a[60:63], v11 offset:21504
    v_mfma_f32_16x16x32_bf16 v[148:151], v[72:75], a[100:103], v[148:151]
    ds_read_b64_tr_b16 v[92:93], v18 offset:28672
    s_waitcnt vmcnt(0)
    v_mfma_f32_16x16x32_bf16 v[148:151], v[76:79], a[116:119], v[148:151]
    ds_read_b64_tr_b16 v[94:95], v18 offset:29184
    s_cmp_lg_u32 s54, 0
    s_cbranch_scc1 L_poll1_done
    s_mov_b32 s78, 0x20000
L_poll1:
    v_cmp_eq_u32 vcc, s12, v63
    s_sub_u32 s78, s78, 1
    s_cbranch_scc1 L_poll1_done
    s_cmp_eq_u32 vcc_lo, 0xff
    s_cbranch_scc1 L_poll1_done
    buffer_load_dword v63, v62, s[48:51], s13 offen sc1
    s_waitcnt vmcnt(0)
    s_branch L_poll1
L_poll1_done:
    v_mfma_f32_16x16x32_bf16 v[152:155], v[64:67], a[72:75], v[152:155]
    v_cndmask_b32 v112, 0, v26, s[100:101]
    v_cmp_gt_i32 s[100:101], 3, v25
    v_mfma_f32_16x16x32_bf16 v[152:155], v[68:71], a[88:91], v[152:155]
    v_cndmask_b32 v113, 0, v26, s[96:97]
    v_cmp_gt_i32 s[96:97], 16, v25
    v_mfma_f32_16x16x32_bf16 v[152:155], v[72:75], a[104:107], v[152:155]
    v_cndmask_b32 v114, 0, v26, s[14:15]
    v_cmp_gt_i32 s[14:15], 17, v25
    v_mfma_f32_16x16x32_bf16 v[152:155], v[76:79], a[120:123], v[152:155]
    v_cndmask_b32 v115, 0, v26, s[100:101]
    v_cmp_gt_i32 s[100:101], 18, v25
    v_mfma_f32_16x16x32_bf16 v[156:159], v[64:67], a[76:79], v[156:159]
    v_cndmask_b32 v116, 0, v26, s[96:97]
    v_cmp_gt_i32 s[96:97], 19, v25
    v_mfma_f32_16x16x32_bf16 v[156:159], v[68:71], a[92:95], v[156:159]
    v_cndmask_b32 v117, 0, v26, s[14:15]
    v_cmp_gt_i32 s[14:15], 0, v23
    v_mfma_f32_16x16x32_bf16 v[156:159], v[72:75], a[108:111], v[156:159]
    v_cndmask_b32 v118, 0, v26, s[100:101]
    v_cmp_gt_i32 s[100:101], 1, v23
    v_mfma_f32_16x16x32_bf16 v[156:159], v[76:79], a[124:127], v[156:159]
    v_cndmask_b32 v119, 0, v26, s[96:97]
    v_cmp_gt_i32 s[96:97], 2, v23
    s_waitcnt lgkmcnt(0)
    s_barrier
    v_mfma_f32_16x16x32_bf16 v[160:163], a[64:67], v[80:83], v[160:163]
    ds_read_b64_tr_b16 v[64:65], v16 offset:32768
    s_lshl_b32 s94, s52, 19
    v_mfma_f32_16x16x32_bf16 v[160:163], a[80:83], v[84:87], v[160:163]
    ds_read_b64_tr_b16 v[66:67], v16 offset:33280
    s_add_u32 s94, s94, s61
    v_mfma_f32_16x16x32_bf16 v[160:163], a[96:99], v[88:91], v[160:163]
    ds_read_b64_tr_b16 v[68:69], v16 offset:36864
    s_mov_b32 s79, s94
    v_mfma_f32_16x16x32_bf16 v[160:163], a[112:115], v[92:95], v[160:163]
    ds_read_b64_tr_b16 v[70:71], v16 offset:37376
    s_add_u32 s92, s61, 65536
    v_mfma_f32_16x16x32_bf16 v[164:167], a[68:71], v[80:83], v[164:167]
    ds_read_b64_tr_b16 v[72:73], v16 offset:40960
    s_lshl_b32 s93, s57, 1
    v_mfma_f32_16x16x32_bf16 v[164:167], a[84:87], v[84:87], v[164:167]
    ds_read_b64_tr_b16 v[74:75], v16 offset:41472
    s_add_u32 s93, s93, 1
    v_mfma_f32_16x16x32_bf16 v[164:167], a[100:103], v[88:91], v[164:167]
    ds_read_b64_tr_b16 v[76:77], v16 offset:45056
    s_lshl_b32 s75, s58, 1
    v_mfma_f32_16x16x32_bf16 v[164:167], a[116:119], v[92:95], v[164:167]
    ds_read_b64_tr_b16 v[78:79], v16 offset:45568
    s_add_u32 s75, s75, 1
    v_mfma_f32_16x16x32_bf16 v[168:171], a[72:75], v[80:83], v[168:171]
    s_mov_b32 m0, s92
    s_add_u32 s98, s79, 16777216
    v_mfma_f32_16x16x32_bf16 v[168:171], a[88:91], v[84:87], v[168:171]
    buffer_load_dwordx4 v1, s[48:51], s79 offen offset:0 sc1 lds
    v_mfma_f32_16x16x32_bf16 v[168:171], a[104:107], v[88:91], v[168:171]
    v_cndmask_b32 v120, 0, v26, s[14:15]
    v_cmp_gt_i32 s[14:15], 3, v23
    v_mfma_f32_16x16x32_bf16 v[168:171], a[120:123], v[92:95], v[168:171]
    v_cndmask_b32 v121, 0, v26, s[100:101]
    v_cmp_gt_i32 s[100:101], 16, v23
    v_mfma_f32_16x16x32_bf16 v[172:175], a[76:79], v[80:83], v[172:175]
    v_cndmask_b32 v122, 0, v26, s[96:97]
    v_cmp_gt_i32 s[96:97], 17, v23
    v_mfma_f32_16x16x32_bf16 v[172:175], a[92:95], v[84:87], v[172:175]
    buffer_load_dwordx4 v1, s[48:51], s79 offen offset:1024 sc1 lds
    v_mfma_f32_16x16x32_bf16 v[172:175], a[108:111], v[88:91], v[172:175]
    v_cndmask_b32 v123, 0, v26, s[14:15]
    v_cmp_gt_i32 s[14:15], 18, v23
    v_mfma_f32_16x16x32_bf16 v[172:175], a[124:127], v[92:95], v[172:175]
    v_cndmask_b32 v124, 0, v26, s[100:101]
    v_cmp_gt_i32 s[100:101], 19, v23
    s_waitcnt lgkmcnt(0)
    v_mfma_f32_16x16x32_bf16 v[128:131], v[64:67], a[128:131], v[128:131]
    ds_read_b64_tr_b16 v[80:81], v17 offset:32768
    s_lshl_b32 s72, s55, 13
    v_mfma_f32_16x16x32_bf16 v[128:131], v[68:71], a[144:147], v[128:131]
    buffer_load_dwordx4 v1, s[48:51], s79 offen offset:2048 sc1 lds
    v_mfma_f32_16x16x32_bf16 v[128:131], v[72:75], a[160:163], v[128:131]
    ds_read_b64_tr_b16 v[82:83], v17 offset:33280
    s_add_u32 s72, s72, 98304
    v_mfma_f32_16x16x32_bf16 v[128:131], v[76:79], a[176:179], v[128:131]
    ds_read_b64_tr_b16 v[84:85], v17 offset:36864
    v_add_u32 v11, s72, v1
    v_mfma_f32_16x16x32_bf16 v[132:135], v[64:67], a[132:135], v[132:135]
    ds_read_b64_tr_b16 v[86:87], v17 offset:37376
    s_lshl_b32 s72, s56, 11
    v_mfma_f32_16x16x32_bf16 v[132:135], v[68:71], a[148:151], v[132:135]
    buffer_load_dwordx4 v1, s[48:51], s79 offen offset:3072 sc1 lds
    v_mfma_f32_16x16x32_bf16 v[132:135], v[72:75], a[164:167], v[132:135]
    ds_read_b64_tr_b16 v[88:89], v17 offset:40960
    v_add_u32 v11, s72, v11
    v_mfma_f32_16x16x32_bf16 v[132:135], v[76:79], a[180:183], v[132:135]
    ds_read_b64_tr_b16 v[90:91], v17 offset:41472
    v_xor_b32 v10, 0x800, v11
    v_mfma_f32_16x16x32_bf16 v[136:139], v[64:67], a[136:139], v[136:139]
    ds_read_b64_tr_b16 v[92:93], v17 offset:45056
    ds_read_b128 a[64:67], v10 offset:0
    v_mfma_f32_16x16x32_bf16 v[136:139], v[68:71], a[152:155], v[136:139]
    ds_read_b64_tr_b16 v[94:95], v17 offset:45568
    ds_read_b128 a[68:71], v10 offset:1024
    v_mfma_f32_16x16x32_bf16 v[136:139], v[72:75], a[168:171], v[136:139]
    ds_read_b128 a[72:75], v11 offset:0
    s_add_u32 m0, s92, 16384
    v_mfma_f32_16x16x32_bf16 v[136:139], v[76:79], a[184:187], v[136:139]
    buffer_load_dwordx4 v1, s[48:51], s98 offen offset:0 sc1 lds
    v_mfma_f32_16x16x32_bf16 v[140:143], v[64:67], a[140:143], v[140:143]
    ds_read_b128 a[76:79], v11 offset:1024
    v_cndmask_b32 v125, 0, v26, s[96:97]
    v_mfma_f32_16x16x32_bf16 v[140:143], v[68:71], a[156:159], v[140:143]
    ds_read_b128 a[80:83], v10 offset:4096
    s_nop 0
    v_mfma_f32_16x16x32_bf16 v[140:143], v[72:75], a[172:175], v[140:143]
    ds_read_b128 a[84:87], v10 offset:5120
    v_cndmask_b32 v126, 0, v26, s[14:15]
    v_mfma_f32_16x16x32_bf16 v[140:143], v[76:79], a[188:191], v[140:143]
    buffer_load_dwordx4 v1, s[48:51], s98 offen offset:1024 sc1 lds
    s_waitcnt lgkmcnt(5)
    v_mfma_f32_16x16x32_bf16 v[144:147], v[80:83], a[128:131], v[144:147]
    ds_read_b64_tr_b16 v[64:65], v18 offset:32768
    ds_read_b128 a[88:91], v11 offset:4096
    v_mfma_f32_16x16x32_bf16 v[144:147], v[84:87], a[144:147], v[144:147]
    ds_read_b64_tr_b16 v[66:67], v18 offset:33280
    ds_read_b128 a[92:95], v11 offset:5120
    v_mfma_f32_16x16x32_bf16 v[144:147], v[88:91], a[160:163], v[144:147]
    ds_read_b64_tr_b16 v[68:69], v18 offset:36864
    ds_read_b128 a[96:99], v10 offset:16384
    v_mfma_f32_16x16x32_bf16 v[144:147], v[92:95], a[176:179], v[144:147]
    buffer_load_dwordx4 v1, s[48:51], s98 offen offset:2048 sc1 lds
    v_mfma_f32_16x16x32_bf16 v[148:151], v[80:83], a[132:135], v[148:151]
    ds_read_b64_tr_b16 v[70:71], v18 offset:37376
    ds_read_b128 a[100:103], v10 offset:17408
    v_mfma_f32_16x16x32_bf16 v[148:151], v[84:87], a[148:151], v[148:151]
    ds_read_b64_tr_b16 v[72:73], v18 offset:40960
    ds_read_b128 a[104:107], v11 offset:16384
    v_mfma_f32_16x16x32_bf16 v[148:151], v[88:91], a[164:167], v[148:151]
    ds_read_b64_tr_b16 v[74:75], v18 offset:41472
    ds_read_b128 a[108:111], v11 offset:17408
    v_mfma_f32_16x16x32_bf16 v[148:151], v[92:95], a[180:183], v[148:151]
    buffer_load_dwordx4 v1, s[48:51], s98 offen offset:3072 sc1 lds
    v_mfma_f32_16x16x32_bf16 v[152:155], v[80:83], a[136:139], v[152:155]
    ds_read_b64_tr_b16 v[76:77], v18 offset:45056
    ds_read_b128 a[112:115], v10 offset:20480
    v_mfma_f32_16x16x32_bf16 v[152:155], v[84:87], a[152:155], v[152:155]
    ds_read_b64_tr_b16 v[78:79], v18 offset:45568
    ds_read_b128 a[116:119], v10 offset:21504
    v_mfma_f32_16x16x32_bf16 v[152:155], v[88:91], a[168:171], v[152:155]
    ds_read_b128 a[120:123], v11 offset:20480
    s_add_u32 s79, s79, 16384
    v_mfma_f32_16x16x32_bf16 v[152:155], v[92:95], a[184:187], v[152:155]
    ds_read_b128 a[124:127], v11 offset:21504
    s_sub_u32 s93, s93, 1
    s_cselect_b32 s79, s94, s79
    s_cselect_b32 s93, s75, s93
    v_mfma_f32_16x16x32_bf16 v[156:159], v[80:83], a[140:143], v[156:159]
    s_add_u32 s92, s92, 32768
    s_sub_u32 s99, s92, 98304
    v_mfma_f32_16x16x32_bf16 v[156:159], v[84:87], a[156:159], v[156:159]
    s_cmp_ge_i32 s99, 65536
    s_cselect_b32 s92, s99, s92
    v_and_b32 v61, 31, v0
    v_mfma_f32_16x16x32_bf16 v[156:159], v[88:91], a[172:175], v[156:159]
    v_lshlrev_b32 v61, 7, v61
    v_lshrrev_b32 v45, 5, v0
    v_mfma_f32_16x16x32_bf16 v[156:159], v[92:95], a[188:191], v[156:159]
    v_lshl_add_u32 v61, v45, 24, v61
    s_nop 0
    s_waitcnt lgkmcnt(3)
    s_barrier
    v_mfma_f32_16x16x32_bf16 v[160:163], a[128:131], v[64:67], v[160:163]
    buffer_load_dword v63, v61, s[48:51], s79 offen sc1
    v_mfma_f32_16x16x32_bf16 v[160:163], a[144:147], v[68:71], v[160:163]
    ds_read_b64_tr_b16 v[80:81], v16 offset:49152
    v_cndmask_b32 v127, 0, v26, s[100:101]
    v_mfma_f32_16x16x32_bf16 v[160:163], a[160:163], v[72:75], v[160:163]
    ds_read_b64_tr_b16 v[82:83], v16 offset:49664
    v_and_b32 v52, 0x27, v0
    v_mfma_f32_16x16x32_bf16 v[160:163], a[176:179], v[76:79], v[160:163]
    ds_read_b64_tr_b16 v[84:85], v16 offset:53248
    v_bfe_u32 v53, v0, 3, 1
    v_mfma_f32_16x16x32_bf16 v[164:167], a[132:135], v[64:67], v[164:167]
    ds_read_b64_tr_b16 v[86:87], v16 offset:53760
    v_lshl_or_b32 v52, v53, 4, v52
    v_mfma_f32_16x16x32_bf16 v[164:167], a[148:151], v[68:71], v[164:167]
    ds_read_b64_tr_b16 v[88:89], v16 offset:57344
    v_bfe_u32 v53, v0, 4, 1
    v_mfma_f32_16x16x32_bf16 v[164:167], a[164:167], v[72:75], v[164:167]
    ds_read_b64_tr_b16 v[90:91], v16 offset:57856
    v_lshl_or_b32 v52, v53, 3, v52
    v_mfma_f32_16x16x32_bf16 v[164:167], a[180:183], v[76:79], v[164:167]
    ds_read_b64_tr_b16 v[92:93], v16 offset:61440
    v_lshlrev_b32 v52, 4, v52
    v_mfma_f32_16x16x32_bf16 v[168:171], a[136:139], v[64:67], v[168:171]
    ds_read_b64_tr_b16 v[94:95], v16 offset:61952
    v_lshrrev_b32 v53, 5, v0
    v_mfma_f32_16x16x32_bf16 v[168:171], a[152:155], v[68:71], v[168:171]
    v_lshl_add_u32 v53, v53, 6, v1
    v_lshrrev_b32 v54, 1, v0
    v_mfma_f32_16x16x32_bf16 v[168:171], a[168:171], v[72:75], v[168:171]
    v_mul_u32_u24 v54, 576, v54
    v_and_b32 v56, 1, v0
    v_mfma_f32_16x16x32_bf16 v[168:171], a[184:187], v[76:79], v[168:171]
    v_lshl_add_u32 v54, v56, 4, v54
    v_lshrrev_b32 v55, 2, v0
    v_mfma_f32_16x16x32_bf16 v[172:175], a[140:143], v[64:67], v[172:175]
    v_min_u32 v55, 1, v55
    v_lshl_or_b32 v54, v55, 30, v54
    v_mfma_f32_16x16x32_bf16 v[172:175], a[156:159], v[68:71], v[172:175]
    v_add_u32 v56, -1, v56
    v_and_b32 v56, 0x3f803f80, v56
    v_mfma_f32_16x16x32_bf16 v[172:175], a[172:175], v[72:75], v[172:175]
    v_mov_b32 v57, v56
    v_mov_b32 v58, v56
    v_mfma_f32_16x16x32_bf16 v[172:175], a[188:191], v[76:79], v[172:175]
    v_mov_b32 v59, v56
    s_lshl_b32 s95, s52, 6
    s_waitcnt lgkmcnt(0)
    v_mfma_f32_16x16x32_bf16 v[128:131], v[80:83], a[192:195], v[128:131]
    ds_read_b64_tr_b16 v[64:65], v17 offset:49152
    s_add_u32 s95, s95, s59
    v_mfma_f32_16x16x32_bf16 v[128:131], v[84:87], a[208:211], v[128:131]
    ds_read_b64_tr_b16 v[66:67], v17 offset:49664
    s_mul_i32 s95, s95, 2176
    v_mfma_f32_16x16x32_bf16 v[128:131], v[88:91], a[224:227], v[128:131]
    ds_read_b64_tr_b16 v[68:69], v17 offset:53248
    s_add_u32 s95, s95, 57147392
    v_mfma_f32_16x16x32_bf16 v[128:131], v[92:95], a[240:243], v[128:131]
    ds_read_b64_tr_b16 v[70:71], v17 offset:53760
    s_lshl_b32 s97, s52, 6
    v_mfma_f32_16x16x32_bf16 v[132:135], v[80:83], a[196:199], v[132:135]
    ds_read_b64_tr_b16 v[72:73], v17 offset:57344
    s_add_u32 s97, s97, s60
    v_mfma_f32_16x16x32_bf16 v[132:135], v[84:87], a[212:215], v[132:135]
    ds_read_b64_tr_b16 v[74:75], v17 offset:57856
    s_mul_i32 s97, s97, 2176
    v_mfma_f32_16x16x32_bf16 v[132:135], v[88:91], a[228:231], v[132:135]
    ds_read_b64_tr_b16 v[76:77], v17 offset:61440
    s_add_u32 s97, s97, 57147392
    v_mfma_f32_16x16x32_bf16 v[132:135], v[92:95], a[244:247], v[132:135]
    ds_read_b64_tr_b16 v[78:79], v17 offset:61952
    v_mfma_f32_16x16x32_bf16 v[136:139], v[80:83], a[200:203], v[136:139]
    v_mfma_f32_16x16x32_bf16 v[136:139], v[84:87], a[216:219], v[136:139]
    v_mfma_f32_16x16x32_bf16 v[136:139], v[88:91], a[232:235], v[136:139]
    v_mfma_f32_16x16x32_bf16 v[136:139], v[92:95], a[248:251], v[136:139]
    v_mfma_f32_16x16x32_bf16 v[140:143], v[80:83], a[204:207], v[140:143]
    v_mfma_f32_16x16x32_bf16 v[140:143], v[84:87], a[220:223], v[140:143]
    v_mfma_f32_16x16x32_bf16 v[140:143], v[88:91], a[236:239], v[140:143]
    v_mfma_f32_16x16x32_bf16 v[140:143], v[92:95], a[252:255], v[140:143]
    s_waitcnt lgkmcnt(0)
    v_mfma_f32_16x16x32_bf16 v[144:147], v[64:67], a[192:195], v[144:147]
    ds_read_b64_tr_b16 v[80:81], v18 offset:49152
    v_mfma_f32_16x16x32_bf16 v[144:147], v[68:71], a[208:211], v[144:147]
    ds_read_b64_tr_b16 v[82:83], v18 offset:49664
    v_mfma_f32_16x16x32_bf16 v[144:147], v[72:75], a[224:227], v[144:147]
    ds_read_b64_tr_b16 v[84:85], v18 offset:53248
    v_mfma_f32_16x16x32_bf16 v[144:147], v[76:79], a[240:243], v[144:147]
    ds_read_b64_tr_b16 v[86:87], v18 offset:53760
    v_mfma_f32_16x16x32_bf16 v[148:151], v[64:67], a[196:199], v[148:151]
    ds_read_b64_tr_b16 v[88:89], v18 offset:57344
    v_mfma_f32_16x16x32_bf16 v[148:151], v[68:71], a[212:215], v[148:151]
    ds_read_b64_tr_b16 v[90:91], v18 offset:57856
    v_mfma_f32_16x16x32_bf16 v[148:151], v[72:75], a[228:231], v[148:151]
    ds_read_b64_tr_b16 v[92:93], v18 offset:61440
    v_mfma_f32_16x16x32_bf16 v[148:151], v[76:79], a[244:247], v[148:151]
    ds_read_b64_tr_b16 v[94:95], v18 offset:61952
    v_mfma_f32_16x16x32_bf16 v[152:155], v[64:67], a[200:203], v[152:155]
    v_mfma_f32_16x16x32_bf16 v[152:155], v[68:71], a[216:219], v[152:155]
    v_mfma_f32_16x16x32_bf16 v[152:155], v[72:75], a[232:235], v[152:155]
    v_mfma_f32_16x16x32_bf16 v[152:155], v[76:79], a[248:251], v[152:155]
    v_mfma_f32_16x16x32_bf16 v[156:159], v[64:67], a[204:207], v[156:159]
    v_mfma_f32_16x16x32_bf16 v[156:159], v[68:71], a[220:223], v[156:159]
    v_mfma_f32_16x16x32_bf16 v[156:159], v[72:75], a[236:239], v[156:159]
    v_mfma_f32_16x16x32_bf16 v[156:159], v[76:79], a[252:255], v[156:159]
    s_waitcnt lgkmcnt(0)
    s_waitcnt vmcnt(1)
    s_barrier
    v_mfma_f32_16x16x32_bf16 v[160:163], a[192:195], v[80:83], v[160:163]
    ds_read_b128 a[128:131], v2 offset:0
    s_mov_b32 m0, s92
    s_add_u32 s98, s79, 16777216
    v_cvt_pk_bf16_f32 v20, v128, v129
    v_mfma_f32_16x16x32_bf16 v[160:163], a[208:211], v[84:87], v[160:163]
    buffer_load_dwordx4 v1, s[48:51], s79 offen offset:0 sc1 lds
    ds_read_b128 a[132:135], v2 offset:1024
    v_cvt_pk_bf16_f32 v21, v130, v131
    v_mfma_f32_16x16x32_bf16 v[160:163], a[224:227], v[88:91], v[160:163]
    ds_read_b128 a[136:139], v2 offset:2048
    v_cvt_pk_bf16_f32 v22, v132, v133
    v_cvt_pk_bf16_f32 v23, v134, v135
    v_mul_f32 v144, s74, v144
    v_mfma_f32_16x16x32_bf16 v[160:163], a[240:243], v[92:95], v[160:163]
    buffer_load_dwordx4 v1, s[48:51], s79 offen offset:1024 sc1 lds
    ds_read_b128 a[140:143], v2 offset:3072
    v_mul_f32 v145, s74, v145
    v_mfma_f32_16x16x32_bf16 v[164:167], a[196:199], v[80:83], v[164:167]
    ds_read_b128 a[144:147], v2 offset:4096
    v_mul_f32 v146, s74, v146
    v_mul_f32 v147, s74, v147
    v_mul_f32 v148, s74, v148
    v_mfma_f32_16x16x32_bf16 v[164:167], a[212:215], v[84:87], v[164:167]
    buffer_load_dwordx4 v1, s[48:51], s79 offen offset:2048 sc1 lds
    ds_read_b128 a[148:151], v2 offset:5120
    v_mul_f32 v149, s74, v149
    v_mfma_f32_16x16x32_bf16 v[164:167], a[228:231], v[88:91], v[164:167]
    ds_read_b128 a[152:155], v2 offset:6144
    v_mul_f32 v150, s74, v150
    v_mul_f32 v151, s74, v151
    v_cvt_pk_bf16_f32 v28, v144, v145
    v_mfma_f32_16x16x32_bf16 v[164:167], a[244:247], v[92:95], v[164:167]
    buffer_load_dwordx4 v1, s[48:51], s79 offen offset:3072 sc1 lds
    ds_read_b128 a[156:159], v2 offset:7168
    s_add_u32 m0, s92, 16384
    v_mfma_f32_16x16x32_bf16 v[168:171], a[200:203], v[80:83], v[168:171]
    v_cvt_pk_bf16_f32 v29, v146, v147
    v_cvt_pk_bf16_f32 v30, v148, v149
    v_cvt_pk_bf16_f32 v31, v150, v151
    v_permlane16_swap_b32 v20, v22
    v_mfma_f32_16x16x32_bf16 v[168:171], a[216:219], v[84:87], v[168:171]
    buffer_load_dwordx4 v1, s[48:51], s98 offen offset:0 sc1 lds
    v_permlane16_swap_b32 v21, v23
    s_nop 0
    v_mfma_f32_16x16x32_bf16 v[168:171], a[232:235], v[88:91], v[168:171]
    v_permlane16_swap_b32 v28, v30
    v_permlane16_swap_b32 v29, v31
    v_mfma_f32_16x16x32_bf16 v[168:171], a[248:251], v[92:95], v[168:171]
    buffer_load_dwordx4 v1, s[48:51], s98 offen offset:1024 sc1 lds
    v_mfma_f32_16x16x32_bf16 v[172:175], a[204:207], v[80:83], v[172:175]
    v_mfma_f32_16x16x32_bf16 v[172:175], a[220:223], v[84:87], v[172:175]
    buffer_load_dwordx4 v1, s[48:51], s98 offen offset:2048 sc1 lds
    v_mfma_f32_16x16x32_bf16 v[172:175], a[236:239], v[88:91], v[172:175]
    v_mfma_f32_16x16x32_bf16 v[172:175], a[252:255], v[92:95], v[172:175]
    buffer_load_dwordx4 v1, s[48:51], s98 offen offset:3072 sc1 lds
    s_add_u32 s79, s79, 16384
    s_sub_u32 s93, s93, 1
    s_cselect_b32 s79, s94, s79
    s_cselect_b32 s93, s75, s93
    s_add_u32 s92, s92, 32768
    s_sub_u32 s99, s92, 98304
    s_cmp_ge_i32 s99, 65536
    s_cselect_b32 s92, s99, s92
    buffer_store_dwordx4 v[28:31], v52, s[48:51], s95 offen sc1
    buffer_store_dwordx4 v[56:59], v54, s[48:51], s95 offen offset:1536 sc1
    v_cvt_pk_bf16_f32 v24, v136, v137
    v_cvt_pk_bf16_f32 v25, v138, v139
    v_cvt_pk_bf16_f32 v26, v140, v141
    v_cvt_pk_bf16_f32 v27, v142, v143
    v_mul_f32 v152, s74, v152
    v_mul_f32 v153, s74, v153
    v_mul_f32 v154, s74, v154
    v_mul_f32 v155, s74, v155
    v_mul_f32 v156, s74, v156
    v_mul_f32 v157, s74, v157
    v_mul_f32 v158, s74, v158
    v_mul_f32 v159, s74, v159
    v_cvt_pk_bf16_f32 v32, v152, v153
    v_cvt_pk_bf16_f32 v33, v154, v155
    v_cvt_pk_bf16_f32 v34, v156, v157
    v_cvt_pk_bf16_f32 v35, v158, v159
    v_permlane16_swap_b32 v24, v26
    v_permlane16_swap_b32 v25, v27
    s_nop 0
    v_permlane16_swap_b32 v32, v34
    v_permlane16_swap_b32 v33, v35
    buffer_store_dwordx4 v[32:35], v52, s[48:51], s97 offen sc1
    buffer_store_dwordx4 v[56:59], v54, s[48:51], s97 offen offset:1536 sc1
    s_cmp_eq_u32 s57, 0
    s_cbranch_scc0 L_t0_gen
    s_waitcnt lgkmcnt(0)
    v_mfma_f32_16x16x32_bf16 v[64:67], a[128:131], a[0:3], v[96:99]
    ds_read_b128 a[192:195], v2 offset:16384
    s_mov_b32 m0, s92
    s_add_u32 s98, s79, 16777216
    v_mfma_f32_16x16x32_bf16 v[64:67], a[132:135], a[4:7], v[64:67]
    ds_read_b128 a[196:199], v2 offset:17408
    buffer_load_dwordx4 v1, s[48:51], s79 offen offset:0 sc1 lds
    v_mfma_f32_16x16x32_bf16 v[64:67], a[136:139], a[64:67], v[64:67]
    ds_read_b128 a[200:203], v2 offset:18432
    buffer_load_dwordx4 v1, s[48:51], s79 offen offset:1024 sc1 lds
    v_mfma_f32_16x16x32_bf16 v[64:67], a[140:143], a[68:71], v[64:67]
    ds_read_b128 a[204:207], v2 offset:19456
    buffer_load_dwordx4 v1, s[48:51], s79 offen offset:2048 sc1 lds
    v_mfma_f32_16x16x32_bf16 v[68:71], a[144:147], a[0:3], v[100:103]
    ds_read_b128 a[208:211], v2 offset:20480
    buffer_load_dwordx4 v1, s[48:51], s79 offen offset:3072 sc1 lds
    v_mfma_f32_16x16x32_bf16 v[68:71], a[148:151], a[4:7], v[68:71]
    ds_read_b128 a[212:215], v2 offset:21504
    s_add_u32 m0, s92, 16384
    v_cvt_pk_bf16_f32 v36, v160, v161
    v_cvt_pk_bf16_f32 v37, v162, v163
    v_mfma_f32_16x16x32_bf16 v[68:71], a[152:155], a[64:67], v[68:71]
    ds_read_b128 a[216:219], v2 offset:22528
    buffer_load_dwordx4 v1, s[48:51], s98 offen offset:0 sc1 lds
    v_cvt_pk_bf16_f32 v38, v164, v165
    v_mfma_f32_16x16x32_bf16 v[68:71], a[156:159], a[68:71], v[68:71]
    ds_read_b128 a[220:223], v2 offset:23552
    buffer_load_dwordx4 v1, s[48:51], s98 offen offset:1024 sc1 lds
    v_cvt_pk_bf16_f32 v39, v166, v167
    v_mfma_f32_16x16x32_bf16 v[72:75], a[128:131], a[8:11], v[104:107]
    buffer_load_dwordx4 v1, s[48:51], s98 offen offset:2048 sc1 lds
    buffer_store_dwordx4 v[36:39], v53, s[48:51], s95 offen offset:1024 sc1
    v_exp_f32 v64, v64
    v_mfma_f32_16x16x32_bf16 v[72:75], a[132:135], a[12:15], v[72:75]
    buffer_load_dwordx4 v1, s[48:51], s98 offen offset:3072 sc1 lds
    s_add_u32 s79, s79, 16384
    v_cvt_pk_bf16_f32 v40, v168, v169
    v_mfma_f32_16x16x32_bf16 v[72:75], a[136:139], a[72:75], v[72:75]
    v_exp_f32 v65, v65
    s_sub_u32 s93, s93, 1
    s_cselect_b32 s79, s94, s79
    v_cvt_pk_bf16_f32 v41, v170, v171
    v_mfma_f32_16x16x32_bf16 v[72:75], a[140:143], a[76:79], v[72:75]
    v_cvt_pk_bf16_f32 v44, v64, v65
    s_cselect_b32 s93, s75, s93
    v_cvt_pk_bf16_f32 v42, v172, v173
    v_mfma_f32_16x16x32_bf16 v[76:79], a[144:147], a[8:11], v[108:111]
    v_exp_f32 v66, v66
    s_add_u32 s92, s92, 32768
    v_cvt_pk_bf16_f32 v43, v174, v175
    v_mfma_f32_16x16x32_bf16 v[76:79], a[148:151], a[12:15], v[76:79]
    buffer_store_dwordx4 v[40:43], v53, s[48:51], s97 offen offset:1024 sc1
    s_sub_u32 s99, s92, 98304
    v_mfma_f32_16x16x32_bf16 v[76:79], a[152:155], a[72:75], v[76:79]
    v_exp_f32 v67, v67
    s_cmp_ge_i32 s99, 65536
    v_mfma_f32_16x16x32_bf16 v[76:79], a[156:159], a[76:79], v[76:79]
    v_cvt_pk_bf16_f32 v45, v66, v67
    s_cselect_b32 s92, s99, s92
    s_add_u32 s62, s62, 32768
    s_cmp_eq_u32 s62, 98304
    s_cselect_b32 s62, 0, s62
    v_add_u32 v2, s62, v3
    v_exp_f32 v68, v68
    v_exp_f32 v69, v69
    v_exp_f32 v70, v70
    v_cvt_pk_bf16_f32 v46, v68, v69
    v_exp_f32 v71, v71
    v_exp_f32 v72, v72
    v_cvt_pk_bf16_f32 v47, v70, v71
    v_exp_f32 v73, v73
    v_exp_f32 v74, v74
    v_cvt_pk_bf16_f32 v48, v72, v73
    v_exp_f32 v75, v75
    v_exp_f32 v76, v76
    v_cvt_pk_bf16_f32 v49, v74, v75
    s_waitcnt vmcnt(14) lgkmcnt(0)
    s_barrier
    v_mfma_f32_16x16x32_bf16 v[80:83], a[128:131], a[16:19], 0
    v_exp_f32 v77, v77
    v_mfma_f32_16x16x32_bf16 v[80:83], a[132:135], a[20:23], v[80:83]
    ds_read_b128 a[160:163], v2 offset:0
    v_cvt_pk_bf16_f32 v50, v76, v77
    v_mfma_f32_16x16x32_bf16 v[80:83], a[136:139], a[80:83], v[80:83]
    v_exp_f32 v78, v78
    v_mfma_f32_16x16x32_bf16 v[80:83], a[140:143], a[84:87], v[80:83]
    ds_read_b128 a[164:167], v2 offset:1024
    v_mfma_f32_16x16x32_bf16 v[84:87], a[144:147], a[16:19], 0
    v_exp_f32 v79, v79
    v_mfma_f32_16x16x32_bf16 v[84:87], a[148:151], a[20:23], v[84:87]
    ds_read_b128 a[168:171], v2 offset:2048
    v_cvt_pk_bf16_f32 v51, v78, v79
    v_mfma_f32_16x16x32_bf16 v[84:87], a[152:155], a[80:83], v[84:87]
    ds_read_b128 a[172:175], v2 offset:3072
    v_mfma_f32_16x16x32_bf16 v[84:87], a[156:159], a[84:87], v[84:87]
    ds_read_b128 a[176:179], v2 offset:4096
    v_mfma_f32_16x16x32_bf16 v[88:91], a[128:131], a[24:27], 0
    v_exp_f32 v80, v80
    v_mfma_f32_16x16x32_bf16 v[88:91], a[132:135], a[28:31], v[88:91]
    ds_read_b128 a[180:183], v2 offset:5120
    v_mfma_f32_16x16x32_bf16 v[88:91], a[136:139], a[88:91], v[88:91]
    v_exp_f32 v81, v81
    v_mfma_f32_16x16x32_bf16 v[88:91], a[140:143], a[92:95], v[88:91]
    ds_read_b128 a[184:187], v2 offset:6144
    v_cvt_pk_bf16_f32 v52, v80, v81
    v_mfma_f32_16x16x32_bf16 v[92:95], a[144:147], a[24:27], 0
    v_exp_f32 v82, v82
    v_mfma_f32_16x16x32_bf16 v[92:95], a[148:151], a[28:31], v[92:95]
    ds_read_b128 a[188:191], v2 offset:7168
    v_mfma_f32_16x16x32_bf16 v[92:95], a[152:155], a[88:91], v[92:95]
    s_mov_b32 m0, s92
    v_exp_f32 v83, v83
    v_mfma_f32_16x16x32_bf16 v[92:95], a[156:159], a[92:95], v[92:95]
    ds_read_b128 a[224:227], v2 offset:16384
    v_cvt_pk_bf16_f32 v53, v82, v83
    v_mfma_f32_16x16x32_bf16 v[128:131], a[192:195], v[44:47], 0
    s_add_u32 s98, s79, 16777216
    v_exp_f32 v84, v84
    v_mfma_f32_16x16x32_bf16 v[132:135], a[196:199], v[44:47], 0
    buffer_load_dwordx4 v1, s[48:51], s79 offen offset:0 sc1 lds
    v_mfma_f32_16x16x32_bf16 v[136:139], a[200:203], v[44:47], 0
    v_exp_f32 v85, v85
    s_lshl_b32 s67, s54, 13
    v_mfma_f32_16x16x32_bf16 v[140:143], a[204:207], v[44:47], 0
    ds_read_b128 a[228:231], v2 offset:17408
    v_cvt_pk_bf16_f32 v54, v84, v85
    v_add_u32 v10, s67, v1
    v_mfma_f32_16x16x32_bf16 v[144:147], a[208:211], v[44:47], 0
    v_exp_f32 v86, v86
    v_xor_b32 v11, 0x4000, v10
    v_mfma_f32_16x16x32_bf16 v[148:151], a[212:215], v[44:47], 0
    buffer_load_dwordx4 v1, s[48:51], s79 offen offset:1024 sc1 lds
    v_add_u32 v19, 4096, v60
    v_mfma_f32_16x16x32_bf16 v[152:155], a[216:219], v[44:47], 0
    v_exp_f32 v87, v87
    v_mfma_f32_16x16x32_bf16 v[156:159], a[220:223], v[44:47], 0
    ds_read_b128 a[232:235], v2 offset:18432
    v_cvt_pk_bf16_f32 v55, v86, v87
    v_mfma_f32_16x16x32_bf16 v[28:31], v[4:7], v[44:47], 0
    v_exp_f32 v88, v88
    v_mfma_f32_16x16x32_bf16 v[160:163], a[192:195], v[48:51], 0
    buffer_load_dwordx4 v1, s[48:51], s79 offen offset:2048 sc1 lds
    v_mfma_f32_16x16x32_bf16 v[164:167], a[196:199], v[48:51], 0
    v_exp_f32 v89, v89
    v_mfma_f32_16x16x32_bf16 v[168:171], a[200:203], v[48:51], 0
    ds_read_b128 a[236:239], v2 offset:19456
    v_cvt_pk_bf16_f32 v56, v88, v89
    v_mfma_f32_16x16x32_bf16 v[172:175], a[204:207], v[48:51], 0
    ds_write_b128 v10, v[128:131] offset:0
    v_exp_f32 v90, v90
    v_mfma_f32_16x16x32_bf16 v[176:179], a[208:211], v[48:51], 0
    buffer_load_dwordx4 v1, s[48:51], s79 offen offset:3072 sc1 lds
    v_mfma_f32_16x16x32_bf16 v[180:183], a[212:215], v[48:51], 0
    s_add_u32 m0, s92, 16384
    v_exp_f32 v91, v91
    v_mfma_f32_16x16x32_bf16 v[184:187], a[216:219], v[48:51], 0
    ds_read_b128 a[240:243], v2 offset:20480
    v_cvt_pk_bf16_f32 v57, v90, v91
    v_mfma_f32_16x16x32_bf16 v[188:191], a[220:223], v[48:51], 0
    v_exp_f32 v92, v92
    v_mfma_f32_16x16x32_bf16 v[32:35], v[4:7], v[48:51], 0
    buffer_load_dwordx4 v1, s[48:51], s98 offen offset:0 sc1 lds
    s_waitcnt lgkmcnt(6)
    v_mfma_f32_16x16x32_bf16 v[64:67], a[160:163], a[16:19], v[112:115]
    ds_write_b128 v10, v[132:135] offset:1024
    v_exp_f32 v93, v93
    v_mfma_f32_16x16x32_bf16 v[64:67], a[164:167], a[20:23], v[64:67]
    ds_read_b128 a[244:247], v2 offset:21504
    v_cvt_pk_bf16_f32 v58, v92, v93
    v_mfma_f32_16x16x32_bf16 v[64:67], a[168:171], a[80:83], v[64:67]
    v_exp_f32 v94, v94
    v_mfma_f32_16x16x32_bf16 v[64:67], a[172:175], a[84:87], v[64:67]
    buffer_load_dwordx4 v1, s[48:51], s98 offen offset:1024 sc1 lds
    v_mfma_f32_16x16x32_bf16 v[68:71], a[176:179], a[16:19], v[116:119]
    v_exp_f32 v95, v95
    v_mfma_f32_16x16x32_bf16 v[68:71], a[180:183], a[20:23], v[68:71]
    ds_read_b128 a[248:251], v2 offset:22528
    v_cvt_pk_bf16_f32 v59, v94, v95
    v_mfma_f32_16x16x32_bf16 v[68:71], a[184:187], a[80:83], v[68:71]
    buffer_load_dwordx4 v1, s[48:51], s98 offen offset:2048 sc1 lds
    v_mfma_f32_16x16x32_bf16 v[68:71], a[188:191], a[84:87], v[68:71]
    ds_write_b128 v10, v[136:139] offset:2048
    v_mfma_f32_16x16x32_bf16 v[72:75], a[160:163], a[24:27], v[120:123]
    s_add_u32 s62, s62, 32768
    v_exp_f32 v64, v64
    v_mfma_f32_16x16x32_bf16 v[72:75], a[164:167], a[28:31], v[72:75]
    buffer_load_dwordx4 v1, s[48:51], s98 offen offset:3072 sc1 lds
    v_mfma_f32_16x16x32_bf16 v[72:75], a[168:171], a[88:91], v[72:75]
    s_cmp_eq_u32 s62, 98304
    v_exp_f32 v65, v65
    v_mfma_f32_16x16x32_bf16 v[72:75], a[172:175], a[92:95], v[72:75]
    ds_read_b128 a[252:255], v2 offset:23552
    v_cvt_pk_bf16_f32 v44, v64, v65
    v_mfma_f32_16x16x32_bf16 v[76:79], a[176:179], a[24:27], v[124:127]
    s_cselect_b32 s62, 0, s62
    v_exp_f32 v66, v66
    v_mfma_f32_16x16x32_bf16 v[76:79], a[180:183], a[28:31], v[76:79]
    ds_write_b128 v10, v[140:143] offset:3072
    v_add_u32 v2, s62, v3
    v_mfma_f32_16x16x32_bf16 v[76:79], a[184:187], a[88:91], v[76:79]
    s_add_u32 s79, s79, 16384
    v_exp_f32 v67, v67
    v_mfma_f32_16x16x32_bf16 v[76:79], a[188:191], a[92:95], v[76:79]
    v_cvt_pk_bf16_f32 v45, v66, v67
    v_mfma_f32_16x16x32_bf16 v[192:195], a[192:195], v[52:55], 0
    s_sub_u32 s93, s93, 1
    v_exp_f32 v68, v68
    v_mfma_f32_16x16x32_bf16 v[196:199], a[196:199], v[52:55], 0
    s_cselect_b32 s79, s94, s79
    ds_write_b128 v10, v[144:147] offset:4096
    v_mfma_f32_16x16x32_bf16 v[200:203], a[200:203], v[52:55], 0
    s_cselect_b32 s93, s75, s93
    v_exp_f32 v69, v69
    v_mfma_f32_16x16x32_bf16 v[204:207], a[204:207], v[52:55], 0
    v_cvt_pk_bf16_f32 v46, v68, v69
    v_mfma_f32_16x16x32_bf16 v[208:211], a[208:211], v[52:55], 0
    s_add_u32 s92, s92, 32768
    v_exp_f32 v70, v70
    v_mfma_f32_16x16x32_bf16 v[212:215], a[212:215], v[52:55], 0
    s_sub_u32 s99, s92, 98304
    ds_write_b128 v10, v[148:151] offset:5120
    v_mfma_f32_16x16x32_bf16 v[216:219], a[216:219], v[52:55], 0
    s_cmp_ge_i32 s99, 65536
    v_exp_f32 v71, v71
    v_mfma_f32_16x16x32_bf16 v[220:223], a[220:223], v[52:55], 0
    v_cvt_pk_bf16_f32 v47, v70, v71
    v_mfma_f32_16x16x32_bf16 v[36:39], v[4:7], v[52:55], 0
    s_cselect_b32 s92, s99, s92
    v_exp_f32 v72, v72
    v_mfma_f32_16x16x32_bf16 v[224:227], a[192:195], v[56:59], 0
    ds_write_b128 v10, v[152:155] offset:6144
    v_mfma_f32_16x16x32_bf16 v[228:231], a[196:199], v[56:59], 0
    v_exp_f32 v73, v73
    v_mfma_f32_16x16x32_bf16 v[232:235], a[200:203], v[56:59], 0
    v_cvt_pk_bf16_f32 v48, v72, v73
    v_mfma_f32_16x16x32_bf16 v[236:239], a[204:207], v[56:59], 0
    ds_write_b128 v10, v[156:159] offset:7168
    v_exp_f32 v74, v74
    v_mfma_f32_16x16x32_bf16 v[240:243], a[208:211], v[56:59], 0
    v_mfma_f32_16x16x32_bf16 v[244:247], a[212:215], v[56:59], 0
    v_exp_f32 v75, v75
    v_mfma_f32_16x16x32_bf16 v[248:251], a[216:219], v[56:59], 0
    v_cvt_pk_bf16_f32 v49, v74, v75
    v_mfma_f32_16x16x32_bf16 v[252:255], a[220:223], v[56:59], 0
    v_exp_f32 v76, v76
    v_mfma_f32_16x16x32_bf16 v[40:43], v[4:7], v[56:59], 0
    s_waitcnt vmcnt(8) lgkmcnt(0)
    s_barrier
    s_cmp_lg_u32 s54, 0
    s_cbranch_scc1 L_sig2
    s_lshl_b32 s67, s52, 7
    s_add_u32 s67, s67, 61673472
    s_lshl2_add_u32 s67, s53, s67
    v_min_u32 v62, 1, v0
    v_lshlrev_b32 v62, 30, v62
    v_mov_b32 v63, s12
    buffer_store_dword v63, v62, s[48:51], s67 offen sc1
L_sig2:
    s_branch L_t0_tail
L_t0_gen:
    s_waitcnt lgkmcnt(0)
    v_mfma_f32_16x16x32_bf16 v[64:67], a[128:131], a[0:3], 0
    ds_read_b128 a[192:195], v2 offset:16384
    s_mov_b32 m0, s92
    s_add_u32 s98, s79, 16777216
    v_mfma_f32_16x16x32_bf16 v[64:67], a[132:135], a[4:7], v[64:67]
    ds_read_b128 a[196:199], v2 offset:17408
    buffer_load_dwordx4 v1, s[48:51], s79 offen offset:0 sc1 lds
    v_mfma_f32_16x16x32_bf16 v[64:67], a[136:139], a[64:67], v[64:67]
    ds_read_b128 a[200:203], v2 offset:18432
    buffer_load_dwordx4 v1, s[48:51], s79 offen offset:1024 sc1 lds
    v_mfma_f32_16x16x32_bf16 v[64:67], a[140:143], a[68:71], v[64:67]
    ds_read_b128 a[204:207], v2 offset:19456
    buffer_load_dwordx4 v1, s[48:51], s79 offen offset:2048 sc1 lds
    v_mfma_f32_16x16x32_bf16 v[68:71], a[144:147], a[0:3], 0
    ds_read_b128 a[208:211], v2 offset:20480
    buffer_load_dwordx4 v1, s[48:51], s79 offen offset:3072 sc1 lds
    v_mfma_f32_16x16x32_bf16 v[68:71], a[148:151], a[4:7], v[68:71]
    ds_read_b128 a[212:215], v2 offset:21504
    s_add_u32 m0, s92, 16384
    v_cvt_pk_bf16_f32 v36, v160, v161
    v_cvt_pk_bf16_f32 v37, v162, v163
    v_mfma_f32_16x16x32_bf16 v[68:71], a[152:155], a[64:67], v[68:71]
    ds_read_b128 a[216:219], v2 offset:22528
    buffer_load_dwordx4 v1, s[48:51], s98 offen offset:0 sc1 lds
    v_cvt_pk_bf16_f32 v38, v164, v165
    v_mfma_f32_16x16x32_bf16 v[68:71], a[156:159], a[68:71], v[68:71]
    ds_read_b128 a[220:223], v2 offset:23552
    buffer_load_dwordx4 v1, s[48:51], s98 offen offset:1024 sc1 lds
    v_cvt_pk_bf16_f32 v39, v166, v167
    v_mfma_f32_16x16x32_bf16 v[72:75], a[128:131], a[8:11], 0
    buffer_load_dwordx4 v1, s[48:51], s98 offen offset:2048 sc1 lds
    buffer_store_dwordx4 v[36:39], v53, s[48:51], s95 offen offset:1024 sc1
    v_exp_f32 v64, v64
    v_mfma_f32_16x16x32_bf16 v[72:75], a[132:135], a[12:15], v[72:75]
    buffer_load_dwordx4 v1, s[48:51], s98 offen offset:3072 sc1 lds
    s_add_u32 s79, s79, 16384
    v_cvt_pk_bf16_f32 v40, v168, v169
    v_mfma_f32_16x16x32_bf16 v[72:75], a[136:139], a[72:75], v[72:75]
    v_exp_f32 v65, v65
    s_sub_u32 s93, s93, 1
    s_cselect_b32 s79, s94, s79
    v_cvt_pk_bf16_f32 v41, v170, v171
    v_mfma_f32_16x16x32_bf16 v[72:75], a[140:143], a[76:79], v[72:75]
    v_cvt_pk_bf16_f32 v44, v64, v65
    s_cselect_b32 s93, s75, s93
    v_cvt_pk_bf16_f32 v42, v172, v173
    v_mfma_f32_16x16x32_bf16 v[76:79], a[144:147], a[8:11], 0
    v_exp_f32 v66, v66
    s_add_u32 s92, s92, 32768
    v_cvt_pk_bf16_f32 v43, v174, v175
    v_mfma_f32_16x16x32_bf16 v[76:79], a[148:151], a[12:15], v[76:79]
    buffer_store_dwordx4 v[40:43], v53, s[48:51], s97 offen offset:1024 sc1
    s_sub_u32 s99, s92, 98304
    v_mfma_f32_16x16x32_bf16 v[76:79], a[152:155], a[72:75], v[76:79]
    v_exp_f32 v67, v67
    s_cmp_ge_i32 s99, 65536
    v_mfma_f32_16x16x32_bf16 v[76:79], a[156:159], a[76:79], v[76:79]
    v_cvt_pk_bf16_f32 v45, v66, v67
    s_cselect_b32 s92, s99, s92
    s_add_u32 s62, s62, 32768
    s_cmp_eq_u32 s62, 98304
    s_cselect_b32 s62, 0, s62
    v_add_u32 v2, s62, v3
    v_exp_f32 v68, v68
    v_exp_f32 v69, v69
    v_exp_f32 v70, v70
    v_cvt_pk_bf16_f32 v46, v68, v69
    v_exp_f32 v71, v71
    v_exp_f32 v72, v72
    v_cvt_pk_bf16_f32 v47, v70, v71
    v_exp_f32 v73, v73
    v_exp_f32 v74, v74
    v_cvt_pk_bf16_f32 v48, v72, v73
    v_exp_f32 v75, v75
    v_exp_f32 v76, v76
    v_cvt_pk_bf16_f32 v49, v74, v75
    s_waitcnt vmcnt(14) lgkmcnt(0)
    s_barrier
    v_mfma_f32_16x16x32_bf16 v[80:83], a[128:131], a[16:19], 0
    v_exp_f32 v77, v77
    v_mfma_f32_16x16x32_bf16 v[80:83], a[132:135], a[20:23], v[80:83]
    ds_read_b128 a[160:163], v2 offset:0
    v_cvt_pk_bf16_f32 v50, v76, v77
    v_mfma_f32_16x16x32_bf16 v[80:83], a[136:139], a[80:83], v[80:83]
    v_exp_f32 v78, v78
    v_mfma_f32_16x16x32_bf16 v[80:83], a[140:143], a[84:87], v[80:83]
    ds_read_b128 a[164:167], v2 offset:1024
    v_mfma_f32_16x16x32_bf16 v[84:87], a[144:147], a[16:19], 0
    v_exp_f32 v79, v79
    v_mfma_f32_16x16x32_bf16 v[84:87], a[148:151], a[20:23], v[84:87]
    ds_read_b128 a[168:171], v2 offset:2048
    v_cvt_pk_bf16_f32 v51, v78, v79
    v_mfma_f32_16x16x32_bf16 v[84:87], a[152:155], a[80:83], v[84:87]
    ds_read_b128 a[172:175], v2 offset:3072
    v_mfma_f32_16x16x32_bf16 v[84:87], a[156:159], a[84:87], v[84:87]
    ds_read_b128 a[176:179], v2 offset:4096
    v_mfma_f32_16x16x32_bf16 v[88:91], a[128:131], a[24:27], 0
    v_exp_f32 v80, v80
    v_mfma_f32_16x16x32_bf16 v[88:91], a[132:135], a[28:31], v[88:91]
    ds_read_b128 a[180:183], v2 offset:5120
    v_mfma_f32_16x16x32_bf16 v[88:91], a[136:139], a[88:91], v[88:91]
    v_exp_f32 v81, v81
    v_mfma_f32_16x16x32_bf16 v[88:91], a[140:143], a[92:95], v[88:91]
    ds_read_b128 a[184:187], v2 offset:6144
    v_cvt_pk_bf16_f32 v52, v80, v81
    v_mfma_f32_16x16x32_bf16 v[92:95], a[144:147], a[24:27], 0
    v_exp_f32 v82, v82
    v_mfma_f32_16x16x32_bf16 v[92:95], a[148:151], a[28:31], v[92:95]
    ds_read_b128 a[188:191], v2 offset:7168
    v_mfma_f32_16x16x32_bf16 v[92:95], a[152:155], a[88:91], v[92:95]
    s_mov_b32 m0, s92
    v_exp_f32 v83, v83
    v_mfma_f32_16x16x32_bf16 v[92:95], a[156:159], a[92:95], v[92:95]
    ds_read_b128 a[224:227], v2 offset:16384
    v_cvt_pk_bf16_f32 v53, v82, v83
    v_mfma_f32_16x16x32_bf16 v[128:131], a[192:195], v[44:47], 0
    s_add_u32 s98, s79, 16777216
    v_exp_f32 v84, v84
    v_mfma_f32_16x16x32_bf16 v[132:135], a[196:199], v[44:47], 0
    buffer_load_dwordx4 v1, s[48:51], s79 offen offset:0 sc1 lds
    v_mfma_f32_16x16x32_bf16 v[136:139], a[200:203], v[44:47], 0
    v_exp_f32 v85, v85
    v_mfma_f32_16x16x32_bf16 v[140:143], a[204:207], v[44:47], 0
    ds_read_b128 a[228:231], v2 offset:17408
    v_cvt_pk_bf16_f32 v54, v84, v85
    v_mfma_f32_16x16x32_bf16 v[144:147], a[208:211], v[44:47], 0
    v_exp_f32 v86, v86
    v_mfma_f32_16x16x32_bf16 v[148:151], a[212:215], v[44:47], 0
    buffer_load_dwordx4 v1, s[48:51], s79 offen offset:1024 sc1 lds
    v_mfma_f32_16x16x32_bf16 v[152:155], a[216:219], v[44:47], 0
    v_exp_f32 v87, v87
    v_mfma_f32_16x16x32_bf16 v[156:159], a[220:223], v[44:47], 0
    ds_read_b128 a[232:235], v2 offset:18432
    v_cvt_pk_bf16_f32 v55, v86, v87
    v_mfma_f32_16x16x32_bf16 v[28:31], v[4:7], v[44:47], 0
    v_exp_f32 v88, v88
    v_mfma_f32_16x16x32_bf16 v[160:163], a[192:195], v[48:51], 0
    buffer_load_dwordx4 v1, s[48:51], s79 offen offset:2048 sc1 lds
    v_mfma_f32_16x16x32_bf16 v[164:167], a[196:199], v[48:51], 0
    v_exp_f32 v89, v89
    v_mfma_f32_16x16x32_bf16 v[168:171], a[200:203], v[48:51], 0
    ds_read_b128 a[236:239], v2 offset:19456
    v_cvt_pk_bf16_f32 v56, v88, v89
    v_mfma_f32_16x16x32_bf16 v[172:175], a[204:207], v[48:51], 0
    v_exp_f32 v90, v90
    v_mfma_f32_16x16x32_bf16 v[176:179], a[208:211], v[48:51], 0
    buffer_load_dwordx4 v1, s[48:51], s79 offen offset:3072 sc1 lds
    v_mfma_f32_16x16x32_bf16 v[180:183], a[212:215], v[48:51], 0
    s_add_u32 m0, s92, 16384
    v_exp_f32 v91, v91
    v_mfma_f32_16x16x32_bf16 v[184:187], a[216:219], v[48:51], 0
    ds_read_b128 a[240:243], v2 offset:20480
    v_cvt_pk_bf16_f32 v57, v90, v91
    v_mfma_f32_16x16x32_bf16 v[188:191], a[220:223], v[48:51], 0
    v_exp_f32 v92, v92
    v_mfma_f32_16x16x32_bf16 v[32:35], v[4:7], v[48:51], 0
    buffer_load_dwordx4 v1, s[48:51], s98 offen offset:0 sc1 lds
    s_waitcnt lgkmcnt(5)
    v_mfma_f32_16x16x32_bf16 v[64:67], a[160:163], a[0:3], 0
    v_exp_f32 v93, v93
    v_mfma_f32_16x16x32_bf16 v[64:67], a[164:167], a[4:7], v[64:67]
    ds_read_b128 a[244:247], v2 offset:21504
    v_cvt_pk_bf16_f32 v58, v92, v93
    v_mfma_f32_16x16x32_bf16 v[64:67], a[168:171], a[64:67], v[64:67]
    v_exp_f32 v94, v94
    v_mfma_f32_16x16x32_bf16 v[64:67], a[172:175], a[68:71], v[64:67]
    buffer_load_dwordx4 v1, s[48:51], s98 offen offset:1024 sc1 lds
    v_mfma_f32_16x16x32_bf16 v[68:71], a[176:179], a[0:3], 0
    v_exp_f32 v95, v95
    v_mfma_f32_16x16x32_bf16 v[68:71], a[180:183], a[4:7], v[68:71]
    ds_read_b128 a[248:251], v2 offset:22528
    v_cvt_pk_bf16_f32 v59, v94, v95
    v_mfma_f32_16x16x32_bf16 v[68:71], a[184:187], a[64:67], v[68:71]
    buffer_load_dwordx4 v1, s[48:51], s98 offen offset:2048 sc1 lds
    v_mfma_f32_16x16x32_bf16 v[68:71], a[188:191], a[68:71], v[68:71]
    v_mfma_f32_16x16x32_bf16 v[72:75], a[160:163], a[8:11], 0
    s_add_u32 s62, s62, 32768
    v_exp_f32 v64, v64
    v_mfma_f32_16x16x32_bf16 v[72:75], a[164:167], a[12:15], v[72:75]
    buffer_load_dwordx4 v1, s[48:51], s98 offen offset:3072 sc1 lds
    v_mfma_f32_16x16x32_bf16 v[72:75], a[168:171], a[72:75], v[72:75]
    s_cmp_eq_u32 s62, 98304
    v_exp_f32 v65, v65
    v_mfma_f32_16x16x32_bf16 v[72:75], a[172:175], a[76:79], v[72:75]
    ds_read_b128 a[252:255], v2 offset:23552
    v_cvt_pk_bf16_f32 v44, v64, v65
    v_mfma_f32_16x16x32_bf16 v[76:79], a[176:179], a[8:11], 0
    s_cselect_b32 s62, 0, s62
    v_exp_f32 v66, v66
    v_mfma_f32_16x16x32_bf16 v[76:79], a[180:183], a[12:15], v[76:79]
    v_add_u32 v2, s62, v3
    v_mfma_f32_16x16x32_bf16 v[76:79], a[184:187], a[72:75], v[76:79]
    s_add_u32 s79, s79, 16384
    v_exp_f32 v67, v67
    v_mfma_f32_16x16x32_bf16 v[76:79], a[188:191], a[76:79], v[76:79]
    v_cvt_pk_bf16_f32 v45, v66, v67
    v_mfma_f32_16x16x32_bf16 v[192:195], a[192:195], v[52:55], 0
    s_sub_u32 s93, s93, 1
    v_exp_f32 v68, v68
    v_mfma_f32_16x16x32_bf16 v[196:199], a[196:199], v[52:55], 0
    s_cselect_b32 s79, s94, s79
    v_mfma_f32_16x16x32_bf16 v[200:203], a[200:203], v[52:55], 0
    s_cselect_b32 s93, s75, s93
    v_exp_f32 v69, v69
    v_mfma_f32_16x16x32_bf16 v[204:207], a[204:207], v[52:55], 0
    v_cvt_pk_bf16_f32 v46, v68, v69
    v_mfma_f32_16x16x32_bf16 v[208:211], a[208:211], v[52:55], 0
    s_add_u32 s92, s92, 32768
    v_exp_f32 v70, v70
    v_mfma_f32_16x16x32_bf16 v[212:215], a[212:215], v[52:55], 0
    s_sub_u32 s99, s92, 98304
    v_mfma_f32_16x16x32_bf16 v[216:219], a[216:219], v[52:55], 0
    s_cmp_ge_i32 s99, 65536
    v_exp_f32 v71, v71
    v_mfma_f32_16x16x32_bf16 v[220:223], a[220:223], v[52:55], 0
    v_cvt_pk_bf16_f32 v47, v70, v71
    v_mfma_f32_16x16x32_bf16 v[36:39], v[4:7], v[52:55], 0
    s_cselect_b32 s92, s99, s92
    v_exp_f32 v72, v72
    v_mfma_f32_16x16x32_bf16 v[224:227], a[192:195], v[56:59], 0
    s_sub_u32 s63, s57, 1
    v_mfma_f32_16x16x32_bf16 v[228:231], a[196:199], v[56:59], 0
    v_exp_f32 v73, v73
    v_mfma_f32_16x16x32_bf16 v[232:235], a[200:203], v[56:59], 0
    v_cvt_pk_bf16_f32 v48, v72, v73
    v_mfma_f32_16x16x32_bf16 v[236:239], a[204:207], v[56:59], 0
    v_exp_f32 v74, v74
    v_mfma_f32_16x16x32_bf16 v[240:243], a[208:211], v[56:59], 0
    v_mfma_f32_16x16x32_bf16 v[244:247], a[212:215], v[56:59], 0
    v_exp_f32 v75, v75
    v_mfma_f32_16x16x32_bf16 v[248:251], a[216:219], v[56:59], 0
    v_cvt_pk_bf16_f32 v49, v74, v75
    v_mfma_f32_16x16x32_bf16 v[252:255], a[220:223], v[56:59], 0
    v_exp_f32 v76, v76
    v_mfma_f32_16x16x32_bf16 v[40:43], v[4:7], v[56:59], 0
    s_waitcnt vmcnt(8) lgkmcnt(0)
    s_barrier
    s_cmp_lg_u32 s54, 0
    s_cbranch_scc1 L_sig3
    s_lshl_b32 s67, s52, 7
    s_add_u32 s67, s67, 61673472
    s_lshl2_add_u32 s67, s53, s67
    v_min_u32 v62, 1, v0
    v_lshlrev_b32 v62, 30, v62
    v_mov_b32 v63, s12
    buffer_store_dword v63, v62, s[48:51], s67 offen sc1
L_sig3:
    s_cmp_eq_u32 s63, 0
    s_cbranch_scc1 L_t0_after
L_t0_loop:
    s_waitcnt vmcnt(8) lgkmcnt(0)
    s_barrier
    v_mfma_f32_16x16x32_bf16 v[80:83], a[160:163], a[16:19], 0
    v_exp_f32 v77, v77
    v_mfma_f32_16x16x32_bf16 v[80:83], a[164:167], a[20:23], v[80:83]
    ds_read_b128 a[128:131], v2 offset:0
    v_cvt_pk_bf16_f32 v50, v76, v77
    v_mfma_f32_16x16x32_bf16 v[80:83], a[168:171], a[80:83], v[80:83]
    v_exp_f32 v78, v78
    v_mfma_f32_16x16x32_bf16 v[80:83], a[172:175], a[84:87], v[80:83]
    ds_read_b128 a[132:135], v2 offset:1024
    v_mfma_f32_16x16x32_bf16 v[84:87], a[176:179], a[16:19], 0
    v_exp_f32 v79, v79
    v_mfma_f32_16x16x32_bf16 v[84:87], a[180:183], a[20:23], v[84:87]
    ds_read_b128 a[136:139], v2 offset:2048
    v_cvt_pk_bf16_f32 v51, v78, v79
    v_mfma_f32_16x16x32_bf16 v[84:87], a[184:187], a[80:83], v[84:87]
    ds_read_b128 a[140:143], v2 offset:3072
    v_mfma_f32_16x16x32_bf16 v[84:87], a[188:191], a[84:87], v[84:87]
    ds_read_b128 a[144:147], v2 offset:4096
    v_mfma_f32_16x16x32_bf16 v[88:91], a[160:163], a[24:27], 0
    v_exp_f32 v80, v80
    v_mfma_f32_16x16x32_bf16 v[88:91], a[164:167], a[28:31], v[88:91]
    ds_read_b128 a[148:151], v2 offset:5120
    v_mfma_f32_16x16x32_bf16 v[88:91], a[168:171], a[88:91], v[88:91]
    v_exp_f32 v81, v81
    v_mfma_f32_16x16x32_bf16 v[88:91], a[172:175], a[92:95], v[88:91]
    ds_read_b128 a[152:155], v2 offset:6144
    v_cvt_pk_bf16_f32 v52, v80, v81
    v_mfma_f32_16x16x32_bf16 v[92:95], a[176:179], a[24:27], 0
    v_exp_f32 v82, v82
    v_mfma_f32_16x16x32_bf16 v[92:95], a[180:183], a[28:31], v[92:95]
    ds_read_b128 a[156:159], v2 offset:7168
    v_mfma_f32_16x16x32_bf16 v[92:95], a[184:187], a[88:91], v[92:95]
    s_mov_b32 m0, s92
    v_exp_f32 v83, v83
    v_mfma_f32_16x16x32_bf16 v[92:95], a[188:191], a[92:95], v[92:95]
    ds_read_b128 a[192:195], v2 offset:16384
    v_cvt_pk_bf16_f32 v53, v82, v83
    v_mfma_f32_16x16x32_bf16 v[128:131], a[224:227], v[44:47], v[128:131]
    s_add_u32 s98, s79, 16777216
    v_exp_f32 v84, v84
    v_mfma_f32_16x16x32_bf16 v[132:135], a[228:231], v[44:47], v[132:135]
    buffer_load_dwordx4 v1, s[48:51], s79 offen offset:0 sc1 lds
    v_mfma_f32_16x16x32_bf16 v[136:139], a[232:235], v[44:47], v[136:139]
    v_exp_f32 v85, v85
    v_mfma_f32_16x16x32_bf16 v[140:143], a[236:239], v[44:47], v[140:143]
    ds_read_b128 a[196:199], v2 offset:17408
    v_cvt_pk_bf16_f32 v54, v84, v85
    v_mfma_f32_16x16x32_bf16 v[144:147], a[240:243], v[44:47], v[144:147]
    v_exp_f32 v86, v86
    v_mfma_f32_16x16x32_bf16 v[148:151], a[244:247], v[44:47], v[148:151]
    buffer_load_dwordx4 v1, s[48:51], s79 offen offset:1024 sc1 lds
    v_mfma_f32_16x16x32_bf16 v[152:155], a[248:251], v[44:47], v[152:155]
    v_exp_f32 v87, v87
    v_mfma_f32_16x16x32_bf16 v[156:159], a[252:255], v[44:47], v[156:159]
    ds_read_b128 a[200:203], v2 offset:18432
    v_cvt_pk_bf16_f32 v55, v86, v87
    v_mfma_f32_16x16x32_bf16 v[28:31], v[4:7], v[44:47], v[28:31]
    v_exp_f32 v88, v88
    v_mfma_f32_16x16x32_bf16 v[160:163], a[224:227], v[48:51], v[160:163]
    buffer_load_dwordx4 v1, s[48:51], s79 offen offset:2048 sc1 lds
    v_mfma_f32_16x16x32_bf16 v[164:167], a[228:231], v[48:51], v[164:167]
    v_exp_f32 v89, v89
    v_mfma_f32_16x16x32_bf16 v[168:171], a[232:235], v[48:51], v[168:171]
    ds_read_b128 a[204:207], v2 offset:19456
    v_cvt_pk_bf16_f32 v56, v88, v89
    v_mfma_f32_16x16x32_bf16 v[172:175], a[236:239], v[48:51], v[172:175]
    v_exp_f32 v90, v90
    v_mfma_f32_16x16x32_bf16 v[176:179], a[240:243], v[48:51], v[176:179]
    buffer_load_dwordx4 v1, s[48:51], s79 offen offset:3072 sc1 lds
    v_mfma_f32_16x16x32_bf16 v[180:183], a[244:247], v[48:51], v[180:183]
    s_add_u32 m0, s92, 16384
    v_exp_f32 v91, v91
    v_mfma_f32_16x16x32_bf16 v[184:187], a[248:251], v[48:51], v[184:187]
    ds_read_b128 a[208:211], v2 offset:20480
    v_cvt_pk_bf16_f32 v57, v90, v91
    v_mfma_f32_16x16x32_bf16 v[188:191], a[252:255], v[48:51], v[188:191]
    v_exp_f32 v92, v92
    v_mfma_f32_16x16x32_bf16 v[32:35], v[4:7], v[48:51], v[32:35]
    buffer_load_dwordx4 v1, s[48:51], s98 offen offset:0 sc1 lds
    s_waitcnt lgkmcnt(5)
    v_mfma_f32_16x16x32_bf16 v[64:67], a[128:131], a[0:3], 0
    v_exp_f32 v93, v93
    v_mfma_f32_16x16x32_bf16 v[64:67], a[132:135], a[4:7], v[64:67]
    ds_read_b128 a[212:215], v2 offset:21504
    v_cvt_pk_bf16_f32 v58, v92, v93
    v_mfma_f32_16x16x32_bf16 v[64:67], a[136:139], a[64:67], v[64:67]
    v_exp_f32 v94, v94
    v_mfma_f32_16x16x32_bf16 v[64:67], a[140:143], a[68:71], v[64:67]
    buffer_load_dwordx4 v1, s[48:51], s98 offen offset:1024 sc1 lds
    v_mfma_f32_16x16x32_bf16 v[68:71], a[144:147], a[0:3], 0
    v_exp_f32 v95, v95
    v_mfma_f32_16x16x32_bf16 v[68:71], a[148:151], a[4:7], v[68:71]
    ds_read_b128 a[216:219], v2 offset:22528
    v_cvt_pk_bf16_f32 v59, v94, v95
    v_mfma_f32_16x16x32_bf16 v[68:71], a[152:155], a[64:67], v[68:71]
    buffer_load_dwordx4 v1, s[48:51], s98 offen offset:2048 sc1 lds
    v_mfma_f32_16x16x32_bf16 v[68:71], a[156:159], a[68:71], v[68:71]
    v_mfma_f32_16x16x32_bf16 v[72:75], a[128:131], a[8:11], 0
    s_add_u32 s62, s62, 32768
    v_exp_f32 v64, v64
    v_mfma_f32_16x16x32_bf16 v[72:75], a[132:135], a[12:15], v[72:75]
    buffer_load_dwordx4 v1, s[48:51], s98 offen offset:3072 sc1 lds
    v_mfma_f32_16x16x32_bf16 v[72:75], a[136:139], a[72:75], v[72:75]
    s_cmp_eq_u32 s62, 98304
    v_exp_f32 v65, v65
    v_mfma_f32_16x16x32_bf16 v[72:75], a[140:143], a[76:79], v[72:75]
    ds_read_b128 a[220:223], v2 offset:23552
    v_cvt_pk_bf16_f32 v44, v64, v65
    v_mfma_f32_16x16x32_bf16 v[76:79], a[144:147], a[8:11], 0
    s_cselect_b32 s62, 0, s62
    v_exp_f32 v66, v66
    v_mfma_f32_16x16x32_bf16 v[76:79], a[148:151], a[12:15], v[76:79]
    v_add_u32 v2, s62, v3
    v_mfma_f32_16x16x32_bf16 v[76:79], a[152:155], a[72:75], v[76:79]
    s_add_u32 s79, s79, 16384
    v_exp_f32 v67, v67
    v_mfma_f32_16x16x32_bf16 v[76:79], a[156:159], a[76:79], v[76:79]
    v_cvt_pk_bf16_f32 v45, v66, v67
    v_mfma_f32_16x16x32_bf16 v[192:195], a[224:227], v[52:55], v[192:195]
    s_sub_u32 s93, s93, 1
    v_exp_f32 v68, v68
    v_mfma_f32_16x16x32_bf16 v[196:199], a[228:231], v[52:55], v[196:199]
    s_cselect_b32 s79, s94, s79
    v_mfma_f32_16x16x32_bf16 v[200:203], a[232:235], v[52:55], v[200:203]
    s_cselect_b32 s93, s75, s93
    v_exp_f32 v69, v69
    v_mfma_f32_16x16x32_bf16 v[204:207], a[236:239], v[52:55], v[204:207]
    v_cvt_pk_bf16_f32 v46, v68, v69
    v_mfma_f32_16x16x32_bf16 v[208:211], a[240:243], v[52:55], v[208:211]
    s_add_u32 s92, s92, 32768
    v_exp_f32 v70, v70
    v_mfma_f32_16x16x32_bf16 v[212:215], a[244:247], v[52:55], v[212:215]
    s_sub_u32 s99, s92, 98304
    v_mfma_f32_16x16x32_bf16 v[216:219], a[248:251], v[52:55], v[216:219]
    s_cmp_ge_i32 s99, 65536
    v_exp_f32 v71, v71
    v_mfma_f32_16x16x32_bf16 v[220:223], a[252:255], v[52:55], v[220:223]
    v_cvt_pk_bf16_f32 v47, v70, v71
    v_mfma_f32_16x16x32_bf16 v[36:39], v[4:7], v[52:55], v[36:39]
    s_cselect_b32 s92, s99, s92
    v_exp_f32 v72, v72
    v_mfma_f32_16x16x32_bf16 v[224:227], a[224:227], v[56:59], v[224:227]
    v_mfma_f32_16x16x32_bf16 v[228:231], a[228:231], v[56:59], v[228:231]
    v_exp_f32 v73, v73
    v_mfma_f32_16x16x32_bf16 v[232:235], a[232:235], v[56:59], v[232:235]
    v_cvt_pk_bf16_f32 v48, v72, v73
    v_mfma_f32_16x16x32_bf16 v[236:239], a[236:239], v[56:59], v[236:239]
    v_exp_f32 v74, v74
    v_mfma_f32_16x16x32_bf16 v[240:243], a[240:243], v[56:59], v[240:243]
    v_mfma_f32_16x16x32_bf16 v[244:247], a[244:247], v[56:59], v[244:247]
    v_exp_f32 v75, v75
    v_mfma_f32_16x16x32_bf16 v[248:251], a[248:251], v[56:59], v[248:251]
    v_cvt_pk_bf16_f32 v49, v74, v75
    v_mfma_f32_16x16x32_bf16 v[252:255], a[252:255], v[56:59], v[252:255]
    v_exp_f32 v76, v76
    v_mfma_f32_16x16x32_bf16 v[40:43], v[4:7], v[56:59], v[40:43]
    s_waitcnt vmcnt(8) lgkmcnt(0)
    s_barrier
    v_mfma_f32_16x16x32_bf16 v[80:83], a[128:131], a[16:19], 0
    v_exp_f32 v77, v77
    v_mfma_f32_16x16x32_bf16 v[80:83], a[132:135], a[20:23], v[80:83]
    ds_read_b128 a[160:163], v2 offset:0
    v_cvt_pk_bf16_f32 v50, v76, v77
    v_mfma_f32_16x16x32_bf16 v[80:83], a[136:139], a[80:83], v[80:83]
    v_exp_f32 v78, v78
    v_mfma_f32_16x16x32_bf16 v[80:83], a[140:143], a[84:87], v[80:83]
    ds_read_b128 a[164:167], v2 offset:1024
    v_mfma_f32_16x16x32_bf16 v[84:87], a[144:147], a[16:19], 0
    v_exp_f32 v79, v79
    v_mfma_f32_16x16x32_bf16 v[84:87], a[148:151], a[20:23], v[84:87]
    ds_read_b128 a[168:171], v2 offset:2048
    v_cvt_pk_bf16_f32 v51, v78, v79
    v_mfma_f32_16x16x32_bf16 v[84:87], a[152:155], a[80:83], v[84:87]
    ds_read_b128 a[172:175], v2 offset:3072
    v_mfma_f32_16x16x32_bf16 v[84:87], a[156:159], a[84:87], v[84:87]
    ds_read_b128 a[176:179], v2 offset:4096
    v_mfma_f32_16x16x32_bf16 v[88:91], a[128:131], a[24:27], 0
    v_exp_f32 v80, v80
    v_mfma_f32_16x16x32_bf16 v[88:91], a[132:135], a[28:31], v[88:91]
    ds_read_b128 a[180:183], v2 offset:5120
    v_mfma_f32_16x16x32_bf16 v[88:91], a[136:139], a[88:91], v[88:91]
    v_exp_f32 v81, v81
    v_mfma_f32_16x16x32_bf16 v[88:91], a[140:143], a[92:95], v[88:91]
    ds_read_b128 a[184:187], v2 offset:6144
    v_cvt_pk_bf16_f32 v52, v80, v81
    v_mfma_f32_16x16x32_bf16 v[92:95], a[144:147], a[24:27], 0
    v_exp_f32 v82, v82
    v_mfma_f32_16x16x32_bf16 v[92:95], a[148:151], a[28:31], v[92:95]
    ds_read_b128 a[188:191], v2 offset:7168
    v_mfma_f32_16x16x32_bf16 v[92:95], a[152:155], a[88:91], v[92:95]
    s_mov_b32 m0, s92
    v_exp_f32 v83, v83
    v_mfma_f32_16x16x32_bf16 v[92:95], a[156:159], a[92:95], v[92:95]
    ds_read_b128 a[224:227], v2 offset:16384
    v_cvt_pk_bf16_f32 v53, v82, v83
    v_mfma_f32_16x16x32_bf16 v[128:131], a[192:195], v[44:47], v[128:131]
    s_add_u32 s98, s79, 16777216
    v_exp_f32 v84, v84
    v_mfma_f32_16x16x32_bf16 v[132:135], a[196:199], v[44:47], v[132:135]
    buffer_load_dwordx4 v1, s[48:51], s79 offen offset:0 sc1 lds
    v_mfma_f32_16x16x32_bf16 v[136:139], a[200:203], v[44:47], v[136:139]
    v_exp_f32 v85, v85
    v_mfma_f32_16x16x32_bf16 v[140:143], a[204:207], v[44:47], v[140:143]
    ds_read_b128 a[228:231], v2 offset:17408
    v_cvt_pk_bf16_f32 v54, v84, v85
    v_mfma_f32_16x16x32_bf16 v[144:147], a[208:211], v[44:47], v[144:147]
    v_exp_f32 v86, v86
    v_mfma_f32_16x16x32_bf16 v[148:151], a[212:215], v[44:47], v[148:151]
    buffer_load_dwordx4 v1, s[48:51], s79 offen offset:1024 sc1 lds
    v_mfma_f32_16x16x32_bf16 v[152:155], a[216:219], v[44:47], v[152:155]
    v_exp_f32 v87, v87
    v_mfma_f32_16x16x32_bf16 v[156:159], a[220:223], v[44:47], v[156:159]
    ds_read_b128 a[232:235], v2 offset:18432
    v_cvt_pk_bf16_f32 v55, v86, v87
    v_mfma_f32_16x16x32_bf16 v[28:31], v[4:7], v[44:47], v[28:31]
    v_exp_f32 v88, v88
    v_mfma_f32_16x16x32_bf16 v[160:163], a[192:195], v[48:51], v[160:163]
    buffer_load_dwordx4 v1, s[48:51], s79 offen offset:2048 sc1 lds
    v_mfma_f32_16x16x32_bf16 v[164:167], a[196:199], v[48:51], v[164:167]
    v_exp_f32 v89, v89
    v_mfma_f32_16x16x32_bf16 v[168:171], a[200:203], v[48:51], v[168:171]
    ds_read_b128 a[236:239], v2 offset:19456
    v_cvt_pk_bf16_f32 v56, v88, v89
    v_mfma_f32_16x16x32_bf16 v[172:175], a[204:207], v[48:51], v[172:175]
    v_exp_f32 v90, v90
    v_mfma_f32_16x16x32_bf16 v[176:179], a[208:211], v[48:51], v[176:179]
    buffer_load_dwordx4 v1, s[48:51], s79 offen offset:3072 sc1 lds
    v_mfma_f32_16x16x32_bf16 v[180:183], a[212:215], v[48:51], v[180:183]
    s_add_u32 m0, s92, 16384
    v_exp_f32 v91, v91
    v_mfma_f32_16x16x32_bf16 v[184:187], a[216:219], v[48:51], v[184:187]
    ds_read_b128 a[240:243], v2 offset:20480
    v_cvt_pk_bf16_f32 v57, v90, v91
    v_mfma_f32_16x16x32_bf16 v[188:191], a[220:223], v[48:51], v[188:191]
    v_exp_f32 v92, v92
    v_mfma_f32_16x16x32_bf16 v[32:35], v[4:7], v[48:51], v[32:35]
    buffer_load_dwordx4 v1, s[48:51], s98 offen offset:0 sc1 lds
    s_waitcnt lgkmcnt(5)
    v_mfma_f32_16x16x32_bf16 v[64:67], a[160:163], a[0:3], 0
    v_exp_f32 v93, v93
    v_mfma_f32_16x16x32_bf16 v[64:67], a[164:167], a[4:7], v[64:67]
    ds_read_b128 a[244:247], v2 offset:21504
    v_cvt_pk_bf16_f32 v58, v92, v93
    v_mfma_f32_16x16x32_bf16 v[64:67], a[168:171], a[64:67], v[64:67]
    v_exp_f32 v94, v94
    v_mfma_f32_16x16x32_bf16 v[64:67], a[172:175], a[68:71], v[64:67]
    buffer_load_dwordx4 v1, s[48:51], s98 offen offset:1024 sc1 lds
    v_mfma_f32_16x16x32_bf16 v[68:71], a[176:179], a[0:3], 0
    v_exp_f32 v95, v95
    v_mfma_f32_16x16x32_bf16 v[68:71], a[180:183], a[4:7], v[68:71]
    ds_read_b128 a[248:251], v2 offset:22528
    v_cvt_pk_bf16_f32 v59, v94, v95
    v_mfma_f32_16x16x32_bf16 v[68:71], a[184:187], a[64:67], v[68:71]
    buffer_load_dwordx4 v1, s[48:51], s98 offen offset:2048 sc1 lds
    v_mfma_f32_16x16x32_bf16 v[68:71], a[188:191], a[68:71], v[68:71]
    v_mfma_f32_16x16x32_bf16 v[72:75], a[160:163], a[8:11], 0
    s_add_u32 s62, s62, 32768
    v_exp_f32 v64, v64
    v_mfma_f32_16x16x32_bf16 v[72:75], a[164:167], a[12:15], v[72:75]
    buffer_load_dwordx4 v1, s[48:51], s98 offen offset:3072 sc1 lds
    v_mfma_f32_16x16x32_bf16 v[72:75], a[168:171], a[72:75], v[72:75]
    s_cmp_eq_u32 s62, 98304
    v_exp_f32 v65, v65
    v_mfma_f32_16x16x32_bf16 v[72:75], a[172:175], a[76:79], v[72:75]
    ds_read_b128 a[252:255], v2 offset:23552
    v_cvt_pk_bf16_f32 v44, v64, v65
    v_mfma_f32_16x16x32_bf16 v[76:79], a[176:179], a[8:11], 0
    s_cselect_b32 s62, 0, s62
    v_exp_f32 v66, v66
    v_mfma_f32_16x16x32_bf16 v[76:79], a[180:183], a[12:15], v[76:79]
    v_add_u32 v2, s62, v3
    v_mfma_f32_16x16x32_bf16 v[76:79], a[184:187], a[72:75], v[76:79]
    s_add_u32 s79, s79, 16384
    v_exp_f32 v67, v67
    v_mfma_f32_16x16x32_bf16 v[76:79], a[188:191], a[76:79], v[76:79]
    v_cvt_pk_bf16_f32 v45, v66, v67
    v_mfma_f32_16x16x32_bf16 v[192:195], a[192:195], v[52:55], v[192:195]
    s_sub_u32 s93, s93, 1
    v_exp_f32 v68, v68
    v_mfma_f32_16x16x32_bf16 v[196:199], a[196:199], v[52:55], v[196:199]
    s_cselect_b32 s79, s94, s79
    v_mfma_f32_16x16x32_bf16 v[200:203], a[200:203], v[52:55], v[200:203]
    s_cselect_b32 s93, s75, s93
    v_exp_f32 v69, v69
    v_mfma_f32_16x16x32_bf16 v[204:207], a[204:207], v[52:55], v[204:207]
    v_cvt_pk_bf16_f32 v46, v68, v69
    v_mfma_f32_16x16x32_bf16 v[208:211], a[208:211], v[52:55], v[208:211]
    s_add_u32 s92, s92, 32768
    v_exp_f32 v70, v70
    v_mfma_f32_16x16x32_bf16 v[212:215], a[212:215], v[52:55], v[212:215]
    s_sub_u32 s99, s92, 98304
    v_mfma_f32_16x16x32_bf16 v[216:219], a[216:219], v[52:55], v[216:219]
    s_cmp_ge_i32 s99, 65536
    v_exp_f32 v71, v71
    v_mfma_f32_16x16x32_bf16 v[220:223], a[220:223], v[52:55], v[220:223]
    v_cvt_pk_bf16_f32 v47, v70, v71
    v_mfma_f32_16x16x32_bf16 v[36:39], v[4:7], v[52:55], v[36:39]
    s_cselect_b32 s92, s99, s92
    v_exp_f32 v72, v72
    v_mfma_f32_16x16x32_bf16 v[224:227], a[192:195], v[56:59], v[224:227]
    s_sub_u32 s63, s63, 1
    v_mfma_f32_16x16x32_bf16 v[228:231], a[196:199], v[56:59], v[228:231]
    s_cmp_lg_u32 s63, 0
    v_exp_f32 v73, v73
    v_mfma_f32_16x16x32_bf16 v[232:235], a[200:203], v[56:59], v[232:235]
    v_cvt_pk_bf16_f32 v48, v72, v73
    v_mfma_f32_16x16x32_bf16 v[236:239], a[204:207], v[56:59], v[236:239]
    v_exp_f32 v74, v74
    v_mfma_f32_16x16x32_bf16 v[240:243], a[208:211], v[56:59], v[240:243]
    v_mfma_f32_16x16x32_bf16 v[244:247], a[212:215], v[56:59], v[244:247]
    v_exp_f32 v75, v75
    v_mfma_f32_16x16x32_bf16 v[248:251], a[216:219], v[56:59], v[248:251]
    v_cvt_pk_bf16_f32 v49, v74, v75
    v_mfma_f32_16x16x32_bf16 v[252:255], a[220:223], v[56:59], v[252:255]
    v_exp_f32 v76, v76
    v_mfma_f32_16x16x32_bf16 v[40:43], v[4:7], v[56:59], v[40:43]
    s_cbranch_scc1 L_t0_loop
L_t0_after:
    s_waitcnt vmcnt(8) lgkmcnt(0)
    s_barrier
    v_mfma_f32_16x16x32_bf16 v[80:83], a[160:163], a[16:19], 0
    v_exp_f32 v77, v77
    v_mfma_f32_16x16x32_bf16 v[80:83], a[164:167], a[20:23], v[80:83]
    ds_read_b128 a[128:131], v2 offset:0
    v_cvt_pk_bf16_f32 v50, v76, v77
    v_mfma_f32_16x16x32_bf16 v[80:83], a[168:171], a[80:83], v[80:83]
    v_exp_f32 v78, v78
    v_mfma_f32_16x16x32_bf16 v[80:83], a[172:175], a[84:87], v[80:83]
    ds_read_b128 a[132:135], v2 offset:1024
    v_mfma_f32_16x16x32_bf16 v[84:87], a[176:179], a[16:19], 0
    v_exp_f32 v79, v79
    v_mfma_f32_16x16x32_bf16 v[84:87], a[180:183], a[20:23], v[84:87]
    ds_read_b128 a[136:139], v2 offset:2048
    v_cvt_pk_bf16_f32 v51, v78, v79
    v_mfma_f32_16x16x32_bf16 v[84:87], a[184:187], a[80:83], v[84:87]
    ds_read_b128 a[140:143], v2 offset:3072
    v_mfma_f32_16x16x32_bf16 v[84:87], a[188:191], a[84:87], v[84:87]
    ds_read_b128 a[144:147], v2 offset:4096
    v_mfma_f32_16x16x32_bf16 v[88:91], a[160:163], a[24:27], 0
    v_exp_f32 v80, v80
    v_mfma_f32_16x16x32_bf16 v[88:91], a[164:167], a[28:31], v[88:91]
    ds_read_b128 a[148:151], v2 offset:5120
    v_mfma_f32_16x16x32_bf16 v[88:91], a[168:171], a[88:91], v[88:91]
    v_exp_f32 v81, v81
    v_mfma_f32_16x16x32_bf16 v[88:91], a[172:175], a[92:95], v[88:91]
    ds_read_b128 a[152:155], v2 offset:6144
    v_cvt_pk_bf16_f32 v52, v80, v81
    v_mfma_f32_16x16x32_bf16 v[92:95], a[176:179], a[24:27], 0
    v_exp_f32 v82, v82
    v_mfma_f32_16x16x32_bf16 v[92:95], a[180:183], a[28:31], v[92:95]
    ds_read_b128 a[156:159], v2 offset:7168
    v_mfma_f32_16x16x32_bf16 v[92:95], a[184:187], a[88:91], v[92:95]
    s_mov_b32 m0, s92
    v_exp_f32 v83, v83
    v_mfma_f32_16x16x32_bf16 v[92:95], a[188:191], a[92:95], v[92:95]
    ds_read_b128 a[192:195], v2 offset:16384
    v_cvt_pk_bf16_f32 v53, v82, v83
    v_mfma_f32_16x16x32_bf16 v[128:131], a[224:227], v[44:47], v[128:131]
    s_add_u32 s98, s79, 16777216
    v_exp_f32 v84, v84
    v_mfma_f32_16x16x32_bf16 v[132:135], a[228:231], v[44:47], v[132:135]
    buffer_load_dwordx4 v1, s[48:51], s79 offen offset:0 sc1 lds
    v_mfma_f32_16x16x32_bf16 v[136:139], a[232:235], v[44:47], v[136:139]
    v_exp_f32 v85, v85
    v_mfma_f32_16x16x32_bf16 v[140:143], a[236:239], v[44:47], v[140:143]
    ds_read_b128 a[196:199], v2 offset:17408
    v_cvt_pk_bf16_f32 v54, v84, v85
    v_mfma_f32_16x16x32_bf16 v[144:147], a[240:243], v[44:47], v[144:147]
    v_exp_f32 v86, v86
    v_mfma_f32_16x16x32_bf16 v[148:151], a[244:247], v[44:47], v[148:151]
    buffer_load_dwordx4 v1, s[48:51], s79 offen offset:1024 sc1 lds
    v_mfma_f32_16x16x32_bf16 v[152:155], a[248:251], v[44:47], v[152:155]
    v_exp_f32 v87, v87
    v_mfma_f32_16x16x32_bf16 v[156:159], a[252:255], v[44:47], v[156:159]
    ds_read_b128 a[200:203], v2 offset:18432
    v_cvt_pk_bf16_f32 v55, v86, v87
    v_mfma_f32_16x16x32_bf16 v[28:31], v[4:7], v[44:47], v[28:31]
    v_exp_f32 v88, v88
    v_mfma_f32_16x16x32_bf16 v[160:163], a[224:227], v[48:51], v[160:163]
    buffer_load_dwordx4 v1, s[48:51], s79 offen offset:2048 sc1 lds
    v_mfma_f32_16x16x32_bf16 v[164:167], a[228:231], v[48:51], v[164:167]
    v_exp_f32 v89, v89
    v_mfma_f32_16x16x32_bf16 v[168:171], a[232:235], v[48:51], v[168:171]
    ds_read_b128 a[204:207], v2 offset:19456
    v_cvt_pk_bf16_f32 v56, v88, v89
    v_mfma_f32_16x16x32_bf16 v[172:175], a[236:239], v[48:51], v[172:175]
    v_exp_f32 v90, v90
    v_mfma_f32_16x16x32_bf16 v[176:179], a[240:243], v[48:51], v[176:179]
    buffer_load_dwordx4 v1, s[48:51], s79 offen offset:3072 sc1 lds
    v_mfma_f32_16x16x32_bf16 v[180:183], a[244:247], v[48:51], v[180:183]
    s_add_u32 m0, s92, 16384
    v_exp_f32 v91, v91
    v_mfma_f32_16x16x32_bf16 v[184:187], a[248:251], v[48:51], v[184:187]
    ds_read_b128 a[208:211], v2 offset:20480
    v_cvt_pk_bf16_f32 v57, v90, v91
    v_mfma_f32_16x16x32_bf16 v[188:191], a[252:255], v[48:51], v[188:191]
    v_exp_f32 v92, v92
    v_mfma_f32_16x16x32_bf16 v[32:35], v[4:7], v[48:51], v[32:35]
    buffer_load_dwordx4 v1, s[48:51], s98 offen offset:0 sc1 lds
    s_waitcnt lgkmcnt(5)
    v_mfma_f32_16x16x32_bf16 v[64:67], a[128:131], a[0:3], v[96:99]
    v_exp_f32 v93, v93
    v_mfma_f32_16x16x32_bf16 v[64:67], a[132:135], a[4:7], v[64:67]
    ds_read_b128 a[212:215], v2 offset:21504
    v_cvt_pk_bf16_f32 v58, v92, v93
    v_mfma_f32_16x16x32_bf16 v[64:67], a[136:139], a[64:67], v[64:67]
    v_exp_f32 v94, v94
    v_mfma_f32_16x16x32_bf16 v[64:67], a[140:143], a[68:71], v[64:67]
    buffer_load_dwordx4 v1, s[48:51], s98 offen offset:1024 sc1 lds
    v_mfma_f32_16x16x32_bf16 v[68:71], a[144:147], a[0:3], v[100:103]
    v_exp_f32 v95, v95
    v_mfma_f32_16x16x32_bf16 v[68:71], a[148:151], a[4:7], v[68:71]
    ds_read_b128 a[216:219], v2 offset:22528
    v_cvt_pk_bf16_f32 v59, v94, v95
    v_mfma_f32_16x16x32_bf16 v[68:71], a[152:155], a[64:67], v[68:71]
    buffer_load_dwordx4 v1, s[48:51], s98 offen offset:2048 sc1 lds
    v_mfma_f32_16x16x32_bf16 v[68:71], a[156:159], a[68:71], v[68:71]
    v_mfma_f32_16x16x32_bf16 v[72:75], a[128:131], a[8:11], v[104:107]
    s_add_u32 s62, s62, 32768
    v_exp_f32 v64, v64
    v_mfma_f32_16x16x32_bf16 v[72:75], a[132:135], a[12:15], v[72:75]
    buffer_load_dwordx4 v1, s[48:51], s98 offen offset:3072 sc1 lds
    v_mfma_f32_16x16x32_bf16 v[72:75], a[136:139], a[72:75], v[72:75]
    s_cmp_eq_u32 s62, 98304
    v_exp_f32 v65, v65
    v_mfma_f32_16x16x32_bf16 v[72:75], a[140:143], a[76:79], v[72:75]
    ds_read_b128 a[220:223], v2 offset:23552
    v_cvt_pk_bf16_f32 v44, v64, v65
    v_mfma_f32_16x16x32_bf16 v[76:79], a[144:147], a[8:11], v[108:111]
    s_cselect_b32 s62, 0, s62
    v_exp_f32 v66, v66
    v_mfma_f32_16x16x32_bf16 v[76:79], a[148:151], a[12:15], v[76:79]
    v_add_u32 v2, s62, v3
    v_mfma_f32_16x16x32_bf16 v[76:79], a[152:155], a[72:75], v[76:79]
    s_add_u32 s79, s79, 16384
    v_exp_f32 v67, v67
    v_mfma_f32_16x16x32_bf16 v[76:79], a[156:159], a[76:79], v[76:79]
    v_cvt_pk_bf16_f32 v45, v66, v67
    v_mfma_f32_16x16x32_bf16 v[192:195], a[224:227], v[52:55], v[192:195]
    s_sub_u32 s93, s93, 1
    v_exp_f32 v68, v68
    v_mfma_f32_16x16x32_bf16 v[196:199], a[228:231], v[52:55], v[196:199]
    s_cselect_b32 s79, s94, s79
    v_mfma_f32_16x16x32_bf16 v[200:203], a[232:235], v[52:55], v[200:203]
    s_cselect_b32 s93, s75, s93
    v_exp_f32 v69, v69
    v_mfma_f32_16x16x32_bf16 v[204:207], a[236:239], v[52:55], v[204:207]
    v_cvt_pk_bf16_f32 v46, v68, v69
    v_mfma_f32_16x16x32_bf16 v[208:211], a[240:243], v[52:55], v[208:211]
    s_add_u32 s92, s92, 32768
    v_exp_f32 v70, v70
    v_mfma_f32_16x16x32_bf16 v[212:215], a[244:247], v[52:55], v[212:215]
    s_sub_u32 s99, s92, 98304
    v_mfma_f32_16x16x32_bf16 v[216:219], a[248:251], v[52:55], v[216:219]
    s_cmp_ge_i32 s99, 65536
    v_exp_f32 v71, v71
    v_mfma_f32_16x16x32_bf16 v[220:223], a[252:255], v[52:55], v[220:223]
    v_cvt_pk_bf16_f32 v47, v70, v71
    v_mfma_f32_16x16x32_bf16 v[36:39], v[4:7], v[52:55], v[36:39]
    s_cselect_b32 s92, s99, s92
    v_exp_f32 v72, v72
    v_mfma_f32_16x16x32_bf16 v[224:227], a[224:227], v[56:59], v[224:227]
    v_mfma_f32_16x16x32_bf16 v[228:231], a[228:231], v[56:59], v[228:231]
    v_exp_f32 v73, v73
    v_mfma_f32_16x16x32_bf16 v[232:235], a[232:235], v[56:59], v[232:235]
    v_cvt_pk_bf16_f32 v48, v72, v73
    v_mfma_f32_16x16x32_bf16 v[236:239], a[236:239], v[56:59], v[236:239]
    v_exp_f32 v74, v74
    v_mfma_f32_16x16x32_bf16 v[240:243], a[240:243], v[56:59], v[240:243]
    v_mfma_f32_16x16x32_bf16 v[244:247], a[244:247], v[56:59], v[244:247]
    v_exp_f32 v75, v75
    v_mfma_f32_16x16x32_bf16 v[248:251], a[248:251], v[56:59], v[248:251]
    v_cvt_pk_bf16_f32 v49, v74, v75
    v_mfma_f32_16x16x32_bf16 v[252:255], a[252:255], v[56:59], v[252:255]
    v_exp_f32 v76, v76
    v_mfma_f32_16x16x32_bf16 v[40:43], v[4:7], v[56:59], v[40:43]
    s_waitcnt vmcnt(8) lgkmcnt(0)
    s_barrier
    v_mfma_f32_16x16x32_bf16 v[80:83], a[128:131], a[16:19], 0
    v_exp_f32 v77, v77
    v_mfma_f32_16x16x32_bf16 v[80:83], a[132:135], a[20:23], v[80:83]
    ds_read_b128 a[160:163], v2 offset:0
    v_cvt_pk_bf16_f32 v50, v76, v77
    v_mfma_f32_16x16x32_bf16 v[80:83], a[136:139], a[80:83], v[80:83]
    v_exp_f32 v78, v78
    v_mfma_f32_16x16x32_bf16 v[80:83], a[140:143], a[84:87], v[80:83]
    ds_read_b128 a[164:167], v2 offset:1024
    v_mfma_f32_16x16x32_bf16 v[84:87], a[144:147], a[16:19], 0
    v_exp_f32 v79, v79
    v_mfma_f32_16x16x32_bf16 v[84:87], a[148:151], a[20:23], v[84:87]
    ds_read_b128 a[168:171], v2 offset:2048
    v_cvt_pk_bf16_f32 v51, v78, v79
    v_mfma_f32_16x16x32_bf16 v[84:87], a[152:155], a[80:83], v[84:87]
    ds_read_b128 a[172:175], v2 offset:3072
    v_mfma_f32_16x16x32_bf16 v[84:87], a[156:159], a[84:87], v[84:87]
    ds_read_b128 a[176:179], v2 offset:4096
    v_mfma_f32_16x16x32_bf16 v[88:91], a[128:131], a[24:27], 0
    v_exp_f32 v80, v80
    v_mfma_f32_16x16x32_bf16 v[88:91], a[132:135], a[28:31], v[88:91]
    ds_read_b128 a[180:183], v2 offset:5120
    v_mfma_f32_16x16x32_bf16 v[88:91], a[136:139], a[88:91], v[88:91]
    v_exp_f32 v81, v81
    v_mfma_f32_16x16x32_bf16 v[88:91], a[140:143], a[92:95], v[88:91]
    ds_read_b128 a[184:187], v2 offset:6144
    v_cvt_pk_bf16_f32 v52, v80, v81
    v_mfma_f32_16x16x32_bf16 v[92:95], a[144:147], a[24:27], 0
    v_exp_f32 v82, v82
    v_mfma_f32_16x16x32_bf16 v[92:95], a[148:151], a[28:31], v[92:95]
    ds_read_b128 a[188:191], v2 offset:7168
    v_mfma_f32_16x16x32_bf16 v[92:95], a[152:155], a[88:91], v[92:95]
    s_mov_b32 m0, s92
    v_exp_f32 v83, v83
    v_mfma_f32_16x16x32_bf16 v[92:95], a[156:159], a[92:95], v[92:95]
    ds_read_b128 a[224:227], v2 offset:16384
    v_cvt_pk_bf16_f32 v53, v82, v83
    v_mfma_f32_16x16x32_bf16 v[128:131], a[192:195], v[44:47], v[128:131]
    s_add_u32 s98, s79, 16777216
    v_exp_f32 v84, v84
    v_mfma_f32_16x16x32_bf16 v[132:135], a[196:199], v[44:47], v[132:135]
    buffer_load_dwordx4 v1, s[48:51], s79 offen offset:0 sc1 lds
    v_mfma_f32_16x16x32_bf16 v[136:139], a[200:203], v[44:47], v[136:139]
    v_exp_f32 v85, v85
    s_lshl_b32 s67, s54, 13
    v_mfma_f32_16x16x32_bf16 v[140:143], a[204:207], v[44:47], v[140:143]
    ds_read_b128 a[228:231], v2 offset:17408
    v_cvt_pk_bf16_f32 v54, v84, v85
    v_add_u32 v10, s67, v1
    v_mfma_f32_16x16x32_bf16 v[144:147], a[208:211], v[44:47], v[144:147]
    v_exp_f32 v86, v86
    v_xor_b32 v11, 0x4000, v10
    v_mfma_f32_16x16x32_bf16 v[148:151], a[212:215], v[44:47], v[148:151]
    buffer_load_dwordx4 v1, s[48:51], s79 offen offset:1024 sc1 lds
    v_add_u32 v19, 4096, v60
    v_mfma_f32_16x16x32_bf16 v[152:155], a[216:219], v[44:47], v[152:155]
    v_exp_f32 v87, v87
    v_mfma_f32_16x16x32_bf16 v[156:159], a[220:223], v[44:47], v[156:159]
    ds_read_b128 a[232:235], v2 offset:18432
    v_cvt_pk_bf16_f32 v55, v86, v87
    v_mfma_f32_16x16x32_bf16 v[28:31], v[4:7], v[44:47], v[28:31]
    v_exp_f32 v88, v88
    v_mfma_f32_16x16x32_bf16 v[160:163], a[192:195], v[48:51], v[160:163]
    buffer_load_dwordx4 v1, s[48:51], s79 offen offset:2048 sc1 lds
    v_mfma_f32_16x16x32_bf16 v[164:167], a[196:199], v[48:51], v[164:167]
    v_exp_f32 v89, v89
    v_mfma_f32_16x16x32_bf16 v[168:171], a[200:203], v[48:51], v[168:171]
    ds_read_b128 a[236:239], v2 offset:19456
    v_cvt_pk_bf16_f32 v56, v88, v89
    v_mfma_f32_16x16x32_bf16 v[172:175], a[204:207], v[48:51], v[172:175]
    ds_write_b128 v10, v[128:131] offset:0
    v_exp_f32 v90, v90
    v_mfma_f32_16x16x32_bf16 v[176:179], a[208:211], v[48:51], v[176:179]
    buffer_load_dwordx4 v1, s[48:51], s79 offen offset:3072 sc1 lds
    v_mfma_f32_16x16x32_bf16 v[180:183], a[212:215], v[48:51], v[180:183]
    s_add_u32 m0, s92, 16384
    v_exp_f32 v91, v91
    v_mfma_f32_16x16x32_bf16 v[184:187], a[216:219], v[48:51], v[184:187]
    ds_read_b128 a[240:243], v2 offset:20480
    v_cvt_pk_bf16_f32 v57, v90, v91
    v_mfma_f32_16x16x32_bf16 v[188:191], a[220:223], v[48:51], v[188:191]
    v_exp_f32 v92, v92
    v_mfma_f32_16x16x32_bf16 v[32:35], v[4:7], v[48:51], v[32:35]
    buffer_load_dwordx4 v1, s[48:51], s98 offen offset:0 sc1 lds
    s_waitcnt lgkmcnt(6)
    v_mfma_f32_16x16x32_bf16 v[64:67], a[160:163], a[16:19], v[112:115]
    ds_write_b128 v10, v[132:135] offset:1024
    v_exp_f32 v93, v93
    v_mfma_f32_16x16x32_bf16 v[64:67], a[164:167], a[20:23], v[64:67]
    ds_read_b128 a[244:247], v2 offset:21504
    v_cvt_pk_bf16_f32 v58, v92, v93
    v_mfma_f32_16x16x32_bf16 v[64:67], a[168:171], a[80:83], v[64:67]
    v_exp_f32 v94, v94
    v_mfma_f32_16x16x32_bf16 v[64:67], a[172:175], a[84:87], v[64:67]
    buffer_load_dwordx4 v1, s[48:51], s98 offen offset:1024 sc1 lds
    v_mfma_f32_16x16x32_bf16 v[68:71], a[176:179], a[16:19], v[116:119]
    v_exp_f32 v95, v95
    v_mfma_f32_16x16x32_bf16 v[68:71], a[180:183], a[20:23], v[68:71]
    ds_read_b128 a[248:251], v2 offset:22528
    v_cvt_pk_bf16_f32 v59, v94, v95
    v_mfma_f32_16x16x32_bf16 v[68:71], a[184:187], a[80:83], v[68:71]
    buffer_load_dwordx4 v1, s[48:51], s98 offen offset:2048 sc1 lds
    v_mfma_f32_16x16x32_bf16 v[68:71], a[188:191], a[84:87], v[68:71]
    ds_write_b128 v10, v[136:139] offset:2048
    v_mfma_f32_16x16x32_bf16 v[72:75], a[160:163], a[24:27], v[120:123]
    s_add_u32 s62, s62, 32768
    v_exp_f32 v64, v64
    v_mfma_f32_16x16x32_bf16 v[72:75], a[164:167], a[28:31], v[72:75]
    buffer_load_dwordx4 v1, s[48:51], s98 offen offset:3072 sc1 lds
    v_mfma_f32_16x16x32_bf16 v[72:75], a[168:171], a[88:91], v[72:75]
    s_cmp_eq_u32 s62, 98304
    v_exp_f32 v65, v65
    v_mfma_f32_16x16x32_bf16 v[72:75], a[172:175], a[92:95], v[72:75]
    ds_read_b128 a[252:255], v2 offset:23552
    v_cvt_pk_bf16_f32 v44, v64, v65
    v_mfma_f32_16x16x32_bf16 v[76:79], a[176:179], a[24:27], v[124:127]
    s_cselect_b32 s62, 0, s62
    v_exp_f32 v66, v66
    v_mfma_f32_16x16x32_bf16 v[76:79], a[180:183], a[28:31], v[76:79]
    ds_write_b128 v10, v[140:143] offset:3072
    v_add_u32 v2, s62, v3
    v_mfma_f32_16x16x32_bf16 v[76:79], a[184:187], a[88:91], v[76:79]
    s_add_u32 s79, s79, 16384
    v_exp_f32 v67, v67
    v_mfma_f32_16x16x32_bf16 v[76:79], a[188:191], a[92:95], v[76:79]
    v_cvt_pk_bf16_f32 v45, v66, v67
    v_mfma_f32_16x16x32_bf16 v[192:195], a[192:195], v[52:55], v[192:195]
    s_sub_u32 s93, s93, 1
    v_exp_f32 v68, v68
    v_mfma_f32_16x16x32_bf16 v[196:199], a[196:199], v[52:55], v[196:199]
    s_cselect_b32 s79, s94, s79
    ds_write_b128 v10, v[144:147] offset:4096
    v_mfma_f32_16x16x32_bf16 v[200:203], a[200:203], v[52:55], v[200:203]
    s_cselect_b32 s93, s75, s93
    v_exp_f32 v69, v69
    v_mfma_f32_16x16x32_bf16 v[204:207], a[204:207], v[52:55], v[204:207]
    v_cvt_pk_bf16_f32 v46, v68, v69
    v_mfma_f32_16x16x32_bf16 v[208:211], a[208:211], v[52:55], v[208:211]
    s_add_u32 s92, s92, 32768
    v_exp_f32 v70, v70
    v_mfma_f32_16x16x32_bf16 v[212:215], a[212:215], v[52:55], v[212:215]
    s_sub_u32 s99, s92, 98304
    ds_write_b128 v10, v[148:151] offset:5120
    v_mfma_f32_16x16x32_bf16 v[216:219], a[216:219], v[52:55], v[216:219]
    s_cmp_ge_i32 s99, 65536
    v_exp_f32 v71, v71
    v_mfma_f32_16x16x32_bf16 v[220:223], a[220:223], v[52:55], v[220:223]
    v_cvt_pk_bf16_f32 v47, v70, v71
    v_mfma_f32_16x16x32_bf16 v[36:39], v[4:7], v[52:55], v[36:39]
    s_cselect_b32 s92, s99, s92
    v_exp_f32 v72, v72
    v_mfma_f32_16x16x32_bf16 v[224:227], a[192:195], v[56:59], v[224:227]
    ds_write_b128 v10, v[152:155] offset:6144
    v_mfma_f32_16x16x32_bf16 v[228:231], a[196:199], v[56:59], v[228:231]
    v_exp_f32 v73, v73
    v_mfma_f32_16x16x32_bf16 v[232:235], a[200:203], v[56:59], v[232:235]
    v_cvt_pk_bf16_f32 v48, v72, v73
    v_mfma_f32_16x16x32_bf16 v[236:239], a[204:207], v[56:59], v[236:239]
    ds_write_b128 v10, v[156:159] offset:7168
    v_exp_f32 v74, v74
    v_mfma_f32_16x16x32_bf16 v[240:243], a[208:211], v[56:59], v[240:243]
    v_mfma_f32_16x16x32_bf16 v[244:247], a[212:215], v[56:59], v[244:247]
    v_exp_f32 v75, v75
    v_mfma_f32_16x16x32_bf16 v[248:251], a[216:219], v[56:59], v[248:251]
    v_cvt_pk_bf16_f32 v49, v74, v75
    v_mfma_f32_16x16x32_bf16 v[252:255], a[220:223], v[56:59], v[252:255]
    v_exp_f32 v76, v76
    v_mfma_f32_16x16x32_bf16 v[40:43], v[4:7], v[56:59], v[40:43]
L_t0_tail:
    s_waitcnt vmcnt(8) lgkmcnt(0)
    s_barrier
    v_mfma_f32_16x16x32_bf16 v[192:195], a[224:227], v[44:47], v[192:195]
    ds_read_b128 a[128:131], v2 offset:0
    v_exp_f32 v77, v77
    v_lshl_add_u32 v12, v0, 2, s92
    v_mfma_f32_16x16x32_bf16 v[196:199], a[228:231], v[44:47], v[196:199]
    ds_read_b128 a[132:135], v2 offset:1024
    v_cvt_pk_bf16_f32 v50, v76, v77
    v_xor_b32 v13, 0x2000, v12
    v_mfma_f32_16x16x32_bf16 v[200:203], a[232:235], v[44:47], v[200:203]
    ds_read_b128 a[136:139], v2 offset:2048
    v_exp_f32 v78, v78
    s_mov_b32 m0, s92
    v_mfma_f32_16x16x32_bf16 v[204:207], a[236:239], v[44:47], v[204:207]
    ds_read_b128 a[140:143], v2 offset:3072
    s_add_u32 s98, s79, 16777216
    v_mfma_f32_16x16x32_bf16 v[208:211], a[240:243], v[44:47], v[208:211]
    ds_read_b128 a[144:147], v2 offset:4096
    buffer_load_dwordx4 v1, s[48:51], s79 offen offset:0 sc1 lds
    v_exp_f32 v79, v79
    v_mfma_f32_16x16x32_bf16 v[212:215], a[244:247], v[44:47], v[212:215]
    ds_read_b128 a[148:151], v2 offset:5120
    v_cvt_pk_bf16_f32 v51, v78, v79
    v_mfma_f32_16x16x32_bf16 v[216:219], a[248:251], v[44:47], v[216:219]
    ds_read_b128 a[152:155], v2 offset:6144
    ds_read_b128 v[128:131], v11 offset:0
    v_mfma_f32_16x16x32_bf16 v[220:223], a[252:255], v[44:47], v[220:223]
    ds_read_b128 a[156:159], v2 offset:7168
    ds_read_b128 v[132:135], v11 offset:1024
    buffer_load_dwordx4 v1, s[48:51], s79 offen offset:1024 sc1 lds
    v_mfma_f32_16x16x32_bf16 v[36:39], v[4:7], v[44:47], v[36:39]
    ds_read_b128 v[136:139], v11 offset:2048
    v_mfma_f32_16x16x32_bf16 v[224:227], a[224:227], v[48:51], v[224:227]
    ds_read_b128 v[140:143], v11 offset:3072
    v_mfma_f32_16x16x32_bf16 v[228:231], a[228:231], v[48:51], v[228:231]
    ds_read_b128 v[144:147], v11 offset:4096
    v_mfma_f32_16x16x32_bf16 v[232:235], a[232:235], v[48:51], v[232:235]
    ds_read_b128 v[148:151], v11 offset:5120
    buffer_load_dwordx4 v1, s[48:51], s79 offen offset:2048 sc1 lds
    v_mfma_f32_16x16x32_bf16 v[236:239], a[236:239], v[48:51], v[236:239]
    ds_read_b128 v[152:155], v11 offset:6144
    v_mfma_f32_16x16x32_bf16 v[240:243], a[240:243], v[48:51], v[240:243]
    ds_read_b128 v[156:159], v11 offset:7168
    v_mfma_f32_16x16x32_bf16 v[244:247], a[244:247], v[48:51], v[244:247]
    buffer_load_dwordx4 v1, s[48:51], s79 offen offset:3072 sc1 lds
    ds_write_b128 v10, v[192:195] offset:32768
    v_mfma_f32_16x16x32_bf16 v[248:251], a[248:251], v[48:51], v[248:251]
    ds_write_b128 v10, v[196:199] offset:33792
    v_mfma_f32_16x16x32_bf16 v[252:255], a[252:255], v[48:51], v[252:255]
    ds_write_b128 v10, v[200:203] offset:34816
    v_mfma_f32_16x16x32_bf16 v[40:43], v[4:7], v[48:51], v[40:43]
    ds_write_b128 v10, v[204:207] offset:35840
    s_waitcnt lgkmcnt(11)
    v_mfma_f32_16x16x32_bf16 v[64:67], a[128:131], a[32:35], 0
    ds_write_b128 v10, v[208:211] offset:36864
    v_mfma_f32_16x16x32_bf16 v[64:67], a[132:135], a[36:39], v[64:67]
    ds_write_b128 v10, v[212:215] offset:37888
    s_waitcnt lgkmcnt(6)
    v_add_f32 v160, v160, v128
    v_add_f32 v161, v161, v129
    v_mfma_f32_16x16x32_bf16 v[64:67], a[136:139], a[96:99], v[64:67]
    ds_write_b128 v10, v[216:219] offset:38912
    v_add_f32 v162, v162, v130
    v_add_f32 v163, v163, v131
    v_mfma_f32_16x16x32_bf16 v[64:67], a[140:143], a[100:103], v[64:67]
    ds_write_b128 v10, v[220:223] offset:39936
    v_add_f32 v164, v164, v132
    v_add_f32 v165, v165, v133
    v_mfma_f32_16x16x32_bf16 v[68:71], a[144:147], a[32:35], 0
    ds_write_b32 v12, v28 offset:16384
    ds_read_b128 a[192:195], v2 offset:16384
    v_add_f32 v166, v166, v134
    v_add_f32 v167, v167, v135
    v_mfma_f32_16x16x32_bf16 v[68:71], a[148:151], a[36:39], v[68:71]
    ds_write_b32 v12, v36 offset:16640
    ds_read_b128 a[196:199], v2 offset:17408
    v_add_f32 v168, v168, v136
    v_add_f32 v169, v169, v137
    v_mfma_f32_16x16x32_bf16 v[68:71], a[152:155], a[96:99], v[68:71]
    ds_read_b128 a[200:203], v2 offset:18432
    v_add_f32 v170, v170, v138
    v_add_f32 v171, v171, v139
    v_add_f32 v172, v172, v140
    v_mfma_f32_16x16x32_bf16 v[68:71], a[156:159], a[100:103], v[68:71]
    ds_read_b128 a[204:207], v2 offset:19456
    v_add_f32 v173, v173, v141
    v_add_f32 v174, v174, v142
    v_mfma_f32_16x16x32_bf16 v[72:75], a[128:131], a[40:43], 0
    ds_read_b128 a[208:211], v2 offset:20480
    v_exp_f32 v64, v64
    v_add_f32 v175, v175, v143
    v_add_f32 v176, v176, v144
    v_mfma_f32_16x16x32_bf16 v[72:75], a[132:135], a[44:47], v[72:75]
    ds_read_b128 a[212:215], v2 offset:21504
    v_add_f32 v177, v177, v145
    v_add_f32 v178, v178, v146
    v_mfma_f32_16x16x32_bf16 v[72:75], a[136:139], a[104:107], v[72:75]
    ds_read_b128 a[216:219], v2 offset:22528
    v_exp_f32 v65, v65
    v_add_f32 v179, v179, v147
    v_add_f32 v180, v180, v148
    v_mfma_f32_16x16x32_bf16 v[72:75], a[140:143], a[108:111], v[72:75]
    ds_read_b128 a[220:223], v2 offset:23552
    v_cvt_pk_bf16_f32 v44, v64, v65
    v_add_f32 v181, v181, v149
    v_add_f32 v182, v182, v150
    v_add_f32 v183, v183, v151
    v_mfma_f32_16x16x32_bf16 v[76:79], a[144:147], a[40:43], 0
    v_exp_f32 v66, v66
    v_add_f32 v184, v184, v152
    v_add_f32 v185, v185, v153
    v_mfma_f32_16x16x32_bf16 v[76:79], a[148:151], a[44:47], v[76:79]
    v_add_f32 v186, v186, v154
    v_add_f32 v187, v187, v155
    v_mfma_f32_16x16x32_bf16 v[76:79], a[152:155], a[104:107], v[76:79]
    v_exp_f32 v67, v67
    v_add_f32 v188, v188, v156
    v_add_f32 v189, v189, v157
    v_mfma_f32_16x16x32_bf16 v[76:79], a[156:159], a[108:111], v[76:79]
    v_cvt_pk_bf16_f32 v45, v66, v67
    v_add_f32 v190, v190, v158
    v_add_f32 v191, v191, v159
    s_waitcnt lgkmcnt(0)
    s_barrier
    ds_read_b32 v14, v13 offset:16384
    ds_read_b32 v15, v13 offset:16640
    ds_read_b128 v[192:195], v11 offset:32768
    ds_read_b128 v[196:199], v11 offset:33792
    ds_read_b128 v[200:203], v11 offset:34816
    ds_read_b128 v[204:207], v11 offset:35840
    ds_read_b128 v[208:211], v11 offset:36864
    ds_read_b128 v[212:215], v11 offset:37888
    ds_read_b128 v[216:219], v11 offset:38912
    ds_read_b128 v[220:223], v11 offset:39936
    s_add_u32 s62, s62, 32768
    s_cmp_eq_u32 s62, 98304
    s_cselect_b32 s62, 0, s62
    v_add_u32 v2, s62, v3
    s_lshl_b32 s66, s57, 2
    s_add_u32 s65, s66, s55
    s_add_u32 s66, s66, 3
    s_sub_u32 s66, s66, s55
    s_lshl_b32 s67, s52, 13
    s_add_u32 s67, s67, 33554432
    s_mul_i32 s65, s65, 294912
    s_mul_i32 s66, s66, 294912
    s_add_u32 s65, s65, s67
    s_add_u32 s66, s66, s67
    v_exp_f32 v68, v68
    v_exp_f32 v69, v69
    v_exp_f32 v70, v70
    v_cvt_pk_bf16_f32 v46, v68, v69
    v_exp_f32 v71, v71
    v_exp_f32 v72, v72
    v_cvt_pk_bf16_f32 v47, v70, v71
    v_exp_f32 v73, v73
    v_exp_f32 v74, v74
    v_cvt_pk_bf16_f32 v48, v72, v73
    v_exp_f32 v75, v75
    v_exp_f32 v76, v76
    v_cvt_pk_bf16_f32 v49, v74, v75
    s_waitcnt vmcnt(4) lgkmcnt(0)
    s_barrier
    v_mfma_f32_16x16x32_bf16 v[80:83], a[128:131], a[48:51], 0
    s_add_u32 m0, s92, 16384
    v_exp_f32 v77, v77
    v_add_f32 v14, v14, v32
    v_add_f32 v15, v15, v40
    v_subrev_u32 v17, 0x2b800000, v14
    v_mfma_f32_16x16x32_bf16 v[80:83], a[132:135], a[52:55], v[80:83]
    ds_read_b128 a[160:163], v2 offset:0
    v_cvt_pk_bf16_f32 v50, v76, v77
    v_subrev_u32 v16, 0x2b800000, v15
    v_max_u32 v17, v17, v16
    v_rcp_f32 v14, v14
    v_mfma_f32_16x16x32_bf16 v[80:83], a[136:139], a[112:115], v[80:83]
    buffer_load_dwordx4 v1, s[48:51], s98 offen offset:0 sc1 lds
    v_exp_f32 v78, v78
    v_rcp_f32 v15, v15
    v_mov_b32 v16, 0x2c000000
    v_cmp_gt_u32 s[96:97], v17, v16
    v_mfma_f32_16x16x32_bf16 v[80:83], a[140:143], a[116:119], v[80:83]
    ds_read_b128 a[164:167], v2 offset:1024
    v_mov_b32 v16, 0
    v_mul_f32 v160, v160, v14
    v_mul_f32 v161, v161, v14
    v_mfma_f32_16x16x32_bf16 v[84:87], a[144:147], a[48:51], 0
    buffer_load_dwordx4 v1, s[48:51], s98 offen offset:1024 sc1 lds
    v_exp_f32 v79, v79
    v_mul_f32 v162, v162, v14
    v_mul_f32 v163, v163, v14
    v_mfma_f32_16x16x32_bf16 v[84:87], a[148:151], a[52:55], v[84:87]
    ds_read_b128 a[168:171], v2 offset:2048
    v_cvt_pk_bf16_f32 v51, v78, v79
    v_mul_f32 v164, v164, v14
    v_mul_f32 v165, v165, v14
    v_mul_f32 v166, v166, v14
    v_mfma_f32_16x16x32_bf16 v[84:87], a[152:155], a[112:115], v[84:87]
    ds_read_b128 a[172:175], v2 offset:3072
    v_mul_f32 v167, v167, v14
    v_cvt_pk_bf16_f32 v160, v160, v161
    v_cvt_pk_bf16_f32 v161, v162, v163
    v_mfma_f32_16x16x32_bf16 v[84:87], a[156:159], a[116:119], v[84:87]
    ds_read_b128 a[176:179], v2 offset:4096
    v_cvt_pk_bf16_f32 v162, v164, v165
    v_cvt_pk_bf16_f32 v163, v166, v167
    v_pk_maximum3_f16 v16, v160, v161, v16
    v_mfma_f32_16x16x32_bf16 v[88:91], a[128:131], a[56:59], 0
    buffer_load_dwordx4 v1, s[48:51], s98 offen offset:2048 sc1 lds
    v_exp_f32 v80, v80
    v_pk_maximum3_f16 v16, v162, v163, v16
    v_mfma_f32_16x16x32_bf16 v[88:91], a[132:135], a[60:63], v[88:91]
    ds_read_b128 a[180:183], v2 offset:5120
    buffer_store_dwordx4 v[160:163], v60, s[48:51], s65 offen offset:0 sc1
    v_mul_f32 v168, v168, v14
    v_mul_f32 v169, v169, v14
    v_mul_f32 v170, v170, v14
    v_mfma_f32_16x16x32_bf16 v[88:91], a[136:139], a[120:123], v[88:91]
    buffer_load_dwordx4 v1, s[48:51], s98 offen offset:3072 sc1 lds
    v_exp_f32 v81, v81
    v_mul_f32 v171, v171, v14
    v_mul_f32 v172, v172, v14
    v_mul_f32 v173, v173, v14
    v_mfma_f32_16x16x32_bf16 v[88:91], a[140:143], a[124:127], v[88:91]
    ds_read_b128 a[184:187], v2 offset:6144
    s_add_u32 s79, s79, 16384
    v_cvt_pk_bf16_f32 v52, v80, v81
    v_mul_f32 v174, v174, v14
    v_mul_f32 v175, v175, v14
    v_cvt_pk_bf16_f32 v168, v168, v169
    v_mfma_f32_16x16x32_bf16 v[92:95], a[144:147], a[56:59], 0
    s_sub_u32 s93, s93, 1
    v_exp_f32 v82, v82
    v_cvt_pk_bf16_f32 v169, v170, v171
    v_cvt_pk_bf16_f32 v170, v172, v173
    v_cvt_pk_bf16_f32 v171, v174, v175
    v_mfma_f32_16x16x32_bf16 v[92:95], a[148:151], a[60:63], v[92:95]
    ds_read_b128 a[188:191], v2 offset:7168
    s_cselect_b32 s79, s94, s79
    v_pk_maximum3_f16 v16, v168, v169, v16
    v_pk_maximum3_f16 v16, v170, v171, v16
    v_mfma_f32_16x16x32_bf16 v[92:95], a[152:155], a[120:123], v[92:95]
    s_cselect_b32 s93, s75, s93
    buffer_store_dwordx4 v[168:171], v60, s[48:51], s65 offen offset:2048 sc1
    v_exp_f32 v83, v83
    v_mul_f32 v176, v176, v14
    v_mul_f32 v177, v177, v14
    v_mfma_f32_16x16x32_bf16 v[92:95], a[156:159], a[124:127], v[92:95]
    ds_read_b128 a[224:227], v2 offset:16384
    s_add_u32 s92, s92, 32768
    v_cvt_pk_bf16_f32 v53, v82, v83
    v_mul_f32 v178, v178, v14
    v_mul_f32 v179, v179, v14
    v_mul_f32 v180, v180, v14
    v_mfma_f32_16x16x32_bf16 v[128:131], a[192:195], v[44:47], 0
    s_sub_u32 s99, s92, 98304
    v_exp_f32 v84, v84
    v_mul_f32 v181, v181, v14
    v_mul_f32 v182, v182, v14
    v_mul_f32 v183, v183, v14
    v_mfma_f32_16x16x32_bf16 v[132:135], a[196:199], v[44:47], 0
    s_cmp_ge_i32 s99, 65536
    v_cvt_pk_bf16_f32 v176, v176, v177
    v_cvt_pk_bf16_f32 v177, v178, v179
    v_cvt_pk_bf16_f32 v178, v180, v181
    v_mfma_f32_16x16x32_bf16 v[136:139], a[200:203], v[44:47], 0
    s_cselect_b32 s92, s99, s92
    v_exp_f32 v85, v85
    v_cvt_pk_bf16_f32 v179, v182, v183
    v_pk_maximum3_f16 v16, v176, v177, v16
    v_pk_maximum3_f16 v16, v178, v179, v16
    v_mfma_f32_16x16x32_bf16 v[140:143], a[204:207], v[44:47], 0
    ds_read_b128 a[228:231], v2 offset:17408
    buffer_store_dwordx4 v[176:179], v19, s[48:51], s65 offen offset:0 sc1
    v_cvt_pk_bf16_f32 v54, v84, v85
    v_mul_f32 v184, v184, v14
    v_mfma_f32_16x16x32_bf16 v[144:147], a[208:211], v[44:47], 0
    v_exp_f32 v86, v86
    v_mul_f32 v185, v185, v14
    v_mul_f32 v186, v186, v14
    v_mul_f32 v187, v187, v14
    v_mfma_f32_16x16x32_bf16 v[148:151], a[212:215], v[44:47], 0
    v_mul_f32 v188, v188, v14
    v_mul_f32 v189, v189, v14
    v_mul_f32 v190, v190, v14
    v_mfma_f32_16x16x32_bf16 v[152:155], a[216:219], v[44:47], 0
    s_mov_b32 m0, s92
    v_exp_f32 v87, v87
    v_mul_f32 v191, v191, v14
    v_cvt_pk_bf16_f32 v184, v184, v185
    v_cvt_pk_bf16_f32 v185, v186, v187
    v_mfma_f32_16x16x32_bf16 v[156:159], a[220:223], v[44:47], 0
    ds_read_b128 a[232:235], v2 offset:18432
    v_cvt_pk_bf16_f32 v55, v86, v87
    v_cvt_pk_bf16_f32 v186, v188, v189
    v_cvt_pk_bf16_f32 v187, v190, v191
    v_pk_maximum3_f16 v16, v184, v185, v16
    v_mfma_f32_16x16x32_bf16 v[28:31], v[4:7], v[44:47], 0
    s_add_u32 s98, s79, 16777216
    v_exp_f32 v88, v88
    v_pk_maximum3_f16 v16, v186, v187, v16
    v_mfma_f32_16x16x32_bf16 v[160:163], a[192:195], v[48:51], 0
    buffer_load_dwordx4 v1, s[48:51], s79 offen offset:0 sc1 lds
    buffer_store_dwordx4 v[184:187], v19, s[48:51], s65 offen offset:2048 sc1
    v_mfma_f32_16x16x32_bf16 v[164:167], a[196:199], v[48:51], 0
    v_exp_f32 v89, v89
    v_add_f32 v224, v224, v192
    v_add_f32 v225, v225, v193
    v_add_f32 v226, v226, v194
    v_mfma_f32_16x16x32_bf16 v[168:171], a[200:203], v[48:51], 0
    ds_read_b128 a[236:239], v2 offset:19456
    v_cvt_pk_bf16_f32 v56, v88, v89
    v_add_f32 v227, v227, v195
    v_add_f32 v228, v228, v196
    v_add_f32 v229, v229, v197
    v_mfma_f32_16x16x32_bf16 v[172:175], a[204:207], v[48:51], 0
    v_exp_f32 v90, v90
    v_add_f32 v230, v230, v198
    v_add_f32 v231, v231, v199
    v_add_f32 v232, v232, v200
    v_mfma_f32_16x16x32_bf16 v[176:179], a[208:211], v[48:51], 0
    buffer_load_dwordx4 v1, s[48:51], s79 offen offset:1024 sc1 lds
    v_add_f32 v233, v233, v201
    v_add_f32 v234, v234, v202
    v_add_f32 v235, v235, v203
    v_mfma_f32_16x16x32_bf16 v[180:183], a[212:215], v[48:51], 0
    v_exp_f32 v91, v91
    v_add_f32 v236, v236, v204
    v_add_f32 v237, v237, v205
    v_add_f32 v238, v238, v206
    v_mfma_f32_16x16x32_bf16 v[184:187], a[216:219], v[48:51], 0
    ds_read_b128 a[240:243], v2 offset:20480
    v_cvt_pk_bf16_f32 v57, v90, v91
    v_add_f32 v239, v239, v207
    v_add_f32 v240, v240, v208
    v_add_f32 v241, v241, v209
    v_mfma_f32_16x16x32_bf16 v[188:191], a[220:223], v[48:51], 0
    v_exp_f32 v92, v92
    v_add_f32 v242, v242, v210
    v_add_f32 v243, v243, v211
    v_add_f32 v244, v244, v212
    v_mfma_f32_16x16x32_bf16 v[32:35], v[4:7], v[48:51], 0
    buffer_load_dwordx4 v1, s[48:51], s79 offen offset:2048 sc1 lds
    v_add_f32 v245, v245, v213
    v_add_f32 v246, v246, v214
    v_add_f32 v247, v247, v215
    s_waitcnt lgkmcnt(5)
    v_mfma_f32_16x16x32_bf16 v[64:67], a[160:163], a[32:35], 0
    v_exp_f32 v93, v93
    v_add_f32 v248, v248, v216
    v_add_f32 v249, v249, v217
    v_add_f32 v250, v250, v218
    v_mfma_f32_16x16x32_bf16 v[64:67], a[164:167], a[36:39], v[64:67]
    ds_read_b128 a[244:247], v2 offset:21504
    v_cvt_pk_bf16_f32 v58, v92, v93
    v_add_f32 v251, v251, v219
    v_add_f32 v252, v252, v220
    v_add_f32 v253, v253, v221
    v_mfma_f32_16x16x32_bf16 v[64:67], a[168:171], a[96:99], v[64:67]
    v_exp_f32 v94, v94
    v_add_f32 v254, v254, v222
    v_add_f32 v255, v255, v223
    v_mfma_f32_16x16x32_bf16 v[64:67], a[172:175], a[100:103], v[64:67]
    buffer_load_dwordx4 v1, s[48:51], s79 offen offset:3072 sc1 lds
    v_mul_f32 v224, v224, v15
    v_mul_f32 v225, v225, v15
    v_mul_f32 v226, v226, v15
    v_mfma_f32_16x16x32_bf16 v[68:71], a[176:179], a[32:35], 0
    s_add_u32 m0, s92, 16384
    v_exp_f32 v95, v95
    v_mul_f32 v227, v227, v15
    v_mul_f32 v228, v228, v15
    v_mul_f32 v229, v229, v15
    v_mfma_f32_16x16x32_bf16 v[68:71], a[180:183], a[36:39], v[68:71]
    ds_read_b128 a[248:251], v2 offset:22528
    v_cvt_pk_bf16_f32 v59, v94, v95
    v_mul_f32 v230, v230, v15
    v_mul_f32 v231, v231, v15
    v_cvt_pk_bf16_f32 v224, v224, v225
    v_mfma_f32_16x16x32_bf16 v[68:71], a[184:187], a[96:99], v[68:71]
    v_cvt_pk_bf16_f32 v225, v226, v227
    v_cvt_pk_bf16_f32 v226, v228, v229
    v_cvt_pk_bf16_f32 v227, v230, v231
    v_mfma_f32_16x16x32_bf16 v[68:71], a[188:191], a[100:103], v[68:71]
    buffer_load_dwordx4 v1, s[48:51], s98 offen offset:0 sc1 lds
    v_pk_maximum3_f16 v16, v224, v225, v16
    v_pk_maximum3_f16 v16, v226, v227, v16
    v_mfma_f32_16x16x32_bf16 v[72:75], a[160:163], a[40:43], 0
    s_add_u32 s62, s62, 32768
    buffer_store_dwordx4 v[224:227], v60, s[48:51], s66 offen offset:0 sc1
    v_exp_f32 v64, v64
    v_mul_f32 v232, v232, v15
    v_mul_f32 v233, v233, v15
    v_mul_f32 v234, v234, v15
    v_mfma_f32_16x16x32_bf16 v[72:75], a[164:167], a[44:47], v[72:75]
    v_mul_f32 v235, v235, v15
    v_mul_f32 v236, v236, v15
    v_mul_f32 v237, v237, v15
    v_mfma_f32_16x16x32_bf16 v[72:75], a[168:171], a[104:107], v[72:75]
    s_cmp_eq_u32 s62, 98304
    v_exp_f32 v65, v65
    v_mul_f32 v238, v238, v15
    v_mul_f32 v239, v239, v15
    v_cvt_pk_bf16_f32 v232, v232, v233
    v_mfma_f32_16x16x32_bf16 v[72:75], a[172:175], a[108:111], v[72:75]
    ds_read_b128 a[252:255], v2 offset:23552
    buffer_load_dwordx4 v1, s[48:51], s98 offen offset:1024 sc1 lds
    v_cvt_pk_bf16_f32 v44, v64, v65
    v_cvt_pk_bf16_f32 v233, v234, v235
    v_cvt_pk_bf16_f32 v234, v236, v237
    v_cvt_pk_bf16_f32 v235, v238, v239
    v_mfma_f32_16x16x32_bf16 v[76:79], a[176:179], a[40:43], 0
    s_cselect_b32 s62, 0, s62
    v_exp_f32 v66, v66
    v_pk_maximum3_f16 v16, v232, v233, v16
    v_pk_maximum3_f16 v16, v234, v235, v16
    v_mfma_f32_16x16x32_bf16 v[76:79], a[180:183], a[44:47], v[76:79]
    buffer_store_dwordx4 v[232:235], v60, s[48:51], s66 offen offset:2048 sc1
    v_add_u32 v2, s62, v3
    v_mul_f32 v240, v240, v15
    v_mul_f32 v241, v241, v15
    v_mfma_f32_16x16x32_bf16 v[76:79], a[184:187], a[104:107], v[76:79]
    v_exp_f32 v67, v67
    v_mul_f32 v242, v242, v15
    v_mul_f32 v243, v243, v15
    v_mul_f32 v244, v244, v15
    v_mfma_f32_16x16x32_bf16 v[76:79], a[188:191], a[108:111], v[76:79]
    buffer_load_dwordx4 v1, s[48:51], s98 offen offset:2048 sc1 lds
    v_cvt_pk_bf16_f32 v45, v66, v67
    v_mul_f32 v245, v245, v15
    v_mul_f32 v246, v246, v15
    v_mul_f32 v247, v247, v15
    v_mfma_f32_16x16x32_bf16 v[192:195], a[192:195], v[52:55], 0
    v_exp_f32 v68, v68
    v_cvt_pk_bf16_f32 v240, v240, v241
    v_cvt_pk_bf16_f32 v241, v242, v243
    v_cvt_pk_bf16_f32 v242, v244, v245
    v_mfma_f32_16x16x32_bf16 v[196:199], a[196:199], v[52:55], 0
    v_cvt_pk_bf16_f32 v243, v246, v247
    v_pk_maximum3_f16 v16, v240, v241, v16
    v_pk_maximum3_f16 v16, v242, v243, v16
    v_mfma_f32_16x16x32_bf16 v[200:203], a[200:203], v[52:55], 0
    buffer_store_dwordx4 v[240:243], v19, s[48:51], s66 offen offset:0 sc1
    v_exp_f32 v69, v69
    v_mul_f32 v248, v248, v15
    v_mul_f32 v249, v249, v15
    v_mfma_f32_16x16x32_bf16 v[204:207], a[204:207], v[52:55], 0
    buffer_load_dwordx4 v1, s[48:51], s98 offen offset:3072 sc1 lds
    v_cvt_pk_bf16_f32 v46, v68, v69
    v_mul_f32 v250, v250, v15
    v_mul_f32 v251, v251, v15
    v_mul_f32 v252, v252, v15
    v_mfma_f32_16x16x32_bf16 v[208:211], a[208:211], v[52:55], 0
    s_add_u32 s79, s79, 16384
    v_exp_f32 v70, v70
    v_mul_f32 v253, v253, v15
    v_mul_f32 v254, v254, v15
    v_mul_f32 v255, v255, v15
    v_mfma_f32_16x16x32_bf16 v[212:215], a[212:215], v[52:55], 0
    s_sub_u32 s93, s93, 1
    v_cvt_pk_bf16_f32 v248, v248, v249
    v_cvt_pk_bf16_f32 v249, v250, v251
    v_cvt_pk_bf16_f32 v250, v252, v253
    v_mfma_f32_16x16x32_bf16 v[216:219], a[216:219], v[52:55], 0
    s_cselect_b32 s79, s94, s79
    v_exp_f32 v71, v71
    v_cvt_pk_bf16_f32 v251, v254, v255
    v_pk_maximum3_f16 v16, v248, v249, v16
    v_pk_maximum3_f16 v16, v250, v251, v16
    v_mfma_f32_16x16x32_bf16 v[220:223], a[220:223], v[52:55], 0
    buffer_store_dwordx4 v[248:251], v19, s[48:51], s66 offen offset:2048 sc1
    v_cvt_pk_bf16_f32 v47, v70, v71
    v_and_b32 v16, 0x7c007c00, v16
    v_add_u32 v16, 0x04000400, v16
    v_mfma_f32_16x16x32_bf16 v[36:39], v[4:7], v[52:55], 0
    s_cselect_b32 s93, s75, s93
    v_exp_f32 v72, v72
    v_and_b32 v16, 0x80008000, v16
    v_cmp_ne_u32 s[100:101], 0, v16
    v_mfma_f32_16x16x32_bf16 v[224:227], a[192:195], v[56:59], 0
    s_add_u32 s92, s92, 32768
    v_mfma_f32_16x16x32_bf16 v[228:231], a[196:199], v[56:59], 0
    s_sub_u32 s99, s92, 98304
    v_exp_f32 v73, v73
    v_mfma_f32_16x16x32_bf16 v[232:235], a[200:203], v[56:59], 0
    v_cvt_pk_bf16_f32 v48, v72, v73
    v_mfma_f32_16x16x32_bf16 v[236:239], a[204:207], v[56:59], 0
    s_cmp_ge_i32 s99, 65536
    v_exp_f32 v74, v74
    v_mfma_f32_16x16x32_bf16 v[240:243], a[208:211], v[56:59], 0
    s_cselect_b32 s92, s99, s92
    v_mfma_f32_16x16x32_bf16 v[244:247], a[212:215], v[56:59], 0
    s_sub_u32 s63, s58, 1
    v_exp_f32 v75, v75
    v_mfma_f32_16x16x32_bf16 v[248:251], a[216:219], v[56:59], 0
    v_cvt_pk_bf16_f32 v49, v74, v75
    v_mfma_f32_16x16x32_bf16 v[252:255], a[220:223], v[56:59], 0
    v_exp_f32 v76, v76
    v_mfma_f32_16x16x32_bf16 v[40:43], v[4:7], v[56:59], 0
    s_waitcnt vmcnt(15) lgkmcnt(0)
    s_barrier
    v_mfma_f32_16x16x32_bf16 v[80:83], a[160:163], a[48:51], 0
    v_exp_f32 v77, v77
    s_or_b64 s[96:97], s[96:97], s[100:101]
    s_cselect_b32 s67, 1, 0
    s_or_b32 s64, s64, s67
    v_mfma_f32_16x16x32_bf16 v[80:83], a[164:167], a[52:55], v[80:83]
    ds_read_b128 a[128:131], v2 offset:0
    v_cvt_pk_bf16_f32 v50, v76, v77
    s_cmp_eq_u32 s54, 0
    s_cselect_b32 s68, 0, 0x40000000
    v_mfma_f32_16x16x32_bf16 v[80:83], a[168:171], a[112:115], v[80:83]
    v_exp_f32 v78, v78
    v_lshrrev_b32 v8, 3, v0
    v_mfma_f32_16x16x32_bf16 v[80:83], a[172:175], a[116:119], v[80:83]
    ds_read_b128 a[132:135], v2 offset:1024
    v_min_u32 v8, 1, v8
    v_mfma_f32_16x16x32_bf16 v[84:87], a[176:179], a[48:51], 0
    v_exp_f32 v79, v79
    v_lshlrev_b32 v8, 30, v8
    v_mfma_f32_16x16x32_bf16 v[84:87], a[180:183], a[52:55], v[84:87]
    ds_read_b128 a[136:139], v2 offset:2048
    v_cvt_pk_bf16_f32 v51, v78, v79
    v_lshl_or_b32 v8, v0, 2, v8
    v_mfma_f32_16x16x32_bf16 v[84:87], a[184:187], a[112:115], v[84:87]
    ds_read_b128 a[140:143], v2 offset:3072
    v_mfma_f32_16x16x32_bf16 v[84:87], a[188:191], a[116:119], v[84:87]
    ds_read_b128 a[144:147], v2 offset:4096
    v_or_b32 v8, s68, v8
    v_mfma_f32_16x16x32_bf16 v[88:91], a[160:163], a[56:59], 0
    v_exp_f32 v80, v80
    s_lshl_b32 s90, s52, 7
    v_mfma_f32_16x16x32_bf16 v[88:91], a[164:167], a[60:63], v[88:91]
    ds_read_b128 a[148:151], v2 offset:5120
    s_add_u32 s90, s90, 61673472
    v_mfma_f32_16x16x32_bf16 v[88:91], a[168:171], a[120:123], v[88:91]
    v_exp_f32 v81, v81
    s_mov_b32 s4, s48
    v_mfma_f32_16x16x32_bf16 v[88:91], a[172:175], a[124:127], v[88:91]
    ds_read_b128 a[152:155], v2 offset:6144
    v_cvt_pk_bf16_f32 v52, v80, v81
    s_mov_b32 s5, s49
    v_mfma_f32_16x16x32_bf16 v[92:95], a[176:179], a[56:59], 0
    v_exp_f32 v82, v82
    v_mfma_f32_16x16x32_bf16 v[92:95], a[180:183], a[60:63], v[92:95]
    ds_read_b128 a[156:159], v2 offset:7168
    s_mul_i32 s91, s52, 139264
    v_mfma_f32_16x16x32_bf16 v[92:95], a[184:187], a[120:123], v[92:95]
    s_mov_b32 m0, s92
    v_exp_f32 v83, v83
    s_add_u32 s91, s91, 57147392
    v_mfma_f32_16x16x32_bf16 v[92:95], a[188:191], a[124:127], v[92:95]
    ds_read_b128 a[192:195], v2 offset:16384
    v_cvt_pk_bf16_f32 v53, v82, v83
    s_add_u32 s6, s91, 139264
    v_mfma_f32_16x16x32_bf16 v[128:131], a[224:227], v[44:47], v[128:131]
    s_add_u32 s98, s79, 16777216
    v_exp_f32 v84, v84
    s_lshl_b32 s71, s54, 13
    v_mfma_f32_16x16x32_bf16 v[132:135], a[228:231], v[44:47], v[132:135]
    buffer_load_dwordx4 v1, s[48:51], s79 offen offset:0 sc1 lds
    s_add_u32 s72, s91, s71
    v_mfma_f32_16x16x32_bf16 v[136:139], a[232:235], v[44:47], v[136:139]
    v_exp_f32 v85, v85
    v_mfma_f32_16x16x32_bf16 v[140:143], a[236:239], v[44:47], v[140:143]
    ds_read_b128 a[196:199], v2 offset:17408
    v_cvt_pk_bf16_f32 v54, v84, v85
    s_lshl_b32 s14, s52, 17
    v_mfma_f32_16x16x32_bf16 v[144:147], a[240:243], v[44:47], v[144:147]
    v_exp_f32 v86, v86
    s_lshl_b32 s68, s54, 15
    v_mfma_f32_16x16x32_bf16 v[148:151], a[244:247], v[44:47], v[148:151]
    buffer_load_dwordx4 v1, s[48:51], s79 offen offset:1024 sc1 lds
    s_add_u32 s14, s14, s68
    v_mfma_f32_16x16x32_bf16 v[152:155], a[248:251], v[44:47], v[152:155]
    v_exp_f32 v87, v87
    v_mfma_f32_16x16x32_bf16 v[156:159], a[252:255], v[44:47], v[156:159]
    ds_read_b128 a[200:203], v2 offset:18432
    v_cvt_pk_bf16_f32 v55, v86, v87
    s_lshl_b32 s68, s53, 7
    v_mfma_f32_16x16x32_bf16 v[28:31], v[4:7], v[44:47], v[28:31]
    v_exp_f32 v88, v88
    s_add_u32 s14, s14, s68
    v_mfma_f32_16x16x32_bf16 v[160:163], a[224:227], v[48:51], v[160:163]
    buffer_load_dwordx4 v1, s[48:51], s79 offen offset:2048 sc1 lds
    s_lshl_b32 s15, s52, 14
    v_mfma_f32_16x16x32_bf16 v[164:167], a[228:231], v[48:51], v[164:167]
    v_exp_f32 v89, v89
    v_mfma_f32_16x16x32_bf16 v[168:171], a[232:235], v[48:51], v[168:171]
    ds_read_b128 a[204:207], v2 offset:19456
    v_cvt_pk_bf16_f32 v56, v88, v89
    s_add_u32 s15, s15, s68
    v_mfma_f32_16x16x32_bf16 v[172:175], a[236:239], v[48:51], v[172:175]
    v_exp_f32 v90, v90
    s_mul_i32 s73, s53, 589824
    v_mfma_f32_16x16x32_bf16 v[176:179], a[240:243], v[48:51], v[176:179]
    buffer_load_dwordx4 v1, s[48:51], s79 offen offset:3072 sc1 lds
    v_mfma_f32_16x16x32_bf16 v[180:183], a[244:247], v[48:51], v[180:183]
    s_add_u32 m0, s92, 16384
    v_exp_f32 v91, v91
    s_mul_i32 s68, s55, 294912
    v_mfma_f32_16x16x32_bf16 v[184:187], a[248:251], v[48:51], v[184:187]
    ds_read_b128 a[208:211], v2 offset:20480
    v_cvt_pk_bf16_f32 v57, v90, v91
    s_add_u32 s74, s73, s68
    v_mfma_f32_16x16x32_bf16 v[188:191], a[252:255], v[48:51], v[188:191]
    v_exp_f32 v92, v92
    s_lshl_b32 s68, s52, 10
    v_mfma_f32_16x16x32_bf16 v[32:35], v[4:7], v[48:51], v[32:35]
    buffer_load_dwordx4 v1, s[48:51], s98 offen offset:0 sc1 lds
    s_waitcnt lgkmcnt(5)
    v_mfma_f32_16x16x32_bf16 v[64:67], a[128:131], a[32:35], 0
    v_exp_f32 v93, v93
    s_add_u32 s74, s74, s68
    v_mfma_f32_16x16x32_bf16 v[64:67], a[132:135], a[36:39], v[64:67]
    ds_read_b128 a[212:215], v2 offset:21504
    v_cvt_pk_bf16_f32 v58, v92, v93
    s_lshl_b32 s68, s52, 13
    v_mfma_f32_16x16x32_bf16 v[64:67], a[136:139], a[96:99], v[64:67]
    v_exp_f32 v94, v94
    s_add_u32 s73, s73, s68
    v_mfma_f32_16x16x32_bf16 v[64:67], a[140:143], a[100:103], v[64:67]
    buffer_load_dwordx4 v1, s[48:51], s98 offen offset:1024 sc1 lds
    v_mfma_f32_16x16x32_bf16 v[68:71], a[144:147], a[32:35], 0
    v_exp_f32 v95, v95
    s_lshl_b32 s68, s54, 11
    v_mfma_f32_16x16x32_bf16 v[68:71], a[148:151], a[36:39], v[68:71]
    ds_read_b128 a[216:219], v2 offset:22528
    v_cvt_pk_bf16_f32 v59, v94, v95
    s_add_u32 s73, s73, s68
    v_mfma_f32_16x16x32_bf16 v[68:71], a[152:155], a[96:99], v[68:71]
    buffer_load_dwordx4 v1, s[48:51], s98 offen offset:2048 sc1 lds
    v_mfma_f32_16x16x32_bf16 v[68:71], a[156:159], a[100:103], v[68:71]
    v_mfma_f32_16x16x32_bf16 v[72:75], a[128:131], a[40:43], 0
    s_add_u32 s62, s62, 32768
    v_exp_f32 v64, v64
    v_mfma_f32_16x16x32_bf16 v[72:75], a[132:135], a[44:47], v[72:75]
    buffer_load_dwordx4 v1, s[48:51], s98 offen offset:3072 sc1 lds
    v_mfma_f32_16x16x32_bf16 v[72:75], a[136:139], a[104:107], v[72:75]
    s_cmp_eq_u32 s62, 98304
    v_exp_f32 v65, v65
    v_mfma_f32_16x16x32_bf16 v[72:75], a[140:143], a[108:111], v[72:75]
    ds_read_b128 a[220:223], v2 offset:23552
    v_cvt_pk_bf16_f32 v44, v64, v65
    v_and_b32 v63, 31, v0
    v_mfma_f32_16x16x32_bf16 v[76:79], a[144:147], a[40:43], 0
    s_cselect_b32 s62, 0, s62
    v_exp_f32 v66, v66
    v_lshlrev_b32 v63, 10, v63
    v_mfma_f32_16x16x32_bf16 v[76:79], a[148:151], a[44:47], v[76:79]
    v_add_u32 v2, s62, v3
    v_mfma_f32_16x16x32_bf16 v[76:79], a[152:155], a[104:107], v[76:79]
    s_add_u32 s79, s79, 16384
    buffer_load_dword v62, v63, s[28:31], s14 offen
    v_exp_f32 v67, v67
    v_mfma_f32_16x16x32_bf16 v[76:79], a[156:159], a[108:111], v[76:79]
    v_cvt_pk_bf16_f32 v45, v66, v67
    v_and_b32 v63, 15, v0
    v_mfma_f32_16x16x32_bf16 v[192:195], a[224:227], v[52:55], v[192:195]
    s_sub_u32 s93, s93, 1
    v_exp_f32 v68, v68
    v_mfma_f32_16x16x32_bf16 v[196:199], a[228:231], v[52:55], v[196:199]
    s_cselect_b32 s79, s94, s79
    v_lshlrev_b32 v63, 10, v63
    v_mfma_f32_16x16x32_bf16 v[200:203], a[232:235], v[52:55], v[200:203]
    s_cselect_b32 s93, s75, s93
    buffer_load_dword v62, v63, s[32:35], s15 offen
    v_exp_f32 v69, v69
    v_mfma_f32_16x16x32_bf16 v[204:207], a[236:239], v[52:55], v[204:207]
    v_cvt_pk_bf16_f32 v46, v68, v69
    v_mfma_f32_16x16x32_bf16 v[208:211], a[240:243], v[52:55], v[208:211]
    s_add_u32 s92, s92, 32768
    v_exp_f32 v70, v70
    v_mfma_f32_16x16x32_bf16 v[212:215], a[244:247], v[52:55], v[212:215]
    s_sub_u32 s99, s92, 98304
    v_mfma_f32_16x16x32_bf16 v[216:219], a[248:251], v[52:55], v[216:219]
    s_cmp_ge_i32 s99, 65536
    v_exp_f32 v71, v71
    v_mfma_f32_16x16x32_bf16 v[220:223], a[252:255], v[52:55], v[220:223]
    v_cvt_pk_bf16_f32 v47, v70, v71
    v_mfma_f32_16x16x32_bf16 v[36:39], v[4:7], v[52:55], v[36:39]
    s_cselect_b32 s92, s99, s92
    v_exp_f32 v72, v72
    v_mfma_f32_16x16x32_bf16 v[224:227], a[224:227], v[56:59], v[224:227]
    v_mfma_f32_16x16x32_bf16 v[228:231], a[228:231], v[56:59], v[228:231]
    v_exp_f32 v73, v73
    v_mfma_f32_16x16x32_bf16 v[232:235], a[232:235], v[56:59], v[232:235]
    v_cvt_pk_bf16_f32 v48, v72, v73
    v_mfma_f32_16x16x32_bf16 v[236:239], a[236:239], v[56:59], v[236:239]
    v_exp_f32 v74, v74
    v_mfma_f32_16x16x32_bf16 v[240:243], a[240:243], v[56:59], v[240:243]
    v_mfma_f32_16x16x32_bf16 v[244:247], a[244:247], v[56:59], v[244:247]
    v_exp_f32 v75, v75
    v_mfma_f32_16x16x32_bf16 v[248:251], a[248:251], v[56:59], v[248:251]
    v_cvt_pk_bf16_f32 v49, v74, v75
    v_mfma_f32_16x16x32_bf16 v[252:255], a[252:255], v[56:59], v[252:255]
    v_exp_f32 v76, v76
    v_mfma_f32_16x16x32_bf16 v[40:43], v[4:7], v[56:59], v[40:43]
    s_branch L_t1_mid
L_t1_loop:
    s_waitcnt vmcnt(8) lgkmcnt(0)
    s_barrier
    v_mfma_f32_16x16x32_bf16 v[80:83], a[160:163], a[48:51], 0
    v_exp_f32 v77, v77
    v_mfma_f32_16x16x32_bf16 v[80:83], a[164:167], a[52:55], v[80:83]
    ds_read_b128 a[128:131], v2 offset:0
    v_cvt_pk_bf16_f32 v50, v76, v77
    v_mfma_f32_16x16x32_bf16 v[80:83], a[168:171], a[112:115], v[80:83]
    v_exp_f32 v78, v78
    v_mfma_f32_16x16x32_bf16 v[80:83], a[172:175], a[116:119], v[80:83]
    ds_read_b128 a[132:135], v2 offset:1024
    v_mfma_f32_16x16x32_bf16 v[84:87], a[176:179], a[48:51], 0
    v_exp_f32 v79, v79
    v_mfma_f32_16x16x32_bf16 v[84:87], a[180:183], a[52:55], v[84:87]
    ds_read_b128 a[136:139], v2 offset:2048
    v_cvt_pk_bf16_f32 v51, v78, v79
    v_mfma_f32_16x16x32_bf16 v[84:87], a[184:187], a[112:115], v[84:87]
    ds_read_b128 a[140:143], v2 offset:3072
    v_mfma_f32_16x16x32_bf16 v[84:87], a[188:191], a[116:119], v[84:87]
    ds_read_b128 a[144:147], v2 offset:4096
    v_mfma_f32_16x16x32_bf16 v[88:91], a[160:163], a[56:59], 0
    v_exp_f32 v80, v80
    v_mfma_f32_16x16x32_bf16 v[88:91], a[164:167], a[60:63], v[88:91]
    ds_read_b128 a[148:151], v2 offset:5120
    v_mfma_f32_16x16x32_bf16 v[88:91], a[168:171], a[120:123], v[88:91]
    v_exp_f32 v81, v81
    v_mfma_f32_16x16x32_bf16 v[88:91], a[172:175], a[124:127], v[88:91]
    ds_read_b128 a[152:155], v2 offset:6144
    v_cvt_pk_bf16_f32 v52, v80, v81
    v_mfma_f32_16x16x32_bf16 v[92:95], a[176:179], a[56:59], 0
    v_exp_f32 v82, v82
    v_mfma_f32_16x16x32_bf16 v[92:95], a[180:183], a[60:63], v[92:95]
    ds_read_b128 a[156:159], v2 offset:7168
    v_mfma_f32_16x16x32_bf16 v[92:95], a[184:187], a[120:123], v[92:95]
    s_mov_b32 m0, s92
    v_exp_f32 v83, v83
    v_mfma_f32_16x16x32_bf16 v[92:95], a[188:191], a[124:127], v[92:95]
    ds_read_b128 a[192:195], v2 offset:16384
    v_cvt_pk_bf16_f32 v53, v82, v83
    v_mfma_f32_16x16x32_bf16 v[128:131], a[224:227], v[44:47], v[128:131]
    s_add_u32 s98, s79, 16777216
    v_exp_f32 v84, v84
    v_mfma_f32_16x16x32_bf16 v[132:135], a[228:231], v[44:47], v[132:135]
    buffer_load_dwordx4 v1, s[48:51], s79 offen offset:0 sc1 lds
    v_mfma_f32_16x16x32_bf16 v[136:139], a[232:235], v[44:47], v[136:139]
    v_exp_f32 v85, v85
    v_mfma_f32_16x16x32_bf16 v[140:143], a[236:239], v[44:47], v[140:143]
    ds_read_b128 a[196:199], v2 offset:17408
    v_cvt_pk_bf16_f32 v54, v84, v85
    v_mfma_f32_16x16x32_bf16 v[144:147], a[240:243], v[44:47], v[144:147]
    v_exp_f32 v86, v86
    v_mfma_f32_16x16x32_bf16 v[148:151], a[244:247], v[44:47], v[148:151]
    buffer_load_dwordx4 v1, s[48:51], s79 offen offset:1024 sc1 lds
    v_mfma_f32_16x16x32_bf16 v[152:155], a[248:251], v[44:47], v[152:155]
    v_exp_f32 v87, v87
    v_mfma_f32_16x16x32_bf16 v[156:159], a[252:255], v[44:47], v[156:159]
    ds_read_b128 a[200:203], v2 offset:18432
    v_cvt_pk_bf16_f32 v55, v86, v87
    v_mfma_f32_16x16x32_bf16 v[28:31], v[4:7], v[44:47], v[28:31]
    v_exp_f32 v88, v88
    v_mfma_f32_16x16x32_bf16 v[160:163], a[224:227], v[48:51], v[160:163]
    buffer_load_dwordx4 v1, s[48:51], s79 offen offset:2048 sc1 lds
    v_mfma_f32_16x16x32_bf16 v[164:167], a[228:231], v[48:51], v[164:167]
    v_exp_f32 v89, v89
    v_mfma_f32_16x16x32_bf16 v[168:171], a[232:235], v[48:51], v[168:171]
    ds_read_b128 a[204:207], v2 offset:19456
    v_cvt_pk_bf16_f32 v56, v88, v89
    v_mfma_f32_16x16x32_bf16 v[172:175], a[236:239], v[48:51], v[172:175]
    v_exp_f32 v90, v90
    v_mfma_f32_16x16x32_bf16 v[176:179], a[240:243], v[48:51], v[176:179]
    buffer_load_dwordx4 v1, s[48:51], s79 offen offset:3072 sc1 lds
    v_mfma_f32_16x16x32_bf16 v[180:183], a[244:247], v[48:51], v[180:183]
    s_add_u32 m0, s92, 16384
    v_exp_f32 v91, v91
    v_mfma_f32_16x16x32_bf16 v[184:187], a[248:251], v[48:51], v[184:187]
    ds_read_b128 a[208:211], v2 offset:20480
    v_cvt_pk_bf16_f32 v57, v90, v91
    v_mfma_f32_16x16x32_bf16 v[188:191], a[252:255], v[48:51], v[188:191]
    v_exp_f32 v92, v92
    v_mfma_f32_16x16x32_bf16 v[32:35], v[4:7], v[48:51], v[32:35]
    buffer_load_dwordx4 v1, s[48:51], s98 offen offset:0 sc1 lds
    s_waitcnt lgkmcnt(5)
    v_mfma_f32_16x16x32_bf16 v[64:67], a[128:131], a[32:35], 0
    v_exp_f32 v93, v93
    v_mfma_f32_16x16x32_bf16 v[64:67], a[132:135], a[36:39], v[64:67]
    ds_read_b128 a[212:215], v2 offset:21504
    v_cvt_pk_bf16_f32 v58, v92, v93
    v_mfma_f32_16x16x32_bf16 v[64:67], a[136:139], a[96:99], v[64:67]
    v_exp_f32 v94, v94
    v_mfma_f32_16x16x32_bf16 v[64:67], a[140:143], a[100:103], v[64:67]
    buffer_load_dwordx4 v1, s[48:51], s98 offen offset:1024 sc1 lds
    v_mfma_f32_16x16x32_bf16 v[68:71], a[144:147], a[32:35], 0
    v_exp_f32 v95, v95
    v_mfma_f32_16x16x32_bf16 v[68:71], a[148:151], a[36:39], v[68:71]
    ds_read_b128 a[216:219], v2 offset:22528
    v_cvt_pk_bf16_f32 v59, v94, v95
    v_mfma_f32_16x16x32_bf16 v[68:71], a[152:155], a[96:99], v[68:71]
    buffer_load_dwordx4 v1, s[48:51], s98 offen offset:2048 sc1 lds
    v_mfma_f32_16x16x32_bf16 v[68:71], a[156:159], a[100:103], v[68:71]
    v_mfma_f32_16x16x32_bf16 v[72:75], a[128:131], a[40:43], 0
    s_add_u32 s62, s62, 32768
    v_exp_f32 v64, v64
    v_mfma_f32_16x16x32_bf16 v[72:75], a[132:135], a[44:47], v[72:75]
    buffer_load_dwordx4 v1, s[48:51], s98 offen offset:3072 sc1 lds
    v_mfma_f32_16x16x32_bf16 v[72:75], a[136:139], a[104:107], v[72:75]
    s_cmp_eq_u32 s62, 98304
    v_exp_f32 v65, v65
    v_mfma_f32_16x16x32_bf16 v[72:75], a[140:143], a[108:111], v[72:75]
    ds_read_b128 a[220:223], v2 offset:23552
    v_cvt_pk_bf16_f32 v44, v64, v65
    v_mfma_f32_16x16x32_bf16 v[76:79], a[144:147], a[40:43], 0
    s_cselect_b32 s62, 0, s62
    v_exp_f32 v66, v66
    v_mfma_f32_16x16x32_bf16 v[76:79], a[148:151], a[44:47], v[76:79]
    v_add_u32 v2, s62, v3
    v_mfma_f32_16x16x32_bf16 v[76:79], a[152:155], a[104:107], v[76:79]
    s_add_u32 s79, s79, 16384
    v_exp_f32 v67, v67
    v_mfma_f32_16x16x32_bf16 v[76:79], a[156:159], a[108:111], v[76:79]
    v_cvt_pk_bf16_f32 v45, v66, v67
    v_mfma_f32_16x16x32_bf16 v[192:195], a[224:227], v[52:55], v[192:195]
    s_sub_u32 s93, s93, 1
    v_exp_f32 v68, v68
    v_mfma_f32_16x16x32_bf16 v[196:199], a[228:231], v[52:55], v[196:199]
    s_cselect_b32 s79, s94, s79
    v_mfma_f32_16x16x32_bf16 v[200:203], a[232:235], v[52:55], v[200:203]
    s_cselect_b32 s93, s75, s93
    v_exp_f32 v69, v69
    v_mfma_f32_16x16x32_bf16 v[204:207], a[236:239], v[52:55], v[204:207]
    v_cvt_pk_bf16_f32 v46, v68, v69
    v_mfma_f32_16x16x32_bf16 v[208:211], a[240:243], v[52:55], v[208:211]
    s_add_u32 s92, s92, 32768
    v_exp_f32 v70, v70
    v_mfma_f32_16x16x32_bf16 v[212:215], a[244:247], v[52:55], v[212:215]
    s_sub_u32 s99, s92, 98304
    v_mfma_f32_16x16x32_bf16 v[216:219], a[248:251], v[52:55], v[216:219]
    s_cmp_ge_i32 s99, 65536
    v_exp_f32 v71, v71
    v_mfma_f32_16x16x32_bf16 v[220:223], a[252:255], v[52:55], v[220:223]
    v_cvt_pk_bf16_f32 v47, v70, v71
    v_mfma_f32_16x16x32_bf16 v[36:39], v[4:7], v[52:55], v[36:39]
    s_cselect_b32 s92, s99, s92
    v_exp_f32 v72, v72
    v_mfma_f32_16x16x32_bf16 v[224:227], a[224:227], v[56:59], v[224:227]
    v_mfma_f32_16x16x32_bf16 v[228:231], a[228:231], v[56:59], v[228:231]
    v_exp_f32 v73, v73
    v_mfma_f32_16x16x32_bf16 v[232:235], a[232:235], v[56:59], v[232:235]
    v_cvt_pk_bf16_f32 v48, v72, v73
    v_mfma_f32_16x16x32_bf16 v[236:239], a[236:239], v[56:59], v[236:239]
    v_exp_f32 v74, v74
    v_mfma_f32_16x16x32_bf16 v[240:243], a[240:243], v[56:59], v[240:243]
    v_mfma_f32_16x16x32_bf16 v[244:247], a[244:247], v[56:59], v[244:247]
    v_exp_f32 v75, v75
    v_mfma_f32_16x16x32_bf16 v[248:251], a[248:251], v[56:59], v[248:251]
    v_cvt_pk_bf16_f32 v49, v74, v75
    v_mfma_f32_16x16x32_bf16 v[252:255], a[252:255], v[56:59], v[252:255]
    v_exp_f32 v76, v76
    v_mfma_f32_16x16x32_bf16 v[40:43], v[4:7], v[56:59], v[40:43]
L_t1_mid:
    s_waitcnt vmcnt(8) lgkmcnt(0)
    s_barrier
    v_mfma_f32_16x16x32_bf16 v[80:83], a[128:131], a[48:51], 0
    v_exp_f32 v77, v77
    v_mfma_f32_16x16x32_bf16 v[80:83], a[132:135], a[52:55], v[80:83]
    ds_read_b128 a[160:163], v2 offset:0
    v_cvt_pk_bf16_f32 v50, v76, v77
    v_mfma_f32_16x16x32_bf16 v[80:83], a[136:139], a[112:115], v[80:83]
    buffer_load_dword v9, v8, s[48:51], s90 offen sc1
    v_exp_f32 v78, v78
    v_mfma_f32_16x16x32_bf16 v[80:83], a[140:143], a[116:119], v[80:83]
    ds_read_b128 a[164:167], v2 offset:1024
    v_mfma_f32_16x16x32_bf16 v[84:87], a[144:147], a[48:51], 0
    v_exp_f32 v79, v79
    v_mfma_f32_16x16x32_bf16 v[84:87], a[148:151], a[52:55], v[84:87]
    ds_read_b128 a[168:171], v2 offset:2048
    v_cvt_pk_bf16_f32 v51, v78, v79
    v_mfma_f32_16x16x32_bf16 v[84:87], a[152:155], a[112:115], v[84:87]
    ds_read_b128 a[172:175], v2 offset:3072
    v_mfma_f32_16x16x32_bf16 v[84:87], a[156:159], a[116:119], v[84:87]
    ds_read_b128 a[176:179], v2 offset:4096
    v_mfma_f32_16x16x32_bf16 v[88:91], a[128:131], a[56:59], 0
    v_exp_f32 v80, v80
    v_mfma_f32_16x16x32_bf16 v[88:91], a[132:135], a[60:63], v[88:91]
    ds_read_b128 a[180:183], v2 offset:5120
    v_mfma_f32_16x16x32_bf16 v[88:91], a[136:139], a[120:123], v[88:91]
    v_exp_f32 v81, v81
    v_mfma_f32_16x16x32_bf16 v[88:91], a[140:143], a[124:127], v[88:91]
    ds_read_b128 a[184:187], v2 offset:6144
    v_cvt_pk_bf16_f32 v52, v80, v81
    v_mfma_f32_16x16x32_bf16 v[92:95], a[144:147], a[56:59], 0
    v_exp_f32 v82, v82
    v_mfma_f32_16x16x32_bf16 v[92:95], a[148:151], a[60:63], v[92:95]
    ds_read_b128 a[188:191], v2 offset:7168
    v_mfma_f32_16x16x32_bf16 v[92:95], a[152:155], a[120:123], v[92:95]
    s_mov_b32 m0, s92
    v_exp_f32 v83, v83
    v_mfma_f32_16x16x32_bf16 v[92:95], a[156:159], a[124:127], v[92:95]
    ds_read_b128 a[224:227], v2 offset:16384
    v_cvt_pk_bf16_f32 v53, v82, v83
    v_mfma_f32_16x16x32_bf16 v[128:131], a[192:195], v[44:47], v[128:131]
    s_add_u32 s98, s79, 16777216
    v_exp_f32 v84, v84
    v_mfma_f32_16x16x32_bf16 v[132:135], a[196:199], v[44:47], v[132:135]
    buffer_load_dwordx4 v1, s[48:51], s79 offen offset:0 sc1 lds
    v_mfma_f32_16x16x32_bf16 v[136:139], a[200:203], v[44:47], v[136:139]
    v_exp_f32 v85, v85
    v_mfma_f32_16x16x32_bf16 v[140:143], a[204:207], v[44:47], v[140:143]
    ds_read_b128 a[228:231], v2 offset:17408
    v_cvt_pk_bf16_f32 v54, v84, v85
    v_mfma_f32_16x16x32_bf16 v[144:147], a[208:211], v[44:47], v[144:147]
    v_exp_f32 v86, v86
    v_mfma_f32_16x16x32_bf16 v[148:151], a[212:215], v[44:47], v[148:151]
    buffer_load_dwordx4 v1, s[48:51], s79 offen offset:1024 sc1 lds
    v_mfma_f32_16x16x32_bf16 v[152:155], a[216:219], v[44:47], v[152:155]
    v_exp_f32 v87, v87
    v_mfma_f32_16x16x32_bf16 v[156:159], a[220:223], v[44:47], v[156:159]
    ds_read_b128 a[232:235], v2 offset:18432
    v_cvt_pk_bf16_f32 v55, v86, v87
    v_mfma_f32_16x16x32_bf16 v[28:31], v[4:7], v[44:47], v[28:31]
    v_exp_f32 v88, v88
    v_mfma_f32_16x16x32_bf16 v[160:163], a[192:195], v[48:51], v[160:163]
    buffer_load_dwordx4 v1, s[48:51], s79 offen offset:2048 sc1 lds
    v_mfma_f32_16x16x32_bf16 v[164:167], a[196:199], v[48:51], v[164:167]
    v_exp_f32 v89, v89
    v_mfma_f32_16x16x32_bf16 v[168:171], a[200:203], v[48:51], v[168:171]
    ds_read_b128 a[236:239], v2 offset:19456
    v_cvt_pk_bf16_f32 v56, v88, v89
    v_mfma_f32_16x16x32_bf16 v[172:175], a[204:207], v[48:51], v[172:175]
    v_exp_f32 v90, v90
    v_mfma_f32_16x16x32_bf16 v[176:179], a[208:211], v[48:51], v[176:179]
    buffer_load_dwordx4 v1, s[48:51], s79 offen offset:3072 sc1 lds
    v_mfma_f32_16x16x32_bf16 v[180:183], a[212:215], v[48:51], v[180:183]
    s_add_u32 m0, s92, 16384
    v_exp_f32 v91, v91
    v_mfma_f32_16x16x32_bf16 v[184:187], a[216:219], v[48:51], v[184:187]
    ds_read_b128 a[240:243], v2 offset:20480
    v_cvt_pk_bf16_f32 v57, v90, v91
    v_mfma_f32_16x16x32_bf16 v[188:191], a[220:223], v[48:51], v[188:191]
    v_exp_f32 v92, v92
    v_mfma_f32_16x16x32_bf16 v[32:35], v[4:7], v[48:51], v[32:35]
    buffer_load_dwordx4 v1, s[48:51], s98 offen offset:0 sc1 lds
    s_waitcnt lgkmcnt(5)
    v_mfma_f32_16x16x32_bf16 v[64:67], a[160:163], a[32:35], 0
    v_exp_f32 v93, v93
    v_mfma_f32_16x16x32_bf16 v[64:67], a[164:167], a[36:39], v[64:67]
    ds_read_b128 a[244:247], v2 offset:21504
    v_cvt_pk_bf16_f32 v58, v92, v93
    v_mfma_f32_16x16x32_bf16 v[64:67], a[168:171], a[96:99], v[64:67]
    v_exp_f32 v94, v94
    v_mfma_f32_16x16x32_bf16 v[64:67], a[172:175], a[100:103], v[64:67]
    buffer_load_dwordx4 v1, s[48:51], s98 offen offset:1024 sc1 lds
    v_mfma_f32_16x16x32_bf16 v[68:71], a[176:179], a[32:35], 0
    v_exp_f32 v95, v95
    v_mfma_f32_16x16x32_bf16 v[68:71], a[180:183], a[36:39], v[68:71]
    ds_read_b128 a[248:251], v2 offset:22528
    v_cvt_pk_bf16_f32 v59, v94, v95
    v_mfma_f32_16x16x32_bf16 v[68:71], a[184:187], a[96:99], v[68:71]
    buffer_load_dwordx4 v1, s[48:51], s98 offen offset:2048 sc1 lds
    v_mfma_f32_16x16x32_bf16 v[68:71], a[188:191], a[100:103], v[68:71]
    v_mfma_f32_16x16x32_bf16 v[72:75], a[160:163], a[40:43], 0
    s_add_u32 s62, s62, 32768
    v_exp_f32 v64, v64
    v_mfma_f32_16x16x32_bf16 v[72:75], a[164:167], a[44:47], v[72:75]
    buffer_load_dwordx4 v1, s[48:51], s98 offen offset:3072 sc1 lds
    v_mfma_f32_16x16x32_bf16 v[72:75], a[168:171], a[104:107], v[72:75]
    s_cmp_eq_u32 s62, 98304
    v_exp_f32 v65, v65
    v_mfma_f32_16x16x32_bf16 v[72:75], a[172:175], a[108:111], v[72:75]
    ds_read_b128 a[252:255], v2 offset:23552
    v_cvt_pk_bf16_f32 v44, v64, v65
    v_mfma_f32_16x16x32_bf16 v[76:79], a[176:179], a[40:43], 0
    s_cselect_b32 s62, 0, s62
    v_exp_f32 v66, v66
    v_mfma_f32_16x16x32_bf16 v[76:79], a[180:183], a[44:47], v[76:79]
    v_add_u32 v2, s62, v3
    v_mfma_f32_16x16x32_bf16 v[76:79], a[184:187], a[104:107], v[76:79]
    s_add_u32 s79, s79, 16384
    v_exp_f32 v67, v67
    v_mfma_f32_16x16x32_bf16 v[76:79], a[188:191], a[108:111], v[76:79]
    v_cvt_pk_bf16_f32 v45, v66, v67
    v_mfma_f32_16x16x32_bf16 v[192:195], a[192:195], v[52:55], v[192:195]
    s_sub_u32 s93, s93, 1
    v_exp_f32 v68, v68
    v_mfma_f32_16x16x32_bf16 v[196:199], a[196:199], v[52:55], v[196:199]
    s_cselect_b32 s79, s94, s79
    v_mfma_f32_16x16x32_bf16 v[200:203], a[200:203], v[52:55], v[200:203]
    s_cselect_b32 s93, s75, s93
    v_exp_f32 v69, v69
    v_mfma_f32_16x16x32_bf16 v[204:207], a[204:207], v[52:55], v[204:207]
    v_cvt_pk_bf16_f32 v46, v68, v69
    v_mfma_f32_16x16x32_bf16 v[208:211], a[208:211], v[52:55], v[208:211]
    s_add_u32 s92, s92, 32768
    v_exp_f32 v70, v70
    v_mfma_f32_16x16x32_bf16 v[212:215], a[212:215], v[52:55], v[212:215]
    s_sub_u32 s99, s92, 98304
    v_mfma_f32_16x16x32_bf16 v[216:219], a[216:219], v[52:55], v[216:219]
    s_cmp_ge_i32 s99, 65536
    v_exp_f32 v71, v71
    v_mfma_f32_16x16x32_bf16 v[220:223], a[220:223], v[52:55], v[220:223]
    v_cvt_pk_bf16_f32 v47, v70, v71
    v_mfma_f32_16x16x32_bf16 v[36:39], v[4:7], v[52:55], v[36:39]
    s_cselect_b32 s92, s99, s92
    v_exp_f32 v72, v72
    v_mfma_f32_16x16x32_bf16 v[224:227], a[192:195], v[56:59], v[224:227]
    s_sub_u32 s63, s63, 1
    v_mfma_f32_16x16x32_bf16 v[228:231], a[196:199], v[56:59], v[228:231]
    s_cmp_lg_u32 s63, 0
    v_exp_f32 v73, v73
    v_mfma_f32_16x16x32_bf16 v[232:235], a[200:203], v[56:59], v[232:235]
    v_cvt_pk_bf16_f32 v48, v72, v73
    v_mfma_f32_16x16x32_bf16 v[236:239], a[204:207], v[56:59], v[236:239]
    v_exp_f32 v74, v74
    v_mfma_f32_16x16x32_bf16 v[240:243], a[208:211], v[56:59], v[240:243]
    v_mfma_f32_16x16x32_bf16 v[244:247], a[212:215], v[56:59], v[244:247]
    v_exp_f32 v75, v75
    v_mfma_f32_16x16x32_bf16 v[248:251], a[216:219], v[56:59], v[248:251]
    v_cvt_pk_bf16_f32 v49, v74, v75
    v_mfma_f32_16x16x32_bf16 v[252:255], a[220:223], v[56:59], v[252:255]
    v_exp_f32 v76, v76
    v_mfma_f32_16x16x32_bf16 v[40:43], v[4:7], v[56:59], v[40:43]
    s_cbranch_scc1 L_t1_loop
    s_waitcnt vmcnt(8) lgkmcnt(0)
    s_cmp_lg_u32 s54, 0
    s_cbranch_scc1 L_poll4_done
    s_mov_b32 s78, 0x20000
L_poll4:
    v_cmp_eq_u32 vcc, s12, v9
    s_sub_u32 s78, s78, 1
    s_cbranch_scc1 L_poll4_done
    s_cmp_eq_u32 vcc_lo, 0xff
    s_cbranch_scc1 L_poll4_done
    buffer_load_dword v9, v8, s[48:51], s90 offen sc1
    s_waitcnt vmcnt(0)
    s_branch L_poll4
L_poll4_done:
    s_barrier
    v_mfma_f32_16x16x32_bf16 v[80:83], a[160:163], a[48:51], 0
    v_exp_f32 v77, v77
    v_lshrrev_b32 v63, 3, v0
    v_mfma_f32_16x16x32_bf16 v[80:83], a[164:167], a[52:55], v[80:83]
    ds_read_b128 a[128:131], v2 offset:0
    v_cvt_pk_bf16_f32 v50, v76, v77
    v_and_b32 v62, 7, v0
    v_mfma_f32_16x16x32_bf16 v[80:83], a[168:171], a[112:115], v[80:83]
    v_exp_f32 v78, v78
    v_lshlrev_b32 v62, 4, v62
    v_mfma_f32_16x16x32_bf16 v[80:83], a[172:175], a[116:119], v[80:83]
    ds_read_b128 a[132:135], v2 offset:1024
    v_lshl_add_u32 v63, v63, 10, v62
    v_mfma_f32_16x16x32_bf16 v[84:87], a[176:179], a[48:51], 0
    v_exp_f32 v79, v79
    s_lshl_b32 s68, s54, 13
    v_mfma_f32_16x16x32_bf16 v[84:87], a[180:183], a[52:55], v[84:87]
    ds_read_b128 a[136:139], v2 offset:2048
    v_cvt_pk_bf16_f32 v51, v78, v79
    s_add_u32 m0, s68, 32768
    v_mfma_f32_16x16x32_bf16 v[84:87], a[184:187], a[112:115], v[84:87]
    ds_read_b128 a[140:143], v2 offset:3072
    s_add_u32 s69, s14, 0
    v_mfma_f32_16x16x32_bf16 v[84:87], a[188:191], a[116:119], v[84:87]
    ds_read_b128 a[144:147], v2 offset:4096
    buffer_load_dwordx4 v63, s[28:31], s69 offen lds
    v_mfma_f32_16x16x32_bf16 v[88:91], a[160:163], a[56:59], 0
    v_exp_f32 v80, v80
    s_add_u32 m0, s68, 33792
    v_mfma_f32_16x16x32_bf16 v[88:91], a[164:167], a[60:63], v[88:91]
    ds_read_b128 a[148:151], v2 offset:5120
    s_add_u32 s69, s14, 8192
    v_mfma_f32_16x16x32_bf16 v[88:91], a[168:171], a[120:123], v[88:91]
    buffer_load_dwordx4 v63, s[28:31], s69 offen lds
    v_exp_f32 v81, v81
    v_mfma_f32_16x16x32_bf16 v[88:91], a[172:175], a[124:127], v[88:91]
    ds_read_b128 a[152:155], v2 offset:6144
    v_cvt_pk_bf16_f32 v52, v80, v81
    s_add_u32 m0, s68, 34816
    v_mfma_f32_16x16x32_bf16 v[92:95], a[176:179], a[56:59], 0
    v_exp_f32 v82, v82
    v_mfma_f32_16x16x32_bf16 v[92:95], a[180:183], a[60:63], v[92:95]
    ds_read_b128 a[156:159], v2 offset:7168
    s_add_u32 s69, s14, 16384
    v_mfma_f32_16x16x32_bf16 v[92:95], a[184:187], a[120:123], v[92:95]
    buffer_load_dwordx4 v63, s[28:31], s69 offen lds
    v_exp_f32 v83, v83
    v_mfma_f32_16x16x32_bf16 v[92:95], a[188:191], a[124:127], v[92:95]
    ds_read_b128 a[192:195], v2 offset:16384
    v_cvt_pk_bf16_f32 v53, v82, v83
    s_add_u32 m0, s68, 35840
    v_mfma_f32_16x16x32_bf16 v[128:131], a[224:227], v[44:47], v[128:131]
    v_exp_f32 v84, v84
    s_add_u32 s69, s14, 24576
    v_mfma_f32_16x16x32_bf16 v[132:135], a[228:231], v[44:47], v[132:135]
    buffer_load_dwordx4 v63, s[28:31], s69 offen lds
    v_mfma_f32_16x16x32_bf16 v[136:139], a[232:235], v[44:47], v[136:139]
    v_exp_f32 v85, v85
    s_add_u32 m0, s68, 36864
    v_mfma_f32_16x16x32_bf16 v[140:143], a[236:239], v[44:47], v[140:143]
    ds_read_b128 a[196:199], v2 offset:17408
    v_cvt_pk_bf16_f32 v54, v84, v85
    s_add_u32 s69, s15, 0
    v_mfma_f32_16x16x32_bf16 v[144:147], a[240:243], v[44:47], v[144:147]
    buffer_load_dwordx4 v63, s[32:35], s69 offen lds
    v_exp_f32 v86, v86
    v_mfma_f32_16x16x32_bf16 v[148:151], a[244:247], v[44:47], v[148:151]
    s_add_u32 m0, s68, 37888
    v_mfma_f32_16x16x32_bf16 v[152:155], a[248:251], v[44:47], v[152:155]
    v_exp_f32 v87, v87
    s_add_u32 s69, s15, 8192
    v_mfma_f32_16x16x32_bf16 v[156:159], a[252:255], v[44:47], v[156:159]
    ds_read_b128 a[200:203], v2 offset:18432
    buffer_load_dwordx4 v63, s[32:35], s69 offen lds
    v_cvt_pk_bf16_f32 v55, v86, v87
    v_mfma_f32_16x16x32_bf16 v[28:31], v[4:7], v[44:47], v[28:31]
    v_exp_f32 v88, v88
    v_mfma_f32_16x16x32_bf16 v[160:163], a[224:227], v[48:51], v[160:163]
    v_mfma_f32_16x16x32_bf16 v[164:167], a[228:231], v[48:51], v[164:167]
    s_add_u32 m0, s71, 98304
    v_exp_f32 v89, v89
    v_mfma_f32_16x16x32_bf16 v[168:171], a[232:235], v[48:51], v[168:171]
    ds_read_b128 a[204:207], v2 offset:19456
    v_cvt_pk_bf16_f32 v56, v88, v89
    v_mfma_f32_16x16x32_bf16 v[172:175], a[236:239], v[48:51], v[172:175]
    s_add_u32 s70, s72, 0
    v_exp_f32 v90, v90
    v_mfma_f32_16x16x32_bf16 v[176:179], a[240:243], v[48:51], v[176:179]
    buffer_load_dwordx4 v1, s[4:7], s70 offen offset:0 sc1 lds
    v_mfma_f32_16x16x32_bf16 v[180:183], a[244:247], v[48:51], v[180:183]
    v_exp_f32 v91, v91
    v_mfma_f32_16x16x32_bf16 v[184:187], a[248:251], v[48:51], v[184:187]
    ds_read_b128 a[208:211], v2 offset:20480
    v_cvt_pk_bf16_f32 v57, v90, v91
    v_mfma_f32_16x16x32_bf16 v[188:191], a[252:255], v[48:51], v[188:191]
    buffer_load_dwordx4 v1, s[4:7], s70 offen offset:1024 sc1 lds
    v_exp_f32 v92, v92
    v_mfma_f32_16x16x32_bf16 v[32:35], v[4:7], v[48:51], v[32:35]
    s_waitcnt lgkmcnt(5)
    v_mfma_f32_16x16x32_bf16 v[64:67], a[128:131], a[32:35], v[96:99]
    v_exp_f32 v93, v93
    v_mfma_f32_16x16x32_bf16 v[64:67], a[132:135], a[36:39], v[64:67]
    ds_read_b128 a[212:215], v2 offset:21504
    buffer_load_dwordx4 v1, s[4:7], s70 offen offset:2048 sc1 lds
    v_cvt_pk_bf16_f32 v58, v92, v93
    v_mfma_f32_16x16x32_bf16 v[64:67], a[136:139], a[96:99], v[64:67]
    v_exp_f32 v94, v94
    v_mfma_f32_16x16x32_bf16 v[64:67], a[140:143], a[100:103], v[64:67]
    v_mfma_f32_16x16x32_bf16 v[68:71], a[144:147], a[32:35], v[100:103]
    buffer_load_dwordx4 v1, s[4:7], s70 offen offset:3072 sc1 lds
    v_exp_f32 v95, v95
    v_mfma_f32_16x16x32_bf16 v[68:71], a[148:151], a[36:39], v[68:71]
    ds_read_b128 a[216:219], v2 offset:22528
    s_add_u32 m0, s71, 102400
    v_cvt_pk_bf16_f32 v59, v94, v95
    v_mfma_f32_16x16x32_bf16 v[68:71], a[152:155], a[96:99], v[68:71]
    v_mfma_f32_16x16x32_bf16 v[68:71], a[156:159], a[100:103], v[68:71]
    s_add_u32 s70, s72, 4096
    v_mfma_f32_16x16x32_bf16 v[72:75], a[128:131], a[40:43], v[104:107]
    s_add_u32 s62, s62, 32768
    buffer_load_dwordx4 v1, s[4:7], s70 offen offset:0 sc1 lds
    v_exp_f32 v64, v64
    v_mfma_f32_16x16x32_bf16 v[72:75], a[132:135], a[44:47], v[72:75]
    v_mfma_f32_16x16x32_bf16 v[72:75], a[136:139], a[104:107], v[72:75]
    s_cmp_eq_u32 s62, 98304
    v_exp_f32 v65, v65
    v_mfma_f32_16x16x32_bf16 v[72:75], a[140:143], a[108:111], v[72:75]
    ds_read_b128 a[220:223], v2 offset:23552
    buffer_load_dwordx4 v1, s[4:7], s70 offen offset:1024 sc1 lds
    v_cvt_pk_bf16_f32 v44, v64, v65
    v_mfma_f32_16x16x32_bf16 v[76:79], a[144:147], a[40:43], v[108:111]
    s_cselect_b32 s62, 0, s62
    v_exp_f32 v66, v66
    v_mfma_f32_16x16x32_bf16 v[76:79], a[148:151], a[44:47], v[76:79]
    v_add_u32 v2, s62, v3
    v_mfma_f32_16x16x32_bf16 v[76:79], a[152:155], a[104:107], v[76:79]
    s_mul_i32 s71, s54, 6144
    buffer_load_dwordx4 v1, s[4:7], s70 offen offset:2048 sc1 lds
    v_exp_f32 v67, v67
    v_mfma_f32_16x16x32_bf16 v[76:79], a[156:159], a[108:111], v[76:79]
    v_cvt_pk_bf16_f32 v45, v66, v67
    v_mfma_f32_16x16x32_bf16 v[192:195], a[224:227], v[52:55], v[192:195]
    s_add_u32 s72, s91, s71
    v_exp_f32 v68, v68
    v_mfma_f32_16x16x32_bf16 v[196:199], a[228:231], v[52:55], v[196:199]
    buffer_load_dwordx4 v1, s[4:7], s70 offen offset:3072 sc1 lds
    v_mfma_f32_16x16x32_bf16 v[200:203], a[232:235], v[52:55], v[200:203]
    v_exp_f32 v69, v69
    v_lshrrev_b32 v62, 5, v0
    v_mfma_f32_16x16x32_bf16 v[204:207], a[236:239], v[52:55], v[204:207]
    v_cvt_pk_bf16_f32 v46, v68, v69
    v_bfe_u32 v63, v0, 2, 2
    v_mfma_f32_16x16x32_bf16 v[208:211], a[240:243], v[52:55], v[208:211]
    v_exp_f32 v70, v70
    v_lshl_add_u32 v62, v62, 2, v63
    v_mfma_f32_16x16x32_bf16 v[212:215], a[244:247], v[52:55], v[212:215]
    v_lshlrev_b32 v62, 7, v62
    v_mfma_f32_16x16x32_bf16 v[216:219], a[248:251], v[52:55], v[216:219]
    v_exp_f32 v71, v71
    v_bfe_u32 v63, v0, 4, 1
    v_mfma_f32_16x16x32_bf16 v[220:223], a[252:255], v[52:55], v[220:223]
    v_cvt_pk_bf16_f32 v47, v70, v71
    v_lshl_add_u32 v62, v63, 5, v62
    v_mfma_f32_16x16x32_bf16 v[36:39], v[4:7], v[52:55], v[36:39]
    v_exp_f32 v72, v72
    v_mfma_f32_16x16x32_bf16 v[224:227], a[224:227], v[56:59], v[224:227]
    v_and_b32 v63, 3, v0
    v_mfma_f32_16x16x32_bf16 v[228:231], a[228:231], v[56:59], v[228:231]
    v_exp_f32 v73, v73
    v_lshl_add_u32 v62, v63, 3, v62
    v_mfma_f32_16x16x32_bf16 v[232:235], a[232:235], v[56:59], v[232:235]
    v_cvt_pk_bf16_f32 v48, v72, v73
    v_add_u32 v62, s68, v62
    v_mfma_f32_16x16x32_bf16 v[236:239], a[236:239], v[56:59], v[236:239]
    v_exp_f32 v74, v74
    s_lshl_b32 s68, s55, 6
    v_mfma_f32_16x16x32_bf16 v[240:243], a[240:243], v[56:59], v[240:243]
    v_add_u32 v63, s68, v62
    v_mfma_f32_16x16x32_bf16 v[244:247], a[244:247], v[56:59], v[244:247]
    v_exp_f32 v75, v75
    v_mfma_f32_16x16x32_bf16 v[248:251], a[248:251], v[56:59], v[248:251]
    v_cvt_pk_bf16_f32 v49, v74, v75
    v_mfma_f32_16x16x32_bf16 v[252:255], a[252:255], v[56:59], v[252:255]
    v_exp_f32 v76, v76
    v_mfma_f32_16x16x32_bf16 v[40:43], v[4:7], v[56:59], v[40:43]
    s_waitcnt vmcnt(14) lgkmcnt(0)
    s_barrier
    v_mfma_f32_16x16x32_bf16 v[80:83], a[128:131], a[48:51], 0
    v_exp_f32 v77, v77
    v_mfma_f32_16x16x32_bf16 v[80:83], a[132:135], a[52:55], v[80:83]
    ds_read_b128 a[160:163], v2 offset:0
    v_cvt_pk_bf16_f32 v50, v76, v77
    s_waitcnt vmcnt(8)
    v_mfma_f32_16x16x32_bf16 v[80:83], a[136:139], a[112:115], v[80:83]
    ds_read_b64_tr_b16 a[0:1], v62 offset:32768
    v_exp_f32 v78, v78
    v_mfma_f32_16x16x32_bf16 v[80:83], a[140:143], a[116:119], v[80:83]
    ds_read_b128 a[164:167], v2 offset:1024
    v_mfma_f32_16x16x32_bf16 v[84:87], a[144:147], a[48:51], 0
    ds_read_b64_tr_b16 a[2:3], v62 offset:34816
    v_exp_f32 v79, v79
    v_mfma_f32_16x16x32_bf16 v[84:87], a[148:151], a[52:55], v[84:87]
    ds_read_b128 a[168:171], v2 offset:2048
    v_cvt_pk_bf16_f32 v51, v78, v79
    v_mfma_f32_16x16x32_bf16 v[84:87], a[152:155], a[112:115], v[84:87]
    ds_read_b128 a[172:175], v2 offset:3072
    v_mfma_f32_16x16x32_bf16 v[84:87], a[156:159], a[116:119], v[84:87]
    ds_read_b128 a[176:179], v2 offset:4096
    v_mfma_f32_16x16x32_bf16 v[88:91], a[128:131], a[56:59], 0
    ds_read_b64_tr_b16 a[4:5], v62 offset:32832
    v_exp_f32 v80, v80
    v_mfma_f32_16x16x32_bf16 v[88:91], a[132:135], a[60:63], v[88:91]
    ds_read_b128 a[180:183], v2 offset:5120
    v_mfma_f32_16x16x32_bf16 v[88:91], a[136:139], a[120:123], v[88:91]
    ds_read_b64_tr_b16 a[6:7], v62 offset:34880
    v_exp_f32 v81, v81
    v_mfma_f32_16x16x32_bf16 v[88:91], a[140:143], a[124:127], v[88:91]
    ds_read_b128 a[184:187], v2 offset:6144
    v_cvt_pk_bf16_f32 v52, v80, v81
    v_mfma_f32_16x16x32_bf16 v[92:95], a[144:147], a[56:59], 0
    ds_read_b64_tr_b16 a[16:17], v62 offset:33792
    v_exp_f32 v82, v82
    v_mfma_f32_16x16x32_bf16 v[92:95], a[148:151], a[60:63], v[92:95]
    ds_read_b128 a[188:191], v2 offset:7168
    v_mfma_f32_16x16x32_bf16 v[92:95], a[152:155], a[120:123], v[92:95]
    s_add_u32 m0, s71, 131072
    v_exp_f32 v83, v83
    v_mfma_f32_16x16x32_bf16 v[92:95], a[156:159], a[124:127], v[92:95]
    ds_read_b128 a[224:227], v2 offset:16384
    v_cvt_pk_bf16_f32 v53, v82, v83
    v_mfma_f32_16x16x32_bf16 v[128:131], a[192:195], v[44:47], v[128:131]
    s_add_u32 s70, s72, 32768
    v_exp_f32 v84, v84
    v_mfma_f32_16x16x32_bf16 v[132:135], a[196:199], v[44:47], v[132:135]
    buffer_load_dwordx4 v1, s[4:7], s70 offen offset:0 sc1 lds
    v_mfma_f32_16x16x32_bf16 v[136:139], a[200:203], v[44:47], v[136:139]
    ds_read_b64_tr_b16 a[18:19], v62 offset:35840
    v_exp_f32 v85, v85
    s_lshl_b32 s67, s54, 13
    v_mfma_f32_16x16x32_bf16 v[140:143], a[204:207], v[44:47], v[140:143]
    ds_read_b128 a[228:231], v2 offset:17408
    v_cvt_pk_bf16_f32 v54, v84, v85
    v_add_u32 v10, s67, v1
    v_mfma_f32_16x16x32_bf16 v[144:147], a[208:211], v[44:47], v[144:147]
    ds_read_b64_tr_b16 a[20:21], v62 offset:33856
    v_exp_f32 v86, v86
    v_xor_b32 v11, 0x4000, v10
    v_mfma_f32_16x16x32_bf16 v[148:151], a[212:215], v[44:47], v[148:151]
    buffer_load_dwordx4 v1, s[4:7], s70 offen offset:1024 sc1 lds
    v_add_u32 v19, 4096, v60
    v_mfma_f32_16x16x32_bf16 v[152:155], a[216:219], v[44:47], v[152:155]
    ds_read_b64_tr_b16 a[22:23], v62 offset:35904
    v_exp_f32 v87, v87
    v_mfma_f32_16x16x32_bf16 v[156:159], a[220:223], v[44:47], v[156:159]
    ds_read_b128 a[232:235], v2 offset:18432
    v_cvt_pk_bf16_f32 v55, v86, v87
    v_mfma_f32_16x16x32_bf16 v[28:31], v[4:7], v[44:47], v[28:31]
    ds_read_b64_tr_b16 a[64:65], v63 offset:36864
    v_exp_f32 v88, v88
    v_mfma_f32_16x16x32_bf16 v[160:163], a[192:195], v[48:51], v[160:163]
    buffer_load_dwordx4 v1, s[4:7], s70 offen offset:2048 sc1 lds
    v_mfma_f32_16x16x32_bf16 v[164:167], a[196:199], v[48:51], v[164:167]
    ds_read_b64_tr_b16 a[66:67], v63 offset:37888
    v_exp_f32 v89, v89
    v_mfma_f32_16x16x32_bf16 v[168:171], a[200:203], v[48:51], v[168:171]
    ds_read_b128 a[236:239], v2 offset:19456
    v_cvt_pk_bf16_f32 v56, v88, v89
    v_mfma_f32_16x16x32_bf16 v[172:175], a[204:207], v[48:51], v[172:175]
    ds_write_b128 v10, v[128:131] offset:0
    v_exp_f32 v90, v90
    v_mfma_f32_16x16x32_bf16 v[176:179], a[208:211], v[48:51], v[176:179]
    buffer_load_dwordx4 v1, s[4:7], s70 offen offset:3072 sc1 lds
    v_mfma_f32_16x16x32_bf16 v[180:183], a[212:215], v[48:51], v[180:183]
    s_add_u32 m0, s71, 135168
    v_exp_f32 v91, v91
    v_mfma_f32_16x16x32_bf16 v[184:187], a[216:219], v[48:51], v[184:187]
    ds_read_b128 a[240:243], v2 offset:20480
    v_cvt_pk_bf16_f32 v57, v90, v91
    v_mfma_f32_16x16x32_bf16 v[188:191], a[220:223], v[48:51], v[188:191]
    s_add_u32 s70, s72, 36864
    v_exp_f32 v92, v92
    v_mfma_f32_16x16x32_bf16 v[32:35], v[4:7], v[48:51], v[32:35]
    buffer_load_dwordx4 v1, s[4:7], s70 offen offset:0 sc1 lds
    s_waitcnt lgkmcnt(11)
    v_mfma_f32_16x16x32_bf16 v[64:67], a[160:163], a[48:51], v[112:115]
    ds_write_b128 v10, v[132:135] offset:1024
    v_exp_f32 v93, v93
    v_mfma_f32_16x16x32_bf16 v[64:67], a[164:167], a[52:55], v[64:67]
    ds_read_b128 a[244:247], v2 offset:21504
    v_cvt_pk_bf16_f32 v58, v92, v93
    v_mfma_f32_16x16x32_bf16 v[64:67], a[168:171], a[112:115], v[64:67]
    v_exp_f32 v94, v94
    v_mfma_f32_16x16x32_bf16 v[64:67], a[172:175], a[116:119], v[64:67]
    buffer_load_dwordx4 v1, s[4:7], s70 offen offset:1024 sc1 lds
    v_mfma_f32_16x16x32_bf16 v[68:71], a[176:179], a[48:51], v[116:119]
    v_exp_f32 v95, v95
    v_mfma_f32_16x16x32_bf16 v[68:71], a[180:183], a[52:55], v[68:71]
    ds_read_b128 a[248:251], v2 offset:22528
    v_cvt_pk_bf16_f32 v59, v94, v95
    v_mfma_f32_16x16x32_bf16 v[68:71], a[184:187], a[112:115], v[68:71]
    v_mfma_f32_16x16x32_bf16 v[68:71], a[188:191], a[116:119], v[68:71]
    ds_write_b128 v10, v[136:139] offset:2048
    v_mfma_f32_16x16x32_bf16 v[72:75], a[160:163], a[56:59], v[120:123]
    s_add_u32 s62, s62, 32768
    v_exp_f32 v64, v64
    v_mfma_f32_16x16x32_bf16 v[72:75], a[164:167], a[60:63], v[72:75]
    v_mfma_f32_16x16x32_bf16 v[72:75], a[168:171], a[120:123], v[72:75]
    s_cmp_eq_u32 s62, 98304
    v_exp_f32 v65, v65
    v_mfma_f32_16x16x32_bf16 v[72:75], a[172:175], a[124:127], v[72:75]
    ds_read_b128 a[252:255], v2 offset:23552
    v_cvt_pk_bf16_f32 v44, v64, v65
    v_mfma_f32_16x16x32_bf16 v[76:79], a[176:179], a[56:59], v[124:127]
    s_cselect_b32 s62, 0, s62
    v_exp_f32 v66, v66
    v_mfma_f32_16x16x32_bf16 v[76:79], a[180:183], a[60:63], v[76:79]
    ds_write_b128 v10, v[140:143] offset:3072
    v_add_u32 v2, s62, v3
    v_mfma_f32_16x16x32_bf16 v[76:79], a[184:187], a[120:123], v[76:79]
    v_exp_f32 v67, v67
    v_mfma_f32_16x16x32_bf16 v[76:79], a[188:191], a[124:127], v[76:79]
    v_cvt_pk_bf16_f32 v45, v66, v67
    v_mfma_f32_16x16x32_bf16 v[192:195], a[192:195], v[52:55], v[192:195]
    v_exp_f32 v68, v68
    v_mfma_f32_16x16x32_bf16 v[196:199], a[196:199], v[52:55], v[196:199]
    ds_write_b128 v10, v[144:147] offset:4096
    v_mfma_f32_16x16x32_bf16 v[200:203], a[200:203], v[52:55], v[200:203]
    v_exp_f32 v69, v69
    v_mfma_f32_16x16x32_bf16 v[204:207], a[204:207], v[52:55], v[204:207]
    v_cvt_pk_bf16_f32 v46, v68, v69
    v_mfma_f32_16x16x32_bf16 v[208:211], a[208:211], v[52:55], v[208:211]
    v_exp_f32 v70, v70
    v_mfma_f32_16x16x32_bf16 v[212:215], a[212:215], v[52:55], v[212:215]
    ds_write_b128 v10, v[148:151] offset:5120
    v_mfma_f32_16x16x32_bf16 v[216:219], a[216:219], v[52:55], v[216:219]
    v_exp_f32 v71, v71
    v_mfma_f32_16x16x32_bf16 v[220:223], a[220:223], v[52:55], v[220:223]
    v_cvt_pk_bf16_f32 v47, v70, v71
    v_mfma_f32_16x16x32_bf16 v[36:39], v[4:7], v[52:55], v[36:39]
    v_exp_f32 v72, v72
    v_mfma_f32_16x16x32_bf16 v[224:227], a[192:195], v[56:59], v[224:227]
    ds_write_b128 v10, v[152:155] offset:6144
    v_mfma_f32_16x16x32_bf16 v[228:231], a[196:199], v[56:59], v[228:231]
    v_exp_f32 v73, v73
    v_mfma_f32_16x16x32_bf16 v[232:235], a[200:203], v[56:59], v[232:235]
    v_cvt_pk_bf16_f32 v48, v72, v73
    v_mfma_f32_16x16x32_bf16 v[236:239], a[204:207], v[56:59], v[236:239]
    ds_write_b128 v10, v[156:159] offset:7168
    v_exp_f32 v74, v74
    v_mfma_f32_16x16x32_bf16 v[240:243], a[208:211], v[56:59], v[240:243]
    v_mfma_f32_16x16x32_bf16 v[244:247], a[212:215], v[56:59], v[244:247]
    v_exp_f32 v75, v75
    v_mfma_f32_16x16x32_bf16 v[248:251], a[216:219], v[56:59], v[248:251]
    v_cvt_pk_bf16_f32 v49, v74, v75
    v_mfma_f32_16x16x32_bf16 v[252:255], a[220:223], v[56:59], v[252:255]
    v_exp_f32 v76, v76
    v_mfma_f32_16x16x32_bf16 v[40:43], v[4:7], v[56:59], v[40:43]
    s_waitcnt lgkmcnt(0)
    s_barrier
    v_mfma_f32_16x16x32_bf16 v[192:195], a[224:227], v[44:47], v[192:195]
    ds_read_b128 v[128:131], v11 offset:0
    v_exp_f32 v77, v77
    s_lshl_b32 s67, s54, 11
    v_mfma_f32_16x16x32_bf16 v[196:199], a[228:231], v[44:47], v[196:199]
    ds_read_b128 v[132:135], v11 offset:1024
    v_cvt_pk_bf16_f32 v50, v76, v77
    s_add_u32 s67, s67, 90112
    v_mfma_f32_16x16x32_bf16 v[200:203], a[232:235], v[44:47], v[200:203]
    ds_read_b128 v[136:139], v11 offset:2048
    v_exp_f32 v78, v78
    v_mfma_f32_16x16x32_bf16 v[204:207], a[236:239], v[44:47], v[204:207]
    ds_read_b128 v[140:143], v11 offset:3072
    v_lshl_add_u32 v12, v0, 2, s67
    v_mfma_f32_16x16x32_bf16 v[208:211], a[240:243], v[44:47], v[208:211]
    ds_read_b128 v[144:147], v11 offset:4096
    v_exp_f32 v79, v79
    v_xor_b32 v13, 0x1000, v12
    v_mfma_f32_16x16x32_bf16 v[212:215], a[244:247], v[44:47], v[212:215]
    ds_read_b128 v[148:151], v11 offset:5120
    v_cvt_pk_bf16_f32 v51, v78, v79
    v_mfma_f32_16x16x32_bf16 v[216:219], a[248:251], v[44:47], v[216:219]
    ds_read_b128 v[152:155], v11 offset:6144
    v_mfma_f32_16x16x32_bf16 v[220:223], a[252:255], v[44:47], v[220:223]
    ds_read_b128 v[156:159], v11 offset:7168
    v_mfma_f32_16x16x32_bf16 v[36:39], v[4:7], v[44:47], v[36:39]
    v_mfma_f32_16x16x32_bf16 v[224:227], a[224:227], v[48:51], v[224:227]
    v_mfma_f32_16x16x32_bf16 v[228:231], a[228:231], v[48:51], v[228:231]
    v_mfma_f32_16x16x32_bf16 v[232:235], a[232:235], v[48:51], v[232:235]
    v_mfma_f32_16x16x32_bf16 v[236:239], a[236:239], v[48:51], v[236:239]
    v_mfma_f32_16x16x32_bf16 v[240:243], a[240:243], v[48:51], v[240:243]
    v_mfma_f32_16x16x32_bf16 v[244:247], a[244:247], v[48:51], v[244:247]
    ds_write_b128 v10, v[192:195] offset:32768
    v_mfma_f32_16x16x32_bf16 v[248:251], a[248:251], v[48:51], v[248:251]
    ds_write_b128 v10, v[196:199] offset:33792
    v_mfma_f32_16x16x32_bf16 v[252:255], a[252:255], v[48:51], v[252:255]
    ds_write_b128 v10, v[200:203] offset:34816
    v_mfma_f32_16x16x32_bf16 v[40:43], v[4:7], v[48:51], v[40:43]
    ds_write_b128 v10, v[204:207] offset:35840
    ds_write_b128 v10, v[208:211] offset:36864
    ds_write_b128 v10, v[212:215] offset:37888
    ds_write_b128 v10, v[216:219] offset:38912
    ds_write_b128 v10, v[220:223] offset:39936
    ds_write_b32 v12, v28 offset:0
    ds_write_b32 v12, v36 offset:256
    s_waitcnt lgkmcnt(10)
    v_pk_add_f32 v[160:161], v[160:161], v[128:129]
    v_pk_add_f32 v[162:163], v[162:163], v[130:131]
    v_pk_add_f32 v[164:165], v[164:165], v[132:133]
    v_pk_add_f32 v[166:167], v[166:167], v[134:135]
    v_pk_add_f32 v[168:169], v[168:169], v[136:137]
    v_pk_add_f32 v[170:171], v[170:171], v[138:139]
    v_pk_add_f32 v[172:173], v[172:173], v[140:141]
    v_pk_add_f32 v[174:175], v[174:175], v[142:143]
    v_pk_add_f32 v[176:177], v[176:177], v[144:145]
    v_pk_add_f32 v[178:179], v[178:179], v[146:147]
    v_pk_add_f32 v[180:181], v[180:181], v[148:149]
    v_pk_add_f32 v[182:183], v[182:183], v[150:151]
    v_pk_add_f32 v[184:185], v[184:185], v[152:153]
    v_pk_add_f32 v[186:187], v[186:187], v[154:155]
    v_pk_add_f32 v[188:189], v[188:189], v[156:157]
    v_pk_add_f32 v[190:191], v[190:191], v[158:159]
    s_lshl_b32 s66, s58, 2
    s_add_u32 s65, s66, s55
    s_add_u32 s66, s66, 3
    s_sub_u32 s66, s66, s55
    s_lshl_b32 s67, s52, 13
    s_add_u32 s67, s67, 33554432
    s_mul_i32 s65, s65, 294912
    s_mul_i32 s66, s66, 294912
    s_add_u32 s65, s65, s67
    s_add_u32 s66, s66, s67
    v_and_b32 v18, 31, v0
    v_lshrrev_b32 v30, 5, v0
    v_lshlrev_b32 v30, 8, v30
    v_lshl_add_u32 v30, v18, 4, v30
    v_cmp_gt_u32 vcc, 16, v18
    v_and_b32 v18, 27, v18
    v_cmp_eq_u32 s[100:101], 16, v18
    v_mov_b32 v18, 528
    v_cndmask_b32 v30, v18, v30, vcc
    v_mov_b32 v18, 512
    v_cndmask_b32 v30, v30, v18, s[100:101]
    v_add_u32 v30, 98304, v30
    v_add_u32 v29, 98304, v1
    s_waitcnt vmcnt(0) lgkmcnt(0)
    s_barrier
    ds_read_b32 v14, v13 offset:0
    ds_read_b32 v15, v13 offset:256
    ds_read_b128 v[192:195], v11 offset:32768
    ds_read_b128 v[196:199], v11 offset:33792
    ds_read_b128 v[200:203], v11 offset:34816
    ds_read_b128 v[204:207], v11 offset:35840
    ds_read_b128 v[208:211], v11 offset:36864
    ds_read_b128 v[212:215], v11 offset:37888
    ds_read_b128 v[216:219], v11 offset:38912
    ds_read_b128 v[220:223], v11 offset:39936
    ds_read_b128 a[128:131], v29 offset:0
    ds_read_b128 a[136:139], v30 offset:1024
    ds_read_b128 a[140:143], v30 offset:1600
    ds_read_b128 a[132:135], v29 offset:2176
    ds_read_b128 a[144:147], v30 offset:3200
    s_waitcnt lgkmcnt(13)
    v_add_f32 v14, v14, v32
    v_add_f32 v15, v15, v40
    v_subrev_u32 v17, 0x2b800000, v14
    v_subrev_u32 v16, 0x2b800000, v15
    v_max_u32 v17, v17, v16
    v_rcp_f32 v14, v14
    v_rcp_f32 v15, v15
    v_mov_b32 v16, 0x2c000000
    v_cmp_gt_u32 s[96:97], v17, v16
    v_mov_b32 v16, 0
    v_pk_mul_f32 v[160:161], v[160:161], v[14:15] op_sel:[0,0] op_sel_hi:[1,0]
    v_pk_mul_f32 v[162:163], v[162:163], v[14:15] op_sel:[0,0] op_sel_hi:[1,0]
    v_pk_mul_f32 v[164:165], v[164:165], v[14:15] op_sel:[0,0] op_sel_hi:[1,0]
    v_pk_mul_f32 v[166:167], v[166:167], v[14:15] op_sel:[0,0] op_sel_hi:[1,0]
    v_cvt_pk_bf16_f32 v160, v160, v161
    v_cvt_pk_bf16_f32 v161, v162, v163
    v_cvt_pk_bf16_f32 v162, v164, v165
    v_cvt_pk_bf16_f32 v163, v166, v167
    v_pk_maximum3_f16 v16, v160, v161, v16
    v_pk_maximum3_f16 v16, v162, v163, v16
    v_pk_mul_f32 v[168:169], v[168:169], v[14:15] op_sel:[0,0] op_sel_hi:[1,0]
    v_pk_mul_f32 v[170:171], v[170:171], v[14:15] op_sel:[0,0] op_sel_hi:[1,0]
    v_pk_mul_f32 v[172:173], v[172:173], v[14:15] op_sel:[0,0] op_sel_hi:[1,0]
    v_pk_mul_f32 v[174:175], v[174:175], v[14:15] op_sel:[0,0] op_sel_hi:[1,0]
    v_cvt_pk_bf16_f32 v168, v168, v169
    v_cvt_pk_bf16_f32 v169, v170, v171
    v_cvt_pk_bf16_f32 v170, v172, v173
    v_cvt_pk_bf16_f32 v171, v174, v175
    v_pk_maximum3_f16 v16, v168, v169, v16
    v_pk_maximum3_f16 v16, v170, v171, v16
    v_pk_mul_f32 v[176:177], v[176:177], v[14:15] op_sel:[0,0] op_sel_hi:[1,0]
    v_pk_mul_f32 v[178:179], v[178:179], v[14:15] op_sel:[0,0] op_sel_hi:[1,0]
    v_pk_mul_f32 v[180:181], v[180:181], v[14:15] op_sel:[0,0] op_sel_hi:[1,0]
    v_pk_mul_f32 v[182:183], v[182:183], v[14:15] op_sel:[0,0] op_sel_hi:[1,0]
    v_cvt_pk_bf16_f32 v176, v176, v177
    v_cvt_pk_bf16_f32 v177, v178, v179
    v_cvt_pk_bf16_f32 v178, v180, v181
    v_cvt_pk_bf16_f32 v179, v182, v183
    v_pk_maximum3_f16 v16, v176, v177, v16
    v_pk_maximum3_f16 v16, v178, v179, v16
    v_pk_mul_f32 v[184:185], v[184:185], v[14:15] op_sel:[0,0] op_sel_hi:[1,0]
    v_pk_mul_f32 v[186:187], v[186:187], v[14:15] op_sel:[0,0] op_sel_hi:[1,0]
    v_pk_mul_f32 v[188:189], v[188:189], v[14:15] op_sel:[0,0] op_sel_hi:[1,0]
    v_pk_mul_f32 v[190:191], v[190:191], v[14:15] op_sel:[0,0] op_sel_hi:[1,0]
    v_cvt_pk_bf16_f32 v184, v184, v185
    v_cvt_pk_bf16_f32 v185, v186, v187
    v_cvt_pk_bf16_f32 v186, v188, v189
    v_cvt_pk_bf16_f32 v187, v190, v191
    v_pk_maximum3_f16 v16, v184, v185, v16
    v_pk_maximum3_f16 v16, v186, v187, v16
    s_waitcnt lgkmcnt(5)
    v_pk_add_f32 v[224:225], v[224:225], v[192:193]
    v_pk_add_f32 v[226:227], v[226:227], v[194:195]
    v_pk_add_f32 v[228:229], v[228:229], v[196:197]
    v_pk_add_f32 v[230:231], v[230:231], v[198:199]
    v_pk_add_f32 v[232:233], v[232:233], v[200:201]
    v_pk_add_f32 v[234:235], v[234:235], v[202:203]
    v_pk_add_f32 v[236:237], v[236:237], v[204:205]
    v_pk_add_f32 v[238:239], v[238:239], v[206:207]
    v_pk_add_f32 v[240:241], v[240:241], v[208:209]
    v_pk_add_f32 v[242:243], v[242:243], v[210:211]
    v_pk_add_f32 v[244:245], v[244:245], v[212:213]
    v_pk_add_f32 v[246:247], v[246:247], v[214:215]
    v_pk_add_f32 v[248:249], v[248:249], v[216:217]
    v_pk_add_f32 v[250:251], v[250:251], v[218:219]
    v_pk_add_f32 v[252:253], v[252:253], v[220:221]
    v_pk_add_f32 v[254:255], v[254:255], v[222:223]
    v_pk_mul_f32 v[224:225], v[224:225], v[14:15] op_sel:[0,1] op_sel_hi:[1,1]
    v_pk_mul_f32 v[226:227], v[226:227], v[14:15] op_sel:[0,1] op_sel_hi:[1,1]
    v_pk_mul_f32 v[228:229], v[228:229], v[14:15] op_sel:[0,1] op_sel_hi:[1,1]
    v_pk_mul_f32 v[230:231], v[230:231], v[14:15] op_sel:[0,1] op_sel_hi:[1,1]
    v_cvt_pk_bf16_f32 v224, v224, v225
    v_cvt_pk_bf16_f32 v225, v226, v227
    v_cvt_pk_bf16_f32 v226, v228, v229
    v_cvt_pk_bf16_f32 v227, v230, v231
    v_pk_maximum3_f16 v16, v224, v225, v16
    v_pk_maximum3_f16 v16, v226, v227, v16
    v_pk_mul_f32 v[232:233], v[232:233], v[14:15] op_sel:[0,1] op_sel_hi:[1,1]
    v_pk_mul_f32 v[234:235], v[234:235], v[14:15] op_sel:[0,1] op_sel_hi:[1,1]
    v_pk_mul_f32 v[236:237], v[236:237], v[14:15] op_sel:[0,1] op_sel_hi:[1,1]
    v_pk_mul_f32 v[238:239], v[238:239], v[14:15] op_sel:[0,1] op_sel_hi:[1,1]
    v_cvt_pk_bf16_f32 v232, v232, v233
    v_cvt_pk_bf16_f32 v233, v234, v235
    v_cvt_pk_bf16_f32 v234, v236, v237
    v_cvt_pk_bf16_f32 v235, v238, v239
    v_pk_maximum3_f16 v16, v232, v233, v16
    v_pk_maximum3_f16 v16, v234, v235, v16
    v_pk_mul_f32 v[240:241], v[240:241], v[14:15] op_sel:[0,1] op_sel_hi:[1,1]
    v_pk_mul_f32 v[242:243], v[242:243], v[14:15] op_sel:[0,1] op_sel_hi:[1,1]
    v_pk_mul_f32 v[244:245], v[244:245], v[14:15] op_sel:[0,1] op_sel_hi:[1,1]
    v_pk_mul_f32 v[246:247], v[246:247], v[14:15] op_sel:[0,1] op_sel_hi:[1,1]
    v_cvt_pk_bf16_f32 v240, v240, v241
    v_cvt_pk_bf16_f32 v241, v242, v243
    v_cvt_pk_bf16_f32 v242, v244, v245
    v_cvt_pk_bf16_f32 v243, v246, v247
    v_pk_maximum3_f16 v16, v240, v241, v16
    v_pk_maximum3_f16 v16, v242, v243, v16
    v_pk_mul_f32 v[248:249], v[248:249], v[14:15] op_sel:[0,1] op_sel_hi:[1,1]
    v_pk_mul_f32 v[250:251], v[250:251], v[14:15] op_sel:[0,1] op_sel_hi:[1,1]
    v_pk_mul_f32 v[252:253], v[252:253], v[14:15] op_sel:[0,1] op_sel_hi:[1,1]
    v_pk_mul_f32 v[254:255], v[254:255], v[14:15] op_sel:[0,1] op_sel_hi:[1,1]
    v_cvt_pk_bf16_f32 v248, v248, v249
    v_cvt_pk_bf16_f32 v249, v250, v251
    v_cvt_pk_bf16_f32 v250, v252, v253
    v_cvt_pk_bf16_f32 v251, v254, v255
    v_pk_maximum3_f16 v16, v248, v249, v16
    v_pk_maximum3_f16 v16, v250, v251, v16
    v_and_b32 v16, 0x7c007c00, v16
    v_add_u32 v16, 0x04000400, v16
    v_and_b32 v16, 0x80008000, v16
    v_cmp_ne_u32 s[100:101], 0, v16
    s_nop 0
    s_or_b64 s[96:97], s[96:97], s[100:101]
    s_cselect_b32 s67, 2, 0
    s_or_b32 s64, s64, s67
    s_cmp_lg_u32 s64, 0
    s_cbranch_scc1 L_slowb0
L_slowb_ret:
    s_waitcnt lgkmcnt(0)
    v_mfma_f32_32x32x16_bf16 v[64:79], a[128:131], v[20:23], 0
    s_barrier
    s_and_b32 s63, s2, 7
    s_bfe_u32 s75, s2, 0x20003
    s_lshr_b32 s79, s2, 5
    s_sub_u32 s67, 15, s63
    s_cmp_lt_u32 s75, 2
    s_cselect_b32 s68, s63, s67
    s_lshl_b32 s68, s68, 2
    s_and_b32 s75, s75, 1
    s_lshl_b32 s75, s75, 1
    s_add_u32 s75, s75, s68
    s_add_u32 s75, s75, s55
    s_mul_i32 s68, s75, 294912
    s_add_u32 s68, s68, 33554432
    v_add_u32 v2, s68, v1
    s_xor_b32 s68, s75, 1
    s_mul_i32 s68, s68, 294912
    s_add_u32 s68, s68, 33554432
    v_add_u32 v3, s68, v1
    s_lshl_b32 s69, s79, 1
    s_add_u32 s69, s69, s56
    s_mul_i32 s68, s69, 294912
    s_add_u32 s68, s68, 52428800
    v_add_u32 v4, s68, v1
    s_xor_b32 s68, s69, 1
    s_mul_i32 s68, s68, 294912
    s_add_u32 s68, s68, 52428800
    v_add_u32 v5, s68, v1
    s_lshl_b32 s62, s54, 16
    s_cmp_eq_u32 s54, 0
    s_cselect_b32 s68, 0, 0x40000000
    s_sub_u32 s67, s79, s63
    s_sub_u32 s67, s67, 1
    s_lshl_b32 s67, s67, 7
    v_lshrrev_b32 v32, 5, v0
    v_mul_lo_u32 v32, v32, s67
    v_lshl_add_u32 v32, v0, 2, v32
    s_lshl_b32 s67, s63, 7
    s_add_u32 s67, s67, s68
    v_add_u32 v36, s67, v32
    s_mov_b32 s90, 61677568
    s_mov_b32 s64, 0
    s_mul_i32 s71, s54, 22528
    s_add_u32 s72, s91, s71
    v_exp_f32 v64, v64
    v_exp_f32 v65, v65
    ds_read_b128 a[148:151], v30 offset:3776
    v_exp_f32 v66, v66
    v_cvt_pk_bf16_f32 v44, v64, v65
    v_exp_f32 v67, v67
    v_exp_f32 v68, v68
    v_mfma_f32_32x32x16_bf16 v[80:95], a[128:131], v[24:27], 0
    ds_read_b128 a[128:131], v29 offset:4352
    v_cvt_pk_bf16_f32 v45, v66, v67
    v_exp_f32 v69, v69
    v_exp_f32 v70, v70
    v_cvt_pk_bf16_f32 v46, v68, v69
    v_exp_f32 v71, v71
    v_exp_f32 v72, v72
    v_cvt_pk_bf16_f32 v47, v70, v71
    v_exp_f32 v73, v73
    v_exp_f32 v74, v74
    v_mfma_f32_32x32x16_bf16 v[96:111], a[136:139], v[44:47], 0
    buffer_store_dwordx4 v[160:163], v60, s[48:51], s65 offen offset:0 sc1
    s_waitcnt lgkmcnt(2)
    v_cvt_pk_bf16_f32 v48, v72, v73
    v_exp_f32 v75, v75
    v_exp_f32 v76, v76
    v_cvt_pk_bf16_f32 v49, v74, v75
    v_exp_f32 v77, v77
    v_exp_f32 v78, v78
    v_exp_f32 v79, v79
    v_cvt_pk_bf16_f32 v50, v76, v77
    v_cvt_pk_bf16_f32 v51, v78, v79
    v_exp_f32 v80, v80
    v_exp_f32 v81, v81
    v_mfma_f32_32x32x16_bf16 v[96:111], a[140:143], v[48:51], v[96:111]
    buffer_store_dwordx4 v[168:171], v60, s[48:51], s65 offen offset:2048 sc1
    v_exp_f32 v82, v82
    v_cvt_pk_bf16_f32 v52, v80, v81
    v_exp_f32 v83, v83
    v_exp_f32 v84, v84
    v_mfma_f32_32x32x16_bf16 v[64:79], a[132:135], v[20:23], 0
    buffer_store_dwordx4 v[176:179], v19, s[48:51], s65 offen offset:0 sc1
    v_cvt_pk_bf16_f32 v53, v82, v83
    v_exp_f32 v85, v85
    v_exp_f32 v86, v86
    v_cvt_pk_bf16_f32 v54, v84, v85
    v_exp_f32 v87, v87
    v_exp_f32 v88, v88
    v_cvt_pk_bf16_f32 v55, v86, v87
    v_exp_f32 v89, v89
    v_exp_f32 v90, v90
    v_mfma_f32_32x32x16_bf16 v[112:127], a[136:139], v[52:55], 0
    ds_read_b128 a[136:139], v30 offset:5376
    v_cvt_pk_bf16_f32 v56, v88, v89
    v_exp_f32 v91, v91
    v_exp_f32 v92, v92
    v_cvt_pk_bf16_f32 v57, v90, v91
    v_exp_f32 v93, v93
    v_exp_f32 v94, v94
    v_exp_f32 v95, v95
    v_cvt_pk_bf16_f32 v58, v92, v93
    v_cvt_pk_bf16_f32 v59, v94, v95
    v_exp_f32 v64, v64
    v_exp_f32 v65, v65
    v_mfma_f32_32x32x16_bf16 v[112:127], a[140:143], v[56:59], v[112:127]
    ds_read_b128 a[140:143], v30 offset:5952
    v_exp_f32 v66, v66
    v_cvt_pk_bf16_f32 v44, v64, v65
    v_exp_f32 v67, v67
    v_exp_f32 v68, v68
    v_mfma_f32_32x32x16_bf16 v[80:95], a[132:135], v[24:27], 0
    ds_read_b128 a[132:135], v29 offset:6528
    v_cvt_pk_bf16_f32 v45, v66, v67
    v_exp_f32 v69, v69
    v_exp_f32 v70, v70
    v_cvt_pk_bf16_f32 v46, v68, v69
    v_exp_f32 v71, v71
    v_exp_f32 v72, v72
    v_cvt_pk_bf16_f32 v47, v70, v71
    v_exp_f32 v73, v73
    v_exp_f32 v74, v74
    v_mfma_f32_32x32x16_bf16 v[96:111], a[144:147], v[44:47], v[96:111]
    buffer_store_dwordx4 v[184:187], v19, s[48:51], s65 offen offset:2048 sc1
    s_waitcnt lgkmcnt(2)
    v_cvt_pk_bf16_f32 v48, v72, v73
    v_exp_f32 v75, v75
    v_exp_f32 v76, v76
    v_cvt_pk_bf16_f32 v49, v74, v75
    v_exp_f32 v77, v77
    v_exp_f32 v78, v78
    v_exp_f32 v79, v79
    v_cvt_pk_bf16_f32 v50, v76, v77
    v_cvt_pk_bf16_f32 v51, v78, v79
    v_exp_f32 v80, v80
    v_exp_f32 v81, v81
    v_mfma_f32_32x32x16_bf16 v[96:111], a[148:151], v[48:51], v[96:111]
    buffer_store_dwordx4 v[224:227], v60, s[48:51], s66 offen offset:0 sc1
    v_exp_f32 v82, v82
    v_cvt_pk_bf16_f32 v52, v80, v81
    v_exp_f32 v83, v83
    v_exp_f32 v84, v84
    v_mfma_f32_32x32x16_bf16 v[64:79], a[128:131], v[20:23], 0
    buffer_store_dwordx4 v[232:235], v60, s[48:51], s66 offen offset:2048 sc1
    v_cvt_pk_bf16_f32 v53, v82, v83
    v_exp_f32 v85, v85
    v_exp_f32 v86, v86
    v_cvt_pk_bf16_f32 v54, v84, v85
    v_exp_f32 v87, v87
    v_exp_f32 v88, v88
    v_cvt_pk_bf16_f32 v55, v86, v87
    v_exp_f32 v89, v89
    v_exp_f32 v90, v90
    v_mfma_f32_32x32x16_bf16 v[112:127], a[144:147], v[52:55], v[112:127]
    ds_read_b128 a[144:147], v30 offset:7552
    v_cvt_pk_bf16_f32 v56, v88, v89
    v_exp_f32 v91, v91
    v_exp_f32 v92, v92
    v_cvt_pk_bf16_f32 v57, v90, v91
    v_exp_f32 v93, v93
    v_exp_f32 v94, v94
    v_exp_f32 v95, v95
    v_cvt_pk_bf16_f32 v58, v92, v93
    v_cvt_pk_bf16_f32 v59, v94, v95
    v_exp_f32 v64, v64
    v_exp_f32 v65, v65
    v_mfma_f32_32x32x16_bf16 v[112:127], a[148:151], v[56:59], v[112:127]
    ds_read_b128 a[148:151], v30 offset:8128
    v_exp_f32 v66, v66
    v_cvt_pk_bf16_f32 v44, v64, v65
    v_exp_f32 v67, v67
    v_exp_f32 v68, v68
    v_mfma_f32_32x32x16_bf16 v[80:95], a[128:131], v[24:27], 0
    ds_read_b128 a[128:131], v29 offset:8704
    v_cvt_pk_bf16_f32 v45, v66, v67
    v_exp_f32 v69, v69
    v_exp_f32 v70, v70
    v_cvt_pk_bf16_f32 v46, v68, v69
    v_exp_f32 v71, v71
    v_exp_f32 v72, v72
    v_cvt_pk_bf16_f32 v47, v70, v71
    v_exp_f32 v73, v73
    v_exp_f32 v74, v74
    v_mfma_f32_32x32x16_bf16 v[96:111], a[136:139], v[44:47], v[96:111]
    buffer_store_dwordx4 v[240:243], v19, s[48:51], s66 offen offset:0 sc1
    s_waitcnt lgkmcnt(2)
    v_cvt_pk_bf16_f32 v48, v72, v73
    v_exp_f32 v75, v75
    v_exp_f32 v76, v76
    v_cvt_pk_bf16_f32 v49, v74, v75
    v_exp_f32 v77, v77
    v_exp_f32 v78, v78
    v_exp_f32 v79, v79
    v_cvt_pk_bf16_f32 v50, v76, v77
    v_cvt_pk_bf16_f32 v51, v78, v79
    v_exp_f32 v80, v80
    v_exp_f32 v81, v81
    v_mfma_f32_32x32x16_bf16 v[96:111], a[140:143], v[48:51], v[96:111]
    buffer_store_dwordx4 v[248:251], v19, s[48:51], s66 offen offset:2048 sc1
    v_exp_f32 v82, v82
    v_cvt_pk_bf16_f32 v52, v80, v81
    v_exp_f32 v83, v83
    v_exp_f32 v84, v84
    v_mfma_f32_32x32x16_bf16 v[64:79], a[132:135], v[20:23], 0
    s_add_u32 s69, s73, 52428800
    buffer_store_dwordx4 a[0:3], v1, s[48:51], s69 offen offset:0 sc1
    v_cvt_pk_bf16_f32 v53, v82, v83
    v_exp_f32 v85, v85
    v_exp_f32 v86, v86
    v_cvt_pk_bf16_f32 v54, v84, v85
    v_exp_f32 v87, v87
    v_exp_f32 v88, v88
    v_cvt_pk_bf16_f32 v55, v86, v87
    v_exp_f32 v89, v89
    v_exp_f32 v90, v90
    v_mfma_f32_32x32x16_bf16 v[112:127], a[136:139], v[52:55], v[112:127]
    ds_read_b128 a[136:139], v30 offset:9728
    v_cvt_pk_bf16_f32 v56, v88, v89
    v_exp_f32 v91, v91
    v_exp_f32 v92, v92
    v_cvt_pk_bf16_f32 v57, v90, v91
    v_exp_f32 v93, v93
    v_exp_f32 v94, v94
    v_exp_f32 v95, v95
    v_cvt_pk_bf16_f32 v58, v92, v93
    v_cvt_pk_bf16_f32 v59, v94, v95
    v_exp_f32 v64, v64
    v_exp_f32 v65, v65
    v_mfma_f32_32x32x16_bf16 v[112:127], a[140:143], v[56:59], v[112:127]
    ds_read_b128 a[140:143], v30 offset:10304
    v_exp_f32 v66, v66
    v_cvt_pk_bf16_f32 v44, v64, v65
    v_exp_f32 v67, v67
    v_exp_f32 v68, v68
    v_mfma_f32_32x32x16_bf16 v[80:95], a[132:135], v[24:27], 0
    ds_read_b128 a[132:135], v29 offset:10880
    v_cvt_pk_bf16_f32 v45, v66, v67
    v_exp_f32 v69, v69
    v_exp_f32 v70, v70
    v_cvt_pk_bf16_f32 v46, v68, v69
    v_exp_f32 v71, v71
    s_add_u32 s69, s73, 52723712
    v_exp_f32 v72, v72
    v_cvt_pk_bf16_f32 v47, v70, v71
    v_exp_f32 v73, v73
    v_exp_f32 v74, v74
    v_mfma_f32_32x32x16_bf16 v[96:111], a[144:147], v[44:47], v[96:111]
    buffer_store_dwordx4 a[4:7], v1, s[48:51], s69 offen offset:0 sc1
    s_waitcnt lgkmcnt(2)
    v_cvt_pk_bf16_f32 v48, v72, v73
    v_exp_f32 v75, v75
    v_exp_f32 v76, v76
    v_cvt_pk_bf16_f32 v49, v74, v75
    s_add_u32 s69, s73, 52428800
    v_exp_f32 v77, v77
    v_exp_f32 v78, v78
    v_exp_f32 v79, v79
    v_cvt_pk_bf16_f32 v50, v76, v77
    v_cvt_pk_bf16_f32 v51, v78, v79
    v_exp_f32 v80, v80
    v_exp_f32 v81, v81
    v_mfma_f32_32x32x16_bf16 v[96:111], a[148:151], v[48:51], v[96:111]
    buffer_store_dwordx4 a[16:19], v1, s[48:51], s69 offen offset:1024 sc1
    v_exp_f32 v82, v82
    v_cvt_pk_bf16_f32 v52, v80, v81
    v_exp_f32 v83, v83
    v_exp_f32 v84, v84
    v_mfma_f32_32x32x16_bf16 v[64:79], a[128:131], v[20:23], 0
    s_add_u32 s69, s73, 52723712
    buffer_store_dwordx4 a[20:23], v1, s[48:51], s69 offen offset:1024 sc1
    v_cvt_pk_bf16_f32 v53, v82, v83
    v_exp_f32 v85, v85
    v_exp_f32 v86, v86
    v_cvt_pk_bf16_f32 v54, v84, v85
    v_exp_f32 v87, v87
    v_exp_f32 v88, v88
    v_cvt_pk_bf16_f32 v55, v86, v87
    v_exp_f32 v89, v89
    v_exp_f32 v90, v90
    v_mfma_f32_32x32x16_bf16 v[112:127], a[144:147], v[52:55], v[112:127]
    ds_read_b128 a[144:147], v30 offset:11904
    v_cvt_pk_bf16_f32 v56, v88, v89
    v_exp_f32 v91, v91
    v_exp_f32 v92, v92
    v_cvt_pk_bf16_f32 v57, v90, v91
    v_exp_f32 v93, v93
    v_exp_f32 v94, v94
    v_exp_f32 v95, v95
    v_cvt_pk_bf16_f32 v58, v92, v93
    v_cvt_pk_bf16_f32 v59, v94, v95
    v_exp_f32 v64, v64
    v_exp_f32 v65, v65
    v_mfma_f32_32x32x16_bf16 v[112:127], a[148:151], v[56:59], v[112:127]
    ds_read_b128 a[148:151], v30 offset:12480
    v_exp_f32 v66, v66
    v_cvt_pk_bf16_f32 v44, v64, v65
    v_exp_f32 v67, v67
    v_exp_f32 v68, v68
    v_mfma_f32_32x32x16_bf16 v[80:95], a[128:131], v[24:27], 0
    ds_read_b128 a[128:131], v29 offset:13056
    v_cvt_pk_bf16_f32 v45, v66, v67
    v_exp_f32 v69, v69
    v_exp_f32 v70, v70
    v_cvt_pk_bf16_f32 v46, v68, v69
    v_exp_f32 v71, v71
    s_add_u32 s69, s74, 52690944
    v_exp_f32 v72, v72
    v_cvt_pk_bf16_f32 v47, v70, v71
    v_exp_f32 v73, v73
    v_exp_f32 v74, v74
    v_mfma_f32_32x32x16_bf16 v[96:111], a[136:139], v[44:47], v[96:111]
    buffer_store_dwordx4 a[64:67], v1, s[48:51], s69 offen sc1
    s_waitcnt lgkmcnt(2)
    v_cvt_pk_bf16_f32 v48, v72, v73
    v_exp_f32 v75, v75
    v_exp_f32 v76, v76
    v_cvt_pk_bf16_f32 v49, v74, v75
    s_add_u32 m0, s71, 0
    s_add_u32 s70, s72, 52224
    v_exp_f32 v77, v77
    v_exp_f32 v78, v78
    v_exp_f32 v79, v79
    v_cvt_pk_bf16_f32 v50, v76, v77
    v_cvt_pk_bf16_f32 v51, v78, v79
    v_exp_f32 v80, v80
    v_exp_f32 v81, v81
    v_mfma_f32_32x32x16_bf16 v[96:111], a[140:143], v[48:51], v[96:111]
    buffer_load_dwordx4 v1, s[4:7], s70 offen offset:0 sc1 lds
    v_exp_f32 v82, v82
    v_cvt_pk_bf16_f32 v52, v80, v81
    v_exp_f32 v83, v83
    v_exp_f32 v84, v84
    v_mfma_f32_32x32x16_bf16 v[64:79], a[132:135], v[20:23], 0
    buffer_load_dwordx4 v1, s[4:7], s70 offen offset:1024 sc1 lds
    v_cvt_pk_bf16_f32 v53, v82, v83
    v_exp_f32 v85, v85
    v_exp_f32 v86, v86
    v_cvt_pk_bf16_f32 v54, v84, v85
    v_exp_f32 v87, v87
    v_exp_f32 v88, v88
    v_cvt_pk_bf16_f32 v55, v86, v87
    v_exp_f32 v89, v89
    v_exp_f32 v90, v90
    v_mfma_f32_32x32x16_bf16 v[112:127], a[136:139], v[52:55], v[112:127]
    ds_read_b128 a[136:139], v30 offset:14080
    v_cvt_pk_bf16_f32 v56, v88, v89
    v_exp_f32 v91, v91
    v_exp_f32 v92, v92
    v_cvt_pk_bf16_f32 v57, v90, v91
    v_exp_f32 v93, v93
    v_exp_f32 v94, v94
    v_exp_f32 v95, v95
    v_cvt_pk_bf16_f32 v58, v92, v93
    v_cvt_pk_bf16_f32 v59, v94, v95
    v_exp_f32 v64, v64
    v_exp_f32 v65, v65
    v_mfma_f32_32x32x16_bf16 v[112:127], a[140:143], v[56:59], v[112:127]
    ds_read_b128 a[140:143], v30 offset:14656
    v_exp_f32 v66, v66
    v_cvt_pk_bf16_f32 v44, v64, v65
    v_exp_f32 v67, v67
    v_exp_f32 v68, v68
    v_mfma_f32_32x32x16_bf16 v[80:95], a[132:135], v[24:27], 0
    ds_read_b128 a[132:135], v29 offset:15232
    v_cvt_pk_bf16_f32 v45, v66, v67
    v_exp_f32 v69, v69
    v_exp_f32 v70, v70
    v_cvt_pk_bf16_f32 v46, v68, v69
    v_exp_f32 v71, v71
    v_exp_f32 v72, v72
    v_cvt_pk_bf16_f32 v47, v70, v71
    v_exp_f32 v73, v73
    v_exp_f32 v74, v74
    v_mfma_f32_32x32x16_bf16 v[96:111], a[144:147], v[44:47], v[96:111]
    buffer_load_dwordx4 v1, s[4:7], s70 offen offset:2048 sc1 lds
    s_waitcnt lgkmcnt(2)
    v_cvt_pk_bf16_f32 v48, v72, v73
    v_exp_f32 v75, v75
    v_exp_f32 v76, v76
    v_cvt_pk_bf16_f32 v49, v74, v75
    v_exp_f32 v77, v77
    v_exp_f32 v78, v78
    v_exp_f32 v79, v79
    v_cvt_pk_bf16_f32 v50, v76, v77
    v_cvt_pk_bf16_f32 v51, v78, v79
    v_exp_f32 v80, v80
    v_exp_f32 v81, v81
    v_mfma_f32_32x32x16_bf16 v[96:111], a[148:151], v[48:51], v[96:111]
    buffer_load_dwordx4 v1, s[4:7], s70 offen offset:3072 sc1 lds
    v_exp_f32 v82, v82
    v_cvt_pk_bf16_f32 v52, v80, v81
    v_exp_f32 v83, v83
    v_exp_f32 v84, v84
    v_mfma_f32_32x32x16_bf16 v[64:79], a[128:131], v[20:23], 0
    s_add_u32 m0, s71, 4096
    s_add_u32 s70, s72, 56320
    buffer_load_dwordx4 v1, s[4:7], s70 offen offset:0 sc1 lds
    v_cvt_pk_bf16_f32 v53, v82, v83
    v_exp_f32 v85, v85
    v_exp_f32 v86, v86
    v_cvt_pk_bf16_f32 v54, v84, v85
    v_exp_f32 v87, v87
    v_exp_f32 v88, v88
    v_cvt_pk_bf16_f32 v55, v86, v87
    v_exp_f32 v89, v89
    v_exp_f32 v90, v90
    v_mfma_f32_32x32x16_bf16 v[112:127], a[144:147], v[52:55], v[112:127]
    ds_read_b128 a[144:147], v30 offset:16256
    v_cvt_pk_bf16_f32 v56, v88, v89
    v_exp_f32 v91, v91
    v_exp_f32 v92, v92
    v_cvt_pk_bf16_f32 v57, v90, v91
    v_exp_f32 v93, v93
    v_exp_f32 v94, v94
    v_exp_f32 v95, v95
    v_cvt_pk_bf16_f32 v58, v92, v93
    v_cvt_pk_bf16_f32 v59, v94, v95
    v_exp_f32 v64, v64
    v_exp_f32 v65, v65
    v_mfma_f32_32x32x16_bf16 v[112:127], a[148:151], v[56:59], v[112:127]
    ds_read_b128 a[148:151], v30 offset:16832
    v_exp_f32 v66, v66
    v_cvt_pk_bf16_f32 v44, v64, v65
    v_exp_f32 v67, v67
    v_exp_f32 v68, v68
    v_mfma_f32_32x32x16_bf16 v[80:95], a[128:131], v[24:27], 0
    ds_read_b128 a[128:131], v29 offset:17408
    v_cvt_pk_bf16_f32 v45, v66, v67
    v_exp_f32 v69, v69
    v_exp_f32 v70, v70
    v_cvt_pk_bf16_f32 v46, v68, v69
    v_exp_f32 v71, v71
    v_exp_f32 v72, v72
    v_cvt_pk_bf16_f32 v47, v70, v71
    v_exp_f32 v73, v73
    v_exp_f32 v74, v74
    v_mfma_f32_32x32x16_bf16 v[96:111], a[136:139], v[44:47], v[96:111]
    buffer_load_dwordx4 v1, s[4:7], s70 offen offset:1024 sc1 lds
    s_waitcnt lgkmcnt(2)
    v_cvt_pk_bf16_f32 v48, v72, v73
    v_exp_f32 v75, v75
    v_exp_f32 v76, v76
    v_cvt_pk_bf16_f32 v49, v74, v75
    v_exp_f32 v77, v77
    v_exp_f32 v78, v78
    v_exp_f32 v79, v79
    v_cvt_pk_bf16_f32 v50, v76, v77
    v_cvt_pk_bf16_f32 v51, v78, v79
    v_exp_f32 v80, v80
    v_exp_f32 v81, v81
    v_mfma_f32_32x32x16_bf16 v[96:111], a[140:143], v[48:51], v[96:111]
    buffer_load_dwordx4 v1, s[4:7], s70 offen offset:2048 sc1 lds
    v_exp_f32 v82, v82
    v_cvt_pk_bf16_f32 v52, v80, v81
    v_exp_f32 v83, v83
    v_exp_f32 v84, v84
    v_mfma_f32_32x32x16_bf16 v[64:79], a[132:135], v[20:23], 0
    buffer_load_dwordx4 v1, s[4:7], s70 offen offset:3072 sc1 lds
    v_cvt_pk_bf16_f32 v53, v82, v83
    v_exp_f32 v85, v85
    v_exp_f32 v86, v86
    v_cvt_pk_bf16_f32 v54, v84, v85
    v_exp_f32 v87, v87
    v_exp_f32 v88, v88
    v_cvt_pk_bf16_f32 v55, v86, v87
    v_exp_f32 v89, v89
    v_exp_f32 v90, v90
    v_mfma_f32_32x32x16_bf16 v[112:127], a[136:139], v[52:55], v[112:127]
    ds_read_b128 a[136:139], v30 offset:18432
    v_cvt_pk_bf16_f32 v56, v88, v89
    v_exp_f32 v91, v91
    v_exp_f32 v92, v92
    v_cvt_pk_bf16_f32 v57, v90, v91
    v_exp_f32 v93, v93
    v_exp_f32 v94, v94
    v_exp_f32 v95, v95
    v_cvt_pk_bf16_f32 v58, v92, v93
    v_cvt_pk_bf16_f32 v59, v94, v95
    v_exp_f32 v64, v64
    v_exp_f32 v65, v65
    v_mfma_f32_32x32x16_bf16 v[112:127], a[140:143], v[56:59], v[112:127]
    ds_read_b128 a[140:143], v30 offset:19008
    v_exp_f32 v66, v66
    v_cvt_pk_bf16_f32 v44, v64, v65
    v_exp_f32 v67, v67
    v_exp_f32 v68, v68
    v_mfma_f32_32x32x16_bf16 v[80:95], a[132:135], v[24:27], 0
    ds_read_b128 a[132:135], v29 offset:19584
    v_cvt_pk_bf16_f32 v45, v66, v67
    v_exp_f32 v69, v69
    v_exp_f32 v70, v70
    v_cvt_pk_bf16_f32 v46, v68, v69
    v_exp_f32 v71, v71
    s_add_u32 m0, s71, 8192
    s_add_u32 s70, s72, 60416
    v_exp_f32 v72, v72
    v_cvt_pk_bf16_f32 v47, v70, v71
    v_exp_f32 v73, v73
    v_exp_f32 v74, v74
    v_mfma_f32_32x32x16_bf16 v[96:111], a[144:147], v[44:47], v[96:111]
    buffer_load_dwordx4 v1, s[4:7], s70 offen offset:0 sc1 lds
    s_waitcnt lgkmcnt(2)
    v_cvt_pk_bf16_f32 v48, v72, v73
    v_exp_f32 v75, v75
    v_exp_f32 v76, v76
    v_cvt_pk_bf16_f32 v49, v74, v75
    v_exp_f32 v77, v77
    v_exp_f32 v78, v78
    v_exp_f32 v79, v79
    v_cvt_pk_bf16_f32 v50, v76, v77
    v_cvt_pk_bf16_f32 v51, v78, v79
    v_exp_f32 v80, v80
    v_exp_f32 v81, v81
    v_mfma_f32_32x32x16_bf16 v[96:111], a[148:151], v[48:51], v[96:111]
    buffer_load_dwordx4 v1, s[4:7], s70 offen offset:1024 sc1 lds
    v_exp_f32 v82, v82
    v_cvt_pk_bf16_f32 v52, v80, v81
    v_exp_f32 v83, v83
    v_exp_f32 v84, v84
    v_mfma_f32_32x32x16_bf16 v[64:79], a[128:131], v[20:23], 0
    buffer_load_dwordx4 v1, s[4:7], s70 offen offset:2048 sc1 lds
    v_cvt_pk_bf16_f32 v53, v82, v83
    v_exp_f32 v85, v85
    v_exp_f32 v86, v86
    v_cvt_pk_bf16_f32 v54, v84, v85
    v_exp_f32 v87, v87
    v_exp_f32 v88, v88
    v_cvt_pk_bf16_f32 v55, v86, v87
    v_exp_f32 v89, v89
    v_exp_f32 v90, v90
    v_mfma_f32_32x32x16_bf16 v[112:127], a[144:147], v[52:55], v[112:127]
    ds_read_b128 a[144:147], v30 offset:20608
    v_cvt_pk_bf16_f32 v56, v88, v89
    v_exp_f32 v91, v91
    v_exp_f32 v92, v92
    v_cvt_pk_bf16_f32 v57, v90, v91
    v_add_u32 v29, 17408, v29
    v_exp_f32 v93, v93
    v_exp_f32 v94, v94
    v_exp_f32 v95, v95
    v_cvt_pk_bf16_f32 v58, v92, v93
    v_cvt_pk_bf16_f32 v59, v94, v95
    v_add_u32 v30, 17408, v30
    s_waitcnt vmcnt(11)
    s_barrier
    s_cmp_lg_u32 s54, 0
    s_cbranch_scc1 L_sig5
    s_lshl_b32 s67, s53, 7
    s_add_u32 s67, s67, 61677568
    s_lshl2_add_u32 s67, s52, s67
    v_min_u32 v62, 1, v0
    v_lshlrev_b32 v62, 30, v62
    v_mov_b32 v63, s12
    buffer_store_dword v63, v62, s[48:51], s67 offen sc1
L_sig5:
    v_exp_f32 v64, v64
    v_exp_f32 v65, v65
    v_mfma_f32_32x32x16_bf16 v[112:127], a[148:151], v[56:59], v[112:127]
    ds_read_b128 a[148:151], v30 offset:3776
    v_exp_f32 v66, v66
    v_cvt_pk_bf16_f32 v44, v64, v65
    v_exp_f32 v67, v67
    v_exp_f32 v68, v68
    v_mfma_f32_32x32x16_bf16 v[80:95], a[128:131], v[24:27], 0
    ds_read_b128 a[128:131], v29 offset:4352
    v_cvt_pk_bf16_f32 v45, v66, v67
    v_exp_f32 v69, v69
    v_exp_f32 v70, v70
    v_cvt_pk_bf16_f32 v46, v68, v69
    v_exp_f32 v71, v71
    v_exp_f32 v72, v72
    v_cvt_pk_bf16_f32 v47, v70, v71
    v_exp_f32 v73, v73
    v_exp_f32 v74, v74
    v_mfma_f32_32x32x16_bf16 v[96:111], a[136:139], v[44:47], v[96:111]
    buffer_load_dwordx4 v1, s[4:7], s70 offen offset:3072 sc1 lds
    s_waitcnt lgkmcnt(2)
    v_cvt_pk_bf16_f32 v48, v72, v73
    v_exp_f32 v75, v75
    v_exp_f32 v76, v76
    v_cvt_pk_bf16_f32 v49, v74, v75
    s_add_u32 m0, s71, 12288
    s_add_u32 s70, s72, 64512
    v_exp_f32 v77, v77
    v_exp_f32 v78, v78
    v_exp_f32 v79, v79
    v_cvt_pk_bf16_f32 v50, v76, v77
    v_cvt_pk_bf16_f32 v51, v78, v79
    v_exp_f32 v80, v80
    v_exp_f32 v81, v81
    v_mfma_f32_32x32x16_bf16 v[96:111], a[140:143], v[48:51], v[96:111]
    buffer_load_dwordx4 v1, s[4:7], s70 offen offset:0 sc1 lds
    v_exp_f32 v82, v82
    v_cvt_pk_bf16_f32 v52, v80, v81
    v_exp_f32 v83, v83
    v_exp_f32 v84, v84
    v_mfma_f32_32x32x16_bf16 v[64:79], a[132:135], v[20:23], 0
    buffer_load_dwordx4 v1, s[4:7], s70 offen offset:1024 sc1 lds
    v_cvt_pk_bf16_f32 v53, v82, v83
    v_exp_f32 v85, v85
    v_exp_f32 v86, v86
    v_cvt_pk_bf16_f32 v54, v84, v85
    v_exp_f32 v87, v87
    v_exp_f32 v88, v88
    v_cvt_pk_bf16_f32 v55, v86, v87
    v_exp_f32 v89, v89
    v_exp_f32 v90, v90
    v_mfma_f32_32x32x16_bf16 v[112:127], a[136:139], v[52:55], v[112:127]
    ds_read_b128 a[136:139], v30 offset:5376
    v_cvt_pk_bf16_f32 v56, v88, v89
    v_exp_f32 v91, v91
    v_exp_f32 v92, v92
    v_cvt_pk_bf16_f32 v57, v90, v91
    v_exp_f32 v93, v93
    v_exp_f32 v94, v94
    v_exp_f32 v95, v95
    v_cvt_pk_bf16_f32 v58, v92, v93
    v_cvt_pk_bf16_f32 v59, v94, v95
    v_exp_f32 v64, v64
    v_exp_f32 v65, v65
    v_mfma_f32_32x32x16_bf16 v[112:127], a[140:143], v[56:59], v[112:127]
    ds_read_b128 a[140:143], v30 offset:5952
    v_exp_f32 v66, v66
    v_cvt_pk_bf16_f32 v44, v64, v65
    v_exp_f32 v67, v67
    v_exp_f32 v68, v68
    v_mfma_f32_32x32x16_bf16 v[80:95], a[132:135], v[24:27], 0
    ds_read_b128 a[132:135], v29 offset:6528
    v_cvt_pk_bf16_f32 v45, v66, v67
    v_exp_f32 v69, v69
    v_exp_f32 v70, v70
    v_cvt_pk_bf16_f32 v46, v68, v69
    v_exp_f32 v71, v71
    v_exp_f32 v72, v72
    v_cvt_pk_bf16_f32 v47, v70, v71
    v_exp_f32 v73, v73
    v_exp_f32 v74, v74
    v_mfma_f32_32x32x16_bf16 v[96:111], a[144:147], v[44:47], v[96:111]
    buffer_load_dwordx4 v1, s[4:7], s70 offen offset:2048 sc1 lds
    s_waitcnt lgkmcnt(2)
    v_cvt_pk_bf16_f32 v48, v72, v73
    v_exp_f32 v75, v75
    v_exp_f32 v76, v76
    v_cvt_pk_bf16_f32 v49, v74, v75
    v_exp_f32 v77, v77
    v_exp_f32 v78, v78
    v_exp_f32 v79, v79
    v_cvt_pk_bf16_f32 v50, v76, v77
    v_cvt_pk_bf16_f32 v51, v78, v79
    v_exp_f32 v80, v80
    v_exp_f32 v81, v81
    v_mfma_f32_32x32x16_bf16 v[96:111], a[148:151], v[48:51], v[96:111]
    buffer_load_dwordx4 v1, s[4:7], s70 offen offset:3072 sc1 lds
    v_exp_f32 v82, v82
    v_cvt_pk_bf16_f32 v52, v80, v81
    v_exp_f32 v83, v83
    v_exp_f32 v84, v84
    v_mfma_f32_32x32x16_bf16 v[64:79], a[128:131], v[20:23], 0
    s_add_u32 m0, s71, 16384
    s_add_u32 s70, s72, 68608
    buffer_load_dwordx4 v1, s[4:7], s70 offen offset:0 sc1 lds
    v_cvt_pk_bf16_f32 v53, v82, v83
    v_exp_f32 v85, v85
    v_exp_f32 v86, v86
    v_cvt_pk_bf16_f32 v54, v84, v85
    v_exp_f32 v87, v87
    v_exp_f32 v88, v88
    v_cvt_pk_bf16_f32 v55, v86, v87
    v_exp_f32 v89, v89
    v_exp_f32 v90, v90
    v_mfma_f32_32x32x16_bf16 v[112:127], a[144:147], v[52:55], v[112:127]
    ds_read_b128 a[144:147], v30 offset:7552
    v_cvt_pk_bf16_f32 v56, v88, v89
    v_exp_f32 v91, v91
    v_exp_f32 v92, v92
    v_cvt_pk_bf16_f32 v57, v90, v91
    v_exp_f32 v93, v93
    v_exp_f32 v94, v94
    v_exp_f32 v95, v95
    v_cvt_pk_bf16_f32 v58, v92, v93
    v_cvt_pk_bf16_f32 v59, v94, v95
    v_exp_f32 v64, v64
    v_exp_f32 v65, v65
    v_mfma_f32_32x32x16_bf16 v[112:127], a[148:151], v[56:59], v[112:127]
    ds_read_b128 a[148:151], v30 offset:8128
    v_exp_f32 v66, v66
    v_cvt_pk_bf16_f32 v44, v64, v65
    v_exp_f32 v67, v67
    v_exp_f32 v68, v68
    v_mfma_f32_32x32x16_bf16 v[80:95], a[128:131], v[24:27], 0
    ds_read_b128 a[128:131], v29 offset:8704
    v_cvt_pk_bf16_f32 v45, v66, v67
    v_exp_f32 v69, v69
    v_exp_f32 v70, v70
    v_cvt_pk_bf16_f32 v46, v68, v69
    v_exp_f32 v71, v71
    v_exp_f32 v72, v72
    v_cvt_pk_bf16_f32 v47, v70, v71
    v_exp_f32 v73, v73
    v_exp_f32 v74, v74
    v_mfma_f32_32x32x16_bf16 v[96:111], a[136:139], v[44:47], v[96:111]
    buffer_load_dwordx4 v1, s[4:7], s70 offen offset:1024 sc1 lds
    s_waitcnt lgkmcnt(2)
    v_cvt_pk_bf16_f32 v48, v72, v73
    v_exp_f32 v75, v75
    v_exp_f32 v76, v76
    v_cvt_pk_bf16_f32 v49, v74, v75
    v_exp_f32 v77, v77
    v_exp_f32 v78, v78
    v_exp_f32 v79, v79
    v_cvt_pk_bf16_f32 v50, v76, v77
    v_cvt_pk_bf16_f32 v51, v78, v79
    v_exp_f32 v80, v80
    v_exp_f32 v81, v81
    v_mfma_f32_32x32x16_bf16 v[96:111], a[140:143], v[48:51], v[96:111]
    buffer_load_dwordx4 v1, s[4:7], s70 offen offset:2048 sc1 lds
    v_exp_f32 v82, v82
    v_cvt_pk_bf16_f32 v52, v80, v81
    v_exp_f32 v83, v83
    v_exp_f32 v84, v84
    v_mfma_f32_32x32x16_bf16 v[64:79], a[132:135], v[20:23], 0
    buffer_load_dwordx4 v1, s[4:7], s70 offen offset:3072 sc1 lds
    v_cvt_pk_bf16_f32 v53, v82, v83
    v_exp_f32 v85, v85
    v_exp_f32 v86, v86
    v_cvt_pk_bf16_f32 v54, v84, v85
    v_exp_f32 v87, v87
    v_exp_f32 v88, v88
    v_cvt_pk_bf16_f32 v55, v86, v87
    v_exp_f32 v89, v89
    v_exp_f32 v90, v90
    v_mfma_f32_32x32x16_bf16 v[112:127], a[136:139], v[52:55], v[112:127]
    ds_read_b128 a[136:139], v30 offset:9728
    v_cvt_pk_bf16_f32 v56, v88, v89
    v_exp_f32 v91, v91
    v_exp_f32 v92, v92
    v_cvt_pk_bf16_f32 v57, v90, v91
    v_exp_f32 v93, v93
    v_exp_f32 v94, v94
    v_exp_f32 v95, v95
    v_cvt_pk_bf16_f32 v58, v92, v93
    v_cvt_pk_bf16_f32 v59, v94, v95
    v_exp_f32 v64, v64
    v_exp_f32 v65, v65
    v_mfma_f32_32x32x16_bf16 v[112:127], a[140:143], v[56:59], v[112:127]
    ds_read_b128 a[140:143], v30 offset:10304
    v_exp_f32 v66, v66
    v_cvt_pk_bf16_f32 v44, v64, v65
    v_exp_f32 v67, v67
    v_exp_f32 v68, v68
    v_mfma_f32_32x32x16_bf16 v[80:95], a[132:135], v[24:27], 0
    ds_read_b128 a[132:135], v29 offset:10880
    v_cvt_pk_bf16_f32 v45, v66, v67
    v_exp_f32 v69, v69
    v_exp_f32 v70, v70
    v_cvt_pk_bf16_f32 v46, v68, v69
    v_exp_f32 v71, v71
    s_add_u32 m0, s71, 20480
    s_add_u32 s70, s72, 72704
    v_exp_f32 v72, v72
    v_cvt_pk_bf16_f32 v47, v70, v71
    v_exp_f32 v73, v73
    v_exp_f32 v74, v74
    v_mfma_f32_32x32x16_bf16 v[96:111], a[144:147], v[44:47], v[96:111]
    buffer_load_dwordx4 v1, s[4:7], s70 offen offset:0 sc1 lds
    s_waitcnt lgkmcnt(2)
    v_cvt_pk_bf16_f32 v48, v72, v73
    v_exp_f32 v75, v75
    v_exp_f32 v76, v76
    v_cvt_pk_bf16_f32 v49, v74, v75
    v_exp_f32 v77, v77
    v_exp_f32 v78, v78
    v_exp_f32 v79, v79
    v_cvt_pk_bf16_f32 v50, v76, v77
    v_cvt_pk_bf16_f32 v51, v78, v79
    v_exp_f32 v80, v80
    v_exp_f32 v81, v81
    v_mfma_f32_32x32x16_bf16 v[96:111], a[148:151], v[48:51], v[96:111]
    buffer_load_dwordx4 v1, s[4:7], s70 offen offset:1024 sc1 lds
    v_exp_f32 v82, v82
    v_cvt_pk_bf16_f32 v52, v80, v81
    v_exp_f32 v83, v83
    v_exp_f32 v84, v84
    v_mfma_f32_32x32x16_bf16 v[64:79], a[128:131], v[20:23], 0
    v_cvt_pk_bf16_f32 v53, v82, v83
    v_exp_f32 v85, v85
    v_exp_f32 v86, v86
    v_cvt_pk_bf16_f32 v54, v84, v85
    v_exp_f32 v87, v87
    v_exp_f32 v88, v88
    v_cvt_pk_bf16_f32 v55, v86, v87
    v_exp_f32 v89, v89
    v_exp_f32 v90, v90
    v_mfma_f32_32x32x16_bf16 v[112:127], a[144:147], v[52:55], v[112:127]
    ds_read_b128 a[144:147], v30 offset:11904
    v_cvt_pk_bf16_f32 v56, v88, v89
    v_exp_f32 v91, v91
    v_exp_f32 v92, v92
    v_cvt_pk_bf16_f32 v57, v90, v91
    v_exp_f32 v93, v93
    v_exp_f32 v94, v94
    v_exp_f32 v95, v95
    v_cvt_pk_bf16_f32 v58, v92, v93
    v_cvt_pk_bf16_f32 v59, v94, v95
    v_exp_f32 v64, v64
    v_exp_f32 v65, v65
    v_mfma_f32_32x32x16_bf16 v[112:127], a[148:151], v[56:59], v[112:127]
    ds_read_b128 a[148:151], v30 offset:12480
    v_exp_f32 v66, v66
    v_cvt_pk_bf16_f32 v44, v64, v65
    v_exp_f32 v67, v67
    v_exp_f32 v68, v68
    v_mfma_f32_32x32x16_bf16 v[80:95], a[128:131], v[24:27], 0
    ds_read_b128 a[128:131], v29 offset:13056
    v_cvt_pk_bf16_f32 v45, v66, v67
    v_exp_f32 v69, v69
    v_exp_f32 v70, v70
    v_cvt_pk_bf16_f32 v46, v68, v69
    v_exp_f32 v71, v71
    v_exp_f32 v72, v72
    v_cvt_pk_bf16_f32 v47, v70, v71
    v_exp_f32 v73, v73
    v_exp_f32 v74, v74
    v_mfma_f32_32x32x16_bf16 v[96:111], a[136:139], v[44:47], v[96:111]
    s_waitcnt lgkmcnt(2)
    v_cvt_pk_bf16_f32 v48, v72, v73
    v_exp_f32 v75, v75
    v_exp_f32 v76, v76
    v_cvt_pk_bf16_f32 v49, v74, v75
    v_exp_f32 v77, v77
    v_exp_f32 v78, v78
    v_exp_f32 v79, v79
    v_cvt_pk_bf16_f32 v50, v76, v77
    v_cvt_pk_bf16_f32 v51, v78, v79
    v_exp_f32 v80, v80
    v_exp_f32 v81, v81
    v_mfma_f32_32x32x16_bf16 v[96:111], a[140:143], v[48:51], v[96:111]
    v_exp_f32 v82, v82
    v_cvt_pk_bf16_f32 v52, v80, v81
    v_exp_f32 v83, v83
    v_exp_f32 v84, v84
    v_mfma_f32_32x32x16_bf16 v[64:79], a[132:135], v[20:23], 0
    v_cvt_pk_bf16_f32 v53, v82, v83
    v_exp_f32 v85, v85
    v_exp_f32 v86, v86
    v_cvt_pk_bf16_f32 v54, v84, v85
    v_exp_f32 v87, v87
    v_exp_f32 v88, v88
    v_cvt_pk_bf16_f32 v55, v86, v87
    v_exp_f32 v89, v89
    v_exp_f32 v90, v90
    v_mfma_f32_32x32x16_bf16 v[112:127], a[136:139], v[52:55], v[112:127]
    ds_read_b128 a[136:139], v30 offset:14080
    v_cvt_pk_bf16_f32 v56, v88, v89
    v_exp_f32 v91, v91
    v_exp_f32 v92, v92
    v_cvt_pk_bf16_f32 v57, v90, v91
    v_exp_f32 v93, v93
    v_exp_f32 v94, v94
    v_exp_f32 v95, v95
    v_cvt_pk_bf16_f32 v58, v92, v93
    v_cvt_pk_bf16_f32 v59, v94, v95
    v_exp_f32 v64, v64
    v_exp_f32 v65, v65
    v_mfma_f32_32x32x16_bf16 v[112:127], a[140:143], v[56:59], v[112:127]
    ds_read_b128 a[140:143], v30 offset:14656
    v_exp_f32 v66, v66
    v_cvt_pk_bf16_f32 v44, v64, v65
    v_exp_f32 v67, v67
    v_exp_f32 v68, v68
    v_mfma_f32_32x32x16_bf16 v[80:95], a[132:135], v[24:27], 0
    ds_read_b128 a[132:135], v29 offset:15232
    v_cvt_pk_bf16_f32 v45, v66, v67
    v_exp_f32 v69, v69
    v_exp_f32 v70, v70
    v_cvt_pk_bf16_f32 v46, v68, v69
    v_exp_f32 v71, v71
    v_exp_f32 v72, v72
    v_cvt_pk_bf16_f32 v47, v70, v71
    v_exp_f32 v73, v73
    v_exp_f32 v74, v74
    v_mfma_f32_32x32x16_bf16 v[96:111], a[144:147], v[44:47], v[96:111]
    s_waitcnt lgkmcnt(2)
    v_cvt_pk_bf16_f32 v48, v72, v73
    v_exp_f32 v75, v75
    v_exp_f32 v76, v76
    v_cvt_pk_bf16_f32 v49, v74, v75
    v_exp_f32 v77, v77
    v_exp_f32 v78, v78
    v_exp_f32 v79, v79
    v_cvt_pk_bf16_f32 v50, v76, v77
    v_cvt_pk_bf16_f32 v51, v78, v79
    v_exp_f32 v80, v80
    v_exp_f32 v81, v81
    v_mfma_f32_32x32x16_bf16 v[96:111], a[148:151], v[48:51], v[96:111]
    buffer_load_dword v37, v36, s[48:51], s90 offen sc1
    v_exp_f32 v82, v82
    v_cvt_pk_bf16_f32 v52, v80, v81
    v_exp_f32 v83, v83
    v_exp_f32 v84, v84
    v_mfma_f32_32x32x16_bf16 v[64:79], a[128:131], v[20:23], 0
    v_cvt_pk_bf16_f32 v53, v82, v83
    v_exp_f32 v85, v85
    v_exp_f32 v86, v86
    v_cvt_pk_bf16_f32 v54, v84, v85
    v_exp_f32 v87, v87
    v_exp_f32 v88, v88
    v_cvt_pk_bf16_f32 v55, v86, v87
    v_exp_f32 v89, v89
    v_exp_f32 v90, v90
    v_mfma_f32_32x32x16_bf16 v[112:127], a[144:147], v[52:55], v[112:127]
    ds_read_b128 a[144:147], v30 offset:16256
    v_cvt_pk_bf16_f32 v56, v88, v89
    v_exp_f32 v91, v91
    v_exp_f32 v92, v92
    v_cvt_pk_bf16_f32 v57, v90, v91
    v_exp_f32 v93, v93
    v_exp_f32 v94, v94
    v_exp_f32 v95, v95
    v_cvt_pk_bf16_f32 v58, v92, v93
    v_cvt_pk_bf16_f32 v59, v94, v95
    v_exp_f32 v64, v64
    v_exp_f32 v65, v65
    v_mfma_f32_32x32x16_bf16 v[112:127], a[148:151], v[56:59], v[112:127]
    ds_read_b128 a[148:151], v30 offset:16832
    v_exp_f32 v66, v66
    v_cvt_pk_bf16_f32 v44, v64, v65
    v_exp_f32 v67, v67
    v_exp_f32 v68, v68
    v_mfma_f32_32x32x16_bf16 v[80:95], a[128:131], v[24:27], 0
    ds_read_b128 a[128:131], v29 offset:17408
    v_cvt_pk_bf16_f32 v45, v66, v67
    v_exp_f32 v69, v69
    v_exp_f32 v70, v70
    v_cvt_pk_bf16_f32 v46, v68, v69
    v_exp_f32 v71, v71
    v_exp_f32 v72, v72
    v_cvt_pk_bf16_f32 v47, v70, v71
    v_exp_f32 v73, v73
    v_exp_f32 v74, v74
    v_mfma_f32_32x32x16_bf16 v[96:111], a[136:139], v[44:47], v[96:111]
    s_waitcnt lgkmcnt(2)
    v_cvt_pk_bf16_f32 v48, v72, v73
    v_exp_f32 v75, v75
    v_exp_f32 v76, v76
    v_cvt_pk_bf16_f32 v49, v74, v75
    v_exp_f32 v77, v77
    v_exp_f32 v78, v78
    v_exp_f32 v79, v79
    v_cvt_pk_bf16_f32 v50, v76, v77
    v_cvt_pk_bf16_f32 v51, v78, v79
    v_exp_f32 v80, v80
    v_exp_f32 v81, v81
    v_mfma_f32_32x32x16_bf16 v[96:111], a[140:143], v[48:51], v[96:111]
    v_exp_f32 v82, v82
    v_cvt_pk_bf16_f32 v52, v80, v81
    v_exp_f32 v83, v83
    v_exp_f32 v84, v84
    v_mfma_f32_32x32x16_bf16 v[64:79], a[132:135], v[20:23], 0
    v_cvt_pk_bf16_f32 v53, v82, v83
    v_exp_f32 v85, v85
    v_exp_f32 v86, v86
    v_cvt_pk_bf16_f32 v54, v84, v85
    v_exp_f32 v87, v87
    v_exp_f32 v88, v88
    v_cvt_pk_bf16_f32 v55, v86, v87
    v_exp_f32 v89, v89
    v_exp_f32 v90, v90
    v_mfma_f32_32x32x16_bf16 v[112:127], a[136:139], v[52:55], v[112:127]
    ds_read_b128 a[136:139], v30 offset:18432
    v_cvt_pk_bf16_f32 v56, v88, v89
    v_exp_f32 v91, v91
    v_exp_f32 v92, v92
    v_cvt_pk_bf16_f32 v57, v90, v91
    v_exp_f32 v93, v93
    v_exp_f32 v94, v94
    v_exp_f32 v95, v95
    v_cvt_pk_bf16_f32 v58, v92, v93
    v_cvt_pk_bf16_f32 v59, v94, v95
    v_exp_f32 v64, v64
    v_exp_f32 v65, v65
    v_mfma_f32_32x32x16_bf16 v[112:127], a[140:143], v[56:59], v[112:127]
    ds_read_b128 a[140:143], v30 offset:19008
    v_exp_f32 v66, v66
    v_cvt_pk_bf16_f32 v44, v64, v65
    v_exp_f32 v67, v67
    v_exp_f32 v68, v68
    v_mfma_f32_32x32x16_bf16 v[80:95], a[132:135], v[24:27], 0
    ds_read_b128 a[132:135], v29 offset:19584
    v_cvt_pk_bf16_f32 v45, v66, v67
    v_exp_f32 v69, v69
    v_exp_f32 v70, v70
    v_cvt_pk_bf16_f32 v46, v68, v69
    v_exp_f32 v71, v71
    v_exp_f32 v72, v72
    v_cvt_pk_bf16_f32 v47, v70, v71
    v_exp_f32 v73, v73
    v_exp_f32 v74, v74
    v_mfma_f32_32x32x16_bf16 v[96:111], a[144:147], v[44:47], v[96:111]
    s_waitcnt lgkmcnt(2)
    v_cvt_pk_bf16_f32 v48, v72, v73
    v_exp_f32 v75, v75
    v_exp_f32 v76, v76
    v_cvt_pk_bf16_f32 v49, v74, v75
    v_exp_f32 v77, v77
    v_exp_f32 v78, v78
    v_exp_f32 v79, v79
    v_cvt_pk_bf16_f32 v50, v76, v77
    v_cvt_pk_bf16_f32 v51, v78, v79
    v_exp_f32 v80, v80
    v_exp_f32 v81, v81
    v_mfma_f32_32x32x16_bf16 v[96:111], a[148:151], v[48:51], v[96:111]
    v_exp_f32 v82, v82
    v_cvt_pk_bf16_f32 v52, v80, v81
    v_exp_f32 v83, v83
    v_exp_f32 v84, v84
    v_mfma_f32_32x32x16_bf16 v[64:79], a[128:131], v[20:23], 0
    v_cvt_pk_bf16_f32 v53, v82, v83
    v_exp_f32 v85, v85
    v_exp_f32 v86, v86
    v_cvt_pk_bf16_f32 v54, v84, v85
    v_exp_f32 v87, v87
    v_exp_f32 v88, v88
    v_cvt_pk_bf16_f32 v55, v86, v87
    v_exp_f32 v89, v89
    v_exp_f32 v90, v90
    v_mfma_f32_32x32x16_bf16 v[112:127], a[144:147], v[52:55], v[112:127]
    ds_read_b128 a[144:147], v30 offset:20608
    v_cvt_pk_bf16_f32 v56, v88, v89
    v_exp_f32 v91, v91
    v_exp_f32 v92, v92
    v_cvt_pk_bf16_f32 v57, v90, v91
    v_add_u32 v29, 17408, v29
    v_exp_f32 v93, v93
    v_exp_f32 v94, v94
    v_exp_f32 v95, v95
    v_cvt_pk_bf16_f32 v58, v92, v93
    v_cvt_pk_bf16_f32 v59, v94, v95
    v_add_u32 v30, 17408, v30
    s_waitcnt vmcnt(0)
    s_cmp_lg_u32 s54, 0
    s_cbranch_scc1 L_poll6_done
    s_mov_b32 s78, 0x20000
L_poll6:
    v_cmp_eq_u32 vcc, s12, v37
    s_sub_u32 s78, s78, 1
    s_cbranch_scc1 L_poll6_done
    s_cmp_eq_u64 vcc, -1
    s_cbranch_scc1 L_poll6_done
    buffer_load_dword v37, v36, s[48:51], s90 offen sc1
    s_waitcnt vmcnt(0)
    s_branch L_poll6
L_poll6_done:
    s_barrier
    v_and_b32 v32, 31, v0
    v_lshlrev_b32 v32, 2, v32
    s_lshl_b32 s67, s75, 7
    s_add_u32 s67, s67, 61603840
    v_exp_f32 v64, v64
    v_exp_f32 v65, v65
    v_mfma_f32_32x32x16_bf16 v[112:127], a[148:151], v[56:59], v[112:127]
    ds_read_b128 a[148:151], v30 offset:3776
    v_exp_f32 v66, v66
    v_cvt_pk_bf16_f32 v44, v64, v65
    v_exp_f32 v67, v67
    v_exp_f32 v68, v68
    v_mfma_f32_32x32x16_bf16 v[80:95], a[128:131], v[24:27], 0
    ds_read_b128 a[128:131], v29 offset:4352
    v_cvt_pk_bf16_f32 v45, v66, v67
    v_exp_f32 v69, v69
    v_exp_f32 v70, v70
    v_cvt_pk_bf16_f32 v46, v68, v69
    v_exp_f32 v71, v71
    s_xor_b32 s68, s67, 128
    buffer_load_dword v10, v32, s[48:51], s68 offen sc1
    v_exp_f32 v72, v72
    v_cvt_pk_bf16_f32 v47, v70, v71
    v_exp_f32 v73, v73
    v_exp_f32 v74, v74
    v_mfma_f32_32x32x16_bf16 v[96:111], a[136:139], v[44:47], v[96:111]
    buffer_load_dword v8, v32, s[48:51], s67 offen sc1
    s_waitcnt lgkmcnt(2)
    v_cvt_pk_bf16_f32 v48, v72, v73
    v_exp_f32 v75, v75
    v_exp_f32 v76, v76
    v_cvt_pk_bf16_f32 v49, v74, v75
    v_exp_f32 v77, v77
    v_exp_f32 v78, v78
    v_exp_f32 v79, v79
    v_cvt_pk_bf16_f32 v50, v76, v77
    v_cvt_pk_bf16_f32 v51, v78, v79
    v_exp_f32 v80, v80
    v_exp_f32 v81, v81
    v_mfma_f32_32x32x16_bf16 v[96:111], a[140:143], v[48:51], v[96:111]
    buffer_load_dwordx4 a[8:11], v4, s[48:51], s62 offen offset:0 sc1
    v_exp_f32 v82, v82
    v_cvt_pk_bf16_f32 v52, v80, v81
    v_exp_f32 v83, v83
    v_exp_f32 v84, v84
    v_mfma_f32_32x32x16_bf16 v[64:79], a[132:135], v[20:23], 0
    buffer_load_dwordx4 a[0:3], v2, s[48:51], s62 offen offset:0 sc1
    v_cvt_pk_bf16_f32 v53, v82, v83
    v_exp_f32 v85, v85
    v_exp_f32 v86, v86
    v_cvt_pk_bf16_f32 v54, v84, v85
    v_exp_f32 v87, v87
    v_exp_f32 v88, v88
    v_cvt_pk_bf16_f32 v55, v86, v87
    v_exp_f32 v89, v89
    v_exp_f32 v90, v90
    v_mfma_f32_32x32x16_bf16 v[112:127], a[136:139], v[52:55], v[112:127]
    ds_read_b128 a[136:139], v30 offset:5376
    v_cvt_pk_bf16_f32 v56, v88, v89
    v_exp_f32 v91, v91
    v_exp_f32 v92, v92
    v_cvt_pk_bf16_f32 v57, v90, v91
    buffer_load_dwordx4 a[4:7], v3, s[48:51], s62 offen offset:0 sc1
    v_exp_f32 v93, v93
    v_exp_f32 v94, v94
    v_exp_f32 v95, v95
    v_cvt_pk_bf16_f32 v58, v92, v93
    v_cvt_pk_bf16_f32 v59, v94, v95
    v_exp_f32 v64, v64
    v_exp_f32 v65, v65
    v_mfma_f32_32x32x16_bf16 v[112:127], a[140:143], v[56:59], v[112:127]
    ds_read_b128 a[140:143], v30 offset:5952
    v_exp_f32 v66, v66
    v_cvt_pk_bf16_f32 v44, v64, v65
    v_exp_f32 v67, v67
    v_exp_f32 v68, v68
    v_mfma_f32_32x32x16_bf16 v[80:95], a[132:135], v[24:27], 0
    ds_read_b128 a[132:135], v29 offset:6528
    v_cvt_pk_bf16_f32 v45, v66, v67
    v_exp_f32 v69, v69
    v_exp_f32 v70, v70
    v_cvt_pk_bf16_f32 v46, v68, v69
    v_exp_f32 v71, v71
    v_exp_f32 v72, v72
    v_cvt_pk_bf16_f32 v47, v70, v71
    v_exp_f32 v73, v73
    v_exp_f32 v74, v74
    v_mfma_f32_32x32x16_bf16 v[96:111], a[144:147], v[44:47], v[96:111]
    buffer_load_dwordx4 a[12:15], v5, s[48:51], s62 offen offset:0 sc1
    s_waitcnt lgkmcnt(2)
    v_cvt_pk_bf16_f32 v48, v72, v73
    v_exp_f32 v75, v75
    v_exp_f32 v76, v76
    v_cvt_pk_bf16_f32 v49, v74, v75
    v_exp_f32 v77, v77
    v_exp_f32 v78, v78
    v_exp_f32 v79, v79
    v_cvt_pk_bf16_f32 v50, v76, v77
    v_cvt_pk_bf16_f32 v51, v78, v79
    v_exp_f32 v80, v80
    v_exp_f32 v81, v81
    v_mfma_f32_32x32x16_bf16 v[96:111], a[148:151], v[48:51], v[96:111]
    buffer_load_dwordx4 a[24:27], v4, s[48:51], s62 offen offset:1024 sc1
    v_exp_f32 v82, v82
    v_cvt_pk_bf16_f32 v52, v80, v81
    v_exp_f32 v83, v83
    v_exp_f32 v84, v84
    v_mfma_f32_32x32x16_bf16 v[64:79], a[128:131], v[20:23], 0
    buffer_load_dwordx4 a[16:19], v2, s[48:51], s62 offen offset:1024 sc1
    v_cvt_pk_bf16_f32 v53, v82, v83
    v_exp_f32 v85, v85
    v_exp_f32 v86, v86
    v_cvt_pk_bf16_f32 v54, v84, v85
    v_exp_f32 v87, v87
    v_exp_f32 v88, v88
    v_cvt_pk_bf16_f32 v55, v86, v87
    v_exp_f32 v89, v89
    v_exp_f32 v90, v90
    v_mfma_f32_32x32x16_bf16 v[112:127], a[144:147], v[52:55], v[112:127]
    ds_read_b128 a[144:147], v30 offset:7552
    v_cvt_pk_bf16_f32 v56, v88, v89
    v_exp_f32 v91, v91
    v_exp_f32 v92, v92
    v_cvt_pk_bf16_f32 v57, v90, v91
    buffer_load_dwordx4 a[20:23], v3, s[48:51], s62 offen offset:1024 sc1
    v_exp_f32 v93, v93
    v_exp_f32 v94, v94
    v_exp_f32 v95, v95
    v_cvt_pk_bf16_f32 v58, v92, v93
    v_cvt_pk_bf16_f32 v59, v94, v95
    v_exp_f32 v64, v64
    v_exp_f32 v65, v65
    v_mfma_f32_32x32x16_bf16 v[112:127], a[148:151], v[56:59], v[112:127]
    ds_read_b128 a[148:151], v30 offset:8128
    v_exp_f32 v66, v66
    v_cvt_pk_bf16_f32 v44, v64, v65
    v_exp_f32 v67, v67
    v_exp_f32 v68, v68
    v_mfma_f32_32x32x16_bf16 v[80:95], a[128:131], v[24:27], 0
    ds_read_b128 a[128:131], v29 offset:8704
    v_cvt_pk_bf16_f32 v45, v66, v67
    v_exp_f32 v69, v69
    v_exp_f32 v70, v70
    v_cvt_pk_bf16_f32 v46, v68, v69
    v_exp_f32 v71, v71
    v_exp_f32 v72, v72
    v_cvt_pk_bf16_f32 v47, v70, v71
    v_exp_f32 v73, v73
    v_exp_f32 v74, v74
    v_mfma_f32_32x32x16_bf16 v[96:111], a[136:139], v[44:47], v[96:111]
    buffer_load_dwordx4 a[28:31], v5, s[48:51], s62 offen offset:1024 sc1
    s_waitcnt lgkmcnt(2)
    v_cvt_pk_bf16_f32 v48, v72, v73
    v_exp_f32 v75, v75
    v_exp_f32 v76, v76
    v_cvt_pk_bf16_f32 v49, v74, v75
    v_exp_f32 v77, v77
    v_exp_f32 v78, v78
    v_exp_f32 v79, v79
    v_cvt_pk_bf16_f32 v50, v76, v77
    v_cvt_pk_bf16_f32 v51, v78, v79
    v_exp_f32 v80, v80
    v_exp_f32 v81, v81
    v_mfma_f32_32x32x16_bf16 v[96:111], a[140:143], v[48:51], v[96:111]
    buffer_load_dwordx4 a[40:43], v4, s[48:51], s62 offen offset:2048 sc1
    v_exp_f32 v82, v82
    v_cvt_pk_bf16_f32 v52, v80, v81
    v_exp_f32 v83, v83
    v_exp_f32 v84, v84
    v_mfma_f32_32x32x16_bf16 v[64:79], a[132:135], v[20:23], 0
    buffer_load_dwordx4 a[32:35], v2, s[48:51], s62 offen offset:2048 sc1
    v_cvt_pk_bf16_f32 v53, v82, v83
    v_exp_f32 v85, v85
    v_exp_f32 v86, v86
    v_cvt_pk_bf16_f32 v54, v84, v85
    v_exp_f32 v87, v87
    v_exp_f32 v88, v88
    v_cvt_pk_bf16_f32 v55, v86, v87
    v_exp_f32 v89, v89
    v_exp_f32 v90, v90
    v_mfma_f32_32x32x16_bf16 v[112:127], a[136:139], v[52:55], v[112:127]
    ds_read_b128 a[136:139], v30 offset:9728
    v_cvt_pk_bf16_f32 v56, v88, v89
    v_exp_f32 v91, v91
    v_exp_f32 v92, v92
    v_cvt_pk_bf16_f32 v57, v90, v91
    buffer_load_dwordx4 a[36:39], v3, s[48:51], s62 offen offset:2048 sc1
    v_exp_f32 v93, v93
    v_exp_f32 v94, v94
    v_exp_f32 v95, v95
    v_cvt_pk_bf16_f32 v58, v92, v93
    v_cvt_pk_bf16_f32 v59, v94, v95
    v_exp_f32 v64, v64
    v_exp_f32 v65, v65
    v_mfma_f32_32x32x16_bf16 v[112:127], a[140:143], v[56:59], v[112:127]
    ds_read_b128 a[140:143], v30 offset:10304
    v_exp_f32 v66, v66
    v_cvt_pk_bf16_f32 v44, v64, v65
    v_exp_f32 v67, v67
    v_exp_f32 v68, v68
    v_mfma_f32_32x32x16_bf16 v[80:95], a[132:135], v[24:27], 0
    ds_read_b128 a[132:135], v29 offset:10880
    v_cvt_pk_bf16_f32 v45, v66, v67
    v_exp_f32 v69, v69
    v_exp_f32 v70, v70
    v_cvt_pk_bf16_f32 v46, v68, v69
    v_exp_f32 v71, v71
    v_exp_f32 v72, v72
    v_cvt_pk_bf16_f32 v47, v70, v71
    v_exp_f32 v73, v73
    v_exp_f32 v74, v74
    v_mfma_f32_32x32x16_bf16 v[96:111], a[144:147], v[44:47], v[96:111]
    buffer_load_dwordx4 a[44:47], v5, s[48:51], s62 offen offset:2048 sc1
    s_waitcnt lgkmcnt(2)
    v_cvt_pk_bf16_f32 v48, v72, v73
    v_exp_f32 v75, v75
    v_exp_f32 v76, v76
    v_cvt_pk_bf16_f32 v49, v74, v75
    v_exp_f32 v77, v77
    v_exp_f32 v78, v78
    v_exp_f32 v79, v79
    v_cvt_pk_bf16_f32 v50, v76, v77
    v_cvt_pk_bf16_f32 v51, v78, v79
    v_exp_f32 v80, v80
    v_exp_f32 v81, v81
    v_mfma_f32_32x32x16_bf16 v[96:111], a[148:151], v[48:51], v[96:111]
    buffer_load_dwordx4 a[56:59], v4, s[48:51], s62 offen offset:3072 sc1
    v_exp_f32 v82, v82
    v_cvt_pk_bf16_f32 v52, v80, v81
    v_exp_f32 v83, v83
    v_exp_f32 v84, v84
    v_mfma_f32_32x32x16_bf16 v[64:79], a[128:131], v[20:23], 0
    buffer_load_dwordx4 a[48:51], v2, s[48:51], s62 offen offset:3072 sc1
    v_cvt_pk_bf16_f32 v53, v82, v83
    v_exp_f32 v85, v85
    v_exp_f32 v86, v86
    v_cvt_pk_bf16_f32 v54, v84, v85
    v_exp_f32 v87, v87
    v_exp_f32 v88, v88
    v_cvt_pk_bf16_f32 v55, v86, v87
    v_exp_f32 v89, v89
    v_exp_f32 v90, v90
    v_mfma_f32_32x32x16_bf16 v[112:127], a[144:147], v[52:55], v[112:127]
    ds_read_b128 a[144:147], v30 offset:11904
    v_cvt_pk_bf16_f32 v56, v88, v89
    v_exp_f32 v91, v91
    v_exp_f32 v92, v92
    v_cvt_pk_bf16_f32 v57, v90, v91
    buffer_load_dwordx4 a[52:55], v3, s[48:51], s62 offen offset:3072 sc1
    v_exp_f32 v93, v93
    v_exp_f32 v94, v94
    v_exp_f32 v95, v95
    v_cvt_pk_bf16_f32 v58, v92, v93
    v_cvt_pk_bf16_f32 v59, v94, v95
    v_exp_f32 v64, v64
    v_exp_f32 v65, v65
    v_mfma_f32_32x32x16_bf16 v[112:127], a[148:151], v[56:59], v[112:127]
    ds_read_b128 a[148:151], v30 offset:12480
    v_exp_f32 v66, v66
    v_cvt_pk_bf16_f32 v44, v64, v65
    v_exp_f32 v67, v67
    v_exp_f32 v68, v68
    v_mfma_f32_32x32x16_bf16 v[80:95], a[128:131], v[24:27], 0
    ds_read_b128 a[128:131], v29 offset:13056
    v_cvt_pk_bf16_f32 v45, v66, v67
    v_exp_f32 v69, v69
    v_exp_f32 v70, v70
    v_cvt_pk_bf16_f32 v46, v68, v69
    v_exp_f32 v71, v71
    v_exp_f32 v72, v72
    v_cvt_pk_bf16_f32 v47, v70, v71
    v_exp_f32 v73, v73
    v_exp_f32 v74, v74
    v_mfma_f32_32x32x16_bf16 v[96:111], a[136:139], v[44:47], v[96:111]
    buffer_load_dwordx4 a[60:63], v5, s[48:51], s62 offen offset:3072 sc1
    s_add_u32 s62, s62, 4096
    s_waitcnt lgkmcnt(2)
    v_cvt_pk_bf16_f32 v48, v72, v73
    v_exp_f32 v75, v75
    v_exp_f32 v76, v76
    v_cvt_pk_bf16_f32 v49, v74, v75
    v_exp_f32 v77, v77
    v_exp_f32 v78, v78
    v_exp_f32 v79, v79
    v_cvt_pk_bf16_f32 v50, v76, v77
    v_cvt_pk_bf16_f32 v51, v78, v79
    v_exp_f32 v80, v80
    v_exp_f32 v81, v81
    v_mfma_f32_32x32x16_bf16 v[96:111], a[140:143], v[48:51], v[96:111]
    buffer_load_dwordx4 a[72:75], v4, s[48:51], s62 offen offset:0 sc1
    v_exp_f32 v82, v82
    v_cvt_pk_bf16_f32 v52, v80, v81
    v_exp_f32 v83, v83
    v_exp_f32 v84, v84
    v_mfma_f32_32x32x16_bf16 v[64:79], a[132:135], v[20:23], 0
    buffer_load_dwordx4 a[64:67], v2, s[48:51], s62 offen offset:0 sc1
    v_cvt_pk_bf16_f32 v53, v82, v83
    v_exp_f32 v85, v85
    v_exp_f32 v86, v86
    v_cvt_pk_bf16_f32 v54, v84, v85
    v_exp_f32 v87, v87
    v_exp_f32 v88, v88
    v_cvt_pk_bf16_f32 v55, v86, v87
    v_exp_f32 v89, v89
    v_exp_f32 v90, v90
    v_mfma_f32_32x32x16_bf16 v[112:127], a[136:139], v[52:55], v[112:127]
    ds_read_b128 a[136:139], v30 offset:14080
    v_cvt_pk_bf16_f32 v56, v88, v89
    v_exp_f32 v91, v91
    v_exp_f32 v92, v92
    v_cvt_pk_bf16_f32 v57, v90, v91
    buffer_load_dwordx4 a[68:71], v3, s[48:51], s62 offen offset:0 sc1
    v_exp_f32 v93, v93
    v_exp_f32 v94, v94
    v_exp_f32 v95, v95
    v_cvt_pk_bf16_f32 v58, v92, v93
    v_cvt_pk_bf16_f32 v59, v94, v95
    v_exp_f32 v64, v64
    v_exp_f32 v65, v65
    v_mfma_f32_32x32x16_bf16 v[112:127], a[140:143], v[56:59], v[112:127]
    ds_read_b128 a[140:143], v30 offset:14656
    v_exp_f32 v66, v66
    v_cvt_pk_bf16_f32 v44, v64, v65
    v_exp_f32 v67, v67
    v_exp_f32 v68, v68
    v_mfma_f32_32x32x16_bf16 v[80:95], a[132:135], v[24:27], 0
    ds_read_b128 a[132:135], v29 offset:15232
    v_cvt_pk_bf16_f32 v45, v66, v67
    v_exp_f32 v69, v69
    v_exp_f32 v70, v70
    v_cvt_pk_bf16_f32 v46, v68, v69
    v_exp_f32 v71, v71
    v_exp_f32 v72, v72
    v_cvt_pk_bf16_f32 v47, v70, v71
    v_exp_f32 v73, v73
    v_exp_f32 v74, v74
    v_mfma_f32_32x32x16_bf16 v[96:111], a[144:147], v[44:47], v[96:111]
    buffer_load_dwordx4 a[76:79], v5, s[48:51], s62 offen offset:0 sc1
    s_waitcnt lgkmcnt(2)
    v_cvt_pk_bf16_f32 v48, v72, v73
    v_exp_f32 v75, v75
    v_exp_f32 v76, v76
    v_cvt_pk_bf16_f32 v49, v74, v75
    v_exp_f32 v77, v77
    v_exp_f32 v78, v78
    v_exp_f32 v79, v79
    v_cvt_pk_bf16_f32 v50, v76, v77
    v_cvt_pk_bf16_f32 v51, v78, v79
    v_exp_f32 v80, v80
    v_exp_f32 v81, v81
    v_mfma_f32_32x32x16_bf16 v[96:111], a[148:151], v[48:51], v[96:111]
    buffer_load_dwordx4 a[88:91], v4, s[48:51], s62 offen offset:1024 sc1
    v_exp_f32 v82, v82
    v_cvt_pk_bf16_f32 v52, v80, v81
    v_exp_f32 v83, v83
    v_exp_f32 v84, v84
    v_mfma_f32_32x32x16_bf16 v[64:79], a[128:131], v[20:23], 0
    buffer_load_dwordx4 a[80:83], v2, s[48:51], s62 offen offset:1024 sc1
    v_cvt_pk_bf16_f32 v53, v82, v83
    v_exp_f32 v85, v85
    v_exp_f32 v86, v86
    v_cvt_pk_bf16_f32 v54, v84, v85
    v_exp_f32 v87, v87
    v_exp_f32 v88, v88
    v_cvt_pk_bf16_f32 v55, v86, v87
    v_exp_f32 v89, v89
    v_exp_f32 v90, v90
    v_mfma_f32_32x32x16_bf16 v[112:127], a[144:147], v[52:55], v[112:127]
    ds_read_b128 a[144:147], v30 offset:16256
    v_cvt_pk_bf16_f32 v56, v88, v89
    v_exp_f32 v91, v91
    v_exp_f32 v92, v92
    v_cvt_pk_bf16_f32 v57, v90, v91
    buffer_load_dwordx4 a[84:87], v3, s[48:51], s62 offen offset:1024 sc1
    v_exp_f32 v93, v93
    v_exp_f32 v94, v94
    v_exp_f32 v95, v95
    v_cvt_pk_bf16_f32 v58, v92, v93
    v_cvt_pk_bf16_f32 v59, v94, v95
    v_exp_f32 v64, v64
    v_exp_f32 v65, v65
    v_mfma_f32_32x32x16_bf16 v[112:127], a[148:151], v[56:59], v[112:127]
    ds_read_b128 a[148:151], v30 offset:16832
    v_exp_f32 v66, v66
    v_cvt_pk_bf16_f32 v44, v64, v65
    v_exp_f32 v67, v67
    v_exp_f32 v68, v68
    v_mfma_f32_32x32x16_bf16 v[80:95], a[128:131], v[24:27], 0
    ds_read_b128 a[128:131], v29 offset:17408
    v_cvt_pk_bf16_f32 v45, v66, v67
    v_exp_f32 v69, v69
    v_exp_f32 v70, v70
    v_cvt_pk_bf16_f32 v46, v68, v69
    v_exp_f32 v71, v71
    v_exp_f32 v72, v72
    v_cvt_pk_bf16_f32 v47, v70, v71
    v_exp_f32 v73, v73
    v_exp_f32 v74, v74
    v_mfma_f32_32x32x16_bf16 v[96:111], a[136:139], v[44:47], v[96:111]
    buffer_load_dwordx4 a[92:95], v5, s[48:51], s62 offen offset:1024 sc1
    s_waitcnt lgkmcnt(2)
    v_cvt_pk_bf16_f32 v48, v72, v73
    v_exp_f32 v75, v75
    v_exp_f32 v76, v76
    v_cvt_pk_bf16_f32 v49, v74, v75
    v_exp_f32 v77, v77
    v_exp_f32 v78, v78
    v_exp_f32 v79, v79
    v_cvt_pk_bf16_f32 v50, v76, v77
    v_cvt_pk_bf16_f32 v51, v78, v79
    v_exp_f32 v80, v80
    v_exp_f32 v81, v81
    v_mfma_f32_32x32x16_bf16 v[96:111], a[140:143], v[48:51], v[96:111]
    buffer_load_dwordx4 a[104:107], v4, s[48:51], s62 offen offset:2048 sc1
    v_exp_f32 v82, v82
    v_cvt_pk_bf16_f32 v52, v80, v81
    v_exp_f32 v83, v83
    v_exp_f32 v84, v84
    v_mfma_f32_32x32x16_bf16 v[64:79], a[132:135], v[20:23], 0
    buffer_load_dwordx4 a[96:99], v2, s[48:51], s62 offen offset:2048 sc1
    v_cvt_pk_bf16_f32 v53, v82, v83
    v_exp_f32 v85, v85
    v_exp_f32 v86, v86
    v_cvt_pk_bf16_f32 v54, v84, v85
    v_exp_f32 v87, v87
    v_exp_f32 v88, v88
    v_cvt_pk_bf16_f32 v55, v86, v87
    v_exp_f32 v89, v89
    v_exp_f32 v90, v90
    v_mfma_f32_32x32x16_bf16 v[112:127], a[136:139], v[52:55], v[112:127]
    ds_read_b128 a[136:139], v30 offset:18432
    v_cvt_pk_bf16_f32 v56, v88, v89
    v_exp_f32 v91, v91
    v_exp_f32 v92, v92
    v_cvt_pk_bf16_f32 v57, v90, v91
    buffer_load_dwordx4 a[100:103], v3, s[48:51], s62 offen offset:2048 sc1
    v_exp_f32 v93, v93
    v_exp_f32 v94, v94
    v_exp_f32 v95, v95
    v_cvt_pk_bf16_f32 v58, v92, v93
    v_cvt_pk_bf16_f32 v59, v94, v95
    v_exp_f32 v64, v64
    v_exp_f32 v65, v65
    v_mfma_f32_32x32x16_bf16 v[112:127], a[140:143], v[56:59], v[112:127]
    ds_read_b128 a[140:143], v30 offset:19008
    v_exp_f32 v66, v66
    v_cvt_pk_bf16_f32 v44, v64, v65
    v_exp_f32 v67, v67
    v_exp_f32 v68, v68
    v_mfma_f32_32x32x16_bf16 v[80:95], a[132:135], v[24:27], 0
    ds_read_b128 a[132:135], v29 offset:19584
    v_cvt_pk_bf16_f32 v45, v66, v67
    v_exp_f32 v69, v69
    v_exp_f32 v70, v70
    v_cvt_pk_bf16_f32 v46, v68, v69
    v_exp_f32 v71, v71
    v_exp_f32 v72, v72
    v_cvt_pk_bf16_f32 v47, v70, v71
    v_exp_f32 v73, v73
    v_exp_f32 v74, v74
    v_mfma_f32_32x32x16_bf16 v[96:111], a[144:147], v[44:47], v[96:111]
    buffer_load_dwordx4 a[108:111], v5, s[48:51], s62 offen offset:2048 sc1
    s_waitcnt lgkmcnt(2)
    v_cvt_pk_bf16_f32 v48, v72, v73
    v_exp_f32 v75, v75
    v_exp_f32 v76, v76
    v_cvt_pk_bf16_f32 v49, v74, v75
    v_exp_f32 v77, v77
    v_exp_f32 v78, v78
    v_exp_f32 v79, v79
    v_cvt_pk_bf16_f32 v50, v76, v77
    v_cvt_pk_bf16_f32 v51, v78, v79
    v_exp_f32 v80, v80
    v_exp_f32 v81, v81
    v_mfma_f32_32x32x16_bf16 v[96:111], a[148:151], v[48:51], v[96:111]
    buffer_load_dwordx4 a[120:123], v4, s[48:51], s62 offen offset:3072 sc1
    v_exp_f32 v82, v82
    v_cvt_pk_bf16_f32 v52, v80, v81
    v_exp_f32 v83, v83
    v_exp_f32 v84, v84
    v_mfma_f32_32x32x16_bf16 v[64:79], a[128:131], v[20:23], 0
    buffer_load_dwordx4 a[112:115], v2, s[48:51], s62 offen offset:3072 sc1
    v_cvt_pk_bf16_f32 v53, v82, v83
    v_exp_f32 v85, v85
    v_exp_f32 v86, v86
    v_cvt_pk_bf16_f32 v54, v84, v85
    v_exp_f32 v87, v87
    s_waitcnt vmcnt(26)
    v_exp_f32 v88, v88
    v_cvt_pk_bf16_f32 v55, v86, v87
    v_exp_f32 v89, v89
    v_exp_f32 v90, v90
    v_mfma_f32_32x32x16_bf16 v[112:127], a[144:147], v[52:55], v[112:127]
    ds_read_b128 a[144:147], v30 offset:20608
    v_cvt_pk_bf16_f32 v56, v88, v89
    v_exp_f32 v91, v91
    v_exp_f32 v92, v92
    v_cvt_pk_bf16_f32 v57, v90, v91
    buffer_load_dwordx4 a[116:119], v3, s[48:51], s62 offen offset:3072 sc1
    v_add_u32 v29, -133120, v29
    v_exp_f32 v93, v93
    v_exp_f32 v94, v94
    v_exp_f32 v95, v95
    v_cvt_pk_bf16_f32 v58, v92, v93
    v_cvt_pk_bf16_f32 v59, v94, v95
    v_add_u32 v30, -133120, v30
    v_mov_b64 v[128:129], 0
    v_mov_b64 v[130:131], 0
    v_mov_b64 v[132:133], 0
    v_mov_b64 v[134:135], 0
    v_mov_b64 v[136:137], 0
    v_mov_b64 v[138:139], 0
    v_mov_b64 v[140:141], 0
    v_mov_b64 v[142:143], 0
    v_mov_b64 v[144:145], 0
    v_mov_b64 v[146:147], 0
    v_mov_b64 v[148:149], 0
    v_mov_b64 v[150:151], 0
    v_mov_b64 v[152:153], 0
    v_mov_b64 v[154:155], 0
    v_mov_b64 v[156:157], 0
    v_mov_b64 v[158:159], 0
    v_mov_b64 v[160:161], 0
    v_mov_b64 v[162:163], 0
    v_mov_b64 v[164:165], 0
    v_mov_b64 v[166:167], 0
    v_mov_b64 v[168:169], 0
    v_mov_b64 v[170:171], 0
    v_mov_b64 v[172:173], 0
    v_mov_b64 v[174:175], 0
    v_mov_b64 v[176:177], 0
    v_mov_b64 v[178:179], 0
    v_mov_b64 v[180:181], 0
    v_mov_b64 v[182:183], 0
    v_mov_b64 v[184:185], 0
    v_mov_b64 v[186:187], 0
    v_mov_b64 v[188:189], 0
    v_mov_b64 v[190:191], 0
    s_mov_b32 s70, 4
L_p45_loop:
    v_exp_f32 v64, v64
    v_exp_f32 v65, v65
    v_mfma_f32_32x32x16_bf16 v[112:127], a[148:151], v[56:59], v[112:127]
    ds_read_b128 a[148:151], v30 offset:3776
    v_exp_f32 v66, v66
    v_cvt_pk_bf16_f32 v44, v64, v65
    v_exp_f32 v67, v67
    v_exp_f32 v68, v68
    v_mfma_f32_32x32x16_bf16 v[80:95], a[128:131], v[24:27], 0
    ds_read_b128 a[128:131], v29 offset:4352
    v_cvt_pk_bf16_f32 v45, v66, v67
    v_exp_f32 v69, v69
    v_exp_f32 v70, v70
    v_cvt_pk_bf16_f32 v46, v68, v69
    v_exp_f32 v71, v71
    v_mfma_f32_32x32x16_bf16 v[128:143], a[8:11], a[0:3], v[128:143]
    buffer_load_dwordx4 a[124:127], v5, s[48:51], s62 offen offset:3072 sc1
    s_add_u32 s62, s62, 4096
    v_exp_f32 v72, v72
    v_cvt_pk_bf16_f32 v47, v70, v71
    v_exp_f32 v73, v73
    v_exp_f32 v74, v74
    v_mfma_f32_32x32x16_bf16 v[96:111], a[136:139], v[44:47], v[96:111]
    s_waitcnt lgkmcnt(2)
    v_cvt_pk_bf16_f32 v48, v72, v73
    v_exp_f32 v75, v75
    v_exp_f32 v76, v76
    v_cvt_pk_bf16_f32 v49, v74, v75
    v_mfma_f32_32x32x16_bf16 v[144:159], a[8:11], a[4:7], v[144:159]
    buffer_load_dwordx4 a[8:11], v4, s[48:51], s62 offen offset:0 sc1
    v_exp_f32 v77, v77
    v_exp_f32 v78, v78
    v_exp_f32 v79, v79
    v_cvt_pk_bf16_f32 v50, v76, v77
    v_cvt_pk_bf16_f32 v51, v78, v79
    v_exp_f32 v80, v80
    v_exp_f32 v81, v81
    v_mfma_f32_32x32x16_bf16 v[96:111], a[140:143], v[48:51], v[96:111]
    v_exp_f32 v82, v82
    v_cvt_pk_bf16_f32 v52, v80, v81
    v_exp_f32 v83, v83
    v_exp_f32 v84, v84
    v_mfma_f32_32x32x16_bf16 v[64:79], a[132:135], v[20:23], 0
    s_waitcnt vmcnt(25)
    v_cvt_pk_bf16_f32 v53, v82, v83
    v_exp_f32 v85, v85
    v_exp_f32 v86, v86
    v_cvt_pk_bf16_f32 v54, v84, v85
    v_exp_f32 v87, v87
    v_mfma_f32_32x32x16_bf16 v[160:175], a[12:15], a[0:3], v[160:175]
    buffer_load_dwordx4 a[0:3], v2, s[48:51], s62 offen offset:0 sc1
    v_exp_f32 v88, v88
    v_cvt_pk_bf16_f32 v55, v86, v87
    v_exp_f32 v89, v89
    v_exp_f32 v90, v90
    v_mfma_f32_32x32x16_bf16 v[112:127], a[136:139], v[52:55], v[112:127]
    ds_read_b128 a[136:139], v30 offset:5376
    v_cvt_pk_bf16_f32 v56, v88, v89
    v_exp_f32 v91, v91
    v_exp_f32 v92, v92
    v_cvt_pk_bf16_f32 v57, v90, v91
    v_mfma_f32_32x32x16_bf16 v[176:191], a[12:15], a[4:7], v[176:191]
    buffer_load_dwordx4 a[4:7], v3, s[48:51], s62 offen offset:0 sc1
    v_exp_f32 v93, v93
    v_exp_f32 v94, v94
    v_exp_f32 v95, v95
    v_cvt_pk_bf16_f32 v58, v92, v93
    v_cvt_pk_bf16_f32 v59, v94, v95
    v_exp_f32 v64, v64
    v_exp_f32 v65, v65
    v_mfma_f32_32x32x16_bf16 v[112:127], a[140:143], v[56:59], v[112:127]
    ds_read_b128 a[140:143], v30 offset:5952
    v_exp_f32 v66, v66
    v_cvt_pk_bf16_f32 v44, v64, v65
    v_exp_f32 v67, v67
    v_exp_f32 v68, v68
    v_mfma_f32_32x32x16_bf16 v[80:95], a[132:135], v[24:27], 0
    ds_read_b128 a[132:135], v29 offset:6528
    v_cvt_pk_bf16_f32 v45, v66, v67
    v_exp_f32 v69, v69
    v_exp_f32 v70, v70
    v_cvt_pk_bf16_f32 v46, v68, v69
    v_exp_f32 v71, v71
    v_mfma_f32_32x32x16_bf16 v[128:143], a[24:27], a[16:19], v[128:143]
    buffer_load_dwordx4 a[12:15], v5, s[48:51], s62 offen offset:0 sc1
    v_exp_f32 v72, v72
    v_cvt_pk_bf16_f32 v47, v70, v71
    v_exp_f32 v73, v73
    v_exp_f32 v74, v74
    v_mfma_f32_32x32x16_bf16 v[96:111], a[144:147], v[44:47], v[96:111]
    s_waitcnt lgkmcnt(2)
    v_cvt_pk_bf16_f32 v48, v72, v73
    v_exp_f32 v75, v75
    v_exp_f32 v76, v76
    v_cvt_pk_bf16_f32 v49, v74, v75
    v_mfma_f32_32x32x16_bf16 v[144:159], a[24:27], a[20:23], v[144:159]
    buffer_load_dwordx4 a[24:27], v4, s[48:51], s62 offen offset:1024 sc1
    v_exp_f32 v77, v77
    v_exp_f32 v78, v78
    v_exp_f32 v79, v79
    v_cvt_pk_bf16_f32 v50, v76, v77
    v_cvt_pk_bf16_f32 v51, v78, v79
    v_exp_f32 v80, v80
    v_exp_f32 v81, v81
    v_mfma_f32_32x32x16_bf16 v[96:111], a[148:151], v[48:51], v[96:111]
    v_exp_f32 v82, v82
    v_cvt_pk_bf16_f32 v52, v80, v81
    v_exp_f32 v83, v83
    v_exp_f32 v84, v84
    v_mfma_f32_32x32x16_bf16 v[64:79], a[128:131], v[20:23], 0
    s_waitcnt vmcnt(25)
    v_cvt_pk_bf16_f32 v53, v82, v83
    v_exp_f32 v85, v85
    v_exp_f32 v86, v86
    v_cvt_pk_bf16_f32 v54, v84, v85
    v_exp_f32 v87, v87
    v_mfma_f32_32x32x16_bf16 v[160:175], a[28:31], a[16:19], v[160:175]
    buffer_load_dwordx4 a[16:19], v2, s[48:51], s62 offen offset:1024 sc1
    v_exp_f32 v88, v88
    v_cvt_pk_bf16_f32 v55, v86, v87
    v_exp_f32 v89, v89
    v_exp_f32 v90, v90
    v_mfma_f32_32x32x16_bf16 v[112:127], a[144:147], v[52:55], v[112:127]
    ds_read_b128 a[144:147], v30 offset:7552
    v_cvt_pk_bf16_f32 v56, v88, v89
    v_exp_f32 v91, v91
    v_exp_f32 v92, v92
    v_cvt_pk_bf16_f32 v57, v90, v91
    v_mfma_f32_32x32x16_bf16 v[176:191], a[28:31], a[20:23], v[176:191]
    buffer_load_dwordx4 a[20:23], v3, s[48:51], s62 offen offset:1024 sc1
    v_exp_f32 v93, v93
    v_exp_f32 v94, v94
    v_exp_f32 v95, v95
    v_cvt_pk_bf16_f32 v58, v92, v93
    v_cvt_pk_bf16_f32 v59, v94, v95
    v_exp_f32 v64, v64
    v_exp_f32 v65, v65
    v_mfma_f32_32x32x16_bf16 v[112:127], a[148:151], v[56:59], v[112:127]
    ds_read_b128 a[148:151], v30 offset:8128
    v_exp_f32 v66, v66
    v_cvt_pk_bf16_f32 v44, v64, v65
    v_exp_f32 v67, v67
    v_exp_f32 v68, v68
    v_mfma_f32_32x32x16_bf16 v[80:95], a[128:131], v[24:27], 0
    ds_read_b128 a[128:131], v29 offset:8704
    v_cvt_pk_bf16_f32 v45, v66, v67
    v_exp_f32 v69, v69
    v_exp_f32 v70, v70
    v_cvt_pk_bf16_f32 v46, v68, v69
    v_exp_f32 v71, v71
    v_mfma_f32_32x32x16_bf16 v[128:143], a[40:43], a[32:35], v[128:143]
    buffer_load_dwordx4 a[28:31], v5, s[48:51], s62 offen offset:1024 sc1
    v_exp_f32 v72, v72
    v_cvt_pk_bf16_f32 v47, v70, v71
    v_exp_f32 v73, v73
    v_exp_f32 v74, v74
    v_mfma_f32_32x32x16_bf16 v[96:111], a[136:139], v[44:47], v[96:111]
    s_waitcnt lgkmcnt(2)
    v_cvt_pk_bf16_f32 v48, v72, v73
    v_exp_f32 v75, v75
    v_exp_f32 v76, v76
    v_cvt_pk_bf16_f32 v49, v74, v75
    v_mfma_f32_32x32x16_bf16 v[144:159], a[40:43], a[36:39], v[144:159]
    buffer_load_dwordx4 a[40:43], v4, s[48:51], s62 offen offset:2048 sc1
    v_exp_f32 v77, v77
    v_exp_f32 v78, v78
    v_exp_f32 v79, v79
    v_cvt_pk_bf16_f32 v50, v76, v77
    v_cvt_pk_bf16_f32 v51, v78, v79
    v_exp_f32 v80, v80
    v_exp_f32 v81, v81
    v_mfma_f32_32x32x16_bf16 v[96:111], a[140:143], v[48:51], v[96:111]
    s_sub_u32 s70, s70, 1
    v_exp_f32 v82, v82
    v_cvt_pk_bf16_f32 v52, v80, v81
    v_exp_f32 v83, v83
    v_exp_f32 v84, v84
    v_mfma_f32_32x32x16_bf16 v[64:79], a[132:135], v[20:23], 0
    s_waitcnt vmcnt(25)
    v_cvt_pk_bf16_f32 v53, v82, v83
    v_exp_f32 v85, v85
    v_exp_f32 v86, v86
    v_cvt_pk_bf16_f32 v54, v84, v85
    v_exp_f32 v87, v87
    v_mfma_f32_32x32x16_bf16 v[160:175], a[44:47], a[32:35], v[160:175]
    buffer_load_dwordx4 a[32:35], v2, s[48:51], s62 offen offset:2048 sc1
    v_exp_f32 v88, v88
    v_cvt_pk_bf16_f32 v55, v86, v87
    v_exp_f32 v89, v89
    v_exp_f32 v90, v90
    v_mfma_f32_32x32x16_bf16 v[112:127], a[136:139], v[52:55], v[112:127]
    ds_read_b128 a[136:139], v30 offset:9728
    v_cvt_pk_bf16_f32 v56, v88, v89
    v_exp_f32 v91, v91
    v_exp_f32 v92, v92
    v_cvt_pk_bf16_f32 v57, v90, v91
    v_mfma_f32_32x32x16_bf16 v[176:191], a[44:47], a[36:39], v[176:191]
    buffer_load_dwordx4 a[36:39], v3, s[48:51], s62 offen offset:2048 sc1
    v_exp_f32 v93, v93
    v_exp_f32 v94, v94
    v_exp_f32 v95, v95
    v_cvt_pk_bf16_f32 v58, v92, v93
    v_cvt_pk_bf16_f32 v59, v94, v95
    v_exp_f32 v64, v64
    v_exp_f32 v65, v65
    v_mfma_f32_32x32x16_bf16 v[112:127], a[140:143], v[56:59], v[112:127]
    ds_read_b128 a[140:143], v30 offset:10304
    v_exp_f32 v66, v66
    v_cvt_pk_bf16_f32 v44, v64, v65
    v_exp_f32 v67, v67
    v_exp_f32 v68, v68
    v_mfma_f32_32x32x16_bf16 v[80:95], a[132:135], v[24:27], 0
    ds_read_b128 a[132:135], v29 offset:10880
    v_cvt_pk_bf16_f32 v45, v66, v67
    v_exp_f32 v69, v69
    v_exp_f32 v70, v70
    v_cvt_pk_bf16_f32 v46, v68, v69
    v_exp_f32 v71, v71
    v_mfma_f32_32x32x16_bf16 v[128:143], a[56:59], a[48:51], v[128:143]
    buffer_load_dwordx4 a[44:47], v5, s[48:51], s62 offen offset:2048 sc1
    v_exp_f32 v72, v72
    v_cvt_pk_bf16_f32 v47, v70, v71
    v_exp_f32 v73, v73
    v_exp_f32 v74, v74
    v_mfma_f32_32x32x16_bf16 v[96:111], a[144:147], v[44:47], v[96:111]
    s_waitcnt lgkmcnt(2)
    v_cvt_pk_bf16_f32 v48, v72, v73
    v_exp_f32 v75, v75
    v_exp_f32 v76, v76
    v_cvt_pk_bf16_f32 v49, v74, v75
    v_mfma_f32_32x32x16_bf16 v[144:159], a[56:59], a[52:55], v[144:159]
    buffer_load_dwordx4 a[56:59], v4, s[48:51], s62 offen offset:3072 sc1
    v_exp_f32 v77, v77
    v_exp_f32 v78, v78
    v_exp_f32 v79, v79
    v_cvt_pk_bf16_f32 v50, v76, v77
    v_cvt_pk_bf16_f32 v51, v78, v79
    v_exp_f32 v80, v80
    v_exp_f32 v81, v81
    v_mfma_f32_32x32x16_bf16 v[96:111], a[148:151], v[48:51], v[96:111]
    v_exp_f32 v82, v82
    v_cvt_pk_bf16_f32 v52, v80, v81
    v_exp_f32 v83, v83
    v_exp_f32 v84, v84
    v_mfma_f32_32x32x16_bf16 v[64:79], a[128:131], v[20:23], 0
    s_waitcnt vmcnt(25)
    v_cvt_pk_bf16_f32 v53, v82, v83
    v_exp_f32 v85, v85
    v_exp_f32 v86, v86
    v_cvt_pk_bf16_f32 v54, v84, v85
    v_exp_f32 v87, v87
    v_mfma_f32_32x32x16_bf16 v[160:175], a[60:63], a[48:51], v[160:175]
    buffer_load_dwordx4 a[48:51], v2, s[48:51], s62 offen offset:3072 sc1
    v_exp_f32 v88, v88
    v_cvt_pk_bf16_f32 v55, v86, v87
    v_exp_f32 v89, v89
    v_exp_f32 v90, v90
    v_mfma_f32_32x32x16_bf16 v[112:127], a[144:147], v[52:55], v[112:127]
    ds_read_b128 a[144:147], v30 offset:11904
    v_cvt_pk_bf16_f32 v56, v88, v89
    v_exp_f32 v91, v91
    v_exp_f32 v92, v92
    v_cvt_pk_bf16_f32 v57, v90, v91
    v_mfma_f32_32x32x16_bf16 v[176:191], a[60:63], a[52:55], v[176:191]
    buffer_load_dwordx4 a[52:55], v3, s[48:51], s62 offen offset:3072 sc1
    v_exp_f32 v93, v93
    v_exp_f32 v94, v94
    v_exp_f32 v95, v95
    v_cvt_pk_bf16_f32 v58, v92, v93
    v_cvt_pk_bf16_f32 v59, v94, v95
    v_exp_f32 v64, v64
    v_exp_f32 v65, v65
    v_mfma_f32_32x32x16_bf16 v[112:127], a[148:151], v[56:59], v[112:127]
    ds_read_b128 a[148:151], v30 offset:12480
    v_exp_f32 v66, v66
    v_cvt_pk_bf16_f32 v44, v64, v65
    v_exp_f32 v67, v67
    v_exp_f32 v68, v68
    v_mfma_f32_32x32x16_bf16 v[80:95], a[128:131], v[24:27], 0
    ds_read_b128 a[128:131], v29 offset:13056
    v_cvt_pk_bf16_f32 v45, v66, v67
    v_exp_f32 v69, v69
    v_exp_f32 v70, v70
    v_cvt_pk_bf16_f32 v46, v68, v69
    v_exp_f32 v71, v71
    v_mfma_f32_32x32x16_bf16 v[128:143], a[72:75], a[64:67], v[128:143]
    buffer_load_dwordx4 a[60:63], v5, s[48:51], s62 offen offset:3072 sc1
    s_add_u32 s62, s62, 4096
    v_exp_f32 v72, v72
    v_cvt_pk_bf16_f32 v47, v70, v71
    v_exp_f32 v73, v73
    v_exp_f32 v74, v74
    v_mfma_f32_32x32x16_bf16 v[96:111], a[136:139], v[44:47], v[96:111]
    s_waitcnt lgkmcnt(2)
    v_cvt_pk_bf16_f32 v48, v72, v73
    v_exp_f32 v75, v75
    v_exp_f32 v76, v76
    v_cvt_pk_bf16_f32 v49, v74, v75
    v_mfma_f32_32x32x16_bf16 v[144:159], a[72:75], a[68:71], v[144:159]
    buffer_load_dwordx4 a[72:75], v4, s[48:51], s62 offen offset:0 sc1
    v_exp_f32 v77, v77
    v_exp_f32 v78, v78
    v_exp_f32 v79, v79
    v_cvt_pk_bf16_f32 v50, v76, v77
    v_cvt_pk_bf16_f32 v51, v78, v79
    v_exp_f32 v80, v80
    v_exp_f32 v81, v81
    v_mfma_f32_32x32x16_bf16 v[96:111], a[140:143], v[48:51], v[96:111]
    v_exp_f32 v82, v82
    v_cvt_pk_bf16_f32 v52, v80, v81
    v_exp_f32 v83, v83
    v_exp_f32 v84, v84
    v_mfma_f32_32x32x16_bf16 v[64:79], a[132:135], v[20:23], 0
    s_waitcnt vmcnt(25)
    v_cvt_pk_bf16_f32 v53, v82, v83
    v_exp_f32 v85, v85
    v_exp_f32 v86, v86
    v_cvt_pk_bf16_f32 v54, v84, v85
    v_exp_f32 v87, v87
    v_mfma_f32_32x32x16_bf16 v[160:175], a[76:79], a[64:67], v[160:175]
    buffer_load_dwordx4 a[64:67], v2, s[48:51], s62 offen offset:0 sc1
    v_exp_f32 v88, v88
    v_cvt_pk_bf16_f32 v55, v86, v87
    v_exp_f32 v89, v89
    v_exp_f32 v90, v90
    v_mfma_f32_32x32x16_bf16 v[112:127], a[136:139], v[52:55], v[112:127]
    ds_read_b128 a[136:139], v30 offset:14080
    v_cvt_pk_bf16_f32 v56, v88, v89
    v_exp_f32 v91, v91
    v_exp_f32 v92, v92
    v_cvt_pk_bf16_f32 v57, v90, v91
    v_mfma_f32_32x32x16_bf16 v[176:191], a[76:79], a[68:71], v[176:191]
    buffer_load_dwordx4 a[68:71], v3, s[48:51], s62 offen offset:0 sc1
    v_exp_f32 v93, v93
    v_exp_f32 v94, v94
    v_exp_f32 v95, v95
    v_cvt_pk_bf16_f32 v58, v92, v93
    v_cvt_pk_bf16_f32 v59, v94, v95
    v_exp_f32 v64, v64
    v_exp_f32 v65, v65
    v_mfma_f32_32x32x16_bf16 v[112:127], a[140:143], v[56:59], v[112:127]
    ds_read_b128 a[140:143], v30 offset:14656
    v_exp_f32 v66, v66
    v_cvt_pk_bf16_f32 v44, v64, v65
    v_exp_f32 v67, v67
    v_exp_f32 v68, v68
    v_mfma_f32_32x32x16_bf16 v[80:95], a[132:135], v[24:27], 0
    ds_read_b128 a[132:135], v29 offset:15232
    v_cvt_pk_bf16_f32 v45, v66, v67
    v_exp_f32 v69, v69
    v_exp_f32 v70, v70
    v_cvt_pk_bf16_f32 v46, v68, v69
    v_exp_f32 v71, v71
    v_mfma_f32_32x32x16_bf16 v[128:143], a[88:91], a[80:83], v[128:143]
    buffer_load_dwordx4 a[76:79], v5, s[48:51], s62 offen offset:0 sc1
    v_exp_f32 v72, v72
    v_cvt_pk_bf16_f32 v47, v70, v71
    v_exp_f32 v73, v73
    v_exp_f32 v74, v74
    v_mfma_f32_32x32x16_bf16 v[96:111], a[144:147], v[44:47], v[96:111]
    s_waitcnt lgkmcnt(2)
    v_cvt_pk_bf16_f32 v48, v72, v73
    v_exp_f32 v75, v75
    v_exp_f32 v76, v76
    v_cvt_pk_bf16_f32 v49, v74, v75
    v_mfma_f32_32x32x16_bf16 v[144:159], a[88:91], a[84:87], v[144:159]
    buffer_load_dwordx4 a[88:91], v4, s[48:51], s62 offen offset:1024 sc1
    v_exp_f32 v77, v77
    v_exp_f32 v78, v78
    v_exp_f32 v79, v79
    v_cvt_pk_bf16_f32 v50, v76, v77
    v_cvt_pk_bf16_f32 v51, v78, v79
    v_exp_f32 v80, v80
    v_exp_f32 v81, v81
    v_mfma_f32_32x32x16_bf16 v[96:111], a[148:151], v[48:51], v[96:111]
    v_exp_f32 v82, v82
    v_cvt_pk_bf16_f32 v52, v80, v81
    v_exp_f32 v83, v83
    v_exp_f32 v84, v84
    v_mfma_f32_32x32x16_bf16 v[64:79], a[128:131], v[20:23], 0
    s_waitcnt vmcnt(25)
    v_cvt_pk_bf16_f32 v53, v82, v83
    v_exp_f32 v85, v85
    v_exp_f32 v86, v86
    v_cvt_pk_bf16_f32 v54, v84, v85
    v_exp_f32 v87, v87
    v_mfma_f32_32x32x16_bf16 v[160:175], a[92:95], a[80:83], v[160:175]
    buffer_load_dwordx4 a[80:83], v2, s[48:51], s62 offen offset:1024 sc1
    v_exp_f32 v88, v88
    v_cvt_pk_bf16_f32 v55, v86, v87
    v_exp_f32 v89, v89
    v_exp_f32 v90, v90
    v_mfma_f32_32x32x16_bf16 v[112:127], a[144:147], v[52:55], v[112:127]
    ds_read_b128 a[144:147], v30 offset:16256
    v_cvt_pk_bf16_f32 v56, v88, v89
    v_exp_f32 v91, v91
    v_exp_f32 v92, v92
    v_cvt_pk_bf16_f32 v57, v90, v91
    v_mfma_f32_32x32x16_bf16 v[176:191], a[92:95], a[84:87], v[176:191]
    buffer_load_dwordx4 a[84:87], v3, s[48:51], s62 offen offset:1024 sc1
    v_exp_f32 v93, v93
    v_exp_f32 v94, v94
    v_exp_f32 v95, v95
    v_cvt_pk_bf16_f32 v58, v92, v93
    v_cvt_pk_bf16_f32 v59, v94, v95
    v_exp_f32 v64, v64
    v_exp_f32 v65, v65
    v_mfma_f32_32x32x16_bf16 v[112:127], a[148:151], v[56:59], v[112:127]
    ds_read_b128 a[148:151], v30 offset:16832
    v_exp_f32 v66, v66
    v_cvt_pk_bf16_f32 v44, v64, v65
    v_exp_f32 v67, v67
    v_exp_f32 v68, v68
    v_mfma_f32_32x32x16_bf16 v[80:95], a[128:131], v[24:27], 0
    ds_read_b128 a[128:131], v29 offset:17408
    v_cvt_pk_bf16_f32 v45, v66, v67
    v_exp_f32 v69, v69
    v_exp_f32 v70, v70
    v_cvt_pk_bf16_f32 v46, v68, v69
    v_exp_f32 v71, v71
    v_mfma_f32_32x32x16_bf16 v[128:143], a[104:107], a[96:99], v[128:143]
    buffer_load_dwordx4 a[92:95], v5, s[48:51], s62 offen offset:1024 sc1
    v_exp_f32 v72, v72
    v_cvt_pk_bf16_f32 v47, v70, v71
    v_exp_f32 v73, v73
    v_exp_f32 v74, v74
    v_mfma_f32_32x32x16_bf16 v[96:111], a[136:139], v[44:47], v[96:111]
    s_waitcnt lgkmcnt(2)
    v_cvt_pk_bf16_f32 v48, v72, v73
    v_exp_f32 v75, v75
    v_exp_f32 v76, v76
    v_cvt_pk_bf16_f32 v49, v74, v75
    v_mfma_f32_32x32x16_bf16 v[144:159], a[104:107], a[100:103], v[144:159]
    buffer_load_dwordx4 a[104:107], v4, s[48:51], s62 offen offset:2048 sc1
    v_exp_f32 v77, v77
    v_exp_f32 v78, v78
    v_exp_f32 v79, v79
    v_cvt_pk_bf16_f32 v50, v76, v77
    v_cvt_pk_bf16_f32 v51, v78, v79
    v_exp_f32 v80, v80
    v_exp_f32 v81, v81
    v_mfma_f32_32x32x16_bf16 v[96:111], a[140:143], v[48:51], v[96:111]
    v_exp_f32 v82, v82
    v_cvt_pk_bf16_f32 v52, v80, v81
    v_exp_f32 v83, v83
    v_exp_f32 v84, v84
    v_mfma_f32_32x32x16_bf16 v[64:79], a[132:135], v[20:23], 0
    s_waitcnt vmcnt(25)
    v_cvt_pk_bf16_f32 v53, v82, v83
    v_exp_f32 v85, v85
    v_exp_f32 v86, v86
    v_cvt_pk_bf16_f32 v54, v84, v85
    v_exp_f32 v87, v87
    v_mfma_f32_32x32x16_bf16 v[160:175], a[108:111], a[96:99], v[160:175]
    buffer_load_dwordx4 a[96:99], v2, s[48:51], s62 offen offset:2048 sc1
    v_exp_f32 v88, v88
    v_cvt_pk_bf16_f32 v55, v86, v87
    v_exp_f32 v89, v89
    v_exp_f32 v90, v90
    v_mfma_f32_32x32x16_bf16 v[112:127], a[136:139], v[52:55], v[112:127]
    ds_read_b128 a[136:139], v30 offset:18432
    v_cvt_pk_bf16_f32 v56, v88, v89
    v_exp_f32 v91, v91
    v_exp_f32 v92, v92
    v_cvt_pk_bf16_f32 v57, v90, v91
    v_mfma_f32_32x32x16_bf16 v[176:191], a[108:111], a[100:103], v[176:191]
    buffer_load_dwordx4 a[100:103], v3, s[48:51], s62 offen offset:2048 sc1
    v_exp_f32 v93, v93
    v_exp_f32 v94, v94
    v_exp_f32 v95, v95
    v_cvt_pk_bf16_f32 v58, v92, v93
    v_cvt_pk_bf16_f32 v59, v94, v95
    v_exp_f32 v64, v64
    v_exp_f32 v65, v65
    v_mfma_f32_32x32x16_bf16 v[112:127], a[140:143], v[56:59], v[112:127]
    ds_read_b128 a[140:143], v30 offset:19008
    v_exp_f32 v66, v66
    v_cvt_pk_bf16_f32 v44, v64, v65
    v_exp_f32 v67, v67
    v_exp_f32 v68, v68
    v_mfma_f32_32x32x16_bf16 v[80:95], a[132:135], v[24:27], 0
    ds_read_b128 a[132:135], v29 offset:19584
    v_cvt_pk_bf16_f32 v45, v66, v67
    v_exp_f32 v69, v69
    v_exp_f32 v70, v70
    v_cvt_pk_bf16_f32 v46, v68, v69
    v_exp_f32 v71, v71
    v_mfma_f32_32x32x16_bf16 v[128:143], a[120:123], a[112:115], v[128:143]
    buffer_load_dwordx4 a[108:111], v5, s[48:51], s62 offen offset:2048 sc1
    v_exp_f32 v72, v72
    v_cvt_pk_bf16_f32 v47, v70, v71
    v_exp_f32 v73, v73
    v_exp_f32 v74, v74
    v_mfma_f32_32x32x16_bf16 v[96:111], a[144:147], v[44:47], v[96:111]
    s_waitcnt lgkmcnt(2)
    v_cvt_pk_bf16_f32 v48, v72, v73
    v_exp_f32 v75, v75
    v_exp_f32 v76, v76
    v_cvt_pk_bf16_f32 v49, v74, v75
    v_mfma_f32_32x32x16_bf16 v[144:159], a[120:123], a[116:119], v[144:159]
    buffer_load_dwordx4 a[120:123], v4, s[48:51], s62 offen offset:3072 sc1
    v_exp_f32 v77, v77
    v_exp_f32 v78, v78
    v_exp_f32 v79, v79
    v_cvt_pk_bf16_f32 v50, v76, v77
    v_cvt_pk_bf16_f32 v51, v78, v79
    v_exp_f32 v80, v80
    v_exp_f32 v81, v81
    v_mfma_f32_32x32x16_bf16 v[96:111], a[148:151], v[48:51], v[96:111]
    v_exp_f32 v82, v82
    v_cvt_pk_bf16_f32 v52, v80, v81
    v_exp_f32 v83, v83
    v_exp_f32 v84, v84
    v_mfma_f32_32x32x16_bf16 v[64:79], a[128:131], v[20:23], 0
    s_waitcnt vmcnt(25)
    v_cvt_pk_bf16_f32 v53, v82, v83
    v_exp_f32 v85, v85
    v_exp_f32 v86, v86
    v_cvt_pk_bf16_f32 v54, v84, v85
    v_exp_f32 v87, v87
    v_mfma_f32_32x32x16_bf16 v[160:175], a[124:127], a[112:115], v[160:175]
    buffer_load_dwordx4 a[112:115], v2, s[48:51], s62 offen offset:3072 sc1
    v_exp_f32 v88, v88
    v_cvt_pk_bf16_f32 v55, v86, v87
    v_exp_f32 v89, v89
    v_exp_f32 v90, v90
    v_mfma_f32_32x32x16_bf16 v[112:127], a[144:147], v[52:55], v[112:127]
    ds_read_b128 a[144:147], v30 offset:20608
    v_cvt_pk_bf16_f32 v56, v88, v89
    v_exp_f32 v91, v91
    v_exp_f32 v92, v92
    v_cvt_pk_bf16_f32 v57, v90, v91
    v_mfma_f32_32x32x16_bf16 v[176:191], a[124:127], a[116:119], v[176:191]
    buffer_load_dwordx4 a[116:119], v3, s[48:51], s62 offen offset:3072 sc1
    v_add_u32 v29, 17408, v29
    v_exp_f32 v93, v93
    v_exp_f32 v94, v94
    v_exp_f32 v95, v95
    v_cvt_pk_bf16_f32 v58, v92, v93
    v_cvt_pk_bf16_f32 v59, v94, v95
    v_add_u32 v30, 17408, v30
    s_cmp_lg_u32 s70, 0
    s_cbranch_scc1 L_p45_loop
    v_exp_f32 v64, v64
    v_exp_f32 v65, v65
    v_mfma_f32_32x32x16_bf16 v[112:127], a[148:151], v[56:59], v[112:127]
    ds_read_b128 a[148:151], v30 offset:3776
    v_exp_f32 v66, v66
    v_cvt_pk_bf16_f32 v44, v64, v65
    v_exp_f32 v67, v67
    s_waitcnt vmcnt(27)
    v_mfma_f32_32x32x16_bf16 v[128:143], a[8:11], a[0:3], v[128:143]
    buffer_load_dwordx4 a[124:127], v5, s[48:51], s62 offen offset:3072 sc1
    s_add_u32 s62, s62, 4096
    v_exp_f32 v68, v68
    v_cvt_pk_bf16_f32 v45, v66, v67
    v_exp_f32 v69, v69
    v_mfma_f32_32x32x16_bf16 v[80:95], a[128:131], v[24:27], 0
    ds_read_b128 a[128:131], v29 offset:4352
    v_exp_f32 v70, v70
    v_cvt_pk_bf16_f32 v46, v68, v69
    v_exp_f32 v71, v71
    v_mfma_f32_32x32x16_bf16 v[144:159], a[8:11], a[4:7], v[144:159]
    buffer_load_dwordx4 a[8:11], v4, s[48:51], s62 offen offset:0 sc1
    v_exp_f32 v72, v72
    v_cvt_pk_bf16_f32 v47, v70, v71
    v_exp_f32 v73, v73
    v_mfma_f32_32x32x16_bf16 v[160:175], a[12:15], a[0:3], v[160:175]
    buffer_load_dwordx4 a[0:3], v2, s[48:51], s62 offen offset:0 sc1
    v_exp_f32 v74, v74
    v_cvt_pk_bf16_f32 v48, v72, v73
    v_exp_f32 v75, v75
    v_mfma_f32_32x32x16_bf16 v[96:111], a[136:139], v[44:47], v[96:111]
    s_waitcnt lgkmcnt(2)
    v_exp_f32 v76, v76
    v_cvt_pk_bf16_f32 v49, v74, v75
    v_exp_f32 v77, v77
    v_mfma_f32_32x32x16_bf16 v[176:191], a[12:15], a[4:7], v[176:191]
    buffer_load_dwordx4 a[4:7], v3, s[48:51], s62 offen offset:0 sc1
    v_exp_f32 v78, v78
    v_exp_f32 v79, v79
    v_cvt_pk_bf16_f32 v50, v76, v77
    v_cvt_pk_bf16_f32 v51, v78, v79
    v_exp_f32 v80, v80
    v_exp_f32 v81, v81
    v_mfma_f32_32x32x16_bf16 v[96:111], a[140:143], v[48:51], v[96:111]
    s_waitcnt vmcnt(27)
    v_exp_f32 v82, v82
    v_cvt_pk_bf16_f32 v52, v80, v81
    v_exp_f32 v83, v83
    v_mfma_f32_32x32x16_bf16 v[128:143], a[24:27], a[16:19], v[128:143]
    buffer_load_dwordx4 a[12:15], v5, s[48:51], s62 offen offset:0 sc1
    v_exp_f32 v84, v84
    v_cvt_pk_bf16_f32 v53, v82, v83
    v_exp_f32 v85, v85
    v_mfma_f32_32x32x16_bf16 v[64:79], a[132:135], v[20:23], 0
    v_exp_f32 v86, v86
    v_cvt_pk_bf16_f32 v54, v84, v85
    v_exp_f32 v87, v87
    v_mfma_f32_32x32x16_bf16 v[144:159], a[24:27], a[20:23], v[144:159]
    buffer_load_dwordx4 a[24:27], v4, s[48:51], s62 offen offset:1024 sc1
    v_exp_f32 v88, v88
    v_cvt_pk_bf16_f32 v55, v86, v87
    v_exp_f32 v89, v89
    v_mfma_f32_32x32x16_bf16 v[160:175], a[28:31], a[16:19], v[160:175]
    buffer_load_dwordx4 a[16:19], v2, s[48:51], s62 offen offset:1024 sc1
    v_exp_f32 v90, v90
    v_cvt_pk_bf16_f32 v56, v88, v89
    v_exp_f32 v91, v91
    v_mfma_f32_32x32x16_bf16 v[112:127], a[136:139], v[52:55], v[112:127]
    ds_read_b128 a[136:139], v30 offset:5376
    v_exp_f32 v92, v92
    v_cvt_pk_bf16_f32 v57, v90, v91
    v_exp_f32 v93, v93
    v_mfma_f32_32x32x16_bf16 v[176:191], a[28:31], a[20:23], v[176:191]
    buffer_load_dwordx4 a[20:23], v3, s[48:51], s62 offen offset:1024 sc1
    v_exp_f32 v94, v94
    v_exp_f32 v95, v95
    v_cvt_pk_bf16_f32 v58, v92, v93
    v_cvt_pk_bf16_f32 v59, v94, v95
    v_exp_f32 v64, v64
    v_exp_f32 v65, v65
    v_mfma_f32_32x32x16_bf16 v[112:127], a[140:143], v[56:59], v[112:127]
    ds_read_b128 a[140:143], v30 offset:5952
    v_exp_f32 v66, v66
    v_cvt_pk_bf16_f32 v44, v64, v65
    v_exp_f32 v67, v67
    s_waitcnt vmcnt(27)
    v_mfma_f32_32x32x16_bf16 v[128:143], a[40:43], a[32:35], v[128:143]
    buffer_load_dwordx4 a[28:31], v5, s[48:51], s62 offen offset:1024 sc1
    v_exp_f32 v68, v68
    v_cvt_pk_bf16_f32 v45, v66, v67
    v_exp_f32 v69, v69
    v_mfma_f32_32x32x16_bf16 v[80:95], a[132:135], v[24:27], 0
    ds_read_b128 a[132:135], v29 offset:6528
    v_exp_f32 v70, v70
    v_cvt_pk_bf16_f32 v46, v68, v69
    v_exp_f32 v71, v71
    v_mfma_f32_32x32x16_bf16 v[144:159], a[40:43], a[36:39], v[144:159]
    buffer_load_dwordx4 a[40:43], v4, s[48:51], s62 offen offset:2048 sc1
    v_exp_f32 v72, v72
    v_cvt_pk_bf16_f32 v47, v70, v71
    v_exp_f32 v73, v73
    v_mfma_f32_32x32x16_bf16 v[160:175], a[44:47], a[32:35], v[160:175]
    buffer_load_dwordx4 a[32:35], v2, s[48:51], s62 offen offset:2048 sc1
    v_exp_f32 v74, v74
    v_cvt_pk_bf16_f32 v48, v72, v73
    v_exp_f32 v75, v75
    v_mfma_f32_32x32x16_bf16 v[96:111], a[144:147], v[44:47], v[96:111]
    s_waitcnt lgkmcnt(2)
    v_exp_f32 v76, v76
    v_cvt_pk_bf16_f32 v49, v74, v75
    v_exp_f32 v77, v77
    v_mfma_f32_32x32x16_bf16 v[176:191], a[44:47], a[36:39], v[176:191]
    buffer_load_dwordx4 a[36:39], v3, s[48:51], s62 offen offset:2048 sc1
    v_exp_f32 v78, v78
    v_exp_f32 v79, v79
    v_cvt_pk_bf16_f32 v50, v76, v77
    v_cvt_pk_bf16_f32 v51, v78, v79
    v_exp_f32 v80, v80
    v_exp_f32 v81, v81
    v_mfma_f32_32x32x16_bf16 v[96:111], a[148:151], v[48:51], v[96:111]
    s_waitcnt vmcnt(27)
    v_exp_f32 v82, v82
    v_cvt_pk_bf16_f32 v52, v80, v81
    v_exp_f32 v83, v83
    v_mfma_f32_32x32x16_bf16 v[128:143], a[56:59], a[48:51], v[128:143]
    buffer_load_dwordx4 a[44:47], v5, s[48:51], s62 offen offset:2048 sc1
    v_exp_f32 v84, v84
    v_cvt_pk_bf16_f32 v53, v82, v83
    v_exp_f32 v85, v85
    v_mfma_f32_32x32x16_bf16 v[64:79], a[128:131], v[20:23], 0
    v_exp_f32 v86, v86
    v_cvt_pk_bf16_f32 v54, v84, v85
    v_exp_f32 v87, v87
    v_mfma_f32_32x32x16_bf16 v[144:159], a[56:59], a[52:55], v[144:159]
    buffer_load_dwordx4 a[56:59], v4, s[48:51], s62 offen offset:3072 sc1
    v_exp_f32 v88, v88
    v_cvt_pk_bf16_f32 v55, v86, v87
    v_exp_f32 v89, v89
    v_mfma_f32_32x32x16_bf16 v[160:175], a[60:63], a[48:51], v[160:175]
    buffer_load_dwordx4 a[48:51], v2, s[48:51], s62 offen offset:3072 sc1
    v_exp_f32 v90, v90
    v_cvt_pk_bf16_f32 v56, v88, v89
    v_exp_f32 v91, v91
    v_mfma_f32_32x32x16_bf16 v[112:127], a[144:147], v[52:55], v[112:127]
    ds_read_b128 a[144:147], v30 offset:7552
    v_exp_f32 v92, v92
    v_cvt_pk_bf16_f32 v57, v90, v91
    v_exp_f32 v93, v93
    v_mfma_f32_32x32x16_bf16 v[176:191], a[60:63], a[52:55], v[176:191]
    buffer_load_dwordx4 a[52:55], v3, s[48:51], s62 offen offset:3072 sc1
    v_exp_f32 v94, v94
    v_exp_f32 v95, v95
    v_cvt_pk_bf16_f32 v58, v92, v93
    v_cvt_pk_bf16_f32 v59, v94, v95
    v_exp_f32 v64, v64
    v_exp_f32 v65, v65
    v_mfma_f32_32x32x16_bf16 v[112:127], a[148:151], v[56:59], v[112:127]
    ds_read_b128 a[148:151], v30 offset:8128
    v_exp_f32 v66, v66
    v_cvt_pk_bf16_f32 v44, v64, v65
    v_exp_f32 v67, v67
    s_waitcnt vmcnt(27)
    v_mfma_f32_32x32x16_bf16 v[128:143], a[72:75], a[64:67], v[128:143]
    buffer_load_dwordx4 a[60:63], v5, s[48:51], s62 offen offset:3072 sc1
    s_add_u32 s62, s62, 4096
    v_exp_f32 v68, v68
    v_cvt_pk_bf16_f32 v45, v66, v67
    v_exp_f32 v69, v69
    v_mfma_f32_32x32x16_bf16 v[80:95], a[128:131], v[24:27], 0
    ds_read_b128 a[128:131], v29 offset:8704
    v_exp_f32 v70, v70
    v_cvt_pk_bf16_f32 v46, v68, v69
    v_exp_f32 v71, v71
    v_mfma_f32_32x32x16_bf16 v[144:159], a[72:75], a[68:71], v[144:159]
    buffer_load_dwordx4 a[72:75], v4, s[48:51], s62 offen offset:0 sc1
    v_exp_f32 v72, v72
    v_cvt_pk_bf16_f32 v47, v70, v71
    v_exp_f32 v73, v73
    v_mfma_f32_32x32x16_bf16 v[160:175], a[76:79], a[64:67], v[160:175]
    buffer_load_dwordx4 a[64:67], v2, s[48:51], s62 offen offset:0 sc1
    v_exp_f32 v74, v74
    v_cvt_pk_bf16_f32 v48, v72, v73
    v_exp_f32 v75, v75
    v_mfma_f32_32x32x16_bf16 v[96:111], a[136:139], v[44:47], v[96:111]
    s_waitcnt lgkmcnt(2)
    v_exp_f32 v76, v76
    v_cvt_pk_bf16_f32 v49, v74, v75
    v_exp_f32 v77, v77
    v_mfma_f32_32x32x16_bf16 v[176:191], a[76:79], a[68:71], v[176:191]
    buffer_load_dwordx4 a[68:71], v3, s[48:51], s62 offen offset:0 sc1
    v_exp_f32 v78, v78
    v_exp_f32 v79, v79
    v_cvt_pk_bf16_f32 v50, v76, v77
    v_cvt_pk_bf16_f32 v51, v78, v79
    v_exp_f32 v80, v80
    v_exp_f32 v81, v81
    v_mfma_f32_32x32x16_bf16 v[96:111], a[140:143], v[48:51], v[96:111]
    s_waitcnt vmcnt(27)
    v_exp_f32 v82, v82
    v_cvt_pk_bf16_f32 v52, v80, v81
    v_exp_f32 v83, v83
    v_mfma_f32_32x32x16_bf16 v[128:143], a[88:91], a[80:83], v[128:143]
    buffer_load_dwordx4 a[76:79], v5, s[48:51], s62 offen offset:0 sc1
    v_exp_f32 v84, v84
    v_cvt_pk_bf16_f32 v53, v82, v83
    v_exp_f32 v85, v85
    v_mfma_f32_32x32x16_bf16 v[64:79], a[132:135], v[20:23], 0
    v_exp_f32 v86, v86
    v_cvt_pk_bf16_f32 v54, v84, v85
    v_exp_f32 v87, v87
    v_mfma_f32_32x32x16_bf16 v[144:159], a[88:91], a[84:87], v[144:159]
    buffer_load_dwordx4 a[88:91], v4, s[48:51], s62 offen offset:1024 sc1
    v_exp_f32 v88, v88
    v_cvt_pk_bf16_f32 v55, v86, v87
    v_exp_f32 v89, v89
    v_mfma_f32_32x32x16_bf16 v[160:175], a[92:95], a[80:83], v[160:175]
    buffer_load_dwordx4 a[80:83], v2, s[48:51], s62 offen offset:1024 sc1
    v_exp_f32 v90, v90
    v_cvt_pk_bf16_f32 v56, v88, v89
    v_exp_f32 v91, v91
    v_mfma_f32_32x32x16_bf16 v[112:127], a[136:139], v[52:55], v[112:127]
    ds_read_b128 a[136:139], v30 offset:9728
    v_exp_f32 v92, v92
    v_cvt_pk_bf16_f32 v57, v90, v91
    v_exp_f32 v93, v93
    v_mfma_f32_32x32x16_bf16 v[176:191], a[92:95], a[84:87], v[176:191]
    buffer_load_dwordx4 a[84:87], v3, s[48:51], s62 offen offset:1024 sc1
    v_exp_f32 v94, v94
    v_exp_f32 v95, v95
    v_cvt_pk_bf16_f32 v58, v92, v93
    v_cvt_pk_bf16_f32 v59, v94, v95
    v_exp_f32 v64, v64
    v_exp_f32 v65, v65
    v_mfma_f32_32x32x16_bf16 v[112:127], a[140:143], v[56:59], v[112:127]
    ds_read_b128 a[140:143], v30 offset:10304
    v_exp_f32 v66, v66
    v_cvt_pk_bf16_f32 v44, v64, v65
    v_exp_f32 v67, v67
    s_waitcnt vmcnt(27)
    v_mfma_f32_32x32x16_bf16 v[128:143], a[104:107], a[96:99], v[128:143]
    buffer_load_dwordx4 a[92:95], v5, s[48:51], s62 offen offset:1024 sc1
    v_exp_f32 v68, v68
    v_cvt_pk_bf16_f32 v45, v66, v67
    v_exp_f32 v69, v69
    v_mfma_f32_32x32x16_bf16 v[80:95], a[132:135], v[24:27], 0
    ds_read_b128 a[132:135], v29 offset:10880
    v_exp_f32 v70, v70
    v_cvt_pk_bf16_f32 v46, v68, v69
    v_exp_f32 v71, v71
    v_mfma_f32_32x32x16_bf16 v[144:159], a[104:107], a[100:103], v[144:159]
    buffer_load_dwordx4 a[104:107], v4, s[48:51], s62 offen offset:2048 sc1
    v_exp_f32 v72, v72
    v_cvt_pk_bf16_f32 v47, v70, v71
    v_exp_f32 v73, v73
    v_mfma_f32_32x32x16_bf16 v[160:175], a[108:111], a[96:99], v[160:175]
    buffer_load_dwordx4 a[96:99], v2, s[48:51], s62 offen offset:2048 sc1
    v_exp_f32 v74, v74
    v_cvt_pk_bf16_f32 v48, v72, v73
    v_exp_f32 v75, v75
    v_mfma_f32_32x32x16_bf16 v[96:111], a[144:147], v[44:47], v[96:111]
    s_waitcnt lgkmcnt(2)
    v_exp_f32 v76, v76
    v_cvt_pk_bf16_f32 v49, v74, v75
    v_exp_f32 v77, v77
    v_mfma_f32_32x32x16_bf16 v[176:191], a[108:111], a[100:103], v[176:191]
    buffer_load_dwordx4 a[100:103], v3, s[48:51], s62 offen offset:2048 sc1
    v_exp_f32 v78, v78
    v_exp_f32 v79, v79
    v_cvt_pk_bf16_f32 v50, v76, v77
    v_cvt_pk_bf16_f32 v51, v78, v79
    v_exp_f32 v80, v80
    v_exp_f32 v81, v81
    v_mfma_f32_32x32x16_bf16 v[96:111], a[148:151], v[48:51], v[96:111]
    s_waitcnt vmcnt(27)
    v_exp_f32 v82, v82
    v_cvt_pk_bf16_f32 v52, v80, v81
    v_exp_f32 v83, v83
    v_mfma_f32_32x32x16_bf16 v[128:143], a[120:123], a[112:115], v[128:143]
    buffer_load_dwordx4 a[108:111], v5, s[48:51], s62 offen offset:2048 sc1
    v_exp_f32 v84, v84
    v_cvt_pk_bf16_f32 v53, v82, v83
    v_exp_f32 v85, v85
    v_mfma_f32_32x32x16_bf16 v[64:79], a[128:131], v[20:23], 0
    v_exp_f32 v86, v86
    v_cvt_pk_bf16_f32 v54, v84, v85
    v_exp_f32 v87, v87
    v_mfma_f32_32x32x16_bf16 v[144:159], a[120:123], a[116:119], v[144:159]
    buffer_load_dwordx4 a[120:123], v4, s[48:51], s62 offen offset:3072 sc1
    v_exp_f32 v88, v88
    v_cvt_pk_bf16_f32 v55, v86, v87
    v_exp_f32 v89, v89
    v_mfma_f32_32x32x16_bf16 v[160:175], a[124:127], a[112:115], v[160:175]
    buffer_load_dwordx4 a[112:115], v2, s[48:51], s62 offen offset:3072 sc1
    v_exp_f32 v90, v90
    v_cvt_pk_bf16_f32 v56, v88, v89
    v_exp_f32 v91, v91
    v_mfma_f32_32x32x16_bf16 v[112:127], a[144:147], v[52:55], v[112:127]
    ds_read_b128 a[144:147], v30 offset:11904
    v_exp_f32 v92, v92
    v_cvt_pk_bf16_f32 v57, v90, v91
    v_exp_f32 v93, v93
    v_mfma_f32_32x32x16_bf16 v[176:191], a[124:127], a[116:119], v[176:191]
    buffer_load_dwordx4 a[116:119], v3, s[48:51], s62 offen offset:3072 sc1
    v_exp_f32 v94, v94
    v_exp_f32 v95, v95
    v_cvt_pk_bf16_f32 v58, v92, v93
    v_cvt_pk_bf16_f32 v59, v94, v95
    v_exp_f32 v64, v64
    v_exp_f32 v65, v65
    v_mfma_f32_32x32x16_bf16 v[112:127], a[148:151], v[56:59], v[112:127]
    ds_read_b128 a[148:151], v30 offset:12480
    v_exp_f32 v66, v66
    v_cvt_pk_bf16_f32 v44, v64, v65
    v_exp_f32 v67, v67
    s_waitcnt vmcnt(27)
    v_mfma_f32_32x32x16_bf16 v[128:143], a[8:11], a[0:3], v[128:143]
    buffer_load_dwordx4 a[124:127], v5, s[48:51], s62 offen offset:3072 sc1
    s_add_u32 s62, s62, 4096
    v_exp_f32 v68, v68
    v_cvt_pk_bf16_f32 v45, v66, v67
    v_exp_f32 v69, v69
    v_mfma_f32_32x32x16_bf16 v[80:95], a[128:131], v[24:27], 0
    ds_read_b128 a[128:131], v29 offset:13056
    v_exp_f32 v70, v70
    v_cvt_pk_bf16_f32 v46, v68, v69
    v_exp_f32 v71, v71
    v_mfma_f32_32x32x16_bf16 v[144:159], a[8:11], a[4:7], v[144:159]
    buffer_load_dwordx4 a[8:11], v4, s[48:51], s62 offen offset:0 sc1
    v_exp_f32 v72, v72
    v_cvt_pk_bf16_f32 v47, v70, v71
    v_exp_f32 v73, v73
    v_mfma_f32_32x32x16_bf16 v[160:175], a[12:15], a[0:3], v[160:175]
    buffer_load_dwordx4 a[0:3], v2, s[48:51], s62 offen offset:0 sc1
    v_exp_f32 v74, v74
    v_cvt_pk_bf16_f32 v48, v72, v73
    v_exp_f32 v75, v75
    v_mfma_f32_32x32x16_bf16 v[96:111], a[136:139], v[44:47], v[96:111]
    s_waitcnt lgkmcnt(2)
    v_exp_f32 v76, v76
    v_cvt_pk_bf16_f32 v49, v74, v75
    v_exp_f32 v77, v77
    v_mfma_f32_32x32x16_bf16 v[176:191], a[12:15], a[4:7], v[176:191]
    buffer_load_dwordx4 a[4:7], v3, s[48:51], s62 offen offset:0 sc1
    v_exp_f32 v78, v78
    v_exp_f32 v79, v79
    v_cvt_pk_bf16_f32 v50, v76, v77
    v_cvt_pk_bf16_f32 v51, v78, v79
    v_exp_f32 v80, v80
    v_exp_f32 v81, v81
    v_mfma_f32_32x32x16_bf16 v[96:111], a[140:143], v[48:51], v[96:111]
    s_waitcnt vmcnt(27)
    v_exp_f32 v82, v82
    v_cvt_pk_bf16_f32 v52, v80, v81
    v_exp_f32 v83, v83
    v_mfma_f32_32x32x16_bf16 v[128:143], a[24:27], a[16:19], v[128:143]
    buffer_load_dwordx4 a[12:15], v5, s[48:51], s62 offen offset:0 sc1
    v_exp_f32 v84, v84
    v_cvt_pk_bf16_f32 v53, v82, v83
    v_exp_f32 v85, v85
    v_mfma_f32_32x32x16_bf16 v[64:79], a[132:135], v[20:23], 0
    v_exp_f32 v86, v86
    v_cvt_pk_bf16_f32 v54, v84, v85
    v_exp_f32 v87, v87
    v_mfma_f32_32x32x16_bf16 v[144:159], a[24:27], a[20:23], v[144:159]
    buffer_load_dwordx4 a[24:27], v4, s[48:51], s62 offen offset:1024 sc1
    v_exp_f32 v88, v88
    v_cvt_pk_bf16_f32 v55, v86, v87
    v_exp_f32 v89, v89
    v_mfma_f32_32x32x16_bf16 v[160:175], a[28:31], a[16:19], v[160:175]
    buffer_load_dwordx4 a[16:19], v2, s[48:51], s62 offen offset:1024 sc1
    v_exp_f32 v90, v90
    v_cvt_pk_bf16_f32 v56, v88, v89
    v_exp_f32 v91, v91
    v_mfma_f32_32x32x16_bf16 v[112:127], a[136:139], v[52:55], v[112:127]
    ds_read_b128 a[136:139], v30 offset:14080
    v_exp_f32 v92, v92
    v_cvt_pk_bf16_f32 v57, v90, v91
    v_exp_f32 v93, v93
    v_mfma_f32_32x32x16_bf16 v[176:191], a[28:31], a[20:23], v[176:191]
    buffer_load_dwordx4 a[20:23], v3, s[48:51], s62 offen offset:1024 sc1
    v_exp_f32 v94, v94
    v_exp_f32 v95, v95
    v_cvt_pk_bf16_f32 v58, v92, v93
    v_cvt_pk_bf16_f32 v59, v94, v95
    v_exp_f32 v64, v64
    v_exp_f32 v65, v65
    v_mfma_f32_32x32x16_bf16 v[112:127], a[140:143], v[56:59], v[112:127]
    ds_read_b128 a[140:143], v30 offset:14656
    v_exp_f32 v66, v66
    v_cvt_pk_bf16_f32 v44, v64, v65
    v_exp_f32 v67, v67
    s_waitcnt vmcnt(27)
    v_mfma_f32_32x32x16_bf16 v[128:143], a[40:43], a[32:35], v[128:143]
    buffer_load_dwordx4 a[28:31], v5, s[48:51], s62 offen offset:1024 sc1
    v_exp_f32 v68, v68
    v_cvt_pk_bf16_f32 v45, v66, v67
    v_exp_f32 v69, v69
    v_mfma_f32_32x32x16_bf16 v[80:95], a[132:135], v[24:27], 0
    ds_read_b128 a[132:135], v29 offset:15232
    v_exp_f32 v70, v70
    v_cvt_pk_bf16_f32 v46, v68, v69
    v_exp_f32 v71, v71
    v_mfma_f32_32x32x16_bf16 v[144:159], a[40:43], a[36:39], v[144:159]
    buffer_load_dwordx4 a[40:43], v4, s[48:51], s62 offen offset:2048 sc1
    v_exp_f32 v72, v72
    v_cvt_pk_bf16_f32 v47, v70, v71
    v_exp_f32 v73, v73
    v_mfma_f32_32x32x16_bf16 v[160:175], a[44:47], a[32:35], v[160:175]
    buffer_load_dwordx4 a[32:35], v2, s[48:51], s62 offen offset:2048 sc1
    v_exp_f32 v74, v74
    v_cvt_pk_bf16_f32 v48, v72, v73
    v_exp_f32 v75, v75
    v_mfma_f32_32x32x16_bf16 v[96:111], a[144:147], v[44:47], v[96:111]
    s_waitcnt lgkmcnt(2)
    v_exp_f32 v76, v76
    v_cvt_pk_bf16_f32 v49, v74, v75
    v_exp_f32 v77, v77
    v_mfma_f32_32x32x16_bf16 v[176:191], a[44:47], a[36:39], v[176:191]
    buffer_load_dwordx4 a[36:39], v3, s[48:51], s62 offen offset:2048 sc1
    v_exp_f32 v78, v78
    v_exp_f32 v79, v79
    v_cvt_pk_bf16_f32 v50, v76, v77
    v_cvt_pk_bf16_f32 v51, v78, v79
    v_exp_f32 v80, v80
    v_exp_f32 v81, v81
    v_mfma_f32_32x32x16_bf16 v[96:111], a[148:151], v[48:51], v[96:111]
    s_waitcnt vmcnt(27)
    v_exp_f32 v82, v82
    v_cvt_pk_bf16_f32 v52, v80, v81
    v_exp_f32 v83, v83
    v_mfma_f32_32x32x16_bf16 v[128:143], a[56:59], a[48:51], v[128:143]
    buffer_load_dwordx4 a[44:47], v5, s[48:51], s62 offen offset:2048 sc1
    v_exp_f32 v84, v84
    v_cvt_pk_bf16_f32 v53, v82, v83
    v_exp_f32 v85, v85
    v_mfma_f32_32x32x16_bf16 v[64:79], a[128:131], v[20:23], 0
    v_exp_f32 v86, v86
    v_cvt_pk_bf16_f32 v54, v84, v85
    v_exp_f32 v87, v87
    v_mfma_f32_32x32x16_bf16 v[144:159], a[56:59], a[52:55], v[144:159]
    buffer_load_dwordx4 a[56:59], v4, s[48:51], s62 offen offset:3072 sc1
    v_exp_f32 v88, v88
    v_cvt_pk_bf16_f32 v55, v86, v87
    v_exp_f32 v89, v89
    v_mfma_f32_32x32x16_bf16 v[160:175], a[60:63], a[48:51], v[160:175]
    buffer_load_dwordx4 a[48:51], v2, s[48:51], s62 offen offset:3072 sc1
    v_exp_f32 v90, v90
    v_cvt_pk_bf16_f32 v56, v88, v89
    v_exp_f32 v91, v91
    v_mfma_f32_32x32x16_bf16 v[112:127], a[144:147], v[52:55], v[112:127]
    ds_read_b128 a[144:147], v30 offset:16256
    v_exp_f32 v92, v92
    v_cvt_pk_bf16_f32 v57, v90, v91
    v_exp_f32 v93, v93
    v_mfma_f32_32x32x16_bf16 v[176:191], a[60:63], a[52:55], v[176:191]
    buffer_load_dwordx4 a[52:55], v3, s[48:51], s62 offen offset:3072 sc1
    v_exp_f32 v94, v94
    v_exp_f32 v95, v95
    v_cvt_pk_bf16_f32 v58, v92, v93
    v_cvt_pk_bf16_f32 v59, v94, v95
    v_exp_f32 v64, v64
    v_exp_f32 v65, v65
    v_mfma_f32_32x32x16_bf16 v[112:127], a[148:151], v[56:59], v[112:127]
    ds_read_b128 a[148:151], v30 offset:16832
    v_exp_f32 v66, v66
    v_cvt_pk_bf16_f32 v44, v64, v65
    v_exp_f32 v67, v67
    s_waitcnt vmcnt(27)
    v_mfma_f32_32x32x16_bf16 v[128:143], a[72:75], a[64:67], v[128:143]
    buffer_load_dwordx4 a[60:63], v5, s[48:51], s62 offen offset:3072 sc1
    s_add_u32 s62, s62, 4096
    v_exp_f32 v68, v68
    v_cvt_pk_bf16_f32 v45, v66, v67
    v_exp_f32 v69, v69
    v_mfma_f32_32x32x16_bf16 v[80:95], a[128:131], v[24:27], 0
    ds_read_b128 a[128:131], v29 offset:17408
    v_exp_f32 v70, v70
    v_cvt_pk_bf16_f32 v46, v68, v69
    v_exp_f32 v71, v71
    v_mfma_f32_32x32x16_bf16 v[144:159], a[72:75], a[68:71], v[144:159]
    buffer_load_dwordx4 a[72:75], v4, s[48:51], s62 offen offset:0 sc1
    v_exp_f32 v72, v72
    v_cvt_pk_bf16_f32 v47, v70, v71
    v_exp_f32 v73, v73
    v_mfma_f32_32x32x16_bf16 v[160:175], a[76:79], a[64:67], v[160:175]
    buffer_load_dwordx4 a[64:67], v2, s[48:51], s62 offen offset:0 sc1
    v_exp_f32 v74, v74
    v_cvt_pk_bf16_f32 v48, v72, v73
    v_exp_f32 v75, v75
    v_mfma_f32_32x32x16_bf16 v[96:111], a[136:139], v[44:47], v[96:111]
    s_waitcnt lgkmcnt(2)
    v_exp_f32 v76, v76
    v_cvt_pk_bf16_f32 v49, v74, v75
    v_exp_f32 v77, v77
    v_mfma_f32_32x32x16_bf16 v[176:191], a[76:79], a[68:71], v[176:191]
    buffer_load_dwordx4 a[68:71], v3, s[48:51], s62 offen offset:0 sc1
    v_exp_f32 v78, v78
    v_exp_f32 v79, v79
    v_cvt_pk_bf16_f32 v50, v76, v77
    v_cvt_pk_bf16_f32 v51, v78, v79
    v_exp_f32 v80, v80
    v_exp_f32 v81, v81
    v_mfma_f32_32x32x16_bf16 v[96:111], a[140:143], v[48:51], v[96:111]
    s_waitcnt vmcnt(27)
    v_exp_f32 v82, v82
    v_cvt_pk_bf16_f32 v52, v80, v81
    v_exp_f32 v83, v83
    v_mfma_f32_32x32x16_bf16 v[128:143], a[88:91], a[80:83], v[128:143]
    buffer_load_dwordx4 a[76:79], v5, s[48:51], s62 offen offset:0 sc1
    v_exp_f32 v84, v84
    v_cvt_pk_bf16_f32 v53, v82, v83
    v_exp_f32 v85, v85
    v_mfma_f32_32x32x16_bf16 v[64:79], a[132:135], v[20:23], 0
    v_exp_f32 v86, v86
    v_cvt_pk_bf16_f32 v54, v84, v85
    v_exp_f32 v87, v87
    v_mfma_f32_32x32x16_bf16 v[144:159], a[88:91], a[84:87], v[144:159]
    buffer_load_dwordx4 a[88:91], v4, s[48:51], s62 offen offset:1024 sc1
    v_exp_f32 v88, v88
    v_cvt_pk_bf16_f32 v55, v86, v87
    v_exp_f32 v89, v89
    v_mfma_f32_32x32x16_bf16 v[160:175], a[92:95], a[80:83], v[160:175]
    buffer_load_dwordx4 a[80:83], v2, s[48:51], s62 offen offset:1024 sc1
    v_exp_f32 v90, v90
    v_cvt_pk_bf16_f32 v56, v88, v89
    v_exp_f32 v91, v91
    v_mfma_f32_32x32x16_bf16 v[112:127], a[136:139], v[52:55], v[112:127]
    ds_read_b128 a[136:139], v30 offset:18432
    v_exp_f32 v92, v92
    v_cvt_pk_bf16_f32 v57, v90, v91
    v_exp_f32 v93, v93
    v_mfma_f32_32x32x16_bf16 v[176:191], a[92:95], a[84:87], v[176:191]
    buffer_load_dwordx4 a[84:87], v3, s[48:51], s62 offen offset:1024 sc1
    v_exp_f32 v94, v94
    v_exp_f32 v95, v95
    v_cvt_pk_bf16_f32 v58, v92, v93
    v_cvt_pk_bf16_f32 v59, v94, v95
    v_exp_f32 v64, v64
    v_exp_f32 v65, v65
    v_mfma_f32_32x32x16_bf16 v[112:127], a[140:143], v[56:59], v[112:127]
    ds_read_b128 a[140:143], v30 offset:19008
    v_exp_f32 v66, v66
    v_cvt_pk_bf16_f32 v44, v64, v65
    v_exp_f32 v67, v67
    s_waitcnt vmcnt(27)
    v_mfma_f32_32x32x16_bf16 v[128:143], a[104:107], a[96:99], v[128:143]
    buffer_load_dwordx4 a[92:95], v5, s[48:51], s62 offen offset:1024 sc1
    v_exp_f32 v68, v68
    v_cvt_pk_bf16_f32 v45, v66, v67
    v_exp_f32 v69, v69
    v_mfma_f32_32x32x16_bf16 v[80:95], a[132:135], v[24:27], 0
    ds_read_b128 a[132:135], v29 offset:19584
    v_exp_f32 v70, v70
    v_cvt_pk_bf16_f32 v46, v68, v69
    v_exp_f32 v71, v71
    v_mfma_f32_32x32x16_bf16 v[144:159], a[104:107], a[100:103], v[144:159]
    buffer_load_dwordx4 a[104:107], v4, s[48:51], s62 offen offset:2048 sc1
    v_exp_f32 v72, v72
    v_cvt_pk_bf16_f32 v47, v70, v71
    v_exp_f32 v73, v73
    v_mfma_f32_32x32x16_bf16 v[160:175], a[108:111], a[96:99], v[160:175]
    buffer_load_dwordx4 a[96:99], v2, s[48:51], s62 offen offset:2048 sc1
    v_exp_f32 v74, v74
    v_cvt_pk_bf16_f32 v48, v72, v73
    v_exp_f32 v75, v75
    v_mfma_f32_32x32x16_bf16 v[96:111], a[144:147], v[44:47], v[96:111]
    s_waitcnt lgkmcnt(2)
    v_exp_f32 v76, v76
    v_cvt_pk_bf16_f32 v49, v74, v75
    v_exp_f32 v77, v77
    v_mfma_f32_32x32x16_bf16 v[176:191], a[108:111], a[100:103], v[176:191]
    buffer_load_dwordx4 a[100:103], v3, s[48:51], s62 offen offset:2048 sc1
    v_exp_f32 v78, v78
    v_exp_f32 v79, v79
    v_cvt_pk_bf16_f32 v50, v76, v77
    v_cvt_pk_bf16_f32 v51, v78, v79
    v_exp_f32 v80, v80
    v_exp_f32 v81, v81
    v_mfma_f32_32x32x16_bf16 v[96:111], a[148:151], v[48:51], v[96:111]
    s_waitcnt vmcnt(27)
    v_exp_f32 v82, v82
    v_cvt_pk_bf16_f32 v52, v80, v81
    v_exp_f32 v83, v83
    v_mfma_f32_32x32x16_bf16 v[128:143], a[120:123], a[112:115], v[128:143]
    buffer_load_dwordx4 a[108:111], v5, s[48:51], s62 offen offset:2048 sc1
    v_exp_f32 v84, v84
    v_cvt_pk_bf16_f32 v53, v82, v83
    v_exp_f32 v85, v85
    v_mfma_f32_32x32x16_bf16 v[64:79], a[128:131], v[20:23], 0
    v_exp_f32 v86, v86
    v_cvt_pk_bf16_f32 v54, v84, v85
    v_exp_f32 v87, v87
    v_mfma_f32_32x32x16_bf16 v[144:159], a[120:123], a[116:119], v[144:159]
    buffer_load_dwordx4 a[120:123], v4, s[48:51], s62 offen offset:3072 sc1
    v_exp_f32 v88, v88
    v_cvt_pk_bf16_f32 v55, v86, v87
    v_exp_f32 v89, v89
    v_mfma_f32_32x32x16_bf16 v[160:175], a[124:127], a[112:115], v[160:175]
    buffer_load_dwordx4 a[112:115], v2, s[48:51], s62 offen offset:3072 sc1
    v_exp_f32 v90, v90
    v_cvt_pk_bf16_f32 v56, v88, v89
    v_exp_f32 v91, v91
    v_mfma_f32_32x32x16_bf16 v[112:127], a[144:147], v[52:55], v[112:127]
    ds_read_b128 a[144:147], v30 offset:20608
    v_exp_f32 v92, v92
    v_cvt_pk_bf16_f32 v57, v90, v91
    v_exp_f32 v93, v93
    v_mfma_f32_32x32x16_bf16 v[176:191], a[124:127], a[116:119], v[176:191]
    buffer_load_dwordx4 a[116:119], v3, s[48:51], s62 offen offset:3072 sc1
    v_exp_f32 v94, v94
    v_exp_f32 v95, v95
    v_cvt_pk_bf16_f32 v58, v92, v93
    v_cvt_pk_bf16_f32 v59, v94, v95
    buffer_load_dwordx4 a[124:127], v5, s[48:51], s62 offen offset:3072 sc1
    s_nop 0
    v_mfma_f32_32x32x16_bf16 v[112:127], a[148:151], v[56:59], v[112:127]
    s_nop 11
L_norm_a:
    v_subrev_u32 v18, 0x2b800000, v104
    v_subrev_u32 v19, 0x2b800000, v120
    v_rcp_f32 v16, v104
    v_rcp_f32 v17, v120
    v_max_u32 v18, v18, v19
    v_cmp_lt_u32 vcc, 0x2c000000, v18
    v_mul_f32 v96, v96, v16
    v_mul_f32 v97, v97, v16
    v_mul_f32 v98, v98, v16
    v_mul_f32 v99, v99, v16
    v_mul_f32 v100, v100, v16
    v_mul_f32 v101, v101, v16
    v_mul_f32 v102, v102, v16
    v_mul_f32 v103, v103, v16
    v_mul_f32 v112, v112, v17
    v_mul_f32 v113, v113, v17
    v_mul_f32 v114, v114, v17
    v_mul_f32 v115, v115, v17
    v_mul_f32 v116, v116, v17
    v_mul_f32 v117, v117, v17
    v_mul_f32 v118, v118, v17
    v_mul_f32 v119, v119, v17
    s_mov_b64 s[96:97], vcc
    v_maximum3_f32 v16, abs(v96), abs(v97), 0
    v_maximum3_f32 v16, abs(v98), abs(v99), v16
    v_maximum3_f32 v16, abs(v100), abs(v101), v16
    v_maximum3_f32 v16, abs(v102), abs(v103), v16
    v_maximum3_f32 v16, abs(v112), abs(v113), v16
    v_maximum3_f32 v16, abs(v114), abs(v115), v16
    v_maximum3_f32 v16, abs(v116), abs(v117), v16
    v_maximum3_f32 v16, abs(v118), abs(v119), v16
    v_cmp_lt_u32 vcc, 0x7f7fffff, v16
    s_nop 0
    s_or_b64 vcc, vcc, s[96:97]
    s_cbranch_vccz L_ok_a
    s_cmp_eq_u32 s64, 0
    s_cbranch_scc1 L_slowa
L_ok_a:
    s_mul_i32 s67, s59, 294912
    s_lshl_b32 s68, s52, 10
    s_add_u32 s67, s67, s68
    s_add_u32 s67, s67, 33816576
    v_cvt_pk_bf16_f32 v96, v96, v97
    v_cvt_pk_bf16_f32 v97, v98, v99
    v_cvt_pk_bf16_f32 v98, v100, v101
    v_cvt_pk_bf16_f32 v99, v102, v103
    buffer_store_dwordx4 v[96:99], v1, s[48:51], s67 offen sc1
    s_mul_i32 s67, s60, 294912
    s_lshl_b32 s68, s52, 10
    s_add_u32 s67, s67, s68
    s_add_u32 s67, s67, 33816576
    v_cvt_pk_bf16_f32 v112, v112, v113
    v_cvt_pk_bf16_f32 v113, v114, v115
    v_cvt_pk_bf16_f32 v114, v116, v117
    v_cvt_pk_bf16_f32 v115, v118, v119
    buffer_store_dwordx4 v[112:115], v1, s[48:51], s67 offen sc1
    s_add_u32 s62, s62, 4096
    s_waitcnt vmcnt(30)
    v_mfma_f32_32x32x16_bf16 v[128:143], a[8:11], a[0:3], v[128:143]
    v_mfma_f32_32x32x16_bf16 v[144:159], a[8:11], a[4:7], v[144:159]
    v_mfma_f32_32x32x16_bf16 v[160:175], a[12:15], a[0:3], v[160:175]
    buffer_load_dwordx4 a[8:11], v4, s[48:51], s62 offen offset:0 sc1
    v_mfma_f32_32x32x16_bf16 v[176:191], a[12:15], a[4:7], v[176:191]
    buffer_load_dwordx4 a[0:3], v2, s[48:51], s62 offen offset:0 sc1
    buffer_load_dwordx4 a[4:7], v3, s[48:51], s62 offen offset:0 sc1
    buffer_load_dwordx4 a[12:15], v5, s[48:51], s62 offen offset:0 sc1
    s_waitcnt vmcnt(30)
    v_mfma_f32_32x32x16_bf16 v[128:143], a[24:27], a[16:19], v[128:143]
    v_mfma_f32_32x32x16_bf16 v[144:159], a[24:27], a[20:23], v[144:159]
    v_mfma_f32_32x32x16_bf16 v[160:175], a[28:31], a[16:19], v[160:175]
    buffer_load_dwordx4 a[24:27], v4, s[48:51], s62 offen offset:1024 sc1
    v_mfma_f32_32x32x16_bf16 v[176:191], a[28:31], a[20:23], v[176:191]
    buffer_load_dwordx4 a[16:19], v2, s[48:51], s62 offen offset:1024 sc1
    buffer_load_dwordx4 a[20:23], v3, s[48:51], s62 offen offset:1024 sc1
    buffer_load_dwordx4 a[28:31], v5, s[48:51], s62 offen offset:1024 sc1
    s_waitcnt vmcnt(30)
    v_mfma_f32_32x32x16_bf16 v[128:143], a[40:43], a[32:35], v[128:143]
    v_mfma_f32_32x32x16_bf16 v[144:159], a[40:43], a[36:39], v[144:159]
    v_mfma_f32_32x32x16_bf16 v[160:175], a[44:47], a[32:35], v[160:175]
    buffer_load_dwordx4 a[40:43], v4, s[48:51], s62 offen offset:2048 sc1
    v_mfma_f32_32x32x16_bf16 v[176:191], a[44:47], a[36:39], v[176:191]
    buffer_load_dwordx4 a[32:35], v2, s[48:51], s62 offen offset:2048 sc1
    buffer_load_dwordx4 a[36:39], v3, s[48:51], s62 offen offset:2048 sc1
    buffer_load_dwordx4 a[44:47], v5, s[48:51], s62 offen offset:2048 sc1
    s_waitcnt vmcnt(12)
    s_barrier
    s_cmp_lg_u32 s54, 0
    s_cbranch_scc1 L_sig7
    s_lshl_b32 s67, s53, 7
    s_add_u32 s67, s67, 61678592
    s_lshl2_add_u32 s67, s52, s67
    v_min_u32 v62, 1, v0
    v_lshlrev_b32 v62, 30, v62
    v_mov_b32 v63, s12
    buffer_store_dword v63, v62, s[48:51], s67 offen sc1
L_sig7:
    s_waitcnt vmcnt(30)
    v_mfma_f32_32x32x16_bf16 v[128:143], a[56:59], a[48:51], v[128:143]
    v_mfma_f32_32x32x16_bf16 v[144:159], a[56:59], a[52:55], v[144:159]
    v_mfma_f32_32x32x16_bf16 v[160:175], a[60:63], a[48:51], v[160:175]
    buffer_load_dwordx4 a[56:59], v4, s[48:51], s62 offen offset:3072 sc1
    v_mfma_f32_32x32x16_bf16 v[176:191], a[60:63], a[52:55], v[176:191]
    buffer_load_dwordx4 a[48:51], v2, s[48:51], s62 offen offset:3072 sc1
    buffer_load_dwordx4 a[52:55], v3, s[48:51], s62 offen offset:3072 sc1
    buffer_load_dwordx4 a[60:63], v5, s[48:51], s62 offen offset:3072 sc1
    s_add_u32 s62, s62, 4096
    s_waitcnt vmcnt(30)
    v_mfma_f32_32x32x16_bf16 v[128:143], a[72:75], a[64:67], v[128:143]
    v_mfma_f32_32x32x16_bf16 v[144:159], a[72:75], a[68:71], v[144:159]
    v_mfma_f32_32x32x16_bf16 v[160:175], a[76:79], a[64:67], v[160:175]
    buffer_load_dwordx4 a[72:75], v4, s[48:51], s62 offen offset:0 sc1
    v_mfma_f32_32x32x16_bf16 v[176:191], a[76:79], a[68:71], v[176:191]
    buffer_load_dwordx4 a[64:67], v2, s[48:51], s62 offen offset:0 sc1
    buffer_load_dwordx4 a[68:71], v3, s[48:51], s62 offen offset:0 sc1
    buffer_load_dwordx4 a[76:79], v5, s[48:51], s62 offen offset:0 sc1
    s_waitcnt vmcnt(30)
    v_mfma_f32_32x32x16_bf16 v[128:143], a[88:91], a[80:83], v[128:143]
    v_mfma_f32_32x32x16_bf16 v[144:159], a[88:91], a[84:87], v[144:159]
    v_mfma_f32_32x32x16_bf16 v[160:175], a[92:95], a[80:83], v[160:175]
    buffer_load_dwordx4 a[88:91], v4, s[48:51], s62 offen offset:1024 sc1
    v_mfma_f32_32x32x16_bf16 v[176:191], a[92:95], a[84:87], v[176:191]
    buffer_load_dwordx4 a[80:83], v2, s[48:51], s62 offen offset:1024 sc1
    buffer_load_dwordx4 a[84:87], v3, s[48:51], s62 offen offset:1024 sc1
    buffer_load_dwordx4 a[92:95], v5, s[48:51], s62 offen offset:1024 sc1
    s_waitcnt vmcnt(30)
    v_mfma_f32_32x32x16_bf16 v[128:143], a[104:107], a[96:99], v[128:143]
    v_mfma_f32_32x32x16_bf16 v[144:159], a[104:107], a[100:103], v[144:159]
    v_mfma_f32_32x32x16_bf16 v[160:175], a[108:111], a[96:99], v[160:175]
    buffer_load_dwordx4 a[104:107], v4, s[48:51], s62 offen offset:2048 sc1
    v_mfma_f32_32x32x16_bf16 v[176:191], a[108:111], a[100:103], v[176:191]
    buffer_load_dwordx4 a[96:99], v2, s[48:51], s62 offen offset:2048 sc1
    buffer_load_dwordx4 a[100:103], v3, s[48:51], s62 offen offset:2048 sc1
    buffer_load_dwordx4 a[108:111], v5, s[48:51], s62 offen offset:2048 sc1
    s_waitcnt vmcnt(30)
    v_mfma_f32_32x32x16_bf16 v[128:143], a[120:123], a[112:115], v[128:143]
    v_mfma_f32_32x32x16_bf16 v[144:159], a[120:123], a[116:119], v[144:159]
    v_mfma_f32_32x32x16_bf16 v[160:175], a[124:127], a[112:115], v[160:175]
    buffer_load_dwordx4 a[120:123], v4, s[48:51], s62 offen offset:3072 sc1
    v_mfma_f32_32x32x16_bf16 v[176:191], a[124:127], a[116:119], v[176:191]
    buffer_load_dwordx4 a[112:115], v2, s[48:51], s62 offen offset:3072 sc1
    buffer_load_dwordx4 a[116:119], v3, s[48:51], s62 offen offset:3072 sc1
    buffer_load_dwordx4 a[124:127], v5, s[48:51], s62 offen offset:3072 sc1
    s_lshl_b32 s62, s54, 13
    s_add_u32 s62, s62, 262144
    s_lshl_b32 s90, s63, 7
    s_add_u32 s90, s90, 61678592
    s_cmp_eq_u32 s54, 0
    s_cselect_b32 s68, 0, 0x40000000
    v_lshrrev_b32 v36, 5, v0
    v_min_u32 v36, 1, v36
    v_lshlrev_b32 v36, 30, v36
    v_lshl_or_b32 v36, v0, 2, v36
    v_or_b32 v36, s68, v36
    s_add_u32 s92, s62, 4096
    s_waitcnt vmcnt(28)
    v_mfma_f32_32x32x16_bf16 v[128:143], a[8:11], a[0:3], v[128:143]
    v_mfma_f32_32x32x16_bf16 v[144:159], a[8:11], a[4:7], v[144:159]
    v_mfma_f32_32x32x16_bf16 v[160:175], a[12:15], a[0:3], v[160:175]
    buffer_load_dwordx4 a[8:11], v4, s[48:51], s62 offen offset:0 sc1
    v_mfma_f32_32x32x16_bf16 v[176:191], a[12:15], a[4:7], v[176:191]
    buffer_load_dwordx4 a[12:15], v5, s[48:51], s62 offen offset:0 sc1
    s_waitcnt vmcnt(26)
    v_mfma_f32_32x32x16_bf16 v[128:143], a[24:27], a[16:19], v[128:143]
    buffer_load_dword v37, v36, s[48:51], s90 offen sc1
    v_mfma_f32_32x32x16_bf16 v[144:159], a[24:27], a[20:23], v[144:159]
    v_mfma_f32_32x32x16_bf16 v[160:175], a[28:31], a[16:19], v[160:175]
    buffer_load_dwordx4 a[24:27], v4, s[48:51], s62 offen offset:1024 sc1
    v_mfma_f32_32x32x16_bf16 v[176:191], a[28:31], a[20:23], v[176:191]
    buffer_load_dwordx4 a[28:31], v5, s[48:51], s62 offen offset:1024 sc1
    s_waitcnt vmcnt(24)
    v_mfma_f32_32x32x16_bf16 v[128:143], a[40:43], a[32:35], v[128:143]
    v_mfma_f32_32x32x16_bf16 v[144:159], a[40:43], a[36:39], v[144:159]
    v_mfma_f32_32x32x16_bf16 v[160:175], a[44:47], a[32:35], v[160:175]
    buffer_load_dwordx4 a[40:43], v4, s[48:51], s62 offen offset:2048 sc1
    v_mfma_f32_32x32x16_bf16 v[176:191], a[44:47], a[36:39], v[176:191]
    buffer_load_dwordx4 a[44:47], v5, s[48:51], s62 offen offset:2048 sc1
    s_waitcnt vmcnt(22)
    v_mfma_f32_32x32x16_bf16 v[128:143], a[56:59], a[48:51], v[128:143]
    v_mfma_f32_32x32x16_bf16 v[144:159], a[56:59], a[52:55], v[144:159]
    v_mfma_f32_32x32x16_bf16 v[160:175], a[60:63], a[48:51], v[160:175]
    buffer_load_dwordx4 a[56:59], v4, s[48:51], s62 offen offset:3072 sc1
    v_mfma_f32_32x32x16_bf16 v[176:191], a[60:63], a[52:55], v[176:191]
    buffer_load_dwordx4 a[60:63], v5, s[48:51], s62 offen offset:3072 sc1
    s_waitcnt vmcnt(6)
    s_cmp_lg_u32 s54, 0
    s_cbranch_scc1 L_poll8_done
    s_mov_b32 s78, 0x20000
L_poll8:
    v_cmp_eq_u32 vcc, s12, v37
    s_sub_u32 s78, s78, 1
    s_cbranch_scc1 L_poll8_done
    s_cmp_eq_u32 vcc_lo, -1
    s_cbranch_scc1 L_poll8_done
    buffer_load_dword v37, v36, s[48:51], s90 offen sc1
    s_waitcnt vmcnt(0)
    s_branch L_poll8
L_poll8_done:
    s_barrier
    buffer_load_dwordx4 a[0:3], v2, s[48:51], s62 offen offset:0 sc1
    buffer_load_dwordx4 a[4:7], v3, s[48:51], s62 offen offset:0 sc1
    buffer_load_dwordx4 a[16:19], v2, s[48:51], s62 offen offset:1024 sc1
    buffer_load_dwordx4 a[20:23], v3, s[48:51], s62 offen offset:1024 sc1
    buffer_load_dwordx4 a[32:35], v2, s[48:51], s62 offen offset:2048 sc1
    buffer_load_dwordx4 a[36:39], v3, s[48:51], s62 offen offset:2048 sc1
    buffer_load_dwordx4 a[48:51], v2, s[48:51], s62 offen offset:3072 sc1
    buffer_load_dwordx4 a[52:55], v3, s[48:51], s62 offen offset:3072 sc1
    v_mfma_f32_32x32x16_bf16 v[128:143], a[72:75], a[64:67], v[128:143]
    v_mfma_f32_32x32x16_bf16 v[144:159], a[72:75], a[68:71], v[144:159]
    v_mfma_f32_32x32x16_bf16 v[160:175], a[76:79], a[64:67], v[160:175]
    buffer_load_dwordx4 a[72:75], v4, s[48:51], s92 offen offset:0 sc1
    v_mfma_f32_32x32x16_bf16 v[176:191], a[76:79], a[68:71], v[176:191]
    buffer_load_dwordx4 a[64:67], v2, s[48:51], s92 offen offset:0 sc1
    buffer_load_dwordx4 a[68:71], v3, s[48:51], s92 offen offset:0 sc1
    buffer_load_dwordx4 a[76:79], v5, s[48:51], s92 offen offset:0 sc1
    v_mfma_f32_32x32x16_bf16 v[128:143], a[88:91], a[80:83], v[128:143]
    v_mfma_f32_32x32x16_bf16 v[144:159], a[88:91], a[84:87], v[144:159]
    v_mfma_f32_32x32x16_bf16 v[160:175], a[92:95], a[80:83], v[160:175]
    buffer_load_dwordx4 a[88:91], v4, s[48:51], s92 offen offset:1024 sc1
    v_mfma_f32_32x32x16_bf16 v[176:191], a[92:95], a[84:87], v[176:191]
    buffer_load_dwordx4 a[80:83], v2, s[48:51], s92 offen offset:1024 sc1
    buffer_load_dwordx4 a[84:87], v3, s[48:51], s92 offen offset:1024 sc1
    buffer_load_dwordx4 a[92:95], v5, s[48:51], s92 offen offset:1024 sc1
    v_mfma_f32_32x32x16_bf16 v[128:143], a[104:107], a[96:99], v[128:143]
    v_mfma_f32_32x32x16_bf16 v[144:159], a[104:107], a[100:103], v[144:159]
    v_mfma_f32_32x32x16_bf16 v[160:175], a[108:111], a[96:99], v[160:175]
    buffer_load_dwordx4 a[104:107], v4, s[48:51], s92 offen offset:2048 sc1
    v_mfma_f32_32x32x16_bf16 v[176:191], a[108:111], a[100:103], v[176:191]
    buffer_load_dwordx4 a[96:99], v2, s[48:51], s92 offen offset:2048 sc1
    buffer_load_dwordx4 a[100:103], v3, s[48:51], s92 offen offset:2048 sc1
    buffer_load_dwordx4 a[108:111], v5, s[48:51], s92 offen offset:2048 sc1
    v_mfma_f32_32x32x16_bf16 v[128:143], a[120:123], a[112:115], v[128:143]
    v_mfma_f32_32x32x16_bf16 v[144:159], a[120:123], a[116:119], v[144:159]
    v_mfma_f32_32x32x16_bf16 v[160:175], a[124:127], a[112:115], v[160:175]
    buffer_load_dwordx4 a[120:123], v4, s[48:51], s92 offen offset:3072 sc1
    v_mfma_f32_32x32x16_bf16 v[176:191], a[124:127], a[116:119], v[176:191]
    buffer_load_dwordx4 a[112:115], v2, s[48:51], s92 offen offset:3072 sc1
    buffer_load_dwordx4 a[116:119], v3, s[48:51], s92 offen offset:3072 sc1
    buffer_load_dwordx4 a[124:127], v5, s[48:51], s92 offen offset:3072 sc1
    s_waitcnt vmcnt(22)
    v_mfma_f32_32x32x16_bf16 v[208:223], a[8:11], a[4:7], 0
    v_sub_f32 v12, 1.0, v8
    v_mov_b32 v9, v8
    v_cvt_pk_bf16_f32 v12, v12, v12
    v_mfma_f32_32x32x16_bf16 v[224:239], a[12:15], a[0:3], 0
    v_and_b32 v12, 0xffff0000, v12
    v_sub_f32 v13, 1.0, v10
    v_mov_b32 v11, v10
    v_mfma_f32_32x32x16_bf16 v[240:255], a[12:15], a[4:7], 0
    v_cvt_pk_bf16_f32 v13, v13, v13
    v_and_b32 v13, 0xffff0000, v13
    v_and_b32 v14, 31, v0
    v_mfma_f32_32x32x16_bf16 v[192:207], a[8:11], a[0:3], 0
    v_lshlrev_b32 v14, 10, v14
    v_lshrrev_b32 v15, 5, v0
    v_lshl_add_u32 v14, v15, 4, v14
    s_waitcnt vmcnt(20)
    v_mfma_f32_32x32x16_bf16 v[208:223], a[24:27], a[20:23], v[208:223]
    s_lshl_b32 s67, s54, 14
    v_add_u32 v20, s67, v1
    s_lshl_b32 s67, s75, 15
    v_mfma_f32_32x32x16_bf16 v[224:239], a[28:31], a[16:19], v[224:239]
    s_lshl_b32 s68, s79, 7
    s_add_u32 s67, s67, s68
    s_lshl_b32 s68, s56, 6
    v_mfma_f32_32x32x16_bf16 v[240:255], a[28:31], a[20:23], v[240:255]
    s_add_u32 s67, s67, s68
    v_xor_b32 v21, 16384, v20
    v_xor_b32 v22, 32768, v20
    v_mfma_f32_32x32x16_bf16 v[192:207], a[24:27], a[16:19], v[192:207]
    v_xor_b32 v23, 49152, v20
    v_mul_f32 v128, v128, v12
    s_waitcnt vmcnt(18)
    v_mfma_f32_32x32x16_bf16 v[208:223], a[40:43], a[36:39], v[208:223]
    v_mul_f32 v129, v129, v12
    v_mul_f32 v130, v130, v12
    v_mul_f32 v131, v131, v12
    v_mfma_f32_32x32x16_bf16 v[224:239], a[44:47], a[32:35], v[224:239]
    v_mul_f32 v132, v132, v12
    v_mul_f32 v133, v133, v12
    v_mul_f32 v134, v134, v12
    v_mfma_f32_32x32x16_bf16 v[240:255], a[44:47], a[36:39], v[240:255]
    v_mul_f32 v135, v135, v12
    v_mul_f32 v136, v136, v12
    v_mul_f32 v137, v137, v12
    v_mfma_f32_32x32x16_bf16 v[192:207], a[40:43], a[32:35], v[192:207]
    v_mul_f32 v138, v138, v12
    v_mul_f32 v139, v139, v12
    v_mul_f32 v140, v140, v12
    s_waitcnt vmcnt(16)
    v_mfma_f32_32x32x16_bf16 v[208:223], a[56:59], a[52:55], v[208:223]
    v_mul_f32 v141, v141, v12
    v_mul_f32 v142, v142, v12
    v_mul_f32 v143, v143, v12
    v_mfma_f32_32x32x16_bf16 v[224:239], a[60:63], a[48:51], v[224:239]
    v_mul_f32 v144, v144, v13
    v_mul_f32 v145, v145, v13
    v_mul_f32 v146, v146, v13
    v_mfma_f32_32x32x16_bf16 v[240:255], a[60:63], a[52:55], v[240:255]
    v_mul_f32 v147, v147, v13
    v_mul_f32 v148, v148, v13
    v_mfma_f32_32x32x16_bf16 v[192:207], a[56:59], a[48:51], v[192:207]
    v_mul_f32 v149, v149, v13
    v_mul_f32 v150, v150, v13
    v_mul_f32 v151, v151, v13
    s_waitcnt vmcnt(12)
    v_mfma_f32_32x32x16_bf16 v[208:223], a[72:75], a[68:71], v[208:223]
    v_mul_f32 v152, v152, v13
    v_mul_f32 v153, v153, v13
    v_mul_f32 v154, v154, v13
    v_mfma_f32_32x32x16_bf16 v[224:239], a[76:79], a[64:67], v[224:239]
    v_mul_f32 v155, v155, v13
    v_mul_f32 v156, v156, v13
    v_mul_f32 v157, v157, v13
    v_mfma_f32_32x32x16_bf16 v[240:255], a[76:79], a[68:71], v[240:255]
    v_mul_f32 v158, v158, v13
    v_mul_f32 v159, v159, v13
    v_mul_f32 v160, v160, v12
    v_mfma_f32_32x32x16_bf16 v[192:207], a[72:75], a[64:67], v[192:207]
    v_mul_f32 v161, v161, v12
    v_mul_f32 v162, v162, v12
    v_mul_f32 v163, v163, v12
    s_waitcnt vmcnt(8)
    v_mfma_f32_32x32x16_bf16 v[208:223], a[88:91], a[84:87], v[208:223]
    v_mul_f32 v164, v164, v12
    v_mul_f32 v165, v165, v12
    v_mul_f32 v166, v166, v12
    v_mfma_f32_32x32x16_bf16 v[224:239], a[92:95], a[80:83], v[224:239]
    v_mul_f32 v167, v167, v12
    v_mul_f32 v168, v168, v12
    v_mul_f32 v169, v169, v12
    v_mfma_f32_32x32x16_bf16 v[240:255], a[92:95], a[84:87], v[240:255]
    v_mul_f32 v170, v170, v12
    v_mul_f32 v171, v171, v12
    v_mfma_f32_32x32x16_bf16 v[192:207], a[88:91], a[80:83], v[192:207]
    v_mul_f32 v172, v172, v12
    v_mul_f32 v173, v173, v12
    v_mul_f32 v174, v174, v12
    s_waitcnt vmcnt(4)
    v_mfma_f32_32x32x16_bf16 v[208:223], a[104:107], a[100:103], v[208:223]
    v_mul_f32 v175, v175, v12
    v_mul_f32 v176, v176, v13
    v_mul_f32 v177, v177, v13
    v_mfma_f32_32x32x16_bf16 v[224:239], a[108:111], a[96:99], v[224:239]
    v_mul_f32 v178, v178, v13
    v_mul_f32 v179, v179, v13
    v_mul_f32 v180, v180, v13
    v_mfma_f32_32x32x16_bf16 v[240:255], a[108:111], a[100:103], v[240:255]
    v_mul_f32 v181, v181, v13
    v_mul_f32 v182, v182, v13
    v_mul_f32 v183, v183, v13
    v_mfma_f32_32x32x16_bf16 v[192:207], a[104:107], a[96:99], v[192:207]
    v_mul_f32 v184, v184, v13
    v_mul_f32 v185, v185, v13
    v_mul_f32 v186, v186, v13
    s_waitcnt vmcnt(0)
    v_mfma_f32_32x32x16_bf16 v[208:223], a[120:123], a[116:119], v[208:223]
    v_mul_f32 v187, v187, v13
    v_mul_f32 v188, v188, v13
    v_mul_f32 v189, v189, v13
    v_mfma_f32_32x32x16_bf16 v[224:239], a[124:127], a[112:115], v[224:239]
    v_mul_f32 v190, v190, v13
    v_mul_f32 v191, v191, v13
    v_mfma_f32_32x32x16_bf16 v[240:255], a[124:127], a[116:119], v[240:255]
    v_mfma_f32_32x32x16_bf16 v[192:207], a[120:123], a[112:115], v[192:207]
    s_nop 7
    v_pk_fma_f32 v[144:145], v[208:209], v[10:11], v[144:145]
    v_pk_fma_f32 v[146:147], v[210:211], v[10:11], v[146:147]
    v_pk_fma_f32 v[148:149], v[212:213], v[10:11], v[148:149]
    v_pk_fma_f32 v[150:151], v[214:215], v[10:11], v[150:151]
    v_pk_fma_f32 v[152:153], v[216:217], v[10:11], v[152:153]
    v_pk_fma_f32 v[154:155], v[218:219], v[10:11], v[154:155]
    v_pk_fma_f32 v[156:157], v[220:221], v[10:11], v[156:157]
    v_pk_fma_f32 v[158:159], v[222:223], v[10:11], v[158:159]
    ds_write_b128 v20, v[144:147] offset:0
    ds_write_b128 v20, v[148:151] offset:1024
    ds_write_b128 v20, v[152:155] offset:2048
    ds_write_b128 v20, v[156:159] offset:3072
    v_pk_fma_f32 v[160:161], v[224:225], v[8:9], v[160:161]
    v_pk_fma_f32 v[162:163], v[226:227], v[8:9], v[162:163]
    v_pk_fma_f32 v[164:165], v[228:229], v[8:9], v[164:165]
    v_pk_fma_f32 v[166:167], v[230:231], v[8:9], v[166:167]
    v_pk_fma_f32 v[168:169], v[232:233], v[8:9], v[168:169]
    v_pk_fma_f32 v[170:171], v[234:235], v[8:9], v[170:171]
    v_pk_fma_f32 v[172:173], v[236:237], v[8:9], v[172:173]
    v_pk_fma_f32 v[174:175], v[238:239], v[8:9], v[174:175]
    ds_write_b128 v20, v[160:163] offset:4096
    ds_write_b128 v20, v[164:167] offset:5120
    ds_write_b128 v20, v[168:171] offset:6144
    ds_write_b128 v20, v[172:175] offset:7168
    v_pk_fma_f32 v[176:177], v[240:241], v[10:11], v[176:177]
    v_pk_fma_f32 v[178:179], v[242:243], v[10:11], v[178:179]
    v_pk_fma_f32 v[180:181], v[244:245], v[10:11], v[180:181]
    v_pk_fma_f32 v[182:183], v[246:247], v[10:11], v[182:183]
    v_pk_fma_f32 v[184:185], v[248:249], v[10:11], v[184:185]
    v_pk_fma_f32 v[186:187], v[250:251], v[10:11], v[186:187]
    v_pk_fma_f32 v[188:189], v[252:253], v[10:11], v[188:189]
    v_pk_fma_f32 v[190:191], v[254:255], v[10:11], v[190:191]
    ds_write_b128 v20, v[176:179] offset:8192
    ds_write_b128 v20, v[180:183] offset:9216
    ds_write_b128 v20, v[184:187] offset:10240
    ds_write_b128 v20, v[188:191] offset:11264
    v_pk_fma_f32 v[128:129], v[192:193], v[8:9], v[128:129]
    v_pk_fma_f32 v[130:131], v[194:195], v[8:9], v[130:131]
    v_pk_fma_f32 v[132:133], v[196:197], v[8:9], v[132:133]
    v_pk_fma_f32 v[134:135], v[198:199], v[8:9], v[134:135]
    v_pk_fma_f32 v[136:137], v[200:201], v[8:9], v[136:137]
    v_pk_fma_f32 v[138:139], v[202:203], v[8:9], v[138:139]
    v_pk_fma_f32 v[140:141], v[204:205], v[8:9], v[140:141]
    v_pk_fma_f32 v[142:143], v[206:207], v[8:9], v[142:143]
    s_waitcnt lgkmcnt(0)
    s_barrier
    ds_read_b128 v[64:67], v21 offset:0
    ds_read_b128 v[68:71], v21 offset:1024
    ds_read_b128 v[72:75], v21 offset:2048
    ds_read_b128 v[76:79], v21 offset:3072
    ds_read_b128 v[80:83], v22 offset:4096
    ds_read_b128 v[84:87], v22 offset:5120
    ds_read_b128 v[88:91], v22 offset:6144
    ds_read_b128 v[92:95], v22 offset:7168
    ds_read_b128 v[96:99], v23 offset:8192
    ds_read_b128 v[100:103], v23 offset:9216
    ds_read_b128 v[104:107], v23 offset:10240
    ds_read_b128 v[108:111], v23 offset:11264
    s_waitcnt lgkmcnt(8)
    v_pk_add_f32 v[128:129], v[128:129], v[64:65]
    v_pk_add_f32 v[130:131], v[130:131], v[66:67]
    v_pk_add_f32 v[132:133], v[132:133], v[68:69]
    v_pk_add_f32 v[134:135], v[134:135], v[70:71]
    v_pk_add_f32 v[136:137], v[136:137], v[72:73]
    v_pk_add_f32 v[138:139], v[138:139], v[74:75]
    v_pk_add_f32 v[140:141], v[140:141], v[76:77]
    v_pk_add_f32 v[142:143], v[142:143], v[78:79]
    s_waitcnt lgkmcnt(4)
    v_pk_add_f32 v[128:129], v[128:129], v[80:81]
    v_pk_add_f32 v[130:131], v[130:131], v[82:83]
    v_pk_add_f32 v[132:133], v[132:133], v[84:85]
    v_pk_add_f32 v[134:135], v[134:135], v[86:87]
    v_pk_add_f32 v[136:137], v[136:137], v[88:89]
    v_pk_add_f32 v[138:139], v[138:139], v[90:91]
    v_pk_add_f32 v[140:141], v[140:141], v[92:93]
    v_pk_add_f32 v[142:143], v[142:143], v[94:95]
    s_waitcnt lgkmcnt(0)
    v_pk_add_f32 v[128:129], v[128:129], v[96:97]
    v_pk_add_f32 v[130:131], v[130:131], v[98:99]
    v_pk_add_f32 v[132:133], v[132:133], v[100:101]
    v_pk_add_f32 v[134:135], v[134:135], v[102:103]
    v_pk_add_f32 v[136:137], v[136:137], v[104:105]
    v_pk_add_f32 v[138:139], v[138:139], v[106:107]
    v_pk_add_f32 v[140:141], v[140:141], v[108:109]
    v_pk_add_f32 v[142:143], v[142:143], v[110:111]
    v_cvt_pk_bf16_f32 v64, v128, v129
    v_cvt_pk_bf16_f32 v65, v130, v131
    v_cvt_pk_bf16_f32 v66, v132, v133
    v_cvt_pk_bf16_f32 v67, v134, v135
    v_cvt_pk_bf16_f32 v68, v136, v137
    v_cvt_pk_bf16_f32 v69, v138, v139
    v_cvt_pk_bf16_f32 v70, v140, v141
    v_cvt_pk_bf16_f32 v71, v142, v143
    s_nop 0
    v_permlane32_swap_b32 v64, v66
    v_permlane32_swap_b32 v65, v67
    v_permlane32_swap_b32 v68, v70
    v_permlane32_swap_b32 v69, v71
    buffer_store_dwordx4 v[64:67], v14, s[40:43], s67 offen offset:0
    buffer_store_dwordx4 v[68:71], v14, s[40:43], s67 offen offset:32
    s_waitcnt vmcnt(0)
    s_endpgm
L_slowb0:
    buffer_store_dwordx4 v[160:163], v60, s[48:51], s65 offen offset:0 sc1
    buffer_store_dwordx4 v[168:171], v60, s[48:51], s65 offen offset:2048 sc1
    buffer_store_dwordx4 v[176:179], v19, s[48:51], s65 offen offset:0 sc1
    buffer_store_dwordx4 v[184:187], v19, s[48:51], s65 offen offset:2048 sc1
    buffer_store_dwordx4 v[224:227], v60, s[48:51], s66 offen offset:0 sc1
    buffer_store_dwordx4 v[232:235], v60, s[48:51], s66 offen offset:2048 sc1
    buffer_store_dwordx4 v[240:243], v19, s[48:51], s66 offen offset:0 sc1
    buffer_store_dwordx4 v[248:251], v19, s[48:51], s66 offen offset:2048 sc1
L_slowb:
    s_waitcnt vmcnt(0) lgkmcnt(0)
    s_bitcmp1_b32 s64, 0
    s_cbranch_scc0 L_slowb_1
    s_bitset0_b32 s64, 0
    s_lshl_b32 s70, s57, 2
    s_lshl_b32 s66, s57, 2
    s_add_u32 s65, s66, s55
    s_add_u32 s66, s66, 3
    s_sub_u32 s66, s66, s55
    s_lshl_b32 s67, s52, 13
    s_add_u32 s67, s67, 33554432
    s_mul_i32 s65, s65, 294912
    s_mul_i32 s66, s66, 294912
    s_add_u32 s65, s65, s67
    s_add_u32 s66, s66, s67
    v_accvgpr_read_b32 v128, a8
    v_accvgpr_read_b32 v129, a9
    v_accvgpr_read_b32 v130, a10
    v_accvgpr_read_b32 v131, a11
    v_accvgpr_read_b32 v132, a12
    v_accvgpr_read_b32 v133, a13
    v_accvgpr_read_b32 v134, a14
    v_accvgpr_read_b32 v135, a15
    v_accvgpr_read_b32 v136, a72
    v_accvgpr_read_b32 v137, a73
    v_accvgpr_read_b32 v138, a74
    v_accvgpr_read_b32 v139, a75
    v_accvgpr_read_b32 v140, a76
    v_accvgpr_read_b32 v141, a77
    v_accvgpr_read_b32 v142, a78
    v_accvgpr_read_b32 v143, a79
    v_accvgpr_read_b32 v144, a24
    v_accvgpr_read_b32 v145, a25
    v_accvgpr_read_b32 v146, a26
    v_accvgpr_read_b32 v147, a27
    v_accvgpr_read_b32 v148, a28
    v_accvgpr_read_b32 v149, a29
    v_accvgpr_read_b32 v150, a30
    v_accvgpr_read_b32 v151, a31
    v_accvgpr_read_b32 v152, a88
    v_accvgpr_read_b32 v153, a89
    v_accvgpr_read_b32 v154, a90
    v_accvgpr_read_b32 v155, a91
    v_accvgpr_read_b32 v156, a92
    v_accvgpr_read_b32 v157, a93
    v_accvgpr_read_b32 v158, a94
    v_accvgpr_read_b32 v159, a95
    s_branch L_slowb_go
L_slowb_1:
    s_bitset0_b32 s64, 1
    s_lshl_b32 s70, s58, 2
    s_lshl_b32 s66, s58, 2
    s_add_u32 s65, s66, s55
    s_add_u32 s66, s66, 3
    s_sub_u32 s66, s66, s55
    s_lshl_b32 s67, s52, 13
    s_add_u32 s67, s67, 33554432
    s_mul_i32 s65, s65, 294912
    s_mul_i32 s66, s66, 294912
    s_add_u32 s65, s65, s67
    s_add_u32 s66, s66, s67
    v_accvgpr_read_b32 v128, a40
    v_accvgpr_read_b32 v129, a41
    v_accvgpr_read_b32 v130, a42
    v_accvgpr_read_b32 v131, a43
    v_accvgpr_read_b32 v132, a44
    v_accvgpr_read_b32 v133, a45
    v_accvgpr_read_b32 v134, a46
    v_accvgpr_read_b32 v135, a47
    v_accvgpr_read_b32 v136, a104
    v_accvgpr_read_b32 v137, a105
    v_accvgpr_read_b32 v138, a106
    v_accvgpr_read_b32 v139, a107
    v_accvgpr_read_b32 v140, a108
    v_accvgpr_read_b32 v141, a109
    v_accvgpr_read_b32 v142, a110
    v_accvgpr_read_b32 v143, a111
    v_accvgpr_read_b32 v144, a56
    v_accvgpr_read_b32 v145, a57
    v_accvgpr_read_b32 v146, a58
    v_accvgpr_read_b32 v147, a59
    v_accvgpr_read_b32 v148, a60
    v_accvgpr_read_b32 v149, a61
    v_accvgpr_read_b32 v150, a62
    v_accvgpr_read_b32 v151, a63
    v_accvgpr_read_b32 v152, a120
    v_accvgpr_read_b32 v153, a121
    v_accvgpr_read_b32 v154, a122
    v_accvgpr_read_b32 v155, a123
    v_accvgpr_read_b32 v156, a124
    v_accvgpr_read_b32 v157, a125
    v_accvgpr_read_b32 v158, a126
    v_accvgpr_read_b32 v159, a127
L_slowb_go:
    v_mov_b32 v160, 0
    v_mov_b32 v161, 0
    v_mov_b32 v162, 0
    v_mov_b32 v163, 0
    v_mov_b32 v164, 0
    v_mov_b32 v165, 0
    v_mov_b32 v166, 0
    v_mov_b32 v167, 0
    v_mov_b32 v168, 0
    v_mov_b32 v169, 0
    v_mov_b32 v170, 0
    v_mov_b32 v171, 0
    v_mov_b32 v172, 0
    v_mov_b32 v173, 0
    v_mov_b32 v174, 0
    v_mov_b32 v175, 0
    v_mov_b32 v176, 0
    v_mov_b32 v177, 0
    v_mov_b32 v178, 0
    v_mov_b32 v179, 0
    v_mov_b32 v180, 0
    v_mov_b32 v181, 0
    v_mov_b32 v182, 0
    v_mov_b32 v183, 0
    v_mov_b32 v184, 0
    v_mov_b32 v185, 0
    v_mov_b32 v186, 0
    v_mov_b32 v187, 0
    v_mov_b32 v188, 0
    v_mov_b32 v189, 0
    v_mov_b32 v190, 0
    v_mov_b32 v191, 0
    v_mov_b32 v224, 0
    v_mov_b32 v225, 0
    v_mov_b32 v226, 0
    v_mov_b32 v227, 0
    v_mov_b32 v228, 0
    v_mov_b32 v229, 0
    v_mov_b32 v230, 0
    v_mov_b32 v231, 0
    v_mov_b32 v232, 0
    v_mov_b32 v233, 0
    v_mov_b32 v234, 0
    v_mov_b32 v235, 0
    v_mov_b32 v236, 0
    v_mov_b32 v237, 0
    v_mov_b32 v238, 0
    v_mov_b32 v239, 0
    v_mov_b32 v240, 0
    v_mov_b32 v241, 0
    v_mov_b32 v242, 0
    v_mov_b32 v243, 0
    v_mov_b32 v244, 0
    v_mov_b32 v245, 0
    v_mov_b32 v246, 0
    v_mov_b32 v247, 0
    v_mov_b32 v248, 0
    v_mov_b32 v249, 0
    v_mov_b32 v250, 0
    v_mov_b32 v251, 0
    v_mov_b32 v252, 0
    v_mov_b32 v253, 0
    v_mov_b32 v254, 0
    v_mov_b32 v255, 0
    v_mov_b32 v80, 0xff7fffff
    v_mov_b32 v81, 0xff7fffff
    v_mov_b32 v14, 0
    v_mov_b32 v15, 0
    v_and_b32 v84, 15, v0
    v_lshrrev_b32 v85, 4, v0
    v_lshlrev_b32 v85, 2, v85
    v_sub_u32 v84, v84, v85
    s_lshl_b32 s67, s56, 4
    v_add_u32 v84, s67, v84
    s_add_u32 s67, s70, s55
    s_add_u32 s70, s70, 3
    s_sub_u32 s70, s70, s55
    s_lshl_b32 s68, s70, 5
    s_lshl_b32 s67, s67, 5
    v_add_u32 v85, s68, v84
    v_add_u32 v84, s67, v84
    v_mov_b32 v86, 0xff7fffff
    s_lshl_b32 s69, s52, 19
    s_add_u32 s70, s70, 1
L_slowb_loop:
    s_add_u32 s67, s69, 0
    s_add_u32 s68, s69, 16777216
    buffer_load_dwordx4 v[192:195], v1, s[48:51], s67 offen offset:0 sc1
    buffer_load_dwordx4 a[224:227], v1, s[48:51], s68 offen offset:0 sc1
    buffer_load_dwordx4 v[196:199], v1, s[48:51], s67 offen offset:1024 sc1
    buffer_load_dwordx4 a[228:231], v1, s[48:51], s68 offen offset:1024 sc1
    buffer_load_dwordx4 v[200:203], v1, s[48:51], s67 offen offset:2048 sc1
    buffer_load_dwordx4 a[232:235], v1, s[48:51], s68 offen offset:2048 sc1
    buffer_load_dwordx4 v[204:207], v1, s[48:51], s67 offen offset:3072 sc1
    buffer_load_dwordx4 a[236:239], v1, s[48:51], s68 offen offset:3072 sc1
    s_add_u32 s67, s69, 4096
    s_add_u32 s68, s69, 16781312
    buffer_load_dwordx4 v[208:211], v1, s[48:51], s67 offen offset:0 sc1
    buffer_load_dwordx4 a[240:243], v1, s[48:51], s68 offen offset:0 sc1
    buffer_load_dwordx4 v[212:215], v1, s[48:51], s67 offen offset:1024 sc1
    buffer_load_dwordx4 a[244:247], v1, s[48:51], s68 offen offset:1024 sc1
    buffer_load_dwordx4 v[216:219], v1, s[48:51], s67 offen offset:2048 sc1
    buffer_load_dwordx4 a[248:251], v1, s[48:51], s68 offen offset:2048 sc1
    buffer_load_dwordx4 v[220:223], v1, s[48:51], s67 offen offset:3072 sc1
    buffer_load_dwordx4 a[252:255], v1, s[48:51], s68 offen offset:3072 sc1
    s_waitcnt vmcnt(0)
    v_mfma_f32_16x16x32_bf16 v[64:67], v[192:195], v[128:131], 0
    v_mfma_f32_16x16x32_bf16 v[64:67], v[196:199], v[132:135], v[64:67]
    v_mfma_f32_16x16x32_bf16 v[64:67], v[200:203], v[136:139], v[64:67]
    v_mfma_f32_16x16x32_bf16 v[64:67], v[204:207], v[140:143], v[64:67]
    v_mfma_f32_16x16x32_bf16 v[68:71], v[208:211], v[128:131], 0
    v_mfma_f32_16x16x32_bf16 v[68:71], v[212:215], v[132:135], v[68:71]
    v_mfma_f32_16x16x32_bf16 v[68:71], v[216:219], v[136:139], v[68:71]
    v_mfma_f32_16x16x32_bf16 v[68:71], v[220:223], v[140:143], v[68:71]
    v_mfma_f32_16x16x32_bf16 v[72:75], v[192:195], v[144:147], 0
    v_mfma_f32_16x16x32_bf16 v[72:75], v[196:199], v[148:151], v[72:75]
    v_mfma_f32_16x16x32_bf16 v[72:75], v[200:203], v[152:155], v[72:75]
    v_mfma_f32_16x16x32_bf16 v[72:75], v[204:207], v[156:159], v[72:75]
    v_mfma_f32_16x16x32_bf16 v[76:79], v[208:211], v[144:147], 0
    v_mfma_f32_16x16x32_bf16 v[76:79], v[212:215], v[148:151], v[76:79]
    v_mfma_f32_16x16x32_bf16 v[76:79], v[216:219], v[152:155], v[76:79]
    v_mfma_f32_16x16x32_bf16 v[76:79], v[220:223], v[156:159], v[76:79]
    s_nop 7
    v_cmp_gt_i32 vcc, 0, v84
    s_nop 1
    v_cndmask_b32 v64, v64, v86, vcc
    v_cmp_gt_i32 vcc, 1, v84
    s_nop 1
    v_cndmask_b32 v65, v65, v86, vcc
    v_cmp_gt_i32 vcc, 2, v84
    s_nop 1
    v_cndmask_b32 v66, v66, v86, vcc
    v_cmp_gt_i32 vcc, 3, v84
    s_nop 1
    v_cndmask_b32 v67, v67, v86, vcc
    v_cmp_gt_i32 vcc, 16, v84
    s_nop 1
    v_cndmask_b32 v68, v68, v86, vcc
    v_cmp_gt_i32 vcc, 17, v84
    s_nop 1
    v_cndmask_b32 v69, v69, v86, vcc
    v_cmp_gt_i32 vcc, 18, v84
    s_nop 1
    v_cndmask_b32 v70, v70, v86, vcc
    v_cmp_gt_i32 vcc, 19, v84
    s_nop 1
    v_cndmask_b32 v71, v71, v86, vcc
    v_cmp_gt_i32 vcc, 0, v85
    s_nop 1
    v_cndmask_b32 v72, v72, v86, vcc
    v_cmp_gt_i32 vcc, 1, v85
    s_nop 1
    v_cndmask_b32 v73, v73, v86, vcc
    v_cmp_gt_i32 vcc, 2, v85
    s_nop 1
    v_cndmask_b32 v74, v74, v86, vcc
    v_cmp_gt_i32 vcc, 3, v85
    s_nop 1
    v_cndmask_b32 v75, v75, v86, vcc
    v_cmp_gt_i32 vcc, 16, v85
    s_nop 1
    v_cndmask_b32 v76, v76, v86, vcc
    v_cmp_gt_i32 vcc, 17, v85
    s_nop 1
    v_cndmask_b32 v77, v77, v86, vcc
    v_cmp_gt_i32 vcc, 18, v85
    s_nop 1
    v_cndmask_b32 v78, v78, v86, vcc
    v_cmp_gt_i32 vcc, 19, v85
    s_nop 1
    v_cndmask_b32 v79, v79, v86, vcc
    v_max3_f32 v87, v64, v65, v80
    v_max3_f32 v87, v66, v67, v87
    v_max3_f32 v87, v68, v69, v87
    v_max3_f32 v87, v70, v71, v87
    v_mov_b32 v88, v87
    s_nop 1
    v_permlane16_swap_b32 v87, v88
    s_nop 1
    v_max_f32 v87, v87, v88
    v_mov_b32 v88, v87
    s_nop 1
    v_permlane32_swap_b32 v87, v88
    s_nop 1
    v_max_f32 v87, v87, v88
    v_sub_f32 v89, v80, v87
    v_exp_f32 v89, v89
    v_mov_b32 v80, v87
    v_sub_f32 v64, v64, v87
    v_sub_f32 v65, v65, v87
    v_sub_f32 v66, v66, v87
    v_sub_f32 v67, v67, v87
    v_sub_f32 v68, v68, v87
    v_sub_f32 v69, v69, v87
    v_sub_f32 v70, v70, v87
    v_sub_f32 v71, v71, v87
    v_exp_f32 v64, v64
    v_exp_f32 v65, v65
    v_exp_f32 v66, v66
    v_exp_f32 v67, v67
    v_exp_f32 v68, v68
    v_exp_f32 v69, v69
    v_exp_f32 v70, v70
    v_exp_f32 v71, v71
    v_mul_f32 v14, v14, v89
    v_add_f32 v14, v14, v64
    v_add_f32 v14, v14, v65
    v_add_f32 v14, v14, v66
    v_add_f32 v14, v14, v67
    v_add_f32 v14, v14, v68
    v_add_f32 v14, v14, v69
    v_add_f32 v14, v14, v70
    v_add_f32 v14, v14, v71
    v_cvt_pk_bf16_f32 v44, v64, v65
    v_cvt_pk_bf16_f32 v45, v66, v67
    v_cvt_pk_bf16_f32 v46, v68, v69
    v_cvt_pk_bf16_f32 v47, v70, v71
    v_mul_f32 v160, v160, v89
    v_mul_f32 v161, v161, v89
    v_mul_f32 v162, v162, v89
    v_mul_f32 v163, v163, v89
    v_mul_f32 v164, v164, v89
    v_mul_f32 v165, v165, v89
    v_mul_f32 v166, v166, v89
    v_mul_f32 v167, v167, v89
    v_mul_f32 v168, v168, v89
    v_mul_f32 v169, v169, v89
    v_mul_f32 v170, v170, v89
    v_mul_f32 v171, v171, v89
    v_mul_f32 v172, v172, v89
    v_mul_f32 v173, v173, v89
    v_mul_f32 v174, v174, v89
    v_mul_f32 v175, v175, v89
    v_mul_f32 v176, v176, v89
    v_mul_f32 v177, v177, v89
    v_mul_f32 v178, v178, v89
    v_mul_f32 v179, v179, v89
    v_mul_f32 v180, v180, v89
    v_mul_f32 v181, v181, v89
    v_mul_f32 v182, v182, v89
    v_mul_f32 v183, v183, v89
    v_mul_f32 v184, v184, v89
    v_mul_f32 v185, v185, v89
    v_mul_f32 v186, v186, v89
    v_mul_f32 v187, v187, v89
    v_mul_f32 v188, v188, v89
    v_mul_f32 v189, v189, v89
    v_mul_f32 v190, v190, v89
    v_mul_f32 v191, v191, v89
    v_max3_f32 v87, v72, v73, v81
    v_max3_f32 v87, v74, v75, v87
    v_max3_f32 v87, v76, v77, v87
    v_max3_f32 v87, v78, v79, v87
    v_mov_b32 v88, v87
    s_nop 1
    v_permlane16_swap_b32 v87, v88
    s_nop 1
    v_max_f32 v87, v87, v88
    v_mov_b32 v88, v87
    s_nop 1
    v_permlane32_swap_b32 v87, v88
    s_nop 1
    v_max_f32 v87, v87, v88
    v_sub_f32 v89, v81, v87
    v_exp_f32 v89, v89
    v_mov_b32 v81, v87
    v_sub_f32 v72, v72, v87
    v_sub_f32 v73, v73, v87
    v_sub_f32 v74, v74, v87
    v_sub_f32 v75, v75, v87
    v_sub_f32 v76, v76, v87
    v_sub_f32 v77, v77, v87
    v_sub_f32 v78, v78, v87
    v_sub_f32 v79, v79, v87
    v_exp_f32 v72, v72
    v_exp_f32 v73, v73
    v_exp_f32 v74, v74
    v_exp_f32 v75, v75
    v_exp_f32 v76, v76
    v_exp_f32 v77, v77
    v_exp_f32 v78, v78
    v_exp_f32 v79, v79
    v_mul_f32 v15, v15, v89
    v_add_f32 v15, v15, v72
    v_add_f32 v15, v15, v73
    v_add_f32 v15, v15, v74
    v_add_f32 v15, v15, v75
    v_add_f32 v15, v15, v76
    v_add_f32 v15, v15, v77
    v_add_f32 v15, v15, v78
    v_add_f32 v15, v15, v79
    v_cvt_pk_bf16_f32 v48, v72, v73
    v_cvt_pk_bf16_f32 v49, v74, v75
    v_cvt_pk_bf16_f32 v50, v76, v77
    v_cvt_pk_bf16_f32 v51, v78, v79
    v_mul_f32 v224, v224, v89
    v_mul_f32 v225, v225, v89
    v_mul_f32 v226, v226, v89
    v_mul_f32 v227, v227, v89
    v_mul_f32 v228, v228, v89
    v_mul_f32 v229, v229, v89
    v_mul_f32 v230, v230, v89
    v_mul_f32 v231, v231, v89
    v_mul_f32 v232, v232, v89
    v_mul_f32 v233, v233, v89
    v_mul_f32 v234, v234, v89
    v_mul_f32 v235, v235, v89
    v_mul_f32 v236, v236, v89
    v_mul_f32 v237, v237, v89
    v_mul_f32 v238, v238, v89
    v_mul_f32 v239, v239, v89
    v_mul_f32 v240, v240, v89
    v_mul_f32 v241, v241, v89
    v_mul_f32 v242, v242, v89
    v_mul_f32 v243, v243, v89
    v_mul_f32 v244, v244, v89
    v_mul_f32 v245, v245, v89
    v_mul_f32 v246, v246, v89
    v_mul_f32 v247, v247, v89
    v_mul_f32 v248, v248, v89
    v_mul_f32 v249, v249, v89
    v_mul_f32 v250, v250, v89
    v_mul_f32 v251, v251, v89
    v_mul_f32 v252, v252, v89
    v_mul_f32 v253, v253, v89
    v_mul_f32 v254, v254, v89
    v_mul_f32 v255, v255, v89
    s_nop 1
    v_mfma_f32_16x16x32_bf16 v[160:163], a[224:227], v[44:47], v[160:163]
    v_mfma_f32_16x16x32_bf16 v[164:167], a[228:231], v[44:47], v[164:167]
    v_mfma_f32_16x16x32_bf16 v[168:171], a[232:235], v[44:47], v[168:171]
    v_mfma_f32_16x16x32_bf16 v[172:175], a[236:239], v[44:47], v[172:175]
    v_mfma_f32_16x16x32_bf16 v[176:179], a[240:243], v[44:47], v[176:179]
    v_mfma_f32_16x16x32_bf16 v[180:183], a[244:247], v[44:47], v[180:183]
    v_mfma_f32_16x16x32_bf16 v[184:187], a[248:251], v[44:47], v[184:187]
    v_mfma_f32_16x16x32_bf16 v[188:191], a[252:255], v[44:47], v[188:191]
    v_mfma_f32_16x16x32_bf16 v[224:227], a[224:227], v[48:51], v[224:227]
    v_mfma_f32_16x16x32_bf16 v[228:231], a[228:231], v[48:51], v[228:231]
    v_mfma_f32_16x16x32_bf16 v[232:235], a[232:235], v[48:51], v[232:235]
    v_mfma_f32_16x16x32_bf16 v[236:239], a[236:239], v[48:51], v[236:239]
    v_mfma_f32_16x16x32_bf16 v[240:243], a[240:243], v[48:51], v[240:243]
    v_mfma_f32_16x16x32_bf16 v[244:247], a[244:247], v[48:51], v[244:247]
    v_mfma_f32_16x16x32_bf16 v[248:251], a[248:251], v[48:51], v[248:251]
    v_mfma_f32_16x16x32_bf16 v[252:255], a[252:255], v[48:51], v[252:255]
    v_subrev_u32 v84, 32, v84
    v_subrev_u32 v85, 32, v85
    s_add_u32 s69, s69, 8192
    s_sub_u32 s70, s70, 1
    s_cmp_lg_u32 s70, 0
    s_nop 7
    s_cbranch_scc1 L_slowb_loop
    v_mov_b32 v87, v14
    s_nop 1
    v_permlane16_swap_b32 v14, v87
    s_nop 1
    v_add_f32 v14, v14, v87
    v_mov_b32 v87, v14
    s_nop 1
    v_permlane32_swap_b32 v14, v87
    s_nop 1
    v_add_f32 v14, v14, v87
    v_rcp_f32 v14, v14
    v_mov_b32 v87, v15
    s_nop 1
    v_permlane16_swap_b32 v15, v87
    s_nop 1
    v_add_f32 v15, v15, v87
    v_mov_b32 v87, v15
    s_nop 1
    v_permlane32_swap_b32 v15, v87
    s_nop 1
    v_add_f32 v15, v15, v87
    v_rcp_f32 v15, v15
    s_nop 0
    v_mul_f32 v160, v160, v14
    v_mul_f32 v161, v161, v14
    v_mul_f32 v162, v162, v14
    v_mul_f32 v163, v163, v14
    v_mul_f32 v164, v164, v14
    v_mul_f32 v165, v165, v14
    v_mul_f32 v166, v166, v14
    v_mul_f32 v167, v167, v14
    v_cvt_pk_bf16_f32 v160, v160, v161
    v_cvt_pk_bf16_f32 v161, v162, v163
    v_cvt_pk_bf16_f32 v162, v164, v165
    v_cvt_pk_bf16_f32 v163, v166, v167
    buffer_store_dwordx4 v[160:163], v60, s[48:51], s65 offen offset:0 sc1
    v_mul_f32 v168, v168, v14
    v_mul_f32 v169, v169, v14
    v_mul_f32 v170, v170, v14
    v_mul_f32 v171, v171, v14
    v_mul_f32 v172, v172, v14
    v_mul_f32 v173, v173, v14
    v_mul_f32 v174, v174, v14
    v_mul_f32 v175, v175, v14
    v_cvt_pk_bf16_f32 v168, v168, v169
    v_cvt_pk_bf16_f32 v169, v170, v171
    v_cvt_pk_bf16_f32 v170, v172, v173
    v_cvt_pk_bf16_f32 v171, v174, v175
    buffer_store_dwordx4 v[168:171], v60, s[48:51], s65 offen offset:2048 sc1
    v_mul_f32 v176, v176, v14
    v_mul_f32 v177, v177, v14
    v_mul_f32 v178, v178, v14
    v_mul_f32 v179, v179, v14
    v_mul_f32 v180, v180, v14
    v_mul_f32 v181, v181, v14
    v_mul_f32 v182, v182, v14
    v_mul_f32 v183, v183, v14
    v_cvt_pk_bf16_f32 v176, v176, v177
    v_cvt_pk_bf16_f32 v177, v178, v179
    v_cvt_pk_bf16_f32 v178, v180, v181
    v_cvt_pk_bf16_f32 v179, v182, v183
    buffer_store_dwordx4 v[176:179], v19, s[48:51], s65 offen offset:0 sc1
    v_mul_f32 v184, v184, v14
    v_mul_f32 v185, v185, v14
    v_mul_f32 v186, v186, v14
    v_mul_f32 v187, v187, v14
    v_mul_f32 v188, v188, v14
    v_mul_f32 v189, v189, v14
    v_mul_f32 v190, v190, v14
    v_mul_f32 v191, v191, v14
    v_cvt_pk_bf16_f32 v184, v184, v185
    v_cvt_pk_bf16_f32 v185, v186, v187
    v_cvt_pk_bf16_f32 v186, v188, v189
    v_cvt_pk_bf16_f32 v187, v190, v191
    buffer_store_dwordx4 v[184:187], v19, s[48:51], s65 offen offset:2048 sc1
    v_mul_f32 v224, v224, v15
    v_mul_f32 v225, v225, v15
    v_mul_f32 v226, v226, v15
    v_mul_f32 v227, v227, v15
    v_mul_f32 v228, v228, v15
    v_mul_f32 v229, v229, v15
    v_mul_f32 v230, v230, v15
    v_mul_f32 v231, v231, v15
    v_cvt_pk_bf16_f32 v224, v224, v225
    v_cvt_pk_bf16_f32 v225, v226, v227
    v_cvt_pk_bf16_f32 v226, v228, v229
    v_cvt_pk_bf16_f32 v227, v230, v231
    buffer_store_dwordx4 v[224:227], v60, s[48:51], s66 offen offset:0 sc1
    v_mul_f32 v232, v232, v15
    v_mul_f32 v233, v233, v15
    v_mul_f32 v234, v234, v15
    v_mul_f32 v235, v235, v15
    v_mul_f32 v236, v236, v15
    v_mul_f32 v237, v237, v15
    v_mul_f32 v238, v238, v15
    v_mul_f32 v239, v239, v15
    v_cvt_pk_bf16_f32 v232, v232, v233
    v_cvt_pk_bf16_f32 v233, v234, v235
    v_cvt_pk_bf16_f32 v234, v236, v237
    v_cvt_pk_bf16_f32 v235, v238, v239
    buffer_store_dwordx4 v[232:235], v60, s[48:51], s66 offen offset:2048 sc1
    v_mul_f32 v240, v240, v15
    v_mul_f32 v241, v241, v15
    v_mul_f32 v242, v242, v15
    v_mul_f32 v243, v243, v15
    v_mul_f32 v244, v244, v15
    v_mul_f32 v245, v245, v15
    v_mul_f32 v246, v246, v15
    v_mul_f32 v247, v247, v15
    v_cvt_pk_bf16_f32 v240, v240, v241
    v_cvt_pk_bf16_f32 v241, v242, v243
    v_cvt_pk_bf16_f32 v242, v244, v245
    v_cvt_pk_bf16_f32 v243, v246, v247
    buffer_store_dwordx4 v[240:243], v19, s[48:51], s66 offen offset:0 sc1
    v_mul_f32 v248, v248, v15
    v_mul_f32 v249, v249, v15
    v_mul_f32 v250, v250, v15
    v_mul_f32 v251, v251, v15
    v_mul_f32 v252, v252, v15
    v_mul_f32 v253, v253, v15
    v_mul_f32 v254, v254, v15
    v_mul_f32 v255, v255, v15
    v_cvt_pk_bf16_f32 v248, v248, v249
    v_cvt_pk_bf16_f32 v249, v250, v251
    v_cvt_pk_bf16_f32 v250, v252, v253
    v_cvt_pk_bf16_f32 v251, v254, v255
    buffer_store_dwordx4 v[248:251], v19, s[48:51], s66 offen offset:2048 sc1
    s_cmp_lg_u32 s64, 0
    s_cbranch_scc1 L_slowb
    s_waitcnt vmcnt(0)
    s_mov_b32 s65, 0x40000000
    s_mov_b32 s66, 0x40000000
    s_branch L_slowb_ret
L_slowa:
    s_mov_b32 s64, 1
    v_and_b32 v205, 31, v0
    v_lshrrev_b32 v208, 5, v0
    v_lshlrev_b32 v208, 8, v208
    v_lshl_add_u32 v208, v205, 4, v208
    v_cmp_gt_u32 vcc, 16, v205
    v_and_b32 v205, 27, v205
    v_cmp_eq_u32 s[100:101], 16, v205
    v_mov_b32 v205, 528
    v_cndmask_b32 v208, v205, v208, vcc
    v_mov_b32 v205, 512
    v_cndmask_b32 v208, v208, v205, s[100:101]
    v_mov_b32 v96, 0
    v_mov_b32 v97, 0
    v_mov_b32 v98, 0
    v_mov_b32 v99, 0
    v_mov_b32 v100, 0
    v_mov_b32 v101, 0
    v_mov_b32 v102, 0
    v_mov_b32 v103, 0
    v_mov_b32 v104, 0
    v_mov_b32 v105, 0
    v_mov_b32 v106, 0
    v_mov_b32 v107, 0
    v_mov_b32 v108, 0
    v_mov_b32 v109, 0
    v_mov_b32 v110, 0
    v_mov_b32 v111, 0
    v_mov_b32 v204, 0xff7fffff
    s_mov_b32 s69, s91
    s_mov_b32 s70, 64
L_slowa_a:
    buffer_load_dwordx4 v[192:195], v1, s[4:7], s69 offen sc1
    buffer_load_dwordx4 v[196:199], v208, s[4:7], s69 offen offset:1024 sc1
    buffer_load_dwordx4 v[200:203], v208, s[4:7], s69 offen offset:1600 sc1
    s_waitcnt vmcnt(0)
    v_mfma_f32_32x32x16_bf16 v[64:79], v[192:195], v[20:23], 0
    s_nop 11
    v_max3_f32 v205, v64, v65, v204
    v_max3_f32 v205, v66, v67, v205
    v_max3_f32 v205, v68, v69, v205
    v_max3_f32 v205, v70, v71, v205
    v_max3_f32 v205, v72, v73, v205
    v_max3_f32 v205, v74, v75, v205
    v_max3_f32 v205, v76, v77, v205
    v_max3_f32 v205, v78, v79, v205
    v_mov_b32 v206, v205
    s_nop 1
    v_permlane32_swap_b32 v205, v206
    s_nop 1
    v_max_f32 v205, v205, v206
    v_sub_f32 v207, v204, v205
    v_exp_f32 v207, v207
    v_mov_b32 v204, v205
    v_sub_f32 v64, v64, v205
    v_sub_f32 v65, v65, v205
    v_sub_f32 v66, v66, v205
    v_sub_f32 v67, v67, v205
    v_sub_f32 v68, v68, v205
    v_sub_f32 v69, v69, v205
    v_sub_f32 v70, v70, v205
    v_sub_f32 v71, v71, v205
    v_sub_f32 v72, v72, v205
    v_sub_f32 v73, v73, v205
    v_sub_f32 v74, v74, v205
    v_sub_f32 v75, v75, v205
    v_sub_f32 v76, v76, v205
    v_sub_f32 v77, v77, v205
    v_sub_f32 v78, v78, v205
    v_sub_f32 v79, v79, v205
    v_exp_f32 v64, v64
    v_exp_f32 v65, v65
    v_exp_f32 v66, v66
    v_exp_f32 v67, v67
    v_exp_f32 v68, v68
    v_exp_f32 v69, v69
    v_exp_f32 v70, v70
    v_exp_f32 v71, v71
    v_exp_f32 v72, v72
    v_exp_f32 v73, v73
    v_exp_f32 v74, v74
    v_exp_f32 v75, v75
    v_exp_f32 v76, v76
    v_exp_f32 v77, v77
    v_exp_f32 v78, v78
    v_exp_f32 v79, v79
    v_mul_f32 v96, v96, v207
    v_mul_f32 v97, v97, v207
    v_mul_f32 v98, v98, v207
    v_mul_f32 v99, v99, v207
    v_mul_f32 v100, v100, v207
    v_mul_f32 v101, v101, v207
    v_mul_f32 v102, v102, v207
    v_mul_f32 v103, v103, v207
    v_mul_f32 v104, v104, v207
    v_mul_f32 v105, v105, v207
    v_mul_f32 v106, v106, v207
    v_mul_f32 v107, v107, v207
    v_mul_f32 v108, v108, v207
    v_mul_f32 v109, v109, v207
    v_mul_f32 v110, v110, v207
    v_mul_f32 v111, v111, v207
    v_cvt_pk_bf16_f32 v44, v64, v65
    v_cvt_pk_bf16_f32 v45, v66, v67
    v_cvt_pk_bf16_f32 v46, v68, v69
    v_cvt_pk_bf16_f32 v47, v70, v71
    v_cvt_pk_bf16_f32 v48, v72, v73
    v_cvt_pk_bf16_f32 v49, v74, v75
    v_cvt_pk_bf16_f32 v50, v76, v77
    v_cvt_pk_bf16_f32 v51, v78, v79
    s_nop 1
    v_mfma_f32_32x32x16_bf16 v[96:111], v[196:199], v[44:47], v[96:111]
    v_mfma_f32_32x32x16_bf16 v[96:111], v[200:203], v[48:51], v[96:111]
    s_add_u32 s69, s69, 2176
    s_sub_u32 s70, s70, 1
    s_cmp_lg_u32 s70, 0
    s_nop 11
    s_cbranch_scc1 L_slowa_a
    v_mov_b32 v112, 0
    v_mov_b32 v113, 0
    v_mov_b32 v114, 0
    v_mov_b32 v115, 0
    v_mov_b32 v116, 0
    v_mov_b32 v117, 0
    v_mov_b32 v118, 0
    v_mov_b32 v119, 0
    v_mov_b32 v120, 0
    v_mov_b32 v121, 0
    v_mov_b32 v122, 0
    v_mov_b32 v123, 0
    v_mov_b32 v124, 0
    v_mov_b32 v125, 0
    v_mov_b32 v126, 0
    v_mov_b32 v127, 0
    v_mov_b32 v204, 0xff7fffff
    s_mov_b32 s69, s91
    s_mov_b32 s70, 64
L_slowa_b:
    buffer_load_dwordx4 v[192:195], v1, s[4:7], s69 offen sc1
    buffer_load_dwordx4 v[196:199], v208, s[4:7], s69 offen offset:1024 sc1
    buffer_load_dwordx4 v[200:203], v208, s[4:7], s69 offen offset:1600 sc1
    s_waitcnt vmcnt(0)
    v_mfma_f32_32x32x16_bf16 v[64:79], v[192:195], v[24:27], 0
    s_nop 11
    v_max3_f32 v205, v64, v65, v204
    v_max3_f32 v205, v66, v67, v205
    v_max3_f32 v205, v68, v69, v205
    v_max3_f32 v205, v70, v71, v205
    v_max3_f32 v205, v72, v73, v205
    v_max3_f32 v205, v74, v75, v205
    v_max3_f32 v205, v76, v77, v205
    v_max3_f32 v205, v78, v79, v205
    v_mov_b32 v206, v205
    s_nop 1
    v_permlane32_swap_b32 v205, v206
    s_nop 1
    v_max_f32 v205, v205, v206
    v_sub_f32 v207, v204, v205
    v_exp_f32 v207, v207
    v_mov_b32 v204, v205
    v_sub_f32 v64, v64, v205
    v_sub_f32 v65, v65, v205
    v_sub_f32 v66, v66, v205
    v_sub_f32 v67, v67, v205
    v_sub_f32 v68, v68, v205
    v_sub_f32 v69, v69, v205
    v_sub_f32 v70, v70, v205
    v_sub_f32 v71, v71, v205
    v_sub_f32 v72, v72, v205
    v_sub_f32 v73, v73, v205
    v_sub_f32 v74, v74, v205
    v_sub_f32 v75, v75, v205
    v_sub_f32 v76, v76, v205
    v_sub_f32 v77, v77, v205
    v_sub_f32 v78, v78, v205
    v_sub_f32 v79, v79, v205
    v_exp_f32 v64, v64
    v_exp_f32 v65, v65
    v_exp_f32 v66, v66
    v_exp_f32 v67, v67
    v_exp_f32 v68, v68
    v_exp_f32 v69, v69
    v_exp_f32 v70, v70
    v_exp_f32 v71, v71
    v_exp_f32 v72, v72
    v_exp_f32 v73, v73
    v_exp_f32 v74, v74
    v_exp_f32 v75, v75
    v_exp_f32 v76, v76
    v_exp_f32 v77, v77
    v_exp_f32 v78, v78
    v_exp_f32 v79, v79
    v_mul_f32 v112, v112, v207
    v_mul_f32 v113, v113, v207
    v_mul_f32 v114, v114, v207
    v_mul_f32 v115, v115, v207
    v_mul_f32 v116, v116, v207
    v_mul_f32 v117, v117, v207
    v_mul_f32 v118, v118, v207
    v_mul_f32 v119, v119, v207
    v_mul_f32 v120, v120, v207
    v_mul_f32 v121, v121, v207
    v_mul_f32 v122, v122, v207
    v_mul_f32 v123, v123, v207
    v_mul_f32 v124, v124, v207
    v_mul_f32 v125, v125, v207
    v_mul_f32 v126, v126, v207
    v_mul_f32 v127, v127, v207
    v_cvt_pk_bf16_f32 v44, v64, v65
    v_cvt_pk_bf16_f32 v45, v66, v67
    v_cvt_pk_bf16_f32 v46, v68, v69
    v_cvt_pk_bf16_f32 v47, v70, v71
    v_cvt_pk_bf16_f32 v48, v72, v73
    v_cvt_pk_bf16_f32 v49, v74, v75
    v_cvt_pk_bf16_f32 v50, v76, v77
    v_cvt_pk_bf16_f32 v51, v78, v79
    s_nop 1
    v_mfma_f32_32x32x16_bf16 v[112:127], v[196:199], v[44:47], v[112:127]
    v_mfma_f32_32x32x16_bf16 v[112:127], v[200:203], v[48:51], v[112:127]
    s_add_u32 s69, s69, 2176
    s_sub_u32 s70, s70, 1
    s_cmp_lg_u32 s70, 0
    s_nop 11
    s_cbranch_scc1 L_slowa_b
    s_branch L_norm_a
L_end:
    s_endpgm
L_codeend:
.section .rodata,"a"
.p2align 6
.amdhsa_kernel gated_mix__softmax_full_mha__compressed_kv_cla__prompt_kernel
  .amdhsa_next_free_vgpr 512
  .amdhsa_next_free_sgpr 102
  .amdhsa_accum_offset 256
  .amdhsa_group_segment_fixed_size 0
  .amdhsa_kernarg_size 104
  .amdhsa_user_sgpr_count 2
  .amdhsa_user_sgpr_kernarg_segment_ptr 1
  .amdhsa_system_sgpr_workgroup_id_x 1
.end_amdhsa_kernel
```
